```python
import torch

def _softmax(x, axis=-1):
    return torch.softmax(x, dim=axis)
def _gelu(x):
    return torch.nn.functional.gelu(x, approximate="tanh")
def _silu(x):
    return torch.nn.functional.silu(x)
def _sigmoid(x):
    return torch.sigmoid(x)
def _layernorm(x, axis=-1, eps=1e-5):
    m = x.mean(dim=axis, keepdim=True)
    v = x.var(dim=axis, keepdim=True, unbiased=False)
    return (x - m) / torch.sqrt(v + eps)
def _scatter_add(tgt, idx, src, axis=0):
    return tgt.clone().index_add_(axis, idx, src)
def _segment_sum(src, seg, n):
    out = torch.zeros((n,) + src.shape[1:], dtype=src.dtype)
    return out.index_add_(0, seg, src)
def _pad(x, pw):
    flat = tuple(v for pair in reversed(pw) for v in pair)
    return torch.nn.functional.pad(x, flat)

kernel_name = 'interleave_layers__linear_kernel_hedgehog__mixer_token_mlp__prompt'

def setup_inputs():

    _w = (lambda a: (lambda t: t.to(torch.bfloat16) if t.is_floating_point() else t)(torch.as_tensor(a)))
    def _A_setup():
        B, S, D, H = 1, 2048, 640, 32
        Dh = D // H
        return {
            "x": _w((lambda *s: torch.randn(*s, dtype=torch.bfloat16) * 0.05)(B, S, D)),
            "wqkv": _w((lambda *s: torch.randn(*s, dtype=torch.bfloat16) * 0.4)(D, 3 * D)),
            "w_phi": _w((lambda *s: torch.randn(*s, dtype=torch.bfloat16) * 0.4)(H, Dh, Dh) * (Dh ** -0.5)),
            "wo": _w((lambda *s: torch.randn(*s, dtype=torch.bfloat16) * 0.05)(D, D)),
        }
    _A_in = _A_setup()

    def _B_setup():
        B, S, D, F = 1, 2048, 640, 1536
        return {
            "x": _w((lambda *s: torch.randn(*s, dtype=torch.bfloat16) * 0.05)(B, S, D)),
            "w1": _w((lambda *s: torch.randn(*s, dtype=torch.bfloat16) * 0.8)(S, F) * (S ** -0.5)),
            "b1": _w((lambda *s: torch.randn(*s, dtype=torch.bfloat16) * 0.8)(F) * 0.02),
            "w2": _w((lambda *s: torch.randn(*s, dtype=torch.bfloat16) * 0.8)(F, S) * (F ** -0.5)),
            "b2": _w((lambda *s: torch.randn(*s, dtype=torch.bfloat16) * 0.8)(S) * 0.02),
        }
    _B_in = _B_setup()

    return {
        "A_x": _A_in["x"],
        "A_wqkv": _A_in["wqkv"],
        "A_w_phi": _A_in["w_phi"],
        "A_wo": _A_in["wo"],
        "B_x": _B_in["x"],
        "B_w1": _B_in["w1"],
        "B_b1": _B_in["b1"],
        "B_w2": _B_in["w2"],
        "B_b2": _B_in["b2"],
    }

def reference(A_x, A_wqkv, A_w_phi, A_wo, B_x, B_w1, B_b1, B_w2, B_b2):
    def _A_ref(x, wqkv, w_phi, wo):
        B, S, D = x.shape
        H = 32; Dh = D // H
        qkv = (lambda x, *d: x.permute(*d))((x @ wqkv).reshape(B, S, 3, H, Dh), 2, 0, 3, 1, 4)
        q, k, v = qkv[0], qkv[1], qkv[2]
        pq = torch.einsum("bhsd,hdf->bhsf", q, w_phi)
        pk = torch.einsum("bhsd,hdf->bhsf", k, w_phi)
        phi_q = torch.concatenate([_softmax(pq, axis=-1), _softmax(-pq, axis=-1)], axis=-1)
        phi_k = torch.concatenate([_softmax(pk, axis=-1), _softmax(-pk, axis=-1)], axis=-1)
        kv = torch.einsum("bhsf,bhsd->bhfd", phi_k, v)
        z  = torch.einsum("bhsf->bhf", phi_k)
        num = torch.einsum("bhqf,bhfd->bhqd", phi_q, kv)
        den = torch.einsum("bhqf,bhf->bhq", phi_q, z)[..., None] + 1e-6
        o = num / den
        return (lambda x, *d: x.permute(*d))(o, 0, 2, 1, 3).reshape(B, S, D) @ wo

    def _B_ref(x, w1, b1, w2, b2):
        B, S, D = x.shape
        h = _layernorm(x, axis=-1)
        u = torch.einsum("bsd,sf->bdf", h, w1) + b1
        u = _gelu(u)
        y = torch.einsum("bdf,fs->bds", u, w2) + b2
        return (lambda x, *d: x.permute(*d))(y, 0, 2, 1)

    x = A_x
    x = x + _A_ref(_layernorm(x, axis=-1), A_wqkv, A_w_phi, A_wo)
    x = x + _B_ref(_layernorm(x, axis=-1), B_w1, B_b1, B_w2, B_b2)
    x = x + _A_ref(_layernorm(x, axis=-1), A_wqkv, A_w_phi, A_wo)
    x = x + _B_ref(_layernorm(x, axis=-1), B_w1, B_b1, B_w2, B_b2)
    return x
```

```asm
; @launch grid=(256,1,1) block=(256,1,1) lds=163840
.amdgcn_target "amdgcn-amd-amdhsa--gfx950"
.text
.globl interleave_layers__linear_kernel_hedgehog__mixer_token_mlp__prompt_kernel
.p2align 8
.type interleave_layers__linear_kernel_hedgehog__mixer_token_mlp__prompt_kernel,@function
interleave_layers__linear_kernel_hedgehog__mixer_token_mlp__prompt_kernel:
  s_cmp_ge_u32 s2, 256
  s_cbranch_scc1 END
  s_load_dwordx16 s[68:83], s[0:1], 0
  s_load_dwordx8 s[84:91], s[0:1], 64
  s_getpc_b64 s[96:97]
  v_and_b32 v1, 63, v0
  v_lshrrev_b32 v2, 6, v0
  s_and_b32 s60, s2, 7
  v_readfirstlane_b32 s52, v2
  s_lshr_b32 s61, s2, 3
  v_lshl_add_u32 v3, s61, 2, v2
  v_mad_u32_u24 v3, v3, 6, v1
  v_min_u32 v3, (CODE_END-interleave_layers__linear_kernel_hedgehog__mixer_token_mlp__prompt_kernel-256)/128, v3
  v_lshlrev_b32 v3, 7, v3
  v_mov_b32 v5, s97
  v_add_co_u32 v4, vcc, s96, v3
  s_nop 1
  v_addc_co_u32 v5, vcc, 0, v5, vcc
  s_mov_b64 exec, 63
  global_load_dword v100, v[4:5], off
  s_mov_b64 exec, -1
  s_lshr_b32 s66, s60, 1
  s_and_b32 s67, s60, 1
  s_lshr_b32 s92, s61, 3
  s_and_b32 s93, s61, 7
  s_lshl_b32 s53, s66, 2
  s_add_u32 s53, s53, s92
  s_lshl_b32 s54, s67, 3
  s_add_u32 s54, s54, s93
  s_lshl_b32 s55, s67, 2
  s_add_u32 s55, s55, s92
  s_lshl_b32 s56, s66, 3
  s_xor_b32 s93, s93, 0
  s_add_u32 s56, s56, s93
  s_lshl_b32 s59, s56, 2
  s_add_u32 s59, s59, s52
  v_and_b32 v16, 15, v1
  v_mul_u32_u24 v16, 1280, v16
  v_lshrrev_b32 v17, 4, v1
  v_lshl_add_u32 v16, v17, 3, v16
  s_mul_i32 s94, s59, 20480
  s_mul_i32 s95, s55, 160
  s_add_u32 s94, s94, s95
  s_mul_i32 s92, s61, 43
  s_lshr_b32 s92, s92, 8
  s_mul_i32 s93, s92, 6
  s_sub_u32 s93, s61, s93
  s_mul_i32 s57, s66, 6
  s_add_u32 s57, s57, s93
  s_mul_i32 s58, s67, 5
  s_add_u32 s58, s58, s92
  s_cmp_ge_u32 s61, 30
  s_cselect_b32 s58, 100, s58
  s_mul_i32 s92, s92, 3
  s_and_b32 s92, s92, 15
  s_lshl_b32 s60, s92, 10
  s_lshr_b32 s92, s61, 3
  s_mul_i32 s61, s92, 3072
  v_lshlrev_b32 v13, 4, v1
  s_waitcnt lgkmcnt(0)
  s_mov_b32 s8, s90
  s_and_b32 s9, s91, 0xffff
  s_mov_b32 s10, 268435456
  s_mov_b32 s11, 0x00020000
  s_mov_b32 s12, s68
  s_and_b32 s13, s69, 0xffff
  s_mov_b32 s14, 2621440
  s_mov_b32 s15, 0x00020000
  s_cmp_lg_u32 s2, 0
  s_cbranch_scc1 NL1
  s_cmp_lg_u32 s52, 3
  s_cbranch_scc1 NL1
  v_lshlrev_b32 v2, 4, v1
  s_movk_i32 s66, 1024
  s_movk_i32 s67, 2048
  s_movk_i32 s92, 3072
  buffer_load_dword v108, v2, s[8:11], 0 offen sc1
  buffer_load_dword v109, v2, s[8:11], s66 offen sc1
  buffer_load_dword v110, v2, s[8:11], s67 offen sc1
  buffer_load_dword v111, v2, s[8:11], s92 offen sc1
  v_mov_b32 v8, 0
  v_lshlrev_b32 v9, 2, v1
  v_add_u32 v9, 161792, v9
  ds_write_b32 v9, v8
NL1:
  buffer_load_dwordx2 v[236:237], v16, s[12:15], s94 offen offset:0
  buffer_load_dwordx2 v[238:239], v16, s[12:15], s94 offen offset:32
  buffer_load_dwordx2 v[240:241], v16, s[12:15], s94 offen offset:64
  buffer_load_dwordx2 v[242:243], v16, s[12:15], s94 offen offset:96
  buffer_load_dwordx2 v[244:245], v16, s[12:15], s94 offen offset:128
  s_mov_b32 s16, s70
  s_and_b32 s17, s71, 0xffff
  s_mov_b32 s18, 2457600
  s_mov_b32 s19, 0x00020000
  s_mov_b32 s24, s74
  s_and_b32 s25, s75, 0xffff
  s_mov_b32 s26, 819200
  s_mov_b32 s27, 0x00020000
  v_and_b32 v17, 15, v0
  v_lshrrev_b32 v18, 4, v0
  v_and_b32 v19, 7, v17
  v_or_b32 v19, 0x0c0c0c00, v19
  v_mov_b32 v20, 1414746448
  v_mov_b32 v21, 2728632402
  v_perm_b32 v20, v21, v20, v19
  v_mov_b32 v21, 50373793
  v_mov_b32 v22, 132097
  v_perm_b32 v21, v22, v21, v19
  v_cmp_gt_u32 vcc, 8, v17
  s_nop 1
  v_cndmask_b32 v20, v21, v20, vcc
  v_lshlrev_b32 v20, 4, v20
  s_and_b32 s66, s2, 15
  s_lshr_b32 s67, s2, 4
  s_mul_i32 s92, s67, 80
  s_lshr_b32 s93, s66, 1
  s_mul_i32 s93, s93, 307200
  s_add_u32 s92, s92, s93
  s_mul_i32 s93, s67, 153600
  s_add_u32 s93, s93, 1048576
  s_and_b32 s95, s66, 1
  s_mul_i32 s95, s95, 5
  v_lshrrev_b32 v21, 3, v18
  v_add_u32 v21, s95, v21
  v_and_b32 v22, 7, v18
  v_and_b32 v23, 1, v21
  v_lshl_add_u32 v23, v23, 3, v22
  v_add_u32 v23, 64, v23
  v_lshrrev_b32 v24, 2, v22
  v_and_b32 v22, 3, v22
  v_lshl_add_u32 v22, v24, 4, v22
  v_lshrrev_b32 v24, 2, v17
  v_and_b32 v25, 3, v17
  v_lshlrev_b32 v25, 4, v25
  v_mul_u32_u24 v26, 40960, v24
  v_add_u32 v25, v25, v26
  v_cmp_eq_u32 vcc, 3, v24
  s_nop 1
  v_cndmask_b32 v24, 64, 48, vcc
  s_mul_i32 s95, s66, 40
  v_add_u32 v26, s95, v18
  v_mad_u32_u24 v25, v26, v24, v25
  v_cmp_gt_u32 vcc, 15, v17
  v_mov_b32 v27, 1073741824
  s_nop 0
  v_cndmask_b32 v20, v27, v20, vcc
  v_cndmask_b32 v25, v27, v25, vcc
  v_lshrrev_b32 v28, 2, v21
  v_and_b32 v29, 3, v21
  v_lshlrev_b32 v29, 2, v29
  v_lshl_add_u32 v28, v28, 5, v29
  v_add_u32 v28, v28, v22
  v_cmp_gt_u32 vcc, 8, v21
  s_nop 1
  v_cndmask_b32 v28, v23, v28, vcc
  v_mul_u32_u24 v28, 3840, v28
  v_add_u32 v28, v28, v20
  v_mov_b32 v32, v25
  buffer_load_dwordx4 v[40:43], v28, s[16:19], s92 offen
  v_add_u32 v21, 2, v21
  v_lshrrev_b32 v28, 2, v21
  v_and_b32 v29, 3, v21
  v_lshlrev_b32 v29, 2, v29
  v_lshl_add_u32 v28, v28, 5, v29
  v_add_u32 v28, v28, v22
  v_cmp_gt_u32 vcc, 8, v21
  s_nop 1
  v_cndmask_b32 v28, v23, v28, vcc
  v_mul_u32_u24 v28, 3840, v28
  v_add_u32 v28, v28, v20
  v_lshl_add_u32 v33, v24, 4, v32
  buffer_load_dwordx4 v[44:47], v28, s[16:19], s92 offen
  v_add_u32 v21, 2, v21
  v_lshrrev_b32 v28, 2, v21
  v_and_b32 v29, 3, v21
  v_lshlrev_b32 v29, 2, v29
  v_lshl_add_u32 v28, v28, 5, v29
  v_add_u32 v28, v28, v22
  v_cmp_gt_u32 vcc, 8, v21
  s_nop 1
  v_cndmask_b32 v28, v23, v28, vcc
  v_mul_u32_u24 v28, 3840, v28
  v_add_u32 v28, v28, v20
  v_lshl_add_u32 v34, v24, 4, v33
  v_cmp_gt_u32 vcc, 128, v0
  s_nop 1
  v_cndmask_b32 v28, v27, v28, vcc
  v_cndmask_b32 v34, v27, v34, vcc
  buffer_load_dwordx4 v[48:51], v28, s[16:19], s92 offen
  v_mul_u32_u24 v17, 205, v0
  v_lshrrev_b32 v17, 11, v17
  v_mul_u32_u24 v18, 10, v17
  v_sub_u32 v18, v0, v18
  s_and_b32 s66, s2, 31
  s_mul_i32 s66, s66, 20
  v_add_u32 v17, s66, v17
  v_mul_u32_u24 v19, 1280, v17
  v_lshl_add_u32 v19, v18, 4, v19
  s_lshr_b32 s67, s2, 5
  s_mul_i32 s94, s67, 160
  v_cmp_gt_u32 vcc, 200, v0
  s_nop 1
  v_cndmask_b32 v19, v27, v19, vcc
  buffer_load_dwordx4 v[52:55], v19, s[24:27], s94 offen
  s_mul_i32 s95, s67, 102400
  s_add_u32 s95, s95, 4194304
  v_lshrrev_b32 v19, 1, v18
  v_mul_u32_u24 v19, 20480, v19
  v_and_b32 v18, 1, v18
  v_lshl_add_u32 v19, v18, 4, v19
  v_lshrrev_b32 v18, 5, v17
  v_lshl_add_u32 v19, v18, 10, v19
  v_bfe_u32 v18, v17, 3, 2
  v_lshl_add_u32 v19, v18, 7, v19
  v_and_b32 v18, 3, v17
  v_lshl_add_u32 v19, v18, 5, v19
  v_bfe_u32 v18, v17, 2, 1
  v_lshl_add_u32 v19, v18, 9, v19
  v_cndmask_b32 v35, v27, v19, vcc
  v_mov_b32 v56, -1
  v_mov_b32 v57, -1
  v_mov_b32 v58, -1
  v_mov_b32 v59, -1
  s_lshl_b32 s66, s2, 2
  s_add_u32 s66, s66, s52
  s_lshl_b32 s62, s66, 10
  s_add_u32 s62, s62, 12713984
  s_lshl_b32 s66, s66, 10
  s_add_u32 s66, s66, 9043968
  buffer_store_dwordx4 v[56:59], v13, s[8:11], s66 offen sc1
  s_mov_b32 s20, s72
  s_and_b32 s21, s73, 0xffff
  s_mov_b32 s22, 25600
  s_mov_b32 s23, 0x00020000
  s_mov_b32 s28, s78
  s_and_b32 s29, s79, 0xffff
  s_mov_b32 s30, 6291456
  s_mov_b32 s31, 0x00020000
  s_mov_b32 s32, s82
  s_and_b32 s33, s83, 0xffff
  s_mov_b32 s34, 6291456
  s_mov_b32 s35, 0x00020000
  s_mov_b32 s36, s80
  s_and_b32 s37, s81, 0xffff
  s_mov_b32 s38, 3072
  s_mov_b32 s39, 0x00020000
  s_mov_b32 s40, s84
  s_and_b32 s41, s85, 0xffff
  s_mov_b32 s42, 4096
  s_mov_b32 s43, 0x00020000
  s_mov_b32 s44, s86
  s_and_b32 s45, s87, 0xffff
  s_mov_b32 s46, 2621440
  s_mov_b32 s47, 0x00020000
  s_mov_b32 s48, s88
  s_and_b32 s49, s89, 0xffff
  s_mov_b32 s50, 256
  s_mov_b32 s51, 0x00020000
  v_lshrrev_b32 v4, 4, v1
  v_and_b32 v3, 15, v1
  v_lshlrev_b32 v3, 4, v3
  v_lshl_add_u32 v2, v4, 9, v3
  v_lshrrev_b32 v4, 5, v1
  v_lshl_add_u32 v3, v4, 9, v3
  v_bfe_u32 v4, v1, 4, 1
  v_lshl_add_u32 v3, v4, 3, v3
  s_lshr_b32 s74, s59, 1
  s_mul_i32 s74, s74, 40960
  s_mul_i32 s66, s55, 5120
  s_add_u32 s74, s74, s66
  s_and_b32 s66, s59, 1
  s_lshl_b32 s66, s66, 8
  s_add_u32 s74, s74, s66
  s_add_u32 s74, s74, 6291456
  s_add_u32 s75, s74, 4096
  s_cmp_lg_u32 s2, 0
  s_cbranch_scc1 NL2
  s_cmp_lg_u32 s52, 3
  s_cbranch_scc1 NL2
  s_waitcnt vmcnt(10)
  v_bfe_u32 v80, v108, 13, 4
  v_lshlrev_b32 v80, 2, v80
  v_add_u32 v80, 161792, v80
  v_bfe_u32 v81, v108, 8, 5
  v_lshlrev_b32 v81, v81, 1
  ds_or_b32 v80, v81
  v_bfe_u32 v80, v109, 13, 4
  v_lshlrev_b32 v80, 2, v80
  v_add_u32 v80, 161792, v80
  v_bfe_u32 v81, v109, 8, 5
  v_lshlrev_b32 v81, v81, 1
  ds_or_b32 v80, v81
  v_bfe_u32 v80, v110, 13, 4
  v_lshlrev_b32 v80, 2, v80
  v_add_u32 v80, 161792, v80
  v_bfe_u32 v81, v110, 8, 5
  v_lshlrev_b32 v81, v81, 1
  ds_or_b32 v80, v81
  v_bfe_u32 v80, v111, 13, 4
  v_lshlrev_b32 v80, 2, v80
  v_add_u32 v80, 161792, v80
  v_bfe_u32 v81, v111, 8, 5
  v_lshlrev_b32 v81, v81, 1
  ds_or_b32 v80, v81
  v_and_b32 v80, 15, v1
  v_lshlrev_b32 v80, 2, v80
  v_add_u32 v80, 161792, v80
  ds_read_b32 v81, v80
  s_waitcnt lgkmcnt(0)
  v_not_b32 v81, v81
  v_cmp_ne_u32 vcc, 0, v81
  s_nop 4
  s_ff1_i32_b64 s76, vcc
  s_nop 4
  v_readlane_b32 s77, v81, s76
  s_nop 4
  s_ff1_i32_b32 s77, s77
  s_lshl_b32 s76, s76, 5
  s_add_u32 s76, s76, s77
  s_lshl_b32 s76, s76, 8
  s_or_b32 s76, s76, 0x80000000
  v_mov_b32 v81, s76
  s_mov_b64 exec, 1
  s_nop 1
  buffer_store_dword v81, off, s[48:51], 0 sc1
  s_mov_b64 exec, -1
NL2:
  s_waitcnt vmcnt(8)
  buffer_store_dwordx4 v[236:239], v2, s[8:11], s74 offen sc1
  s_waitcnt vmcnt(7)
  buffer_store_dwordx4 v[240:243], v2, s[8:11], s74 offen offset:2048 sc1
  s_waitcnt vmcnt(7)
  buffer_store_dwordx2 v[244:245], v3, s[8:11], s75 offen sc1
  v_lshlrev_b32 v60, 16, v236
  v_and_b32 v61, 0xffff0000, v236
  v_lshlrev_b32 v62, 16, v237
  v_and_b32 v63, 0xffff0000, v237
  v_lshlrev_b32 v64, 16, v238
  v_and_b32 v65, 0xffff0000, v238
  v_lshlrev_b32 v66, 16, v239
  v_and_b32 v67, 0xffff0000, v239
  v_lshlrev_b32 v68, 16, v240
  v_and_b32 v69, 0xffff0000, v240
  v_lshlrev_b32 v70, 16, v241
  v_and_b32 v71, 0xffff0000, v241
  v_lshlrev_b32 v72, 16, v242
  v_and_b32 v73, 0xffff0000, v242
  v_lshlrev_b32 v74, 16, v243
  v_and_b32 v75, 0xffff0000, v243
  v_lshlrev_b32 v76, 16, v244
  v_and_b32 v77, 0xffff0000, v244
  v_lshlrev_b32 v78, 16, v245
  v_and_b32 v79, 0xffff0000, v245
  v_pk_add_f32 v[8:9], v[60:61], v[62:63]
  v_pk_mul_f32 v[10:11], v[60:61], v[60:61]
  v_pk_fma_f32 v[10:11], v[62:63], v[62:63], v[10:11]
  v_pk_add_f32 v[8:9], v[8:9], v[64:65]
  v_pk_fma_f32 v[10:11], v[64:65], v[64:65], v[10:11]
  v_pk_add_f32 v[8:9], v[8:9], v[66:67]
  v_pk_fma_f32 v[10:11], v[66:67], v[66:67], v[10:11]
  v_pk_add_f32 v[8:9], v[8:9], v[68:69]
  v_pk_fma_f32 v[10:11], v[68:69], v[68:69], v[10:11]
  v_pk_add_f32 v[8:9], v[8:9], v[70:71]
  v_pk_fma_f32 v[10:11], v[70:71], v[70:71], v[10:11]
  v_pk_add_f32 v[8:9], v[8:9], v[72:73]
  v_pk_fma_f32 v[10:11], v[72:73], v[72:73], v[10:11]
  v_pk_add_f32 v[8:9], v[8:9], v[74:75]
  v_pk_fma_f32 v[10:11], v[74:75], v[74:75], v[10:11]
  v_pk_add_f32 v[8:9], v[8:9], v[76:77]
  v_pk_fma_f32 v[10:11], v[76:77], v[76:77], v[10:11]
  v_pk_add_f32 v[8:9], v[8:9], v[78:79]
  v_pk_fma_f32 v[10:11], v[78:79], v[78:79], v[10:11]
  v_add_f32 v8, v8, v9
  v_add_f32 v9, v10, v11
  v_mov_b32 v10, v8
  v_mov_b32 v11, v9
  s_nop 0
  v_permlane16_swap_b32 v8, v10
  v_permlane16_swap_b32 v9, v11
  v_add_f32 v8, v8, v10
  v_add_f32 v9, v9, v11
  v_mov_b32 v10, v8
  v_mov_b32 v11, v9
  s_nop 0
  v_permlane32_swap_b32 v8, v10
  v_permlane32_swap_b32 v9, v11
  v_add_f32 v8, v8, v10
  v_add_f32 v9, v9, v11
  v_lshlrev_b32 v12, 3, v1
  v_cmp_gt_u32 vcc, 16, v1
  v_mov_b32 v14, 1073741824
  s_nop 0
  v_cndmask_b32 v14, v14, v12, vcc
  s_lshl_b32 s76, s59, 10
  s_add_u32 s76, s76, 8912896
  s_lshl_b32 s77, s55, 7
  s_add_u32 s77, s77, s76
  buffer_store_dwordx2 v[8:9], v14, s[8:11], s77 offen sc1
  v_accvgpr_write_b32 a184, v236
  v_accvgpr_write_b32 a185, v237
  v_accvgpr_write_b32 a186, v238
  v_accvgpr_write_b32 a187, v239
  v_accvgpr_write_b32 a188, v240
  v_accvgpr_write_b32 a189, v241
  v_accvgpr_write_b32 a190, v242
  v_accvgpr_write_b32 a191, v243
  v_accvgpr_write_b32 a192, v244
  v_accvgpr_write_b32 a193, v245
  s_waitcnt vmcnt(8)
  buffer_store_dwordx4 v[40:43], v32, s[8:11], s93 offen sc1
  s_waitcnt vmcnt(8)
  buffer_store_dwordx4 v[44:47], v33, s[8:11], s93 offen sc1
  s_waitcnt vmcnt(8)
  buffer_store_dwordx4 v[48:51], v34, s[8:11], s93 offen sc1
  s_waitcnt vmcnt(8)
  buffer_store_dwordx4 v[52:55], v35, s[8:11], s95 offen sc1
  s_mov_b32 s67, 262144
N3:
  buffer_load_dword v15, off, s[48:51], 0 sc1
  s_waitcnt vmcnt(0)
  v_readfirstlane_b32 s63, v15
  s_nop 1
  s_cmp_lg_u32 s63, 0
  s_cbranch_scc1 ND4
  s_sub_u32 s67, s67, 1
  s_cmp_lg_u32 s67, 0
  s_cbranch_scc1 N3
ND4:
  s_waitcnt vmcnt(0)
  s_barrier
  s_cmp_lg_u32 s52, 0
  s_cbranch_scc1 F5
  s_add_u32 s67, s63, 1
  s_lshl_b32 s68, s2, 4
  v_mov_b32 v14, s67
  s_mov_b64 exec, 1
  s_nop 1
  buffer_store_dword v14, off, s[8:11], s68 sc1
  s_mov_b64 exec, -1
F5:
  v_and_b32 v32, 31, v1
  v_lshrrev_b32 v33, 5, v1
  v_bfe_u32 v34, v32, 2, 1
  v_and_b32 v35, 3, v32
  v_lshrrev_b32 v36, 3, v32
  v_lshl_add_u32 v35, v36, 2, v35
  s_lshl_b32 s76, s54, 1
  v_add_u32 v36, s76, v33
  v_mul_u32_u24 v36, 800, v36
  v_lshl_add_u32 v36, v35, 1, v36
  v_cmp_eq_u32 vcc, v33, v34
  s_nop 1
  v_cndmask_b32 v36, v27, v36, vcc
  v_cmp_gt_u32 vcc, 4, v35
  v_add_u32 v38, 32, v36
  s_nop 0
  v_cndmask_b32 v38, v27, v38, vcc
  s_lshl_b32 s76, s52, 1
  s_add_u32 s76, s76, 0
  s_cmp_ge_u32 s76, 16
  s_cselect_b32 s77, -16, 4
  s_mul_i32 s77, s77, 40
  s_mul_i32 s78, s76, 40
  s_cmp_ge_u32 s76, 20
  s_cselect_b32 s78, 1073741824, s78
  v_mul_lo_u32 v39, v33, s77
  v_add_u32 v60, v39, v36
  buffer_load_ushort v88, v60, s[20:23], s78 offen
  v_add_u32 v60, v39, v38
  buffer_load_ushort v91, v60, s[20:23], s78 offen
  s_lshl_b32 s76, s52, 1
  s_add_u32 s76, s76, 1
  s_cmp_ge_u32 s76, 16
  s_cselect_b32 s77, -16, 4
  s_mul_i32 s77, s77, 40
  s_mul_i32 s78, s76, 40
  s_cmp_ge_u32 s76, 20
  s_cselect_b32 s78, 1073741824, s78
  v_mul_lo_u32 v39, v33, s77
  v_add_u32 v60, v39, v36
  buffer_load_ushort v94, v60, s[20:23], s78 offen
  v_add_u32 v60, v39, v38
  buffer_load_ushort v97, v60, s[20:23], s78 offen
  s_lshl_b32 s76, s52, 1
  s_add_u32 s76, s76, 8
  s_cmp_ge_u32 s76, 16
  s_cselect_b32 s77, -16, 4
  s_mul_i32 s77, s77, 40
  s_mul_i32 s78, s76, 40
  s_cmp_ge_u32 s76, 20
  s_cselect_b32 s78, 1073741824, s78
  v_mul_lo_u32 v39, v33, s77
  v_add_u32 v60, v39, v36
  buffer_load_ushort v89, v60, s[20:23], s78 offen
  v_add_u32 v60, v39, v38
  buffer_load_ushort v92, v60, s[20:23], s78 offen
  s_lshl_b32 s76, s52, 1
  s_add_u32 s76, s76, 9
  s_cmp_ge_u32 s76, 16
  s_cselect_b32 s77, -16, 4
  s_mul_i32 s77, s77, 40
  s_mul_i32 s78, s76, 40
  s_cmp_ge_u32 s76, 20
  s_cselect_b32 s78, 1073741824, s78
  v_mul_lo_u32 v39, v33, s77
  v_add_u32 v60, v39, v36
  buffer_load_ushort v95, v60, s[20:23], s78 offen
  v_add_u32 v60, v39, v38
  buffer_load_ushort v98, v60, s[20:23], s78 offen
  s_lshl_b32 s76, s52, 1
  s_add_u32 s76, s76, 16
  s_cmp_ge_u32 s76, 16
  s_cselect_b32 s77, -16, 4
  s_mul_i32 s77, s77, 40
  s_mul_i32 s78, s76, 40
  s_cmp_ge_u32 s76, 20
  s_cselect_b32 s78, 1073741824, s78
  v_mul_lo_u32 v39, v33, s77
  v_add_u32 v60, v39, v36
  buffer_load_ushort v90, v60, s[20:23], s78 offen
  v_add_u32 v60, v39, v38
  buffer_load_ushort v93, v60, s[20:23], s78 offen
  s_lshl_b32 s76, s52, 1
  s_add_u32 s76, s76, 17
  s_cmp_ge_u32 s76, 16
  s_cselect_b32 s77, -16, 4
  s_mul_i32 s77, s77, 40
  s_mul_i32 s78, s76, 40
  s_cmp_ge_u32 s76, 20
  s_cselect_b32 s78, 1073741824, s78
  v_mul_lo_u32 v39, v33, s77
  v_add_u32 v60, v39, v36
  buffer_load_ushort v96, v60, s[20:23], s78 offen
  v_add_u32 v60, v39, v38
  buffer_load_ushort v99, v60, s[20:23], s78 offen
  v_bfe_u32 v16, v1, 3, 1
  s_lshl_b32 s66, s53, 1
  v_add_u32 v16, s66, v16
  v_and_b32 v17, 7, v1
  v_and_b32 v18, 3, v17
  v_lshlrev_b32 v18, 3, v18
  v_and_b32 v19, 7, v16
  v_xor_b32 v19, 0, v19
  v_add_u32 v18, v18, v19
  v_lshlrev_b32 v18, 3, v18
  v_lshrrev_b32 v19, 3, v16
  v_lshl_add_u32 v18, v19, 1, v18
  v_lshrrev_b32 v19, 2, v17
  v_add_u32 v18, v18, v19
  v_lshlrev_b32 v18, 4, v18
  v_and_b32 v16, 15, v1
  s_lshl_b32 s66, s54, 4
  v_add_u32 v16, s66, v16
  v_and_b32 v17, 31, v1
  s_lshl_b32 s66, s55, 5
  v_add_u32 v17, s66, v17
  v_cmp_gt_u32 vcc, 32, v1
  s_nop 1
  v_cndmask_b32 v16, v17, v16, vcc
  v_lshlrev_b32 v16, 4, v16
  v_cmp_gt_u32 vcc, 16, v1
  s_nop 1
  v_cndmask_b32 v18, v16, v18, vcc
  s_add_u32 s71, s63, 1
  s_lshl_b32 s76, s52, 2
  s_add_u32 s76, s76, 153600
  v_add_u32 v32, s76, v13
  s_waitcnt vmcnt(9)
  v_lshl_or_b32 v88, v94, 16, v88
  ds_write_b32 v32, v88 offset:0
  s_waitcnt vmcnt(5)
  v_lshl_or_b32 v89, v95, 16, v89
  ds_write_b32 v32, v89 offset:1024
  s_waitcnt vmcnt(1)
  v_lshl_or_b32 v90, v96, 16, v90
  ds_write_b32 v32, v90 offset:2048
  v_lshl_or_b32 v91, v97, 16, v91
  ds_write_b32 v32, v91 offset:3072
  v_lshl_or_b32 v92, v98, 16, v92
  ds_write_b32 v32, v92 offset:4096
  s_waitcnt vmcnt(0)
  v_lshl_or_b32 v93, v99, 16, v93
  ds_write_b32 v32, v93 offset:5120
  v_mov_b32 v23, v18
  v_and_b32 v16, 31, v1
  v_lshrrev_b32 v17, 5, v1
  v_bfe_u32 v18, v16, 2, 1
  v_and_b32 v19, 3, v16
  v_lshrrev_b32 v20, 3, v16
  v_lshl_add_u32 v19, v20, 2, v19
  v_cmp_eq_u32 vcc, v17, v18
  s_nop 1
  v_cndmask_b32 v19, 63, v19, vcc
  v_mov_b32 v21, 0x3f80
  v_mov_b32 v22, 0x3f800000
  v_cmp_eq_u32 vcc, 0, v19
  s_nop 1
  v_cndmask_b32 v20, 0, v21, vcc
  v_cmp_eq_u32 vcc, 1, v19
  s_nop 1
  v_cndmask_b32 v20, v20, v22, vcc
  v_mov_b32 v248, v20
  v_cmp_eq_u32 vcc, 2, v19
  s_nop 1
  v_cndmask_b32 v20, 0, v21, vcc
  v_cmp_eq_u32 vcc, 3, v19
  s_nop 1
  v_cndmask_b32 v20, v20, v22, vcc
  v_mov_b32 v249, v20
  v_cmp_eq_u32 vcc, 4, v19
  s_nop 1
  v_cndmask_b32 v20, 0, v21, vcc
  v_cmp_eq_u32 vcc, 5, v19
  s_nop 1
  v_cndmask_b32 v20, v20, v22, vcc
  v_mov_b32 v250, v20
  v_cmp_eq_u32 vcc, 6, v19
  s_nop 1
  v_cndmask_b32 v20, 0, v21, vcc
  v_cmp_eq_u32 vcc, 7, v19
  s_nop 1
  v_cndmask_b32 v20, v20, v22, vcc
  v_mov_b32 v251, v20
  s_mul_i32 s84, s52, 25344
  s_mul_i32 s85, s52, 8448
  s_add_u32 s85, s85, 118784
  s_mul_i32 s86, s52, 38016
  s_lshl_b32 s87, s52, 10
  s_mul_i32 s88, s54, 153600
  s_add_u32 s88, s88, 1048576
  s_add_u32 s88, s88, s87
  s_mul_i32 s89, s55, 102400
  s_add_u32 s89, s89, 4194304
  s_add_u32 s89, s89, s87
  s_waitcnt lgkmcnt(0)
  s_cmp_eq_u32 s52, 0
  s_cbranch_scc1 CA6
  s_add_u32 s66, s62, 0
  buffer_store_dwordx4 v[56:59], v13, s[8:11], s66 offen sc1
  s_nop 0
  s_add_u32 s66, s62, 1048576
  buffer_store_dwordx4 v[56:59], v13, s[8:11], s66 offen sc1
  s_nop 0
  s_add_u32 s66, s62, 2097152
  buffer_store_dwordx4 v[56:59], v13, s[8:11], s66 offen sc1
  s_nop 0
  s_add_u32 s66, s62, 3145728
  buffer_store_dwordx4 v[56:59], v13, s[8:11], s66 offen sc1
  s_nop 0
  s_add_u32 s66, s62, 4194304
  buffer_store_dwordx4 v[56:59], v13, s[8:11], s66 offen sc1
  s_nop 0
  s_add_u32 s66, s62, 5242880
  buffer_store_dwordx4 v[56:59], v13, s[8:11], s66 offen sc1
  s_branch CB7
CA6:
  s_mov_b32 s67, 262144
P8:
  buffer_load_dword v15, v23, s[8:11], 0 offen sc1
  s_waitcnt vmcnt(0)
  v_subrev_u32 v15, s71, v15
  v_cmp_gt_u32 vcc, 128, v15
  s_cmp_eq_u64 vcc, -1
  s_cbranch_scc1 PD9
  s_sub_u32 s67, s67, 1
  s_cmp_lg_u32 s67, 0
  s_cbranch_scc1 P8
PD9:
  s_add_u32 s66, s62, 0
  buffer_store_dwordx4 v[56:59], v13, s[8:11], s66 offen sc1
  s_nop 0
  s_add_u32 s66, s62, 1048576
  buffer_store_dwordx4 v[56:59], v13, s[8:11], s66 offen sc1
  s_nop 0
  s_add_u32 s66, s62, 2097152
  buffer_store_dwordx4 v[56:59], v13, s[8:11], s66 offen sc1
  s_nop 0
  s_add_u32 s66, s62, 3145728
  buffer_store_dwordx4 v[56:59], v13, s[8:11], s66 offen sc1
  s_nop 0
  s_add_u32 s66, s62, 4194304
  buffer_store_dwordx4 v[56:59], v13, s[8:11], s66 offen sc1
  s_nop 0
  s_add_u32 s66, s62, 5242880
  buffer_store_dwordx4 v[56:59], v13, s[8:11], s66 offen sc1
CB7:
  s_barrier
  s_add_u32 m0, s87, 0
  s_add_u32 s69, s88, 0
  buffer_load_dwordx4 v13, s[8:11], s69 offen sc1 lds
  s_add_u32 m0, s87, 4096
  s_add_u32 s69, s88, 4096
  buffer_load_dwordx4 v13, s[8:11], s69 offen sc1 lds
  s_add_u32 m0, s87, 8192
  s_add_u32 s69, s88, 8192
  buffer_load_dwordx4 v13, s[8:11], s69 offen sc1 lds
  v_and_b32 v48, 31, v1
  v_lshlrev_b32 v48, 5, v48
  v_lshrrev_b32 v49, 5, v1
  v_mul_u32_u24 v49, 20480, v49
  s_lshl_b32 s66, s52, 10
  v_add3_u32 v48, v48, v49, s66
  v_accvgpr_write_b32 a194, v48
  s_add_u32 m0, s87, 12288
  s_add_u32 s69, s88, 12288
  buffer_load_dwordx4 v13, s[8:11], s69 offen sc1 lds
  s_add_u32 m0, s87, 16384
  s_add_u32 s69, s88, 16384
  buffer_load_dwordx4 v13, s[8:11], s69 offen sc1 lds
  s_add_u32 m0, s87, 20480
  s_add_u32 s69, s88, 20480
  buffer_load_dwordx4 v13, s[8:11], s69 offen sc1 lds
  v_lshrrev_b32 v48, 2, v1
  v_lshlrev_b32 v48, 5, v48
  v_and_b32 v49, 3, v1
  v_lshl_add_u32 v48, v49, 3, v48
  s_lshr_b32 s66, s52, 1
  s_mul_i32 s66, s66, 20480
  s_add_u32 s66, s66, 0
  v_add_u32 v48, s66, v48
  s_and_b32 s67, s52, 1
  s_lshl_b32 s67, s67, 12
  s_add_u32 s67, s67, 12288
  v_add_u32 v49, s67, v48
  v_accvgpr_write_b32 a195, v48
  v_accvgpr_write_b32 a196, v49
  s_add_u32 m0, s87, 24576
  s_add_u32 s69, s88, 24576
  buffer_load_dwordx4 v13, s[8:11], s69 offen sc1 lds
  s_add_u32 m0, s87, 28672
  s_add_u32 s69, s88, 28672
  buffer_load_dwordx4 v13, s[8:11], s69 offen sc1 lds
  s_add_u32 m0, s87, 32768
  s_add_u32 s69, s88, 32768
  buffer_load_dwordx4 v13, s[8:11], s69 offen sc1 lds
  v_and_b32 v48, 15, v1
  s_and_b32 s67, s52, 1
  s_lshl_b32 s67, s67, 4
  v_add_u32 v48, s67, v48
  v_cmp_gt_u32 vcc, 21, v48
  s_lshr_b32 s66, s52, 1
  s_mul_i32 s66, s66, 21
  v_add_u32 v48, s66, v48
  v_mul_u32_u24 v48, 80, v48
  v_mov_b32 v49, 1073741824
  v_cndmask_b32 v48, v49, v48, vcc
  v_lshrrev_b32 v50, 4, v1
  v_lshl_add_u32 v51, v50, 3, v48
  v_lshl_add_u32 v48, v50, 4, v48
  v_cmp_gt_u32 vcc, 2, v50
  s_nop 1
  v_cndmask_b32 v51, v49, v51, vcc
  s_lshl_b32 s66, s54, 4
  s_add_u32 s66, s66, s53
  s_lshl_b32 s66, s66, 12
  s_add_u32 s92, s66, 9043968
  s_lshl_b32 s93, s2, 4
  s_cmp_eq_u32 s52, 0
  s_cselect_b32 s93, s93, 1073741824
  s_add_u32 s83, s63, 2
  v_mov_b32 v52, s83
  v_cmp_eq_u32 vcc, 0, v1
  s_nop 1
  v_cndmask_b32 v53, v49, v1, vcc
  v_accvgpr_write_b32 a197, v48
  v_accvgpr_write_b32 a198, v51
  v_accvgpr_write_b32 a199, v52
  v_accvgpr_write_b32 a200, v53
  s_add_u32 m0, s87, 36864
  s_add_u32 s69, s88, 36864
  buffer_load_dwordx4 v13, s[8:11], s69 offen sc1 lds
  s_add_u32 m0, s87, 40960
  s_add_u32 s69, s88, 40960
  buffer_load_dwordx4 v13, s[8:11], s69 offen sc1 lds
  s_add_u32 m0, s87, 45056
  s_add_u32 s69, s88, 45056
  buffer_load_dwordx4 v13, s[8:11], s69 offen sc1 lds
  v_and_b32 v48, 15, v1
  s_lshr_b32 s66, s56, 1
  v_mov_b32 v49, s66
  v_and_b32 v50, 3, v49
  v_lshlrev_b32 v50, 3, v50
  v_and_b32 v51, 7, v48
  v_add_u32 v50, v50, v51
  v_lshlrev_b32 v50, 3, v50
  v_lshrrev_b32 v51, 2, v49
  v_lshl_add_u32 v50, v51, 1, v50
  v_lshrrev_b32 v51, 3, v48
  v_add_u32 v50, v50, v51
  v_lshlrev_b32 v50, 4, v50
  v_lshlrev_b32 v49, 4, v0
  v_cmp_gt_u32 vcc, 210, v0
  v_mov_b32 v51, 1073741824
  s_nop 0
  v_cndmask_b32 v51, v51, v49, vcc
  v_add_u32 v49, 102400, v49
  v_accvgpr_write_b32 a201, v49
  v_accvgpr_write_b32 a202, v50
  v_accvgpr_write_b32 a203, v51
  s_add_u32 m0, s87, 49152
  s_add_u32 s69, s88, 49152
  buffer_load_dwordx4 v13, s[8:11], s69 offen sc1 lds
  s_add_u32 m0, s87, 53248
  s_add_u32 s69, s88, 53248
  buffer_load_dwordx4 v13, s[8:11], s69 offen sc1 lds
  s_add_u32 m0, s87, 57344
  s_add_u32 s69, s88, 57344
  buffer_load_dwordx4 v13, s[8:11], s69 offen sc1 lds
  v_lshrrev_b32 v48, 3, v1
  v_mul_u32_u24 v48, 12288, v48
  v_and_b32 v49, 7, v1
  v_lshl_add_u32 v48, v49, 4, v48
  s_mul_i32 s66, s52, 1572864
  s_lshl_b32 s67, s57, 7
  s_add_u32 s66, s66, s67
  s_cmp_eq_u32 s58, 100
  s_cselect_b32 s66, 1073741824, s66
  v_add_u32 v50, s66, v48
  v_add_u32 v51, 2016, v50
  v_add_u32 v52, 4032, v50
  v_add_u32 v53, 6048, v50
  v_bfe_u32 v48, v1, 2, 2
  v_mul_u32_u24 v48, 1056, v48
  v_lshrrev_b32 v49, 4, v1
  v_lshl_add_u32 v48, v49, 7, v48
  v_and_b32 v49, 3, v1
  v_lshl_add_u32 v48, v49, 3, v48
  v_add_u32 v54, s85, v48
  v_add_u32 v55, s84, v48
  v_accvgpr_write_b32 a224, v50
  v_accvgpr_write_b32 a225, v51
  v_accvgpr_write_b32 a226, v52
  v_accvgpr_write_b32 a227, v53
  v_accvgpr_write_b32 a228, v54
  v_accvgpr_write_b32 a229, v55
  s_add_u32 m0, s87, 61440
  s_add_u32 s69, s88, 61440
  buffer_load_dwordx4 v13, s[8:11], s69 offen sc1 lds
  s_add_u32 m0, s87, 65536
  s_add_u32 s69, s88, 65536
  buffer_load_dwordx4 v13, s[8:11], s69 offen sc1 lds
  s_add_u32 m0, s87, 69632
  s_add_u32 s69, s88, 69632
  buffer_load_dwordx4 v13, s[8:11], s69 offen sc1 lds
  v_lshrrev_b32 v48, 5, v1
  v_bfe_u32 v49, v1, 4, 1
  v_mul_u32_u24 v49, 20480, v49
  v_and_b32 v50, 15, v1
  v_lshl_add_u32 v49, v50, 4, v49
  v_lshl_add_u32 v50, v48, 3, v49
  v_mul_u32_u24 v48, 768, v48
  v_add_u32 v49, v49, v48
  s_lshl_b32 s94, s53, 2
  s_add_u32 s94, s94, s52
  s_mul_i32 s94, s94, 40960
  s_mul_i32 s67, s54, 1280
  s_add_u32 s94, s94, s67
  s_add_u32 s94, s94, 10092544
  v_accvgpr_write_b32 a230, v49
  v_accvgpr_write_b32 a231, v50
  s_add_u32 m0, s87, 73728
  s_add_u32 s69, s88, 73728
  buffer_load_dwordx4 v13, s[8:11], s69 offen sc1 lds
  s_add_u32 m0, s87, 77824
  s_add_u32 s69, s88, 77824
  buffer_load_dwordx4 v13, s[8:11], s69 offen sc1 lds
  s_lshl_b32 s66, s53, 2
  s_add_u32 s66, s66, s52
  s_lshl_b32 s72, s66, 11
  s_add_u32 s72, s72, 8912896
  s_mul_i32 s73, s66, 40960
  s_add_u32 s73, s73, 6291456
  v_and_b32 v14, 15, v1
  v_lshlrev_b32 v14, 3, v14
  v_bfe_u32 v15, v1, 4, 1
  v_lshl_add_u32 v14, v15, 10, v14
  v_lshrrev_b32 v15, 5, v1
  v_lshl_add_u32 v14, v15, 9, v14
  s_mov_b32 s82, 131072
  v_bfe_u32 v16, v1, 4, 1
  v_and_b32 v17, 3, v1
  v_lshl_add_u32 v16, v16, 2, v17
  v_lshlrev_b32 v16, 2, v16
  v_lshrrev_b32 v17, 5, v1
  v_lshlrev_b32 v17, 3, v17
  v_bfe_u32 v18, v1, 2, 2
  v_add_u32 v17, v17, v18
  v_mov_b32 v18, 1935823168
  v_bfe_u32 v18, v18, v16, 4
  v_lshlrev_b32 v18, 3, v18
  v_mad_u32_u24 v18, v17, 64, v18
  v_add_u32 v2, 0, v18
  v_mov_b32 v18, 1985167888
  v_bfe_u32 v18, v18, v16, 4
  v_lshlrev_b32 v18, 3, v18
  v_mad_u32_u24 v18, v17, 64, v18
  v_add_u32 v3, 40960, v18
  v_mov_b32 v18, 1969500448
  v_bfe_u32 v18, v18, v16, 4
  v_lshlrev_b32 v18, 3, v18
  v_mad_u32_u24 v18, v17, 64, v18
  v_add_u32 v4, 81920, v18
  v_mov_b32 v18, 1414803744
  v_bfe_u32 v18, v18, v16, 4
  v_lshlrev_b32 v18, 3, v18
  v_mad_u32_u24 v18, v17, 48, v18
  v_add_u32 v5, 122880, v18
  v_accvgpr_write_b32 a240, -1
  v_accvgpr_write_b32 a241, -1
  v_accvgpr_write_b32 a242, -1
  v_accvgpr_write_b32 a243, -1
  v_lshrrev_b32 v7, 5, v1
  v_bfe_u32 v224, v1, 4, 1
  v_mul_u32_u24 v224, 20480, v224
  v_and_b32 v225, 15, v1
  v_lshl_add_u32 v224, v225, 4, v224
  v_lshl_add_u32 v225, v7, 3, v224
  v_mul_u32_u24 v7, 768, v7
  v_add_u32 v224, v224, v7
  s_lshl_b32 s74, s53, 2
  s_add_u32 s74, s74, s52
  s_mul_i32 s74, s74, 40960
  s_mul_i32 s67, s54, 1280
  s_add_u32 s74, s74, s67
  s_add_u32 s74, s74, 10092544
  s_add_u32 s77, s73, 0
  buffer_load_dwordx4 a[0:3], v13, s[8:11], s77 offen offset:0 sc1
  s_add_u32 s77, s73, 0
  buffer_load_dwordx4 a[4:7], v13, s[8:11], s77 offen offset:1024 sc1
  s_add_u32 s77, s73, 0
  buffer_load_dwordx4 a[8:11], v13, s[8:11], s77 offen offset:2048 sc1
  s_add_u32 s77, s73, 0
  buffer_load_dwordx4 a[12:15], v13, s[8:11], s77 offen offset:3072 sc1
  s_add_u32 s77, s73, 4096
  buffer_load_dwordx4 a[16:19], v13, s[8:11], s77 offen offset:0 sc1
  s_add_u32 s77, s73, 4096
  buffer_load_dwordx4 a[20:23], v13, s[8:11], s77 offen offset:1024 sc1
  s_waitcnt vmcnt(6)
  s_waitcnt lgkmcnt(0)
  s_barrier
  v_add_u32 v6, 153600, v13
  ds_read_b128 a[160:163], v6 offset:0
  ds_read_b128 a[164:167], v6 offset:1024
  ds_read_b128 a[168:171], v6 offset:2048
  ds_read_b128 a[172:175], v6 offset:3072
  ds_read_b128 a[176:179], v6 offset:4096
  ds_read_b128 a[180:183], v6 offset:5120
  v_mov_b32 v176, 0x3f803f80
  v_mov_b32 v177, 0x3f803f80
  v_mov_b32 v178, 0x3f803f80
  v_mov_b32 v179, 0x3f803f80
  s_lshr_b32 s66, s52, 1
  s_and_b32 s67, s52, 1
  v_cmp_eq_u32 vcc, s67, 1
  s_mov_b32 s68, 20480
  s_mul_i32 s68, s68, s66
  v_cndmask_b32 v15, v2, v3, vcc
  v_add_u32 v15, s68, v15
  ds_read_b64_tr_b16 v[80:81], v15 offset:0
  ds_read_b64_tr_b16 v[82:83], v15 offset:256
  ds_read_b64_tr_b16 v[84:85], v15 offset:1024
  ds_read_b64_tr_b16 v[86:87], v15 offset:1280
  ds_read_b64_tr_b16 v[88:89], v15 offset:2048
  ds_read_b64_tr_b16 v[90:91], v15 offset:2304
  ds_read_b64_tr_b16 v[92:93], v15 offset:3072
  ds_read_b64_tr_b16 v[94:95], v15 offset:3328
  ds_read_b64_tr_b16 v[96:97], v15 offset:4096
  ds_read_b64_tr_b16 v[98:99], v15 offset:4352
  s_waitcnt lgkmcnt(8)
  v_mfma_f32_32x32x16_bf16 v[144:159], v[80:83], v[176:179], 0
  s_add_u32 s77, s73, 4096
  buffer_load_dwordx4 a[24:27], v13, s[8:11], s77 offen offset:2048 sc1
  ds_read_b64_tr_b16 v[100:101], v15 offset:5120
  ds_read_b64_tr_b16 v[102:103], v15 offset:5376
  s_waitcnt lgkmcnt(8)
  v_mfma_f32_32x32x16_bf16 v[144:159], v[84:87], v[176:179], v[144:159]
  ds_read_b64_tr_b16 v[104:105], v15 offset:6144
  ds_read_b64_tr_b16 v[106:107], v15 offset:6400
  s_waitcnt lgkmcnt(8)
  v_mfma_f32_32x32x16_bf16 v[144:159], v[88:91], v[176:179], v[144:159]
  s_add_u32 s77, s73, 4096
  buffer_load_dwordx4 a[28:31], v13, s[8:11], s77 offen offset:3072 sc1
  ds_read_b64_tr_b16 v[108:109], v15 offset:7168
  ds_read_b64_tr_b16 v[110:111], v15 offset:7424
  s_waitcnt lgkmcnt(8)
  v_mfma_f32_32x32x16_bf16 v[144:159], v[92:95], v[176:179], v[144:159]
  ds_read_b64_tr_b16 v[112:113], v15 offset:8192
  ds_read_b64_tr_b16 v[114:115], v15 offset:8448
  s_waitcnt lgkmcnt(8)
  v_mfma_f32_32x32x16_bf16 v[144:159], v[96:99], v[176:179], v[144:159]
  s_add_u32 s77, s73, 8192
  buffer_load_dwordx4 a[32:35], v13, s[8:11], s77 offen offset:0 sc1
  ds_read_b64_tr_b16 v[116:117], v15 offset:9216
  ds_read_b64_tr_b16 v[118:119], v15 offset:9472
  s_waitcnt lgkmcnt(8)
  v_mfma_f32_32x32x16_bf16 v[144:159], v[100:103], v[176:179], v[144:159]
  ds_read_b64_tr_b16 v[120:121], v15 offset:10240
  ds_read_b64_tr_b16 v[122:123], v15 offset:10496
  s_waitcnt lgkmcnt(8)
  v_mfma_f32_32x32x16_bf16 v[144:159], v[104:107], v[176:179], v[144:159]
  s_add_u32 s77, s73, 8192
  buffer_load_dwordx4 a[36:39], v13, s[8:11], s77 offen offset:1024 sc1
  ds_read_b64_tr_b16 v[124:125], v15 offset:11264
  ds_read_b64_tr_b16 v[126:127], v15 offset:11520
  s_waitcnt lgkmcnt(8)
  v_mfma_f32_32x32x16_bf16 v[144:159], v[108:111], v[176:179], v[144:159]
  ds_read_b64_tr_b16 v[128:129], v15 offset:12288
  ds_read_b64_tr_b16 v[130:131], v15 offset:12544
  s_waitcnt lgkmcnt(8)
  v_mfma_f32_32x32x16_bf16 v[144:159], v[112:115], v[176:179], v[144:159]
  ds_read_b64_tr_b16 v[132:133], v15 offset:13312
  ds_read_b64_tr_b16 v[134:135], v15 offset:13568
  s_waitcnt lgkmcnt(8)
  v_mfma_f32_32x32x16_bf16 v[144:159], v[116:119], v[176:179], v[144:159]
  s_add_u32 s77, s73, 8192
  buffer_load_dwordx4 a[40:43], v13, s[8:11], s77 offen offset:2048 sc1
  ds_read_b64_tr_b16 v[136:137], v15 offset:14336
  ds_read_b64_tr_b16 v[138:139], v15 offset:14592
  s_waitcnt lgkmcnt(8)
  v_mfma_f32_32x32x16_bf16 v[144:159], v[120:123], v[176:179], v[144:159]
  ds_read_b64_tr_b16 v[140:141], v15 offset:15360
  ds_read_b64_tr_b16 v[142:143], v15 offset:15616
  s_waitcnt lgkmcnt(8)
  v_mfma_f32_32x32x16_bf16 v[144:159], v[124:127], v[176:179], v[144:159]
  s_add_u32 s77, s73, 8192
  buffer_load_dwordx4 a[44:47], v13, s[8:11], s77 offen offset:3072 sc1
  ds_read_b64_tr_b16 v[80:81], v15 offset:16384
  ds_read_b64_tr_b16 v[82:83], v15 offset:16640
  s_waitcnt lgkmcnt(8)
  v_mfma_f32_32x32x16_bf16 v[144:159], v[128:131], v[176:179], v[144:159]
  ds_read_b64_tr_b16 v[84:85], v15 offset:17408
  ds_read_b64_tr_b16 v[86:87], v15 offset:17664
  s_waitcnt lgkmcnt(8)
  v_mfma_f32_32x32x16_bf16 v[144:159], v[132:135], v[176:179], v[144:159]
  s_add_u32 s77, s73, 12288
  buffer_load_dwordx4 a[48:51], v13, s[8:11], s77 offen offset:0 sc1
  ds_read_b64_tr_b16 v[88:89], v15 offset:18432
  ds_read_b64_tr_b16 v[90:91], v15 offset:18688
  s_waitcnt lgkmcnt(8)
  v_mfma_f32_32x32x16_bf16 v[144:159], v[136:139], v[176:179], v[144:159]
  ds_read_b64_tr_b16 v[92:93], v15 offset:19456
  ds_read_b64_tr_b16 v[94:95], v15 offset:19712
  s_waitcnt lgkmcnt(8)
  v_mfma_f32_32x32x16_bf16 v[144:159], v[140:143], v[176:179], v[144:159]
  s_add_u32 s77, s73, 12288
  buffer_load_dwordx4 a[52:55], v13, s[8:11], s77 offen offset:1024 sc1
  s_waitcnt lgkmcnt(6)
  v_mfma_f32_32x32x16_bf16 v[144:159], v[80:83], v[176:179], v[144:159]
  s_waitcnt lgkmcnt(4)
  v_mfma_f32_32x32x16_bf16 v[144:159], v[84:87], v[176:179], v[144:159]
  s_waitcnt lgkmcnt(2)
  v_mfma_f32_32x32x16_bf16 v[144:159], v[88:91], v[176:179], v[144:159]
  s_add_u32 s77, s73, 12288
  buffer_load_dwordx4 a[56:59], v13, s[8:11], s77 offen offset:2048 sc1
  s_waitcnt lgkmcnt(0)
  v_mfma_f32_32x32x16_bf16 v[144:159], v[92:95], v[176:179], v[144:159]
  v_lshrrev_b32 v6, 5, v1
  v_lshlrev_b32 v6, 6, v6
  s_lshl_b32 s66, s66, 9
  s_lshl_b32 s67, s67, 7
  s_add_u32 s66, s66, s67
  s_add_u32 s66, s66, 159744
  v_add_u32 v6, s66, v6
  s_nop 4
  ds_write_b128 v6, v[144:147] offset:0
  ds_write_b128 v6, v[148:151] offset:16
  ds_write_b128 v6, v[152:155] offset:32
  ds_write_b128 v6, v[156:159] offset:48
  s_waitcnt lgkmcnt(0)
  s_barrier
  v_lshrrev_b32 v6, 5, v1
  v_lshlrev_b32 v6, 6, v6
  v_add_u32 v6, 159744, v6
  ds_read_b128 v[144:147], v6 offset:0
  ds_read_b128 v[48:51], v6 offset:512
  ds_read_b128 v[148:151], v6 offset:16
  ds_read_b128 v[52:55], v6 offset:528
  ds_read_b128 v[152:155], v6 offset:32
  ds_read_b128 v[56:59], v6 offset:544
  ds_read_b128 v[156:159], v6 offset:48
  ds_read_b128 v[60:63], v6 offset:560
  ds_read_b128 v[160:163], v6 offset:128
  ds_read_b128 v[64:67], v6 offset:640
  ds_read_b128 v[164:167], v6 offset:144
  ds_read_b128 v[68:71], v6 offset:656
  ds_read_b128 v[168:171], v6 offset:160
  ds_read_b128 v[72:75], v6 offset:672
  ds_read_b128 v[172:175], v6 offset:176
  ds_read_b128 v[76:79], v6 offset:688
  ds_read_b64_tr_b16 v[80:81], v2 offset:0
  ds_read_b64_tr_b16 v[82:83], v2 offset:256
  ds_read_b64_tr_b16 v[84:85], v3 offset:0
  ds_read_b64_tr_b16 v[86:87], v3 offset:256
  ds_read_b64_tr_b16 v[88:89], v2 offset:1024
  ds_read_b64_tr_b16 v[90:91], v2 offset:1280
  ds_read_b64_tr_b16 v[92:93], v3 offset:1024
  ds_read_b64_tr_b16 v[94:95], v3 offset:1280
  ds_read_b64_tr_b16 v[96:97], v2 offset:2048
  ds_read_b64_tr_b16 v[98:99], v2 offset:2304
  ds_read_b64_tr_b16 v[100:101], v3 offset:2048
  ds_read_b64_tr_b16 v[102:103], v3 offset:2304
  ds_read_b64_tr_b16 v[104:105], v2 offset:3072
  ds_read_b64_tr_b16 v[106:107], v2 offset:3328
  s_waitcnt vmcnt(14) lgkmcnt(12)
  v_mfma_f32_32x32x16_bf16 v[16:31], v[80:83], a[0:3], 0
  s_add_u32 s77, s73, 12288
  buffer_load_dwordx4 a[60:63], v13, s[8:11], s77 offen offset:3072 sc1
  ds_read_b64_tr_b16 v[108:109], v3 offset:3072
  ds_read_b64_tr_b16 v[110:111], v3 offset:3328
  s_waitcnt lgkmcnt(12)
  v_mfma_f32_32x32x16_bf16 v[32:47], v[84:87], a[0:3], 0
  ds_read_b64_tr_b16 v[112:113], v2 offset:4096
  ds_read_b64_tr_b16 v[114:115], v2 offset:4352
  s_waitcnt vmcnt(14) lgkmcnt(12)
  v_mfma_f32_32x32x16_bf16 v[16:31], v[88:91], a[4:7], v[16:31]
  s_add_u32 s77, s73, 16384
  buffer_load_dwordx4 a[64:67], v13, s[8:11], s77 offen offset:0 sc1
  ds_read_b64_tr_b16 v[116:117], v3 offset:4096
  ds_read_b64_tr_b16 v[118:119], v3 offset:4352
  s_waitcnt lgkmcnt(12)
  v_mfma_f32_32x32x16_bf16 v[32:47], v[92:95], a[4:7], v[32:47]
  v_add_f32 v144, v144, v48
  v_add_f32 v145, v145, v49
  ds_read_b64_tr_b16 v[120:121], v2 offset:5120
  ds_read_b64_tr_b16 v[122:123], v2 offset:5376
  s_waitcnt vmcnt(14) lgkmcnt(12)
  v_mfma_f32_32x32x16_bf16 v[16:31], v[96:99], a[8:11], v[16:31]
  s_add_u32 s77, s73, 16384
  buffer_load_dwordx4 a[68:71], v13, s[8:11], s77 offen offset:1024 sc1
  v_add_f32 v146, v146, v50
  v_add_f32 v147, v147, v51
  ds_read_b64_tr_b16 v[124:125], v3 offset:5120
  ds_read_b64_tr_b16 v[126:127], v3 offset:5376
  s_waitcnt lgkmcnt(12)
  v_mfma_f32_32x32x16_bf16 v[32:47], v[100:103], a[8:11], v[32:47]
  v_add_f32 v148, v148, v52
  v_add_f32 v149, v149, v53
  ds_read_b64_tr_b16 v[128:129], v2 offset:6144
  ds_read_b64_tr_b16 v[130:131], v2 offset:6400
  s_waitcnt vmcnt(14) lgkmcnt(12)
  v_mfma_f32_32x32x16_bf16 v[16:31], v[104:107], a[12:15], v[16:31]
  s_add_u32 s77, s73, 16384
  buffer_load_dwordx4 a[72:75], v13, s[8:11], s77 offen offset:2048 sc1
  v_add_f32 v150, v150, v54
  v_add_f32 v151, v151, v55
  ds_read_b64_tr_b16 v[132:133], v3 offset:6144
  ds_read_b64_tr_b16 v[134:135], v3 offset:6400
  s_waitcnt lgkmcnt(12)
  v_mfma_f32_32x32x16_bf16 v[32:47], v[108:111], a[12:15], v[32:47]
  v_add_f32 v152, v152, v56
  v_add_f32 v153, v153, v57
  ds_read_b64_tr_b16 v[136:137], v2 offset:7168
  ds_read_b64_tr_b16 v[138:139], v2 offset:7424
  s_waitcnt vmcnt(14) lgkmcnt(12)
  v_mfma_f32_32x32x16_bf16 v[16:31], v[112:115], a[16:19], v[16:31]
  s_add_u32 s77, s73, 16384
  buffer_load_dwordx4 a[76:79], v13, s[8:11], s77 offen offset:3072 sc1
  v_add_f32 v154, v154, v58
  v_add_f32 v155, v155, v59
  ds_read_b64_tr_b16 v[140:141], v3 offset:7168
  ds_read_b64_tr_b16 v[142:143], v3 offset:7424
  s_waitcnt lgkmcnt(12)
  v_mfma_f32_32x32x16_bf16 v[32:47], v[116:119], a[16:19], v[32:47]
  v_add_f32 v156, v156, v60
  v_add_f32 v157, v157, v61
  ds_read_b64_tr_b16 v[80:81], v2 offset:8192
  ds_read_b64_tr_b16 v[82:83], v2 offset:8448
  s_waitcnt vmcnt(14) lgkmcnt(12)
  v_mfma_f32_32x32x16_bf16 v[16:31], v[120:123], a[20:23], v[16:31]
  s_add_u32 s77, s73, 20480
  buffer_load_dwordx4 a[80:83], v13, s[8:11], s77 offen offset:0 sc1
  v_add_f32 v158, v158, v62
  v_add_f32 v159, v159, v63
  ds_read_b64_tr_b16 v[84:85], v3 offset:8192
  ds_read_b64_tr_b16 v[86:87], v3 offset:8448
  s_waitcnt lgkmcnt(12)
  v_mfma_f32_32x32x16_bf16 v[32:47], v[124:127], a[20:23], v[32:47]
  v_add_f32 v160, v160, v64
  v_add_f32 v161, v161, v65
  ds_read_b64_tr_b16 v[88:89], v2 offset:9216
  ds_read_b64_tr_b16 v[90:91], v2 offset:9472
  s_waitcnt vmcnt(14) lgkmcnt(12)
  v_mfma_f32_32x32x16_bf16 v[16:31], v[128:131], a[24:27], v[16:31]
  s_add_u32 s77, s73, 20480
  buffer_load_dwordx4 a[84:87], v13, s[8:11], s77 offen offset:1024 sc1
  v_add_f32 v162, v162, v66
  v_add_f32 v163, v163, v67
  ds_read_b64_tr_b16 v[92:93], v3 offset:9216
  ds_read_b64_tr_b16 v[94:95], v3 offset:9472
  s_waitcnt lgkmcnt(12)
  v_mfma_f32_32x32x16_bf16 v[32:47], v[132:135], a[24:27], v[32:47]
  v_add_f32 v164, v164, v68
  v_add_f32 v165, v165, v69
  ds_read_b64_tr_b16 v[96:97], v2 offset:10240
  ds_read_b64_tr_b16 v[98:99], v2 offset:10496
  s_waitcnt vmcnt(14) lgkmcnt(12)
  v_mfma_f32_32x32x16_bf16 v[16:31], v[136:139], a[28:31], v[16:31]
  s_add_u32 s77, s73, 20480
  buffer_load_dwordx4 a[88:91], v13, s[8:11], s77 offen offset:2048 sc1
  v_add_f32 v166, v166, v70
  v_add_f32 v167, v167, v71
  ds_read_b64_tr_b16 v[100:101], v3 offset:10240
  ds_read_b64_tr_b16 v[102:103], v3 offset:10496
  s_waitcnt lgkmcnt(12)
  v_mfma_f32_32x32x16_bf16 v[32:47], v[140:143], a[28:31], v[32:47]
  v_add_f32 v168, v168, v72
  v_add_f32 v169, v169, v73
  ds_read_b64_tr_b16 v[104:105], v2 offset:11264
  ds_read_b64_tr_b16 v[106:107], v2 offset:11520
  s_waitcnt vmcnt(14) lgkmcnt(12)
  v_mfma_f32_32x32x16_bf16 v[16:31], v[80:83], a[32:35], v[16:31]
  s_add_u32 s77, s73, 20480
  buffer_load_dwordx4 a[92:95], v13, s[8:11], s77 offen offset:3072 sc1
  v_add_f32 v170, v170, v74
  v_add_f32 v171, v171, v75
  ds_read_b64_tr_b16 v[108:109], v3 offset:11264
  ds_read_b64_tr_b16 v[110:111], v3 offset:11520
  s_waitcnt lgkmcnt(12)
  v_mfma_f32_32x32x16_bf16 v[32:47], v[84:87], a[32:35], v[32:47]
  v_add_f32 v172, v172, v76
  v_add_f32 v173, v173, v77
  ds_read_b64_tr_b16 v[112:113], v2 offset:12288
  ds_read_b64_tr_b16 v[114:115], v2 offset:12544
  s_waitcnt vmcnt(14) lgkmcnt(12)
  v_mfma_f32_32x32x16_bf16 v[16:31], v[88:91], a[36:39], v[16:31]
  s_add_u32 s77, s73, 24576
  buffer_load_dwordx4 a[96:99], v13, s[8:11], s77 offen offset:0 sc1
  v_add_f32 v174, v174, v78
  v_add_f32 v175, v175, v79
  ds_read_b64_tr_b16 v[116:117], v3 offset:12288
  ds_read_b64_tr_b16 v[118:119], v3 offset:12544
  s_waitcnt lgkmcnt(12)
  v_mfma_f32_32x32x16_bf16 v[32:47], v[92:95], a[36:39], v[32:47]
  ds_read_b64_tr_b16 v[120:121], v2 offset:13312
  ds_read_b64_tr_b16 v[122:123], v2 offset:13568
  s_waitcnt vmcnt(14) lgkmcnt(12)
  v_mfma_f32_32x32x16_bf16 v[16:31], v[96:99], a[40:43], v[16:31]
  s_add_u32 s77, s73, 24576
  buffer_load_dwordx4 a[100:103], v13, s[8:11], s77 offen offset:1024 sc1
  ds_read_b64_tr_b16 v[124:125], v3 offset:13312
  ds_read_b64_tr_b16 v[126:127], v3 offset:13568
  s_waitcnt lgkmcnt(12)
  v_mfma_f32_32x32x16_bf16 v[32:47], v[100:103], a[40:43], v[32:47]
  ds_read_b64_tr_b16 v[128:129], v2 offset:14336
  ds_read_b64_tr_b16 v[130:131], v2 offset:14592
  s_waitcnt vmcnt(14) lgkmcnt(12)
  v_mfma_f32_32x32x16_bf16 v[16:31], v[104:107], a[44:47], v[16:31]
  s_add_u32 s77, s73, 24576
  buffer_load_dwordx4 a[104:107], v13, s[8:11], s77 offen offset:2048 sc1
  ds_read_b64_tr_b16 v[132:133], v3 offset:14336
  ds_read_b64_tr_b16 v[134:135], v3 offset:14592
  s_waitcnt lgkmcnt(12)
  v_mfma_f32_32x32x16_bf16 v[32:47], v[108:111], a[44:47], v[32:47]
  ds_read_b64_tr_b16 v[136:137], v2 offset:15360
  ds_read_b64_tr_b16 v[138:139], v2 offset:15616
  s_waitcnt vmcnt(14) lgkmcnt(12)
  v_mfma_f32_32x32x16_bf16 v[16:31], v[112:115], a[48:51], v[16:31]
  s_add_u32 s77, s73, 24576
  buffer_load_dwordx4 a[108:111], v13, s[8:11], s77 offen offset:3072 sc1
  ds_read_b64_tr_b16 v[140:141], v3 offset:15360
  ds_read_b64_tr_b16 v[142:143], v3 offset:15616
  s_waitcnt lgkmcnt(12)
  v_mfma_f32_32x32x16_bf16 v[32:47], v[116:119], a[48:51], v[32:47]
  ds_read_b64_tr_b16 v[80:81], v2 offset:16384
  ds_read_b64_tr_b16 v[82:83], v2 offset:16640
  s_waitcnt vmcnt(14) lgkmcnt(12)
  v_mfma_f32_32x32x16_bf16 v[16:31], v[120:123], a[52:55], v[16:31]
  s_add_u32 s77, s73, 28672
  buffer_load_dwordx4 a[112:115], v13, s[8:11], s77 offen offset:0 sc1
  ds_read_b64_tr_b16 v[84:85], v3 offset:16384
  ds_read_b64_tr_b16 v[86:87], v3 offset:16640
  s_waitcnt lgkmcnt(12)
  v_mfma_f32_32x32x16_bf16 v[32:47], v[124:127], a[52:55], v[32:47]
  ds_read_b64_tr_b16 v[88:89], v2 offset:17408
  ds_read_b64_tr_b16 v[90:91], v2 offset:17664
  s_waitcnt vmcnt(14) lgkmcnt(12)
  v_mfma_f32_32x32x16_bf16 v[16:31], v[128:131], a[56:59], v[16:31]
  s_add_u32 s77, s73, 28672
  buffer_load_dwordx4 a[116:119], v13, s[8:11], s77 offen offset:1024 sc1
  ds_read_b64_tr_b16 v[92:93], v3 offset:17408
  ds_read_b64_tr_b16 v[94:95], v3 offset:17664
  s_waitcnt lgkmcnt(12)
  v_mfma_f32_32x32x16_bf16 v[32:47], v[132:135], a[56:59], v[32:47]
  ds_read_b64_tr_b16 v[96:97], v2 offset:18432
  ds_read_b64_tr_b16 v[98:99], v2 offset:18688
  s_waitcnt vmcnt(14) lgkmcnt(12)
  v_mfma_f32_32x32x16_bf16 v[16:31], v[136:139], a[60:63], v[16:31]
  s_add_u32 s77, s73, 28672
  buffer_load_dwordx4 a[120:123], v13, s[8:11], s77 offen offset:2048 sc1
  ds_read_b64_tr_b16 v[100:101], v3 offset:18432
  ds_read_b64_tr_b16 v[102:103], v3 offset:18688
  s_waitcnt lgkmcnt(12)
  v_mfma_f32_32x32x16_bf16 v[32:47], v[140:143], a[60:63], v[32:47]
  ds_read_b64_tr_b16 v[104:105], v2 offset:19456
  ds_read_b64_tr_b16 v[106:107], v2 offset:19712
  s_waitcnt vmcnt(14) lgkmcnt(12)
  v_mfma_f32_32x32x16_bf16 v[16:31], v[80:83], a[64:67], v[16:31]
  s_add_u32 s77, s73, 28672
  buffer_load_dwordx4 a[124:127], v13, s[8:11], s77 offen offset:3072 sc1
  ds_read_b64_tr_b16 v[108:109], v3 offset:19456
  ds_read_b64_tr_b16 v[110:111], v3 offset:19712
  s_waitcnt lgkmcnt(12)
  v_mfma_f32_32x32x16_bf16 v[32:47], v[84:87], a[64:67], v[32:47]
  ds_read_b64_tr_b16 v[112:113], v2 offset:20480
  ds_read_b64_tr_b16 v[114:115], v2 offset:20736
  s_waitcnt vmcnt(14) lgkmcnt(12)
  v_mfma_f32_32x32x16_bf16 v[16:31], v[88:91], a[68:71], v[16:31]
  s_add_u32 s77, s73, 32768
  buffer_load_dwordx4 a[128:131], v13, s[8:11], s77 offen offset:0 sc1
  ds_read_b64_tr_b16 v[116:117], v3 offset:20480
  ds_read_b64_tr_b16 v[118:119], v3 offset:20736
  s_waitcnt lgkmcnt(12)
  v_mfma_f32_32x32x16_bf16 v[32:47], v[92:95], a[68:71], v[32:47]
  ds_read_b64_tr_b16 v[120:121], v2 offset:21504
  ds_read_b64_tr_b16 v[122:123], v2 offset:21760
  s_waitcnt vmcnt(14) lgkmcnt(12)
  v_mfma_f32_32x32x16_bf16 v[16:31], v[96:99], a[72:75], v[16:31]
  s_add_u32 s77, s73, 32768
  buffer_load_dwordx4 a[132:135], v13, s[8:11], s77 offen offset:1024 sc1
  ds_read_b64_tr_b16 v[124:125], v3 offset:21504
  ds_read_b64_tr_b16 v[126:127], v3 offset:21760
  s_waitcnt lgkmcnt(12)
  v_mfma_f32_32x32x16_bf16 v[32:47], v[100:103], a[72:75], v[32:47]
  ds_read_b64_tr_b16 v[128:129], v2 offset:22528
  ds_read_b64_tr_b16 v[130:131], v2 offset:22784
  s_waitcnt vmcnt(14) lgkmcnt(12)
  v_mfma_f32_32x32x16_bf16 v[16:31], v[104:107], a[76:79], v[16:31]
  s_add_u32 s77, s73, 32768
  buffer_load_dwordx4 a[136:139], v13, s[8:11], s77 offen offset:2048 sc1
  ds_read_b64_tr_b16 v[132:133], v3 offset:22528
  ds_read_b64_tr_b16 v[134:135], v3 offset:22784
  s_waitcnt lgkmcnt(12)
  v_mfma_f32_32x32x16_bf16 v[32:47], v[108:111], a[76:79], v[32:47]
  ds_read_b64_tr_b16 v[136:137], v2 offset:23552
  ds_read_b64_tr_b16 v[138:139], v2 offset:23808
  s_waitcnt vmcnt(14) lgkmcnt(12)
  v_mfma_f32_32x32x16_bf16 v[16:31], v[112:115], a[80:83], v[16:31]
  s_add_u32 s77, s73, 32768
  buffer_load_dwordx4 a[140:143], v13, s[8:11], s77 offen offset:3072 sc1
  ds_read_b64_tr_b16 v[140:141], v3 offset:23552
  ds_read_b64_tr_b16 v[142:143], v3 offset:23808
  s_waitcnt lgkmcnt(12)
  v_mfma_f32_32x32x16_bf16 v[32:47], v[116:119], a[80:83], v[32:47]
  s_add_u32 m0, s87, 81920
  s_add_u32 s69, s88, 81920
  buffer_load_dwordx4 v13, s[8:11], s69 offen sc1 lds
  ds_read_b64_tr_b16 v[80:81], v2 offset:24576
  ds_read_b64_tr_b16 v[82:83], v2 offset:24832
  s_waitcnt vmcnt(15) lgkmcnt(12)
  v_mfma_f32_32x32x16_bf16 v[16:31], v[120:123], a[84:87], v[16:31]
  s_add_u32 s77, s73, 36864
  buffer_load_dwordx4 a[144:147], v13, s[8:11], s77 offen offset:0 sc1
  ds_read_b64_tr_b16 v[84:85], v3 offset:24576
  ds_read_b64_tr_b16 v[86:87], v3 offset:24832
  s_waitcnt lgkmcnt(12)
  v_mfma_f32_32x32x16_bf16 v[32:47], v[124:127], a[84:87], v[32:47]
  s_add_u32 m0, s87, 86016
  s_add_u32 s69, s88, 86016
  buffer_load_dwordx4 v13, s[8:11], s69 offen sc1 lds
  ds_read_b64_tr_b16 v[88:89], v2 offset:25600
  ds_read_b64_tr_b16 v[90:91], v2 offset:25856
  s_waitcnt vmcnt(16) lgkmcnt(12)
  v_mfma_f32_32x32x16_bf16 v[16:31], v[128:131], a[88:91], v[16:31]
  s_add_u32 s77, s73, 36864
  buffer_load_dwordx4 a[148:151], v13, s[8:11], s77 offen offset:1024 sc1
  ds_read_b64_tr_b16 v[92:93], v3 offset:25600
  ds_read_b64_tr_b16 v[94:95], v3 offset:25856
  s_waitcnt lgkmcnt(12)
  v_mfma_f32_32x32x16_bf16 v[32:47], v[132:135], a[88:91], v[32:47]
  s_add_u32 m0, s87, 90112
  s_add_u32 s69, s88, 90112
  buffer_load_dwordx4 v13, s[8:11], s69 offen sc1 lds
  ds_read_b64_tr_b16 v[96:97], v2 offset:26624
  ds_read_b64_tr_b16 v[98:99], v2 offset:26880
  s_waitcnt vmcnt(17) lgkmcnt(12)
  v_mfma_f32_32x32x16_bf16 v[16:31], v[136:139], a[92:95], v[16:31]
  s_add_u32 s77, s73, 36864
  buffer_load_dwordx4 a[152:155], v13, s[8:11], s77 offen offset:2048 sc1
  ds_read_b64_tr_b16 v[100:101], v3 offset:26624
  ds_read_b64_tr_b16 v[102:103], v3 offset:26880
  s_waitcnt lgkmcnt(12)
  v_mfma_f32_32x32x16_bf16 v[32:47], v[140:143], a[92:95], v[32:47]
  s_add_u32 m0, s87, 94208
  s_add_u32 s69, s88, 94208
  buffer_load_dwordx4 v13, s[8:11], s69 offen sc1 lds
  ds_read_b64_tr_b16 v[104:105], v2 offset:27648
  ds_read_b64_tr_b16 v[106:107], v2 offset:27904
  s_waitcnt vmcnt(18) lgkmcnt(12)
  v_mfma_f32_32x32x16_bf16 v[16:31], v[80:83], a[96:99], v[16:31]
  s_add_u32 s77, s73, 36864
  buffer_load_dwordx4 a[156:159], v13, s[8:11], s77 offen offset:3072 sc1
  ds_read_b64_tr_b16 v[108:109], v3 offset:27648
  ds_read_b64_tr_b16 v[110:111], v3 offset:27904
  s_waitcnt lgkmcnt(12)
  v_mfma_f32_32x32x16_bf16 v[32:47], v[84:87], a[96:99], v[32:47]
  s_add_u32 m0, s87, 98304
  s_add_u32 s69, s88, 98304
  buffer_load_dwordx4 v13, s[8:11], s69 offen sc1 lds
  buffer_load_dwordx2 v[188:189], v14, s[8:11], s72 offen offset:0 sc1
  buffer_load_dwordx2 v[190:191], v14, s[8:11], s72 offen offset:128 sc1
  buffer_load_dwordx2 v[192:193], v14, s[8:11], s72 offen offset:256 sc1
  buffer_load_dwordx2 v[194:195], v14, s[8:11], s72 offen offset:384 sc1
  ds_read_b64_tr_b16 v[112:113], v2 offset:28672
  ds_read_b64_tr_b16 v[114:115], v2 offset:28928
  s_waitcnt vmcnt(23) lgkmcnt(12)
  v_mfma_f32_32x32x16_bf16 v[16:31], v[88:91], a[100:103], v[16:31]
  ds_read_b64_tr_b16 v[116:117], v3 offset:28672
  ds_read_b64_tr_b16 v[118:119], v3 offset:28928
  s_waitcnt lgkmcnt(12)
  v_mfma_f32_32x32x16_bf16 v[32:47], v[92:95], a[100:103], v[32:47]
  s_add_u32 m0, s87, 102400
  s_add_u32 s69, s88, 102400
  buffer_load_dwordx4 v13, s[8:11], s69 offen sc1 lds
  ds_read_b64_tr_b16 v[120:121], v2 offset:29696
  ds_read_b64_tr_b16 v[122:123], v2 offset:29952
  s_waitcnt vmcnt(23) lgkmcnt(12)
  v_mfma_f32_32x32x16_bf16 v[16:31], v[96:99], a[104:107], v[16:31]
  ds_read_b64_tr_b16 v[124:125], v3 offset:29696
  ds_read_b64_tr_b16 v[126:127], v3 offset:29952
  s_waitcnt lgkmcnt(12)
  v_mfma_f32_32x32x16_bf16 v[32:47], v[100:103], a[104:107], v[32:47]
  s_add_u32 m0, s87, 106496
  s_add_u32 s69, s88, 106496
  buffer_load_dwordx4 v13, s[8:11], s69 offen sc1 lds
  ds_read_b64_tr_b16 v[128:129], v2 offset:30720
  ds_read_b64_tr_b16 v[130:131], v2 offset:30976
  s_waitcnt vmcnt(23) lgkmcnt(12)
  v_mfma_f32_32x32x16_bf16 v[16:31], v[104:107], a[108:111], v[16:31]
  ds_read_b64_tr_b16 v[132:133], v3 offset:30720
  ds_read_b64_tr_b16 v[134:135], v3 offset:30976
  s_waitcnt lgkmcnt(12)
  v_mfma_f32_32x32x16_bf16 v[32:47], v[108:111], a[108:111], v[32:47]
  s_add_u32 m0, s87, 110592
  s_add_u32 s69, s88, 110592
  buffer_load_dwordx4 v13, s[8:11], s69 offen sc1 lds
  ds_read_b64_tr_b16 v[136:137], v2 offset:31744
  ds_read_b64_tr_b16 v[138:139], v2 offset:32000
  s_waitcnt vmcnt(23) lgkmcnt(12)
  v_mfma_f32_32x32x16_bf16 v[16:31], v[112:115], a[112:115], v[16:31]
  ds_read_b64_tr_b16 v[140:141], v3 offset:31744
  ds_read_b64_tr_b16 v[142:143], v3 offset:32000
  s_waitcnt lgkmcnt(12)
  v_mfma_f32_32x32x16_bf16 v[32:47], v[116:119], a[112:115], v[32:47]
  s_add_u32 m0, s87, 114688
  s_add_u32 s69, s88, 114688
  buffer_load_dwordx4 v13, s[8:11], s69 offen sc1 lds
  ds_read_b64_tr_b16 v[80:81], v2 offset:32768
  ds_read_b64_tr_b16 v[82:83], v2 offset:33024
  s_waitcnt vmcnt(23) lgkmcnt(12)
  v_mfma_f32_32x32x16_bf16 v[16:31], v[120:123], a[116:119], v[16:31]
  ds_read_b64_tr_b16 v[84:85], v3 offset:32768
  ds_read_b64_tr_b16 v[86:87], v3 offset:33024
  s_waitcnt lgkmcnt(12)
  v_mfma_f32_32x32x16_bf16 v[32:47], v[124:127], a[116:119], v[32:47]
  s_add_u32 m0, s87, 118784
  s_add_u32 s69, s88, 118784
  buffer_load_dwordx4 v13, s[8:11], s69 offen sc1 lds
  ds_read_b64_tr_b16 v[88:89], v2 offset:33792
  ds_read_b64_tr_b16 v[90:91], v2 offset:34048
  s_waitcnt vmcnt(23) lgkmcnt(12)
  v_mfma_f32_32x32x16_bf16 v[16:31], v[128:131], a[120:123], v[16:31]
  ds_read_b64_tr_b16 v[92:93], v3 offset:33792
  ds_read_b64_tr_b16 v[94:95], v3 offset:34048
  s_waitcnt lgkmcnt(12)
  v_mfma_f32_32x32x16_bf16 v[32:47], v[132:135], a[120:123], v[32:47]
  s_add_u32 m0, s87, 122880
  s_add_u32 s69, s88, 122880
  buffer_load_dwordx4 v13, s[8:11], s69 offen sc1 lds
  ds_read_b64_tr_b16 v[96:97], v2 offset:34816
  ds_read_b64_tr_b16 v[98:99], v2 offset:35072
  s_waitcnt vmcnt(23) lgkmcnt(12)
  v_mfma_f32_32x32x16_bf16 v[16:31], v[136:139], a[124:127], v[16:31]
  ds_read_b64_tr_b16 v[100:101], v3 offset:34816
  ds_read_b64_tr_b16 v[102:103], v3 offset:35072
  s_waitcnt lgkmcnt(12)
  v_mfma_f32_32x32x16_bf16 v[32:47], v[140:143], a[124:127], v[32:47]
  s_add_u32 m0, s87, 126976
  s_add_u32 s69, s88, 126976
  buffer_load_dwordx4 v13, s[8:11], s69 offen sc1 lds
  ds_read_b64_tr_b16 v[104:105], v2 offset:35840
  ds_read_b64_tr_b16 v[106:107], v2 offset:36096
  s_waitcnt vmcnt(23) lgkmcnt(12)
  v_mfma_f32_32x32x16_bf16 v[16:31], v[80:83], a[128:131], v[16:31]
  ds_read_b64_tr_b16 v[108:109], v3 offset:35840
  ds_read_b64_tr_b16 v[110:111], v3 offset:36096
  s_waitcnt lgkmcnt(12)
  v_mfma_f32_32x32x16_bf16 v[32:47], v[84:87], a[128:131], v[32:47]
  s_add_u32 m0, s87, 131072
  s_add_u32 s69, s88, 131072
  buffer_load_dwordx4 v13, s[8:11], s69 offen sc1 lds
  ds_read_b64_tr_b16 v[112:113], v2 offset:36864
  ds_read_b64_tr_b16 v[114:115], v2 offset:37120
  s_waitcnt vmcnt(23) lgkmcnt(12)
  v_mfma_f32_32x32x16_bf16 v[16:31], v[88:91], a[132:135], v[16:31]
  ds_read_b64_tr_b16 v[116:117], v3 offset:36864
  ds_read_b64_tr_b16 v[118:119], v3 offset:37120
  s_waitcnt lgkmcnt(12)
  v_mfma_f32_32x32x16_bf16 v[32:47], v[92:95], a[132:135], v[32:47]
  s_add_u32 m0, s87, 135168
  s_add_u32 s69, s88, 135168
  buffer_load_dwordx4 v13, s[8:11], s69 offen sc1 lds
  ds_read_b64_tr_b16 v[120:121], v2 offset:37888
  ds_read_b64_tr_b16 v[122:123], v2 offset:38144
  s_waitcnt vmcnt(23) lgkmcnt(12)
  v_mfma_f32_32x32x16_bf16 v[16:31], v[96:99], a[136:139], v[16:31]
  ds_read_b64_tr_b16 v[124:125], v3 offset:37888
  ds_read_b64_tr_b16 v[126:127], v3 offset:38144
  s_waitcnt lgkmcnt(12)
  v_mfma_f32_32x32x16_bf16 v[32:47], v[100:103], a[136:139], v[32:47]
  s_add_u32 m0, s87, 139264
  s_add_u32 s69, s88, 139264
  buffer_load_dwordx4 v13, s[8:11], s69 offen sc1 lds
  ds_read_b64_tr_b16 v[128:129], v2 offset:38912
  ds_read_b64_tr_b16 v[130:131], v2 offset:39168
  s_waitcnt vmcnt(23) lgkmcnt(12)
  v_mfma_f32_32x32x16_bf16 v[16:31], v[104:107], a[140:143], v[16:31]
  ds_read_b64_tr_b16 v[132:133], v3 offset:38912
  ds_read_b64_tr_b16 v[134:135], v3 offset:39168
  s_waitcnt lgkmcnt(12)
  v_mfma_f32_32x32x16_bf16 v[32:47], v[108:111], a[140:143], v[32:47]
  s_add_u32 m0, s87, 143360
  s_add_u32 s69, s88, 143360
  buffer_load_dwordx4 v13, s[8:11], s69 offen sc1 lds
  ds_read_b64_tr_b16 v[136:137], v2 offset:39936
  ds_read_b64_tr_b16 v[138:139], v2 offset:40192
  s_waitcnt vmcnt(22) lgkmcnt(12)
  v_mfma_f32_32x32x16_bf16 v[16:31], v[112:115], a[144:147], v[16:31]
  ds_read_b64_tr_b16 v[140:141], v3 offset:39936
  ds_read_b64_tr_b16 v[142:143], v3 offset:40192
  s_waitcnt lgkmcnt(12)
  v_mfma_f32_32x32x16_bf16 v[32:47], v[116:119], a[144:147], v[32:47]
  s_add_u32 m0, s87, 147456
  s_add_u32 s69, s88, 147456
  buffer_load_dwordx4 v13, s[8:11], s69 offen sc1 lds
  s_waitcnt vmcnt(21) lgkmcnt(10)
  v_mfma_f32_32x32x16_bf16 v[16:31], v[120:123], a[148:151], v[16:31]
  s_waitcnt lgkmcnt(8)
  v_mfma_f32_32x32x16_bf16 v[32:47], v[124:127], a[148:151], v[32:47]
  s_add_u32 m0, s87, 149504
  s_add_u32 s69, s88, 149504
  buffer_load_dwordx4 v13, s[8:11], s69 offen sc1 lds
VC10:
  s_waitcnt vmcnt(14)
  v_max3_u32 v6, v188, v190, v192
  s_waitcnt vmcnt(13)
  v_max_u32 v6, v6, v194
  v_cmp_eq_u32 vcc, -1, v6
  s_cbranch_vccnz VR11
VK12:
  v_add_f32 v188, v188, v190
  v_add_f32 v189, v189, v191
  v_add_f32 v192, v192, v194
  v_add_f32 v193, v193, v195
  v_add_f32 v188, v188, v192
  v_add_f32 v189, v189, v193
  v_mov_b32 v190, v188
  v_mov_b32 v191, v189
  s_nop 0
  v_permlane32_swap_b32 v188, v190
  v_permlane32_swap_b32 v189, v191
  v_add_f32 v188, v188, v190
  v_add_f32 v189, v189, v191
  v_mul_f32 v12, 0xbacccccd, v188
  v_mul_f32 v189, 0x3acccccd, v189
  v_fma_f32 v189, -v12, v12, v189
  v_max_f32 v189, 0, v189
  v_add_f32 v189, 0x3727c5ac, v189
  v_rsq_f32 v11, v189
  s_nop 0
  v_mul_f32 v10, 0x3fb8aa3b, v11
  s_waitcnt lgkmcnt(6)
  v_mfma_f32_32x32x16_bf16 v[16:31], v[128:131], a[152:155], v[16:31]
  s_waitcnt lgkmcnt(4)
  v_mfma_f32_32x32x16_bf16 v[32:47], v[132:135], a[152:155], v[32:47]
  s_waitcnt lgkmcnt(2)
  v_mfma_f32_32x32x16_bf16 v[16:31], v[136:139], a[156:159], v[16:31]
  s_waitcnt lgkmcnt(0)
  v_mfma_f32_32x32x16_bf16 v[32:47], v[140:143], a[156:159], v[32:47]
  s_nop 9
  v_pk_fma_f32 v[16:17], v[144:145], v[12:13], v[16:17] op_sel_hi:[1,0,1]
  v_pk_fma_f32 v[18:19], v[146:147], v[12:13], v[18:19] op_sel_hi:[1,0,1]
  v_pk_fma_f32 v[20:21], v[148:149], v[12:13], v[20:21] op_sel_hi:[1,0,1]
  v_pk_fma_f32 v[22:23], v[150:151], v[12:13], v[22:23] op_sel_hi:[1,0,1]
  v_pk_fma_f32 v[24:25], v[152:153], v[12:13], v[24:25] op_sel_hi:[1,0,1]
  v_pk_fma_f32 v[26:27], v[154:155], v[12:13], v[26:27] op_sel_hi:[1,0,1]
  v_pk_fma_f32 v[28:29], v[156:157], v[12:13], v[28:29] op_sel_hi:[1,0,1]
  v_pk_fma_f32 v[30:31], v[158:159], v[12:13], v[30:31] op_sel_hi:[1,0,1]
  v_pk_fma_f32 v[32:33], v[160:161], v[12:13], v[32:33] op_sel_hi:[1,0,1]
  v_pk_fma_f32 v[34:35], v[162:163], v[12:13], v[34:35] op_sel_hi:[1,0,1]
  v_pk_fma_f32 v[36:37], v[164:165], v[12:13], v[36:37] op_sel_hi:[1,0,1]
  v_pk_fma_f32 v[38:39], v[166:167], v[12:13], v[38:39] op_sel_hi:[1,0,1]
  v_pk_fma_f32 v[40:41], v[168:169], v[12:13], v[40:41] op_sel_hi:[1,0,1]
  v_pk_fma_f32 v[42:43], v[170:171], v[12:13], v[42:43] op_sel_hi:[1,0,1]
  v_pk_fma_f32 v[44:45], v[172:173], v[12:13], v[44:45] op_sel_hi:[1,0,1]
  v_pk_fma_f32 v[46:47], v[174:175], v[12:13], v[46:47] op_sel_hi:[1,0,1]
  s_waitcnt vmcnt(0)
  s_barrier
  v_mov_b32 v176, 0x3f803f80
  v_accvgpr_write_b32 a244, v176
  v_accvgpr_write_b32 a245, v176
  v_accvgpr_write_b32 a246, v176
  v_accvgpr_write_b32 a247, v176
  s_lshr_b32 s66, s52, 1
  s_and_b32 s67, s52, 1
  v_cmp_eq_u32 vcc, s67, 1
  s_lshl_b32 s69, s67, 8
  s_sub_u32 s69, 1024, s69
  s_mul_i32 s68, s69, 20
  s_mul_i32 s68, s68, s66
  v_cndmask_b32 v64, v4, v5, vcc
  v_add_u32 v64, s68, v64
  v_mov_b32 v65, s69
  v_lshrrev_b32 v66, 2, v65
  v_add_u32 v66, v66, v64
  v_lshrrev_b32 v67, 5, v1
  v_lshlrev_b32 v67, 6, v67
  s_lshl_b32 s66, s66, 9
  s_lshl_b32 s67, s67, 7
  s_add_u32 s66, s66, s67
  s_add_u32 s66, s66, 160000
  v_add_u32 v67, s66, v67
  v_cvt_pk_bf16_f32 v176, v16, v17
  v_cvt_pk_bf16_f32 v177, v18, v19
  v_cvt_pk_bf16_f32 v178, v20, v21
  v_cvt_pk_bf16_f32 v179, v22, v23
  v_cvt_pk_bf16_f32 v180, v24, v25
  v_cvt_pk_bf16_f32 v181, v26, v27
  v_cvt_pk_bf16_f32 v182, v28, v29
  v_cvt_pk_bf16_f32 v183, v30, v31
  v_cvt_pk_bf16_f32 v184, v32, v33
  v_cvt_pk_bf16_f32 v185, v34, v35
  v_mov_b32 v186, 0
  v_mov_b32 v187, 0
  ds_read_b64_tr_b16 v[96:97], v64
  ds_read_b64_tr_b16 v[98:99], v66
  v_add_u32 v64, v65, v64
  v_add_u32 v66, v65, v66
  ds_read_b64_tr_b16 v[100:101], v64
  ds_read_b64_tr_b16 v[102:103], v66
  v_add_u32 v64, v65, v64
  v_add_u32 v66, v65, v66
  ds_read_b64_tr_b16 v[104:105], v64
  ds_read_b64_tr_b16 v[106:107], v66
  v_add_u32 v64, v65, v64
  v_add_u32 v66, v65, v66
  ds_read_b64_tr_b16 v[108:109], v64
  ds_read_b64_tr_b16 v[110:111], v66
  v_add_u32 v64, v65, v64
  v_add_u32 v66, v65, v66
  ds_read_b64_tr_b16 v[112:113], v64
  ds_read_b64_tr_b16 v[114:115], v66
  v_add_u32 v64, v65, v64
  v_add_u32 v66, v65, v66
  s_waitcnt lgkmcnt(8)
  v_mfma_f32_32x32x16_bf16 a[208:223], v[96:99], a[244:247], 0
  v_mfma_f32_32x32x16_bf16 v[144:159], a[160:163], v[176:179], 0
  v_mfma_f32_32x32x16_bf16 v[160:175], a[172:175], v[176:179], 0
  buffer_store_dwordx4 a[240:243], v224, s[8:11], s74 offen sc1
  ds_read_b64_tr_b16 v[116:117], v64
  ds_read_b64_tr_b16 v[118:119], v66
  v_add_u32 v64, v65, v64
  v_add_u32 v66, v65, v66
  s_waitcnt lgkmcnt(8)
  v_mfma_f32_32x32x16_bf16 a[208:223], v[100:103], a[244:247], a[208:223]
  v_mfma_f32_32x32x16_bf16 v[144:159], a[164:167], v[180:183], v[144:159]
  v_mfma_f32_32x32x16_bf16 v[160:175], a[176:179], v[180:183], v[160:175]
  ds_read_b64_tr_b16 v[120:121], v64
  ds_read_b64_tr_b16 v[122:123], v66
  v_add_u32 v64, v65, v64
  v_add_u32 v66, v65, v66
  s_waitcnt lgkmcnt(8)
  v_mfma_f32_32x32x16_bf16 a[208:223], v[104:107], a[244:247], a[208:223]
  v_mfma_f32_32x32x16_bf16 v[144:159], a[168:171], v[184:187], v[144:159]
  v_mfma_f32_32x32x16_bf16 v[160:175], a[180:183], v[184:187], v[160:175]
  ds_read_b64_tr_b16 v[124:125], v64
  ds_read_b64_tr_b16 v[126:127], v66
  v_add_u32 v64, v65, v64
  v_add_u32 v66, v65, v66
  s_waitcnt lgkmcnt(8)
  v_mfma_f32_32x32x16_bf16 a[208:223], v[108:111], a[244:247], a[208:223]
  buffer_store_dwordx4 a[240:243], v224, s[8:11], s74 offen offset:256 sc1
  ds_read_b64_tr_b16 v[128:129], v64
  ds_read_b64_tr_b16 v[130:131], v66
  v_add_u32 v64, v65, v64
  v_add_u32 v66, v65, v66
  s_waitcnt lgkmcnt(8)
  v_mfma_f32_32x32x16_bf16 a[208:223], v[112:115], a[244:247], a[208:223]
  v_max3_f32 v6, v144, v145, v146
  v_min3_f32 v8, v144, v145, v146
  v_max3_f32 v6, v6, v147, v148
  v_min3_f32 v8, v8, v147, v148
  ds_read_b64_tr_b16 v[132:133], v64
  ds_read_b64_tr_b16 v[134:135], v66
  v_add_u32 v64, v65, v64
  v_add_u32 v66, v65, v66
  s_waitcnt lgkmcnt(8)
  v_mfma_f32_32x32x16_bf16 a[208:223], v[116:119], a[244:247], a[208:223]
  v_max3_f32 v6, v6, v149, v150
  v_min3_f32 v8, v8, v149, v150
  v_max3_f32 v6, v6, v151, v152
  v_min3_f32 v8, v8, v151, v152
  ds_read_b64_tr_b16 v[136:137], v64
  ds_read_b64_tr_b16 v[138:139], v66
  v_add_u32 v64, v65, v64
  v_add_u32 v66, v65, v66
  s_waitcnt lgkmcnt(8)
  v_mfma_f32_32x32x16_bf16 a[208:223], v[120:123], a[244:247], a[208:223]
  v_max3_f32 v6, v6, v153, v154
  v_min3_f32 v8, v8, v153, v154
  v_max3_f32 v6, v6, v155, v156
  v_min3_f32 v8, v8, v155, v156
  ds_read_b64_tr_b16 v[140:141], v64
  ds_read_b64_tr_b16 v[142:143], v66
  v_add_u32 v64, v65, v64
  v_add_u32 v66, v65, v66
  s_waitcnt lgkmcnt(8)
  v_mfma_f32_32x32x16_bf16 a[208:223], v[124:127], a[244:247], a[208:223]
  v_max3_f32 v6, v6, v157, v158
  v_min3_f32 v8, v8, v157, v158
  v_max3_f32 v6, v6, v159, v160
  v_min3_f32 v8, v8, v159, v160
  buffer_store_dwordx2 a[240:241], v225, s[8:11], s74 offen offset:512 sc1
  ds_read_b64_tr_b16 v[96:97], v64
  ds_read_b64_tr_b16 v[98:99], v66
  v_add_u32 v64, v65, v64
  v_add_u32 v66, v65, v66
  s_waitcnt lgkmcnt(8)
  v_mfma_f32_32x32x16_bf16 a[208:223], v[128:131], a[244:247], a[208:223]
  v_max3_f32 v6, v6, v161, v162
  v_min3_f32 v8, v8, v161, v162
  v_max_f32 v6, v6, v163
  v_min_f32 v8, v8, v163
  ds_read_b64_tr_b16 v[100:101], v64
  ds_read_b64_tr_b16 v[102:103], v66
  v_add_u32 v64, v65, v64
  v_add_u32 v66, v65, v66
  s_waitcnt lgkmcnt(8)
  v_mfma_f32_32x32x16_bf16 a[208:223], v[132:135], a[244:247], a[208:223]
  v_mul_f32 v6, v6, v10
  v_mul_f32 v8, v8, v10
  v_fma_f32 v188, v144, v10, -v6
  v_fma_f32 v208, v144, -v10, v8
  ds_read_b64_tr_b16 v[104:105], v64
  ds_read_b64_tr_b16 v[106:107], v66
  v_add_u32 v64, v65, v64
  v_add_u32 v66, v65, v66
  s_waitcnt lgkmcnt(8)
  v_mfma_f32_32x32x16_bf16 a[208:223], v[136:139], a[244:247], a[208:223]
  v_fma_f32 v189, v145, v10, -v6
  v_fma_f32 v209, v145, -v10, v8
  v_exp_f32 v188, v188
  v_exp_f32 v208, v208
  s_add_u32 s75, s62, 6291456
  buffer_store_dwordx4 a[240:243], v13, s[8:11], s75 offen sc1
  ds_read_b64_tr_b16 v[108:109], v64
  ds_read_b64_tr_b16 v[110:111], v66
  v_add_u32 v64, v65, v64
  v_add_u32 v66, v65, v66
  s_waitcnt lgkmcnt(8)
  v_mfma_f32_32x32x16_bf16 a[208:223], v[140:143], a[244:247], a[208:223]
  v_fma_f32 v190, v146, v10, -v6
  v_fma_f32 v210, v146, -v10, v8
  v_exp_f32 v189, v189
  v_exp_f32 v209, v209
  ds_read_b64_tr_b16 v[112:113], v64
  ds_read_b64_tr_b16 v[114:115], v66
  v_add_u32 v64, v65, v64
  v_add_u32 v66, v65, v66
  s_waitcnt lgkmcnt(8)
  v_mfma_f32_32x32x16_bf16 a[208:223], v[96:99], a[244:247], a[208:223]
  v_fma_f32 v191, v147, v10, -v6
  v_fma_f32 v211, v147, -v10, v8
  v_exp_f32 v190, v190
  v_exp_f32 v210, v210
  ds_read_b64_tr_b16 v[116:117], v64
  ds_read_b64_tr_b16 v[118:119], v66
  v_add_u32 v64, v65, v64
  v_add_u32 v66, v65, v66
  s_waitcnt lgkmcnt(8)
  v_mfma_f32_32x32x16_bf16 a[208:223], v[100:103], a[244:247], a[208:223]
  v_add_f32 v7, v188, v189
  v_add_f32 v9, v208, v209
  v_fma_f32 v192, v148, v10, -v6
  v_fma_f32 v212, v148, -v10, v8
  ds_read_b64_tr_b16 v[120:121], v64
  ds_read_b64_tr_b16 v[122:123], v66
  v_add_u32 v64, v65, v64
  v_add_u32 v66, v65, v66
  s_waitcnt lgkmcnt(8)
  v_mfma_f32_32x32x16_bf16 a[208:223], v[104:107], a[244:247], a[208:223]
  v_exp_f32 v191, v191
  v_exp_f32 v211, v211
  v_add_f32 v7, v7, v190
  v_add_f32 v9, v9, v210
  s_add_u32 s75, s62, 7340032
  buffer_store_dwordx4 a[240:243], v13, s[8:11], s75 offen sc1
  ds_read_b64_tr_b16 v[124:125], v64
  ds_read_b64_tr_b16 v[126:127], v66
  v_add_u32 v64, v65, v64
  v_add_u32 v66, v65, v66
  s_waitcnt lgkmcnt(8)
  v_mfma_f32_32x32x16_bf16 a[208:223], v[108:111], a[244:247], a[208:223]
  v_fma_f32 v193, v149, v10, -v6
  v_fma_f32 v213, v149, -v10, v8
  v_exp_f32 v192, v192
  v_exp_f32 v212, v212
  ds_read_b64_tr_b16 v[80:81], v4 offset:0
  ds_read_b64_tr_b16 v[82:83], v4 offset:256
  ds_read_b64_tr_b16 v[84:85], v4 offset:1024
  ds_read_b64_tr_b16 v[86:87], v4 offset:1280
  ds_read_b64_tr_b16 v[88:89], v4 offset:2048
  ds_read_b64_tr_b16 v[90:91], v4 offset:2304
  ds_read_b64_tr_b16 v[92:93], v4 offset:3072
  ds_read_b64_tr_b16 v[94:95], v4 offset:3328
  s_waitcnt lgkmcnt(14)
  v_mfma_f32_32x32x16_bf16 a[208:223], v[112:115], a[244:247], a[208:223]
  v_add_f32 v7, v7, v191
  v_add_f32 v9, v9, v211
  v_fma_f32 v194, v150, v10, -v6
  v_fma_f32 v214, v150, -v10, v8
  s_waitcnt lgkmcnt(12)
  v_mfma_f32_32x32x16_bf16 a[208:223], v[116:119], a[244:247], a[208:223]
  v_exp_f32 v193, v193
  v_exp_f32 v213, v213
  v_add_f32 v7, v7, v192
  v_add_f32 v9, v9, v212
  s_waitcnt lgkmcnt(10)
  v_mfma_f32_32x32x16_bf16 a[208:223], v[120:123], a[244:247], a[208:223]
  v_fma_f32 v195, v151, v10, -v6
  v_fma_f32 v215, v151, -v10, v8
  v_exp_f32 v194, v194
  v_exp_f32 v214, v214
  s_add_u32 s75, s62, 8388608
  buffer_store_dwordx4 a[240:243], v13, s[8:11], s75 offen sc1
  s_waitcnt lgkmcnt(8)
  v_mfma_f32_32x32x16_bf16 a[208:223], v[124:127], a[244:247], a[208:223]
  v_add_f32 v7, v7, v193
  v_add_f32 v9, v9, v213
  v_fma_f32 v196, v152, v10, -v6
  v_fma_f32 v216, v152, -v10, v8
  ds_read_b64_tr_b16 v[96:97], v4 offset:4096
  ds_read_b64_tr_b16 v[98:99], v4 offset:4352
  s_waitcnt lgkmcnt(8)
  v_mfma_f32_32x32x16_bf16 v[48:63], v[80:83], a[0:3], 0
  v_exp_f32 v195, v195
  v_exp_f32 v215, v215
  v_add_f32 v7, v7, v194
  v_add_f32 v9, v9, v214
  ds_read_b64_tr_b16 v[100:101], v4 offset:5120
  ds_read_b64_tr_b16 v[102:103], v4 offset:5376
  s_waitcnt lgkmcnt(8)
  v_mfma_f32_32x32x16_bf16 v[48:63], v[84:87], a[4:7], v[48:63]
  v_fma_f32 v197, v153, v10, -v6
  v_fma_f32 v217, v153, -v10, v8
  v_exp_f32 v196, v196
  v_exp_f32 v216, v216
  ds_write_b128 v67, a[208:211] offset:0
  ds_write_b128 v67, a[212:215] offset:16
  ds_write_b128 v67, a[216:219] offset:32
  ds_write_b128 v67, a[220:223] offset:48
  ds_read_b64_tr_b16 v[104:105], v4 offset:6144
  ds_read_b64_tr_b16 v[106:107], v4 offset:6400
  s_waitcnt lgkmcnt(12)
  v_mfma_f32_32x32x16_bf16 v[48:63], v[88:91], a[8:11], v[48:63]
  v_add_f32 v7, v7, v195
  v_add_f32 v9, v9, v215
  v_fma_f32 v198, v154, v10, -v6
  v_fma_f32 v218, v154, -v10, v8
  ds_read_b64_tr_b16 v[108:109], v4 offset:7168
  ds_read_b64_tr_b16 v[110:111], v4 offset:7424
  s_waitcnt lgkmcnt(12)
  v_mfma_f32_32x32x16_bf16 v[48:63], v[92:95], a[12:15], v[48:63]
  v_exp_f32 v197, v197
  v_exp_f32 v217, v217
  v_add_f32 v7, v7, v196
  v_add_f32 v9, v9, v216
  ds_read_b64_tr_b16 v[112:113], v4 offset:8192
  ds_read_b64_tr_b16 v[114:115], v4 offset:8448
  s_waitcnt lgkmcnt(12)
  v_mfma_f32_32x32x16_bf16 v[48:63], v[96:99], a[16:19], v[48:63]
  v_fma_f32 v199, v155, v10, -v6
  v_fma_f32 v219, v155, -v10, v8
  v_exp_f32 v198, v198
  v_exp_f32 v218, v218
  ds_read_b64_tr_b16 v[116:117], v4 offset:9216
  ds_read_b64_tr_b16 v[118:119], v4 offset:9472
  s_waitcnt lgkmcnt(12)
  v_mfma_f32_32x32x16_bf16 v[48:63], v[100:103], a[20:23], v[48:63]
  v_add_f32 v7, v7, v197
  v_add_f32 v9, v9, v217
  v_fma_f32 v200, v156, v10, -v6
  v_fma_f32 v220, v156, -v10, v8
  s_lshr_b32 s79, s2, 3
  s_lshl_b32 s79, s79, 2
  s_add_u32 s79, s79, s52
  s_mul_i32 s79, s79, 49152
  s_bfe_u32 s78, s2, 0x20001
  s_mul_i32 s78, s78, 768
  s_add_u32 s79, s79, s78
  v_lshrrev_b32 v252, 1, v1
  v_mul_u32_u24 v252, 24, v252
  v_and_or_b32 v252, v1, 1, v252
  v_lshlrev_b32 v252, 7, v252
  v_lshrrev_b32 v253, 5, v1
  v_lshl_or_b32 v252, v253, 30, v252
  buffer_load_dword a255, v252, s[28:31], s79 offen offset:0
  ds_read_b64_tr_b16 v[120:121], v4 offset:10240
  ds_read_b64_tr_b16 v[122:123], v4 offset:10496
  s_waitcnt lgkmcnt(8)
  v_mfma_f32_32x32x16_bf16 v[48:63], v[104:107], a[24:27], v[48:63]
  v_exp_f32 v199, v199
  v_exp_f32 v219, v219
  v_add_f32 v7, v7, v198
  v_add_f32 v9, v9, v218
  ds_read_b64_tr_b16 v[124:125], v4 offset:11264
  ds_read_b64_tr_b16 v[126:127], v4 offset:11520
  s_waitcnt lgkmcnt(8)
  v_mfma_f32_32x32x16_bf16 v[48:63], v[108:111], a[28:31], v[48:63]
  v_fma_f32 v201, v157, v10, -v6
  v_fma_f32 v221, v157, -v10, v8
  v_exp_f32 v200, v200
  v_exp_f32 v220, v220
  ds_read_b64_tr_b16 v[128:129], v4 offset:12288
  ds_read_b64_tr_b16 v[130:131], v4 offset:12544
  s_waitcnt lgkmcnt(8)
  v_mfma_f32_32x32x16_bf16 v[48:63], v[112:115], a[32:35], v[48:63]
  v_add_f32 v7, v7, v199
  v_add_f32 v9, v9, v219
  v_fma_f32 v202, v158, v10, -v6
  v_fma_f32 v222, v158, -v10, v8
  ds_read_b64_tr_b16 v[132:133], v4 offset:13312
  ds_read_b64_tr_b16 v[134:135], v4 offset:13568
  s_waitcnt lgkmcnt(8)
  v_mfma_f32_32x32x16_bf16 v[48:63], v[116:119], a[36:39], v[48:63]
  v_exp_f32 v201, v201
  v_exp_f32 v221, v221
  v_add_f32 v7, v7, v200
  v_add_f32 v9, v9, v220
  ds_read_b64_tr_b16 v[136:137], v4 offset:14336
  ds_read_b64_tr_b16 v[138:139], v4 offset:14592
  s_waitcnt lgkmcnt(8)
  v_mfma_f32_32x32x16_bf16 v[48:63], v[120:123], a[40:43], v[48:63]
  v_fma_f32 v203, v159, v10, -v6
  v_fma_f32 v223, v159, -v10, v8
  v_exp_f32 v202, v202
  v_exp_f32 v222, v222
  ds_read_b64_tr_b16 v[140:141], v4 offset:15360
  ds_read_b64_tr_b16 v[142:143], v4 offset:15616
  s_waitcnt lgkmcnt(8)
  v_mfma_f32_32x32x16_bf16 v[48:63], v[124:127], a[44:47], v[48:63]
  v_add_f32 v7, v7, v201
  v_add_f32 v9, v9, v221
  v_fma_f32 v204, v160, v10, -v6
  v_fma_f32 v224, v160, -v10, v8
  ds_read_b64_tr_b16 v[80:81], v4 offset:16384
  ds_read_b64_tr_b16 v[82:83], v4 offset:16640
  s_waitcnt lgkmcnt(8)
  v_mfma_f32_32x32x16_bf16 v[48:63], v[128:131], a[48:51], v[48:63]
  v_exp_f32 v203, v203
  v_exp_f32 v223, v223
  v_add_f32 v7, v7, v202
  v_add_f32 v9, v9, v222
  ds_read_b64_tr_b16 v[84:85], v4 offset:17408
  ds_read_b64_tr_b16 v[86:87], v4 offset:17664
  s_waitcnt lgkmcnt(8)
  v_mfma_f32_32x32x16_bf16 v[48:63], v[132:135], a[52:55], v[48:63]
  v_fma_f32 v205, v161, v10, -v6
  v_fma_f32 v225, v161, -v10, v8
  v_exp_f32 v204, v204
  v_exp_f32 v224, v224
  ds_read_b64_tr_b16 v[88:89], v4 offset:18432
  ds_read_b64_tr_b16 v[90:91], v4 offset:18688
  s_waitcnt lgkmcnt(8)
  v_mfma_f32_32x32x16_bf16 v[48:63], v[136:139], a[56:59], v[48:63]
  v_add_f32 v7, v7, v203
  v_add_f32 v9, v9, v223
  v_fma_f32 v206, v162, v10, -v6
  v_fma_f32 v226, v162, -v10, v8
  ds_read_b64_tr_b16 v[92:93], v4 offset:19456
  ds_read_b64_tr_b16 v[94:95], v4 offset:19712
  s_waitcnt lgkmcnt(8)
  v_mfma_f32_32x32x16_bf16 v[48:63], v[140:143], a[60:63], v[48:63]
  v_exp_f32 v205, v205
  v_exp_f32 v225, v225
  v_add_f32 v7, v7, v204
  v_add_f32 v9, v9, v224
  s_barrier
  ds_read_b64_tr_b16 v[96:97], v4 offset:20480
  ds_read_b64_tr_b16 v[98:99], v4 offset:20736
  s_waitcnt lgkmcnt(8)
  v_mfma_f32_32x32x16_bf16 v[48:63], v[80:83], a[64:67], v[48:63]
  v_fma_f32 v207, v163, v10, -v6
  v_fma_f32 v227, v163, -v10, v8
  v_exp_f32 v206, v206
  v_exp_f32 v226, v226
  ds_read_b64_tr_b16 v[100:101], v4 offset:21504
  ds_read_b64_tr_b16 v[102:103], v4 offset:21760
  s_waitcnt lgkmcnt(8)
  v_mfma_f32_32x32x16_bf16 v[48:63], v[84:87], a[68:71], v[48:63]
  v_add_f32 v7, v7, v205
  v_add_f32 v9, v9, v225
  v_exp_f32 v207, v207
  v_exp_f32 v227, v227
  ds_read_b64_tr_b16 v[104:105], v4 offset:22528
  ds_read_b64_tr_b16 v[106:107], v4 offset:22784
  s_waitcnt lgkmcnt(8)
  v_mfma_f32_32x32x16_bf16 v[48:63], v[88:91], a[72:75], v[48:63]
  v_add_f32 v7, v7, v206
  v_add_f32 v9, v9, v226
  v_mov_b32 v6, v207
  v_mov_b32 v8, v227
  ds_read_b64_tr_b16 v[108:109], v4 offset:23552
  ds_read_b64_tr_b16 v[110:111], v4 offset:23808
  s_waitcnt lgkmcnt(8)
  v_mfma_f32_32x32x16_bf16 v[48:63], v[92:95], a[76:79], v[48:63]
  v_add_f32 v6, v6, v7
  v_add_f32 v8, v8, v9
  v_rcp_f32 v6, v6
  v_rcp_f32 v8, v8
  ds_read_b64_tr_b16 v[112:113], v4 offset:24576
  ds_read_b64_tr_b16 v[114:115], v4 offset:24832
  s_waitcnt lgkmcnt(8)
  v_mfma_f32_32x32x16_bf16 v[48:63], v[96:99], a[80:83], v[48:63]
  v_mul_f32 v188, v188, v6
  v_mul_f32 v189, v189, v6
  v_mul_f32 v190, v190, v6
  v_mul_f32 v191, v191, v6
  ds_read_b64_tr_b16 v[116:117], v4 offset:25600
  ds_read_b64_tr_b16 v[118:119], v4 offset:25856
  s_waitcnt lgkmcnt(8)
  v_mfma_f32_32x32x16_bf16 v[48:63], v[100:103], a[84:87], v[48:63]
  v_cvt_pk_bf16_f32 v228, v188, v189
  v_mul_f32 v192, v192, v6
  v_mul_f32 v193, v193, v6
  v_cvt_pk_bf16_f32 v229, v190, v191
  ds_read_b64_tr_b16 v[120:121], v4 offset:26624
  ds_read_b64_tr_b16 v[122:123], v4 offset:26880
  s_waitcnt lgkmcnt(8)
  v_mfma_f32_32x32x16_bf16 v[48:63], v[104:107], a[88:91], v[48:63]
  v_mul_f32 v194, v194, v6
  v_mul_f32 v195, v195, v6
  v_cvt_pk_bf16_f32 v236, v192, v193
  v_mul_f32 v196, v196, v6
  ds_read_b64_tr_b16 v[124:125], v4 offset:27648
  ds_read_b64_tr_b16 v[126:127], v4 offset:27904
  s_waitcnt lgkmcnt(8)
  v_mfma_f32_32x32x16_bf16 v[48:63], v[108:111], a[92:95], v[48:63]
  v_mul_f32 v197, v197, v6
  v_cvt_pk_bf16_f32 v237, v194, v195
  v_mul_f32 v198, v198, v6
  v_mul_f32 v199, v199, v6
  ds_read_b64_tr_b16 v[128:129], v4 offset:28672
  ds_read_b64_tr_b16 v[130:131], v4 offset:28928
  s_waitcnt lgkmcnt(8)
  v_mfma_f32_32x32x16_bf16 v[48:63], v[112:115], a[96:99], v[48:63]
  v_cvt_pk_bf16_f32 v230, v196, v197
  v_mul_f32 v200, v200, v6
  v_mul_f32 v201, v201, v6
  v_cvt_pk_bf16_f32 v231, v198, v199
  ds_read_b64_tr_b16 v[132:133], v4 offset:29696
  ds_read_b64_tr_b16 v[134:135], v4 offset:29952
  s_waitcnt lgkmcnt(8)
  v_mfma_f32_32x32x16_bf16 v[48:63], v[116:119], a[100:103], v[48:63]
  v_mul_f32 v202, v202, v6
  v_mul_f32 v203, v203, v6
  v_cvt_pk_bf16_f32 v238, v200, v201
  v_mul_f32 v204, v204, v6
  ds_read_b64_tr_b16 v[136:137], v4 offset:30720
  ds_read_b64_tr_b16 v[138:139], v4 offset:30976
  s_waitcnt lgkmcnt(8)
  v_mfma_f32_32x32x16_bf16 v[48:63], v[120:123], a[104:107], v[48:63]
  v_mul_f32 v205, v205, v6
  v_cvt_pk_bf16_f32 v239, v202, v203
  v_mul_f32 v206, v206, v6
  v_mul_f32 v207, v207, v6
  ds_read_b64_tr_b16 v[140:141], v4 offset:31744
  ds_read_b64_tr_b16 v[142:143], v4 offset:32000
  s_waitcnt lgkmcnt(8)
  v_mfma_f32_32x32x16_bf16 v[48:63], v[124:127], a[108:111], v[48:63]
  v_cvt_pk_bf16_f32 v232, v204, v205
  v_mul_f32 v208, v208, v8
  v_mul_f32 v209, v209, v8
  v_cvt_pk_bf16_f32 v233, v206, v207
  ds_read_b64_tr_b16 v[80:81], v4 offset:32768
  ds_read_b64_tr_b16 v[82:83], v4 offset:33024
  s_waitcnt lgkmcnt(8)
  v_mfma_f32_32x32x16_bf16 v[48:63], v[128:131], a[112:115], v[48:63]
  v_lshrrev_b32 v68, 5, v1
  v_lshlrev_b32 v68, 6, v68
  v_add_u32 v68, 159744, v68
  ds_read_b128 v[144:147], v68 offset:256
  ds_read_b64_tr_b16 v[84:85], v4 offset:33792
  ds_read_b64_tr_b16 v[86:87], v4 offset:34048
  s_waitcnt lgkmcnt(9)
  v_mfma_f32_32x32x16_bf16 v[48:63], v[132:135], a[116:119], v[48:63]
  ds_read_b128 v[160:163], v68 offset:768
  ds_read_b128 v[148:151], v68 offset:272
  ds_read_b128 v[164:167], v68 offset:784
  ds_read_b128 v[152:155], v68 offset:288
  ds_read_b64_tr_b16 v[88:89], v4 offset:34816
  ds_read_b64_tr_b16 v[90:91], v4 offset:35072
  s_waitcnt lgkmcnt(13)
  v_mfma_f32_32x32x16_bf16 v[48:63], v[136:139], a[120:123], v[48:63]
  ds_read_b128 v[168:171], v68 offset:800
  ds_read_b128 v[156:159], v68 offset:304
  ds_read_b128 v[172:175], v68 offset:816
  v_mul_f32 v210, v210, v8
  ds_read_b64_tr_b16 v[92:93], v4 offset:35840
  ds_read_b64_tr_b16 v[94:95], v4 offset:36096
  s_waitcnt lgkmcnt(15)
  v_mfma_f32_32x32x16_bf16 v[48:63], v[140:143], a[124:127], v[48:63]
  v_mul_f32 v211, v211, v8
  v_cvt_pk_bf16_f32 v240, v208, v209
  v_mul_f32 v212, v212, v8
  v_mul_f32 v213, v213, v8
  ds_read_b64_tr_b16 v[96:97], v4 offset:36864
  ds_read_b64_tr_b16 v[98:99], v4 offset:37120
  s_waitcnt lgkmcnt(15)
  v_mfma_f32_32x32x16_bf16 v[48:63], v[80:83], a[128:131], v[48:63]
  v_cvt_pk_bf16_f32 v241, v210, v211
  v_mul_f32 v214, v214, v8
  v_mul_f32 v215, v215, v8
  v_cvt_pk_bf16_f32 v234, v212, v213
  ds_read_b64_tr_b16 v[100:101], v4 offset:37888
  ds_read_b64_tr_b16 v[102:103], v4 offset:38144
  s_waitcnt lgkmcnt(15)
  v_mfma_f32_32x32x16_bf16 v[48:63], v[84:87], a[132:135], v[48:63]
  v_mul_f32 v216, v216, v8
  v_mul_f32 v217, v217, v8
  v_cvt_pk_bf16_f32 v235, v214, v215
  v_mul_f32 v218, v218, v8
  ds_read_b64_tr_b16 v[104:105], v4 offset:38912
  ds_read_b64_tr_b16 v[106:107], v4 offset:39168
  s_waitcnt lgkmcnt(11)
  v_mfma_f32_32x32x16_bf16 v[48:63], v[88:91], a[136:139], v[48:63]
  v_mul_f32 v219, v219, v8
  v_cvt_pk_bf16_f32 v242, v216, v217
  v_mul_f32 v220, v220, v8
  v_mul_f32 v221, v221, v8
  ds_read_b64_tr_b16 v[108:109], v4 offset:39936
  ds_read_b64_tr_b16 v[110:111], v4 offset:40192
  s_waitcnt lgkmcnt(8)
  v_mfma_f32_32x32x16_bf16 v[48:63], v[92:95], a[140:143], v[48:63]
  v_cvt_pk_bf16_f32 v243, v218, v219
  v_mul_f32 v222, v222, v8
  v_mul_f32 v223, v223, v8
  v_cvt_pk_bf16_f32 v244, v220, v221
  s_waitcnt lgkmcnt(6)
  v_mfma_f32_32x32x16_bf16 v[48:63], v[96:99], a[144:147], v[48:63]
  v_mul_f32 v224, v224, v8
  v_mul_f32 v225, v225, v8
  v_cvt_pk_bf16_f32 v245, v222, v223
  v_mul_f32 v226, v226, v8
  s_waitcnt lgkmcnt(4)
  v_mfma_f32_32x32x16_bf16 v[48:63], v[100:103], a[148:151], v[48:63]
  v_mul_f32 v227, v227, v8
  v_cvt_pk_bf16_f32 v246, v224, v225
  v_cvt_pk_bf16_f32 v247, v226, v227
  v_mul_f32 v36, v36, v11
  s_waitcnt lgkmcnt(2)
  v_mfma_f32_32x32x16_bf16 v[48:63], v[104:107], a[152:155], v[48:63]
  v_mul_f32 v37, v37, v11
  v_mul_f32 v38, v38, v11
  v_mul_f32 v39, v39, v11
  v_mul_f32 v40, v40, v11
  s_waitcnt lgkmcnt(0)
  v_mfma_f32_32x32x16_bf16 v[48:63], v[108:111], a[156:159], v[48:63]
  v_mul_f32 v41, v41, v11
  v_mul_f32 v42, v42, v11
  v_mul_f32 v43, v43, v11
  v_mul_f32 v44, v44, v11
  s_waitcnt vmcnt(0)
  buffer_load_dword a255, v252, s[28:31], s79 offen offset:256
  v_mul_f32 v45, v45, v11
  v_mul_f32 v46, v46, v11
  v_mul_f32 v47, v47, v11
  v_pk_add_f32 v[144:145], v[144:145], v[160:161]
  v_pk_add_f32 v[146:147], v[146:147], v[162:163]
  v_pk_add_f32 v[148:149], v[148:149], v[164:165]
  v_pk_add_f32 v[150:151], v[150:151], v[166:167]
  v_pk_add_f32 v[152:153], v[152:153], v[168:169]
  v_pk_add_f32 v[154:155], v[154:155], v[170:171]
  v_pk_add_f32 v[156:157], v[156:157], v[172:173]
  v_pk_add_f32 v[158:159], v[158:159], v[174:175]
  v_pk_fma_f32 v[48:49], v[144:145], v[12:13], v[48:49] op_sel_hi:[1,0,1]
  v_pk_fma_f32 v[50:51], v[146:147], v[12:13], v[50:51] op_sel_hi:[1,0,1]
  v_pk_fma_f32 v[52:53], v[148:149], v[12:13], v[52:53] op_sel_hi:[1,0,1]
  v_pk_fma_f32 v[54:55], v[150:151], v[12:13], v[54:55] op_sel_hi:[1,0,1]
  v_pk_fma_f32 v[56:57], v[152:153], v[12:13], v[56:57] op_sel_hi:[1,0,1]
  v_pk_fma_f32 v[58:59], v[154:155], v[12:13], v[58:59] op_sel_hi:[1,0,1]
  v_pk_fma_f32 v[60:61], v[156:157], v[12:13], v[60:61] op_sel_hi:[1,0,1]
  v_pk_fma_f32 v[62:63], v[158:159], v[12:13], v[62:63] op_sel_hi:[1,0,1]
  v_mul_f32 v48, v48, v11
  v_mul_f32 v49, v49, v11
  v_mul_f32 v50, v50, v11
  v_mul_f32 v51, v51, v11
  v_mul_f32 v52, v52, v11
  v_mul_f32 v53, v53, v11
  v_mul_f32 v54, v54, v11
  v_mul_f32 v55, v55, v11
  v_cvt_pk_bf16_f32 v176, v36, v37
  v_cvt_pk_bf16_f32 v177, v38, v39
  v_cvt_pk_bf16_f32 v178, v40, v41
  v_cvt_pk_bf16_f32 v179, v42, v43
  v_cvt_pk_bf16_f32 v180, v48, v49
  v_cvt_pk_bf16_f32 v181, v50, v51
  v_cvt_pk_bf16_f32 v182, v52, v53
  v_cvt_pk_bf16_f32 v183, v54, v55
  v_cvt_pk_bf16_f32 v184, v44, v45
  v_cvt_pk_bf16_f32 v185, v46, v47
  v_mov_b32 v186, 0x3f80
  v_mov_b32 v187, 0
  v_accvgpr_read_b32 v6, a194
  ds_write_b128 v6, v[228:231] offset:0
  ds_write_b128 v6, v[232:235] offset:16
  ds_write_b128 v6, v[236:239] offset:4096
  ds_write_b128 v6, v[240:243] offset:4112
  ds_write_b128 v6, v[244:247] offset:8192
  ds_write_b128 v6, v[176:179] offset:12288
  ds_write_b128 v6, v[180:183] offset:12304
  ds_write_b128 v6, v[184:187] offset:16384
  s_nop 1
  v_accvgpr_read_b32 v6, a195
  v_accvgpr_read_b32 v7, a196
  s_waitcnt lgkmcnt(0)
  s_barrier
  ds_read_b64_tr_b16 v[80:81], v7 offset:0
  ds_read_b64_tr_b16 v[82:83], v7 offset:512
  ds_read_b64_tr_b16 v[84:85], v6 offset:0
  ds_read_b64_tr_b16 v[86:87], v6 offset:512
  ds_read_b64_tr_b16 v[88:89], v6 offset:4096
  ds_read_b64_tr_b16 v[90:91], v6 offset:4608
  ds_read_b64_tr_b16 v[92:93], v6 offset:8192
  ds_read_b64_tr_b16 v[94:95], v6 offset:8704
  ds_read_b64_tr_b16 v[96:97], v7 offset:1024
  ds_read_b64_tr_b16 v[98:99], v7 offset:1536
  ds_read_b64_tr_b16 v[100:101], v6 offset:1024
  ds_read_b64_tr_b16 v[102:103], v6 offset:1536
  ds_read_b64_tr_b16 v[104:105], v6 offset:5120
  ds_read_b64_tr_b16 v[106:107], v6 offset:5632
  ds_read_b64_tr_b16 v[108:109], v6 offset:9216
  ds_read_b64_tr_b16 v[110:111], v6 offset:9728
  ds_read_b64_tr_b16 v[112:113], v7 offset:2048
  ds_read_b64_tr_b16 v[114:115], v7 offset:2560
  ds_read_b64_tr_b16 v[116:117], v6 offset:2048
  ds_read_b64_tr_b16 v[118:119], v6 offset:2560
  ds_read_b64_tr_b16 v[120:121], v6 offset:6144
  ds_read_b64_tr_b16 v[122:123], v6 offset:6656
  ds_read_b64_tr_b16 v[124:125], v6 offset:10240
  ds_read_b64_tr_b16 v[126:127], v6 offset:10752
  ds_read_b64_tr_b16 v[128:129], v7 offset:3072
  ds_read_b64_tr_b16 v[130:131], v7 offset:3584
  ds_read_b64_tr_b16 v[132:133], v6 offset:3072
  ds_read_b64_tr_b16 v[134:135], v6 offset:3584
  ds_read_b64_tr_b16 v[136:137], v6 offset:7168
  ds_read_b64_tr_b16 v[138:139], v6 offset:7680
  ds_read_b64_tr_b16 v[140:141], v6 offset:11264
  ds_read_b64_tr_b16 v[142:143], v6 offset:11776
  v_mov_b32 v8, v68
  ds_read_b128 v[64:67], v8 offset:384
  ds_read_b128 v[160:163], v8 offset:896
  ds_read_b128 v[68:71], v8 offset:400
  ds_read_b128 v[164:167], v8 offset:912
  ds_read_b128 v[72:75], v8 offset:416
  ds_read_b128 v[168:171], v8 offset:928
  ds_read_b128 v[76:79], v8 offset:432
  ds_read_b128 v[172:175], v8 offset:944
  v_accvgpr_read_b32 v6, a197
  v_accvgpr_read_b32 v9, a198
  v_accvgpr_read_b32 v14, a199
  v_accvgpr_read_b32 v15, a200
  s_waitcnt lgkmcnt(15)
  v_mfma_f32_16x16x32_bf16 v[144:147], v[84:87], v[80:83], 0
  v_mfma_f32_16x16x32_bf16 v[148:151], v[88:91], v[80:83], 0
  v_mfma_f32_16x16x32_bf16 v[152:155], v[92:95], v[80:83], 0
  v_mfma_f32_16x16x32_bf16 v[144:147], v[100:103], v[96:99], v[144:147]
  v_mfma_f32_16x16x32_bf16 v[148:151], v[104:107], v[96:99], v[148:151]
  v_mfma_f32_16x16x32_bf16 v[152:155], v[108:111], v[96:99], v[152:155]
  v_mfma_f32_16x16x32_bf16 v[144:147], v[116:119], v[112:115], v[144:147]
  v_mfma_f32_16x16x32_bf16 v[148:151], v[120:123], v[112:115], v[148:151]
  v_mfma_f32_16x16x32_bf16 v[152:155], v[124:127], v[112:115], v[152:155]
  s_waitcnt lgkmcnt(12)
  v_mfma_f32_16x16x32_bf16 v[144:147], v[132:135], v[128:131], v[144:147]
  s_waitcnt lgkmcnt(10)
  v_mfma_f32_16x16x32_bf16 v[148:151], v[136:139], v[128:131], v[148:151]
  s_waitcnt lgkmcnt(8)
  v_mfma_f32_16x16x32_bf16 v[152:155], v[140:143], v[128:131], v[152:155]
  s_nop 3
  v_cvt_pk_bf16_f32 v176, v144, v145
  v_cvt_pk_bf16_f32 v177, v146, v147
  v_cvt_pk_bf16_f32 v178, v148, v149
  v_cvt_pk_bf16_f32 v179, v150, v151
  v_cvt_pk_bf16_f32 v180, v152, v153
  v_cvt_pk_bf16_f32 v181, v154, v155
  buffer_store_dwordx4 v[176:179], v6, s[8:11], s92 offen sc1
  buffer_store_dwordx2 v[180:181], v9, s[8:11], s92 offen offset:64 sc1
  s_waitcnt lgkmcnt(6)
  v_pk_add_f32 v[64:65], v[64:65], v[160:161]
  v_pk_add_f32 v[66:67], v[66:67], v[162:163]
  s_waitcnt lgkmcnt(4)
  v_pk_add_f32 v[68:69], v[68:69], v[164:165]
  v_pk_add_f32 v[70:71], v[70:71], v[166:167]
  s_waitcnt lgkmcnt(2)
  v_pk_add_f32 v[72:73], v[72:73], v[168:169]
  v_pk_add_f32 v[74:75], v[74:75], v[170:171]
  s_waitcnt lgkmcnt(0)
  v_pk_add_f32 v[76:77], v[76:77], v[172:173]
  v_pk_add_f32 v[78:79], v[78:79], v[174:175]
  v_pk_mul_f32 v[64:65], v[64:65], v[12:13] op_sel_hi:[1,0]
  v_pk_mul_f32 v[66:67], v[66:67], v[12:13] op_sel_hi:[1,0]
  v_pk_mul_f32 v[68:69], v[68:69], v[12:13] op_sel_hi:[1,0]
  v_pk_mul_f32 v[70:71], v[70:71], v[12:13] op_sel_hi:[1,0]
  v_pk_mul_f32 v[72:73], v[72:73], v[12:13] op_sel_hi:[1,0]
  v_pk_mul_f32 v[74:75], v[74:75], v[12:13] op_sel_hi:[1,0]
  v_pk_mul_f32 v[76:77], v[76:77], v[12:13] op_sel_hi:[1,0]
  v_pk_mul_f32 v[78:79], v[78:79], v[12:13] op_sel_hi:[1,0]
  s_barrier
  buffer_store_dword v14, v15, s[8:11], s93 offen sc1
  s_add_u32 m0, s87, 0
  s_add_u32 s69, s89, 0
  buffer_load_dwordx4 v13, s[8:11], s69 offen sc1 lds
  ds_read_b64_tr_b16 v[80:81], v5 offset:0
  ds_read_b64_tr_b16 v[82:83], v5 offset:192
  ds_read_b64_tr_b16 v[84:85], v5 offset:768
  ds_read_b64_tr_b16 v[86:87], v5 offset:960
  ds_read_b64_tr_b16 v[88:89], v5 offset:1536
  ds_read_b64_tr_b16 v[90:91], v5 offset:1728
  ds_read_b64_tr_b16 v[92:93], v5 offset:2304
  ds_read_b64_tr_b16 v[94:95], v5 offset:2496
  ds_read_b64_tr_b16 v[96:97], v5 offset:3072
  ds_read_b64_tr_b16 v[98:99], v5 offset:3264
  s_waitcnt lgkmcnt(8)
  v_mfma_f32_32x32x16_bf16 v[64:79], v[80:83], a[0:3], v[64:79]
  s_add_u32 m0, s87, 4096
  s_add_u32 s69, s89, 4096
  buffer_load_dwordx4 v13, s[8:11], s69 offen sc1 lds
  ds_read_b64_tr_b16 v[100:101], v5 offset:3840
  ds_read_b64_tr_b16 v[102:103], v5 offset:4032
  s_waitcnt lgkmcnt(8)
  v_mfma_f32_32x32x16_bf16 v[64:79], v[84:87], a[4:7], v[64:79]
  ds_read_b64_tr_b16 v[104:105], v5 offset:4608
  ds_read_b64_tr_b16 v[106:107], v5 offset:4800
  s_waitcnt lgkmcnt(8)
  v_mfma_f32_32x32x16_bf16 v[64:79], v[88:91], a[8:11], v[64:79]
  s_add_u32 m0, s87, 8192
  s_add_u32 s69, s89, 8192
  buffer_load_dwordx4 v13, s[8:11], s69 offen sc1 lds
  ds_read_b64_tr_b16 v[108:109], v5 offset:5376
  ds_read_b64_tr_b16 v[110:111], v5 offset:5568
  s_waitcnt lgkmcnt(8)
  v_mfma_f32_32x32x16_bf16 v[64:79], v[92:95], a[12:15], v[64:79]
  ds_read_b64_tr_b16 v[112:113], v5 offset:6144
  ds_read_b64_tr_b16 v[114:115], v5 offset:6336
  s_waitcnt lgkmcnt(8)
  v_mfma_f32_32x32x16_bf16 v[64:79], v[96:99], a[16:19], v[64:79]
  s_add_u32 m0, s87, 12288
  s_add_u32 s69, s89, 12288
  buffer_load_dwordx4 v13, s[8:11], s69 offen sc1 lds
  ds_read_b64_tr_b16 v[116:117], v5 offset:6912
  ds_read_b64_tr_b16 v[118:119], v5 offset:7104
  s_waitcnt lgkmcnt(8)
  v_mfma_f32_32x32x16_bf16 v[64:79], v[100:103], a[20:23], v[64:79]
  ds_read_b64_tr_b16 v[120:121], v5 offset:7680
  ds_read_b64_tr_b16 v[122:123], v5 offset:7872
  s_waitcnt lgkmcnt(8)
  v_mfma_f32_32x32x16_bf16 v[64:79], v[104:107], a[24:27], v[64:79]
  s_add_u32 m0, s87, 16384
  s_add_u32 s69, s89, 16384
  buffer_load_dwordx4 v13, s[8:11], s69 offen sc1 lds
  ds_read_b64_tr_b16 v[124:125], v5 offset:8448
  ds_read_b64_tr_b16 v[126:127], v5 offset:8640
  s_waitcnt lgkmcnt(8)
  v_mfma_f32_32x32x16_bf16 v[64:79], v[108:111], a[28:31], v[64:79]
  ds_read_b64_tr_b16 v[128:129], v5 offset:9216
  ds_read_b64_tr_b16 v[130:131], v5 offset:9408
  s_waitcnt lgkmcnt(8)
  v_mfma_f32_32x32x16_bf16 v[64:79], v[112:115], a[32:35], v[64:79]
  s_add_u32 m0, s87, 20480
  s_add_u32 s69, s89, 20480
  buffer_load_dwordx4 v13, s[8:11], s69 offen sc1 lds
  ds_read_b64_tr_b16 v[132:133], v5 offset:9984
  ds_read_b64_tr_b16 v[134:135], v5 offset:10176
  s_waitcnt lgkmcnt(8)
  v_mfma_f32_32x32x16_bf16 v[64:79], v[116:119], a[36:39], v[64:79]
  ds_read_b64_tr_b16 v[136:137], v5 offset:10752
  ds_read_b64_tr_b16 v[138:139], v5 offset:10944
  s_waitcnt lgkmcnt(8)
  v_mfma_f32_32x32x16_bf16 v[64:79], v[120:123], a[40:43], v[64:79]
  s_add_u32 m0, s87, 24576
  s_add_u32 s69, s89, 24576
  buffer_load_dwordx4 v13, s[8:11], s69 offen sc1 lds
  ds_read_b64_tr_b16 v[140:141], v5 offset:11520
  ds_read_b64_tr_b16 v[142:143], v5 offset:11712
  s_waitcnt lgkmcnt(8)
  v_mfma_f32_32x32x16_bf16 v[64:79], v[124:127], a[44:47], v[64:79]
  s_add_u32 m0, s87, 28672
  s_add_u32 s69, s89, 28672
  buffer_load_dwordx4 v13, s[8:11], s69 offen sc1 lds
  ds_read_b64_tr_b16 v[80:81], v5 offset:12288
  ds_read_b64_tr_b16 v[82:83], v5 offset:12480
  s_waitcnt lgkmcnt(8)
  v_mfma_f32_32x32x16_bf16 v[64:79], v[128:131], a[48:51], v[64:79]
  ds_read_b64_tr_b16 v[84:85], v5 offset:13056
  ds_read_b64_tr_b16 v[86:87], v5 offset:13248
  s_waitcnt lgkmcnt(8)
  v_mfma_f32_32x32x16_bf16 v[64:79], v[132:135], a[52:55], v[64:79]
  s_add_u32 m0, s87, 32768
  s_add_u32 s69, s89, 32768
  buffer_load_dwordx4 v13, s[8:11], s69 offen sc1 lds
  ds_read_b64_tr_b16 v[88:89], v5 offset:13824
  ds_read_b64_tr_b16 v[90:91], v5 offset:14016
  s_waitcnt lgkmcnt(8)
  v_mfma_f32_32x32x16_bf16 v[64:79], v[136:139], a[56:59], v[64:79]
  ds_read_b64_tr_b16 v[92:93], v5 offset:14592
  ds_read_b64_tr_b16 v[94:95], v5 offset:14784
  s_waitcnt lgkmcnt(8)
  v_mfma_f32_32x32x16_bf16 v[64:79], v[140:143], a[60:63], v[64:79]
  s_add_u32 m0, s87, 36864
  s_add_u32 s69, s89, 36864
  buffer_load_dwordx4 v13, s[8:11], s69 offen sc1 lds
  ds_read_b64_tr_b16 v[96:97], v5 offset:15360
  ds_read_b64_tr_b16 v[98:99], v5 offset:15552
  s_waitcnt lgkmcnt(8)
  v_mfma_f32_32x32x16_bf16 v[64:79], v[80:83], a[64:67], v[64:79]
  ds_read_b64_tr_b16 v[100:101], v5 offset:16128
  ds_read_b64_tr_b16 v[102:103], v5 offset:16320
  s_waitcnt lgkmcnt(8)
  v_mfma_f32_32x32x16_bf16 v[64:79], v[84:87], a[68:71], v[64:79]
  s_add_u32 m0, s87, 40960
  s_add_u32 s69, s89, 40960
  buffer_load_dwordx4 v13, s[8:11], s69 offen sc1 lds
  ds_read_b64_tr_b16 v[104:105], v5 offset:16896
  ds_read_b64_tr_b16 v[106:107], v5 offset:17088
  s_waitcnt lgkmcnt(8)
  v_mfma_f32_32x32x16_bf16 v[64:79], v[88:91], a[72:75], v[64:79]
  ds_read_b64_tr_b16 v[108:109], v5 offset:17664
  ds_read_b64_tr_b16 v[110:111], v5 offset:17856
  s_waitcnt lgkmcnt(8)
  v_mfma_f32_32x32x16_bf16 v[64:79], v[92:95], a[76:79], v[64:79]
  s_add_u32 m0, s87, 45056
  s_add_u32 s69, s89, 45056
  buffer_load_dwordx4 v13, s[8:11], s69 offen sc1 lds
  ds_read_b64_tr_b16 v[112:113], v5 offset:18432
  ds_read_b64_tr_b16 v[114:115], v5 offset:18624
  s_waitcnt lgkmcnt(8)
  v_mfma_f32_32x32x16_bf16 v[64:79], v[96:99], a[80:83], v[64:79]
  ds_read_b64_tr_b16 v[116:117], v5 offset:19200
  ds_read_b64_tr_b16 v[118:119], v5 offset:19392
  s_waitcnt lgkmcnt(8)
  v_mfma_f32_32x32x16_bf16 v[64:79], v[100:103], a[84:87], v[64:79]
  s_add_u32 m0, s87, 49152
  s_add_u32 s69, s89, 49152
  buffer_load_dwordx4 v13, s[8:11], s69 offen sc1 lds
  ds_read_b64_tr_b16 v[120:121], v5 offset:19968
  ds_read_b64_tr_b16 v[122:123], v5 offset:20160
  s_waitcnt lgkmcnt(8)
  v_mfma_f32_32x32x16_bf16 v[64:79], v[104:107], a[88:91], v[64:79]
  s_add_u32 m0, s87, 53248
  s_add_u32 s69, s89, 53248
  buffer_load_dwordx4 v13, s[8:11], s69 offen sc1 lds
  ds_read_b64_tr_b16 v[124:125], v5 offset:20736
  ds_read_b64_tr_b16 v[126:127], v5 offset:20928
  s_waitcnt lgkmcnt(8)
  v_mfma_f32_32x32x16_bf16 v[64:79], v[108:111], a[92:95], v[64:79]
  ds_read_b64_tr_b16 v[128:129], v5 offset:21504
  ds_read_b64_tr_b16 v[130:131], v5 offset:21696
  s_waitcnt lgkmcnt(8)
  v_mfma_f32_32x32x16_bf16 v[64:79], v[112:115], a[96:99], v[64:79]
  s_add_u32 m0, s87, 57344
  s_add_u32 s69, s89, 57344
  buffer_load_dwordx4 v13, s[8:11], s69 offen sc1 lds
  ds_read_b64_tr_b16 v[132:133], v5 offset:22272
  ds_read_b64_tr_b16 v[134:135], v5 offset:22464
  s_waitcnt lgkmcnt(8)
  v_mfma_f32_32x32x16_bf16 v[64:79], v[116:119], a[100:103], v[64:79]
  ds_read_b64_tr_b16 v[136:137], v5 offset:23040
  ds_read_b64_tr_b16 v[138:139], v5 offset:23232
  s_waitcnt lgkmcnt(8)
  v_mfma_f32_32x32x16_bf16 v[64:79], v[120:123], a[104:107], v[64:79]
  s_add_u32 m0, s87, 61440
  s_add_u32 s69, s89, 61440
  buffer_load_dwordx4 v13, s[8:11], s69 offen sc1 lds
  ds_read_b64_tr_b16 v[140:141], v5 offset:23808
  ds_read_b64_tr_b16 v[142:143], v5 offset:24000
  s_waitcnt lgkmcnt(8)
  v_mfma_f32_32x32x16_bf16 v[64:79], v[124:127], a[108:111], v[64:79]
  ds_read_b64_tr_b16 v[80:81], v5 offset:24576
  ds_read_b64_tr_b16 v[82:83], v5 offset:24768
  s_waitcnt lgkmcnt(8)
  v_mfma_f32_32x32x16_bf16 v[64:79], v[128:131], a[112:115], v[64:79]
  s_add_u32 m0, s87, 65536
  s_add_u32 s69, s89, 65536
  buffer_load_dwordx4 v13, s[8:11], s69 offen sc1 lds
  ds_read_b64_tr_b16 v[84:85], v5 offset:25344
  ds_read_b64_tr_b16 v[86:87], v5 offset:25536
  s_waitcnt lgkmcnt(8)
  v_mfma_f32_32x32x16_bf16 v[64:79], v[132:135], a[116:119], v[64:79]
  s_waitcnt vmcnt(20)
  buffer_load_dword a255, v252, s[28:31], s79 offen offset:512
  ds_read_b64_tr_b16 v[88:89], v5 offset:26112
  ds_read_b64_tr_b16 v[90:91], v5 offset:26304
  s_waitcnt lgkmcnt(8)
  v_mfma_f32_32x32x16_bf16 v[64:79], v[136:139], a[120:123], v[64:79]
  s_add_u32 m0, s87, 69632
  s_add_u32 s69, s89, 69632
  buffer_load_dwordx4 v13, s[8:11], s69 offen sc1 lds
  ds_read_b64_tr_b16 v[92:93], v5 offset:26880
  ds_read_b64_tr_b16 v[94:95], v5 offset:27072
  s_waitcnt lgkmcnt(8)
  v_mfma_f32_32x32x16_bf16 v[64:79], v[140:143], a[124:127], v[64:79]
  ds_read_b64_tr_b16 v[96:97], v5 offset:27648
  ds_read_b64_tr_b16 v[98:99], v5 offset:27840
  s_waitcnt lgkmcnt(8)
  v_mfma_f32_32x32x16_bf16 v[64:79], v[80:83], a[128:131], v[64:79]
  s_add_u32 m0, s87, 73728
  s_add_u32 s69, s89, 73728
  buffer_load_dwordx4 v13, s[8:11], s69 offen sc1 lds
  ds_read_b64_tr_b16 v[100:101], v5 offset:28416
  ds_read_b64_tr_b16 v[102:103], v5 offset:28608
  s_waitcnt lgkmcnt(8)
  v_mfma_f32_32x32x16_bf16 v[64:79], v[84:87], a[132:135], v[64:79]
  s_add_u32 m0, s87, 77824
  s_add_u32 s69, s89, 77824
  buffer_load_dwordx4 v13, s[8:11], s69 offen sc1 lds
  ds_read_b64_tr_b16 v[104:105], v5 offset:29184
  ds_read_b64_tr_b16 v[106:107], v5 offset:29376
  s_waitcnt lgkmcnt(8)
  v_mfma_f32_32x32x16_bf16 v[64:79], v[88:91], a[136:139], v[64:79]
  ds_read_b64_tr_b16 v[108:109], v5 offset:29952
  ds_read_b64_tr_b16 v[110:111], v5 offset:30144
  s_waitcnt lgkmcnt(8)
  v_mfma_f32_32x32x16_bf16 v[64:79], v[92:95], a[140:143], v[64:79]
  s_add_u32 m0, s87, 81920
  s_add_u32 s69, s89, 81920
  buffer_load_dwordx4 v13, s[8:11], s69 offen sc1 lds
  s_waitcnt lgkmcnt(6)
  v_mfma_f32_32x32x16_bf16 v[64:79], v[96:99], a[144:147], v[64:79]
  s_waitcnt lgkmcnt(4)
  v_mfma_f32_32x32x16_bf16 v[64:79], v[100:103], a[148:151], v[64:79]
  s_add_u32 m0, s87, 86016
  s_add_u32 s69, s89, 86016
  buffer_load_dwordx4 v13, s[8:11], s69 offen sc1 lds
  s_waitcnt lgkmcnt(2)
  v_mfma_f32_32x32x16_bf16 v[64:79], v[104:107], a[152:155], v[64:79]
  s_waitcnt lgkmcnt(0)
  v_mfma_f32_32x32x16_bf16 v[64:79], v[108:111], a[156:159], v[64:79]
  s_add_u32 m0, s87, 90112
  s_add_u32 s69, s89, 90112
  buffer_load_dwordx4 v13, s[8:11], s69 offen sc1 lds
  v_cvt_pk_bf16_f32 v176, v56, v57
  v_cvt_pk_bf16_f32 v177, v58, v59
  v_cvt_pk_bf16_f32 v178, v60, v61
  v_cvt_pk_bf16_f32 v179, v62, v63
  s_nop 4
  v_cvt_pk_bf16_f32 v180, v64, v65
  v_cvt_pk_bf16_f32 v181, v66, v67
  v_cvt_pk_bf16_f32 v182, v68, v69
  v_cvt_pk_bf16_f32 v183, v70, v71
  v_cvt_pk_bf16_f32 v184, v72, v73
  v_cvt_pk_bf16_f32 v185, v74, v75
  v_mov_b32 v186, 0
  v_mov_b32 v187, 0
  v_mfma_f32_32x32x16_bf16 v[144:159], a[160:163], v[176:179], 0
  v_mfma_f32_32x32x16_bf16 v[160:175], a[172:175], v[176:179], 0
  s_add_u32 m0, s87, 94208
  s_add_u32 s69, s89, 94208
  buffer_load_dwordx4 v13, s[8:11], s69 offen sc1 lds
  v_mfma_f32_32x32x16_bf16 v[144:159], a[164:167], v[180:183], v[144:159]
  v_mfma_f32_32x32x16_bf16 v[160:175], a[176:179], v[180:183], v[160:175]
  s_add_u32 m0, s87, 98304
  s_add_u32 s69, s89, 98304
  buffer_load_dwordx4 v13, s[8:11], s69 offen sc1 lds
  v_mfma_f32_32x32x16_bf16 v[144:159], a[168:171], v[184:187], v[144:159]
  v_mfma_f32_32x32x16_bf16 v[160:175], a[180:183], v[184:187], v[160:175]
  v_accvgpr_read_b32 v3, a201
  v_accvgpr_read_b32 v4, a202
  v_accvgpr_read_b32 v5, a203
  s_lshl_b32 s72, s54, 16
  s_add_u32 s72, s72, 9043968
  s_mov_b32 s82, 131072
  s_nop 4
  v_max3_f32 v6, v144, v145, v146
  v_min3_f32 v8, v144, v145, v146
  v_max3_f32 v6, v6, v147, v148
  v_min3_f32 v8, v8, v147, v148
  v_max3_f32 v6, v6, v149, v150
  v_min3_f32 v8, v8, v149, v150
  v_max3_f32 v6, v6, v151, v152
  v_min3_f32 v8, v8, v151, v152
  v_max3_f32 v6, v6, v153, v154
  v_min3_f32 v8, v8, v153, v154
  v_max3_f32 v6, v6, v155, v156
  v_min3_f32 v8, v8, v155, v156
  v_max3_f32 v6, v6, v157, v158
  v_min3_f32 v8, v8, v157, v158
  v_max3_f32 v6, v6, v159, v160
  v_min3_f32 v8, v8, v159, v160
  v_max3_f32 v6, v6, v161, v162
  v_min3_f32 v8, v8, v161, v162
  v_max_f32 v6, v6, v163
  v_min_f32 v8, v8, v163
  v_mul_f32 v6, v6, v10
  v_mul_f32 v8, v8, v10
  v_pk_fma_f32 v[188:189], v[144:145], v[10:11], v[6:7] op_sel_hi:[1,0,0] neg_lo:[0,0,1] neg_hi:[0,0,1]
  v_pk_fma_f32 v[208:209], v[144:145], v[10:11], v[8:9] op_sel_hi:[1,0,0] neg_lo:[0,1,0] neg_hi:[0,1,0]
  v_pk_fma_f32 v[190:191], v[146:147], v[10:11], v[6:7] op_sel_hi:[1,0,0] neg_lo:[0,0,1] neg_hi:[0,0,1]
  v_pk_fma_f32 v[210:211], v[146:147], v[10:11], v[8:9] op_sel_hi:[1,0,0] neg_lo:[0,1,0] neg_hi:[0,1,0]
  v_pk_fma_f32 v[192:193], v[148:149], v[10:11], v[6:7] op_sel_hi:[1,0,0] neg_lo:[0,0,1] neg_hi:[0,0,1]
  v_pk_fma_f32 v[212:213], v[148:149], v[10:11], v[8:9] op_sel_hi:[1,0,0] neg_lo:[0,1,0] neg_hi:[0,1,0]
  v_pk_fma_f32 v[194:195], v[150:151], v[10:11], v[6:7] op_sel_hi:[1,0,0] neg_lo:[0,0,1] neg_hi:[0,0,1]
  v_pk_fma_f32 v[214:215], v[150:151], v[10:11], v[8:9] op_sel_hi:[1,0,0] neg_lo:[0,1,0] neg_hi:[0,1,0]
  v_pk_fma_f32 v[196:197], v[152:153], v[10:11], v[6:7] op_sel_hi:[1,0,0] neg_lo:[0,0,1] neg_hi:[0,0,1]
  v_pk_fma_f32 v[216:217], v[152:153], v[10:11], v[8:9] op_sel_hi:[1,0,0] neg_lo:[0,1,0] neg_hi:[0,1,0]
  v_pk_fma_f32 v[198:199], v[154:155], v[10:11], v[6:7] op_sel_hi:[1,0,0] neg_lo:[0,0,1] neg_hi:[0,0,1]
  v_pk_fma_f32 v[218:219], v[154:155], v[10:11], v[8:9] op_sel_hi:[1,0,0] neg_lo:[0,1,0] neg_hi:[0,1,0]
  v_pk_fma_f32 v[200:201], v[156:157], v[10:11], v[6:7] op_sel_hi:[1,0,0] neg_lo:[0,0,1] neg_hi:[0,0,1]
  v_pk_fma_f32 v[220:221], v[156:157], v[10:11], v[8:9] op_sel_hi:[1,0,0] neg_lo:[0,1,0] neg_hi:[0,1,0]
  v_pk_fma_f32 v[202:203], v[158:159], v[10:11], v[6:7] op_sel_hi:[1,0,0] neg_lo:[0,0,1] neg_hi:[0,0,1]
  v_pk_fma_f32 v[222:223], v[158:159], v[10:11], v[8:9] op_sel_hi:[1,0,0] neg_lo:[0,1,0] neg_hi:[0,1,0]
  v_pk_fma_f32 v[204:205], v[160:161], v[10:11], v[6:7] op_sel_hi:[1,0,0] neg_lo:[0,0,1] neg_hi:[0,0,1]
  v_pk_fma_f32 v[224:225], v[160:161], v[10:11], v[8:9] op_sel_hi:[1,0,0] neg_lo:[0,1,0] neg_hi:[0,1,0]
  v_pk_fma_f32 v[206:207], v[162:163], v[10:11], v[6:7] op_sel_hi:[1,0,0] neg_lo:[0,0,1] neg_hi:[0,0,1]
  v_pk_fma_f32 v[226:227], v[162:163], v[10:11], v[8:9] op_sel_hi:[1,0,0] neg_lo:[0,1,0] neg_hi:[0,1,0]
  v_exp_f32 v188, v188
  v_exp_f32 v189, v189
  v_exp_f32 v190, v190
  v_exp_f32 v191, v191
  v_exp_f32 v192, v192
  v_exp_f32 v193, v193
  v_exp_f32 v194, v194
  v_exp_f32 v195, v195
  v_exp_f32 v196, v196
  v_exp_f32 v197, v197
  v_exp_f32 v198, v198
  v_exp_f32 v199, v199
  v_exp_f32 v200, v200
  v_exp_f32 v201, v201
  v_exp_f32 v202, v202
  v_exp_f32 v203, v203
  v_exp_f32 v204, v204
  v_exp_f32 v205, v205
  v_exp_f32 v206, v206
  v_exp_f32 v207, v207
  v_exp_f32 v208, v208
  v_exp_f32 v209, v209
  v_exp_f32 v210, v210
  v_exp_f32 v211, v211
  v_exp_f32 v212, v212
  v_exp_f32 v213, v213
  v_exp_f32 v214, v214
  v_exp_f32 v215, v215
  v_exp_f32 v216, v216
  v_exp_f32 v217, v217
  v_exp_f32 v218, v218
  v_exp_f32 v219, v219
  v_exp_f32 v220, v220
  v_exp_f32 v221, v221
  v_exp_f32 v222, v222
  v_exp_f32 v223, v223
  v_exp_f32 v224, v224
  v_exp_f32 v225, v225
  v_exp_f32 v226, v226
  v_exp_f32 v227, v227
  v_pk_add_f32 v[6:7], v[188:189], v[190:191]
  v_pk_add_f32 v[8:9], v[208:209], v[210:211]
  v_pk_add_f32 v[6:7], v[6:7], v[192:193]
  v_pk_add_f32 v[8:9], v[8:9], v[212:213]
  v_pk_add_f32 v[6:7], v[6:7], v[194:195]
  v_pk_add_f32 v[8:9], v[8:9], v[214:215]
  v_pk_add_f32 v[6:7], v[6:7], v[196:197]
  v_pk_add_f32 v[8:9], v[8:9], v[216:217]
  v_pk_add_f32 v[6:7], v[6:7], v[198:199]
  v_pk_add_f32 v[8:9], v[8:9], v[218:219]
  v_pk_add_f32 v[6:7], v[6:7], v[200:201]
  v_pk_add_f32 v[8:9], v[8:9], v[220:221]
  v_pk_add_f32 v[6:7], v[6:7], v[202:203]
  v_pk_add_f32 v[8:9], v[8:9], v[222:223]
  v_pk_add_f32 v[6:7], v[6:7], v[204:205]
  v_pk_add_f32 v[8:9], v[8:9], v[224:225]
  v_pk_add_f32 v[6:7], v[6:7], v[206:207]
  v_pk_add_f32 v[8:9], v[8:9], v[226:227]
  v_add_f32 v6, v6, v7
  v_add_f32 v8, v8, v9
  v_rcp_f32 v6, v6
  v_rcp_f32 v8, v8
  v_pk_mul_f32 v[188:189], v[188:189], v[6:7] op_sel_hi:[1,0]
  v_pk_mul_f32 v[190:191], v[190:191], v[6:7] op_sel_hi:[1,0]
  v_pk_mul_f32 v[192:193], v[192:193], v[6:7] op_sel_hi:[1,0]
  v_pk_mul_f32 v[194:195], v[194:195], v[6:7] op_sel_hi:[1,0]
  v_pk_mul_f32 v[196:197], v[196:197], v[6:7] op_sel_hi:[1,0]
  v_pk_mul_f32 v[198:199], v[198:199], v[6:7] op_sel_hi:[1,0]
  v_pk_mul_f32 v[200:201], v[200:201], v[6:7] op_sel_hi:[1,0]
  v_pk_mul_f32 v[202:203], v[202:203], v[6:7] op_sel_hi:[1,0]
  v_pk_mul_f32 v[204:205], v[204:205], v[6:7] op_sel_hi:[1,0]
  v_pk_mul_f32 v[206:207], v[206:207], v[6:7] op_sel_hi:[1,0]
  v_pk_mul_f32 v[208:209], v[208:209], v[8:9] op_sel_hi:[1,0]
  v_pk_mul_f32 v[210:211], v[210:211], v[8:9] op_sel_hi:[1,0]
  v_pk_mul_f32 v[212:213], v[212:213], v[8:9] op_sel_hi:[1,0]
  v_pk_mul_f32 v[214:215], v[214:215], v[8:9] op_sel_hi:[1,0]
  v_pk_mul_f32 v[216:217], v[216:217], v[8:9] op_sel_hi:[1,0]
  v_pk_mul_f32 v[218:219], v[218:219], v[8:9] op_sel_hi:[1,0]
  v_pk_mul_f32 v[220:221], v[220:221], v[8:9] op_sel_hi:[1,0]
  v_pk_mul_f32 v[222:223], v[222:223], v[8:9] op_sel_hi:[1,0]
  v_pk_mul_f32 v[224:225], v[224:225], v[8:9] op_sel_hi:[1,0]
  v_pk_mul_f32 v[226:227], v[226:227], v[8:9] op_sel_hi:[1,0]
  v_cvt_pk_bf16_f32 v228, v188, v189
  v_cvt_pk_bf16_f32 v229, v190, v191
  v_cvt_pk_bf16_f32 v230, v192, v193
  v_cvt_pk_bf16_f32 v231, v194, v195
  v_cvt_pk_bf16_f32 v232, v196, v197
  v_cvt_pk_bf16_f32 v233, v198, v199
  v_cvt_pk_bf16_f32 v234, v200, v201
  v_cvt_pk_bf16_f32 v235, v202, v203
  v_cvt_pk_bf16_f32 v236, v204, v205
  v_cvt_pk_bf16_f32 v237, v206, v207
  v_cvt_pk_bf16_f32 v238, v208, v209
  v_cvt_pk_bf16_f32 v239, v210, v211
  v_cvt_pk_bf16_f32 v240, v212, v213
  v_cvt_pk_bf16_f32 v241, v214, v215
  v_cvt_pk_bf16_f32 v242, v216, v217
  v_cvt_pk_bf16_f32 v243, v218, v219
  v_cvt_pk_bf16_f32 v244, v220, v221
  v_cvt_pk_bf16_f32 v245, v222, v223
  v_cvt_pk_bf16_f32 v246, v224, v225
  v_cvt_pk_bf16_f32 v247, v226, v227
  v_accvgpr_read_b32 v192, a224
  v_accvgpr_read_b32 v193, a225
  v_accvgpr_read_b32 v194, a226
  v_accvgpr_read_b32 v195, a227
  v_accvgpr_read_b32 v196, a228
  v_accvgpr_read_b32 v197, a229
  s_add_u32 s66, s72, 0
  buffer_load_dwordx4 v[80:83], v5, s[8:11], s66 offen sc1
  s_add_u32 s66, s72, 4096
  buffer_load_dwordx4 v[84:87], v5, s[8:11], s66 offen sc1
  s_add_u32 s66, s72, 8192
  buffer_load_dwordx4 v[88:91], v5, s[8:11], s66 offen sc1
  s_add_u32 s66, s72, 12288
  buffer_load_dwordx4 v[92:95], v5, s[8:11], s66 offen sc1
  s_add_u32 s66, s72, 16384
  buffer_load_dwordx4 v[96:99], v5, s[8:11], s66 offen sc1
  s_add_u32 s66, s72, 20480
  buffer_load_dwordx4 v[100:103], v5, s[8:11], s66 offen sc1
  s_add_u32 s66, s72, 24576
  buffer_load_dwordx4 v[104:107], v5, s[8:11], s66 offen sc1
  s_add_u32 s66, s72, 28672
  buffer_load_dwordx4 v[108:111], v5, s[8:11], s66 offen sc1
  s_add_u32 s66, s72, 32768
  buffer_load_dwordx4 v[112:115], v5, s[8:11], s66 offen sc1
  s_add_u32 s66, s72, 36864
  buffer_load_dwordx4 v[116:119], v5, s[8:11], s66 offen sc1
  s_add_u32 s66, s72, 40960
  buffer_load_dwordx4 v[120:123], v5, s[8:11], s66 offen sc1
  s_add_u32 s66, s72, 45056
  buffer_load_dwordx4 v[124:127], v5, s[8:11], s66 offen sc1
  s_add_u32 s66, s72, 49152
  buffer_load_dwordx4 v[128:131], v5, s[8:11], s66 offen sc1
  s_add_u32 s66, s72, 53248
  buffer_load_dwordx4 v[132:135], v5, s[8:11], s66 offen sc1
  s_add_u32 s66, s72, 57344
  buffer_load_dwordx4 v[136:139], v5, s[8:11], s66 offen sc1
  s_add_u32 s66, s72, 61440
  buffer_load_dwordx4 v[140:143], v5, s[8:11], s66 offen sc1
  buffer_load_dword v14, v4, s[8:11], 0 offen sc1
  v_and_b32 v6, 31, v1
  v_lshrrev_b32 v7, 5, v1
  v_bfe_u32 v8, v6, 2, 1
  v_and_b32 v9, 3, v6
  v_lshrrev_b32 v6, 3, v6
  v_lshl_add_u32 v9, v6, 2, v9
  v_mad_u32_u24 v6, v7, 21, v9
  v_mul_u32_u24 v6, 80, v6
  v_cmp_eq_u32 vcc, v7, v8
  v_mov_b32 v8, 3360
  s_nop 0
  v_cndmask_b32 v6, v8, v6, vcc
  v_cmp_gt_u32 s[66:67], 5, v9
  s_and_b64 vcc, vcc, s[66:67]
  v_add_u32 v9, 1280, v6
  v_cndmask_b32 v9, v8, v9, vcc
  v_add_u32 v6, 102400, v6
  v_add_u32 v9, 102400, v9
VC13:
  s_waitcnt vmcnt(15)
  v_max3_u32 v2, v80, v83, v84
  s_waitcnt vmcnt(14)
  v_max3_u32 v2, v2, v87, v88
  s_waitcnt vmcnt(13)
  v_max3_u32 v2, v2, v91, v92
  v_max_u32 v2, v2, v95
  v_cmp_eq_u32 vcc, -1, v2
  s_cbranch_vccnz VR14
VK15:
  v_mfma_f32_32x32x16_bf16 v[144:159], v[248:251], v[80:83], 0
  v_mfma_f32_32x32x16_bf16 v[160:175], v[248:251], v[84:87], 0
  v_mfma_f32_32x32x16_bf16 v[144:159], v[248:251], v[88:91], v[144:159]
  v_mfma_f32_32x32x16_bf16 v[160:175], v[248:251], v[92:95], v[160:175]
VC16:
  s_waitcnt vmcnt(11)
  v_max3_u32 v2, v96, v99, v100
  s_waitcnt vmcnt(10)
  v_max3_u32 v2, v2, v103, v104
  s_waitcnt vmcnt(9)
  v_max3_u32 v2, v2, v107, v108
  v_max_u32 v2, v2, v111
  v_cmp_eq_u32 vcc, -1, v2
  s_cbranch_vccnz VR17
VK18:
  v_mfma_f32_32x32x16_bf16 v[144:159], v[248:251], v[96:99], v[144:159]
  v_mfma_f32_32x32x16_bf16 v[160:175], v[248:251], v[100:103], v[160:175]
  v_mfma_f32_32x32x16_bf16 v[144:159], v[248:251], v[104:107], v[144:159]
  v_mfma_f32_32x32x16_bf16 v[160:175], v[248:251], v[108:111], v[160:175]
VC19:
  s_waitcnt vmcnt(7)
  v_max3_u32 v2, v112, v115, v116
  s_waitcnt vmcnt(6)
  v_max3_u32 v2, v2, v119, v120
  s_waitcnt vmcnt(5)
  v_max3_u32 v2, v2, v123, v124
  v_max_u32 v2, v2, v127
  v_cmp_eq_u32 vcc, -1, v2
  s_cbranch_vccnz VR20
VK21:
  v_mfma_f32_32x32x16_bf16 v[144:159], v[248:251], v[112:115], v[144:159]
  v_mfma_f32_32x32x16_bf16 v[160:175], v[248:251], v[116:119], v[160:175]
  v_mfma_f32_32x32x16_bf16 v[144:159], v[248:251], v[120:123], v[144:159]
  v_mfma_f32_32x32x16_bf16 v[160:175], v[248:251], v[124:127], v[160:175]
VC22:
  s_waitcnt vmcnt(3)
  v_max3_u32 v2, v128, v131, v132
  s_waitcnt vmcnt(2)
  v_max3_u32 v2, v2, v135, v136
  s_waitcnt vmcnt(1)
  v_max3_u32 v2, v2, v139, v140
  v_max_u32 v2, v2, v143
  v_cmp_eq_u32 vcc, -1, v2
  s_cbranch_vccnz VR23
VK24:
  v_mfma_f32_32x32x16_bf16 v[144:159], v[248:251], v[128:131], v[144:159]
  v_mfma_f32_32x32x16_bf16 v[160:175], v[248:251], v[132:135], v[160:175]
  v_mfma_f32_32x32x16_bf16 v[144:159], v[248:251], v[136:139], v[144:159]
  v_mfma_f32_32x32x16_bf16 v[160:175], v[248:251], v[140:143], v[160:175]
  s_nop 11
  v_pk_add_f32 v[144:145], v[144:145], v[160:161]
  v_pk_add_f32 v[146:147], v[146:147], v[162:163]
  v_pk_add_f32 v[148:149], v[148:149], v[164:165]
  v_pk_add_f32 v[150:151], v[150:151], v[166:167]
  v_cvt_pk_bf16_f32 v176, v144, v145
  v_cvt_pk_bf16_f32 v177, v146, v147
  v_cvt_pk_bf16_f32 v178, v148, v149
  v_cvt_pk_bf16_f32 v179, v150, v151
  ds_write_b128 v3, v[176:179]
  s_waitcnt lgkmcnt(0)
  s_barrier
  ds_read_b128 v[80:83], v6 offset:0
  ds_read_b128 v[84:87], v9 offset:0
  ds_read_b128 v[88:91], v6 offset:16
  ds_read_b128 v[92:95], v9 offset:16
  ds_read_b128 v[96:99], v6 offset:32
  ds_read_b128 v[100:103], v9 offset:32
  ds_read_b128 v[104:107], v6 offset:48
  ds_read_b128 v[108:111], v9 offset:48
  ds_read_b128 v[112:115], v6 offset:64
  ds_read_b128 v[116:119], v9 offset:64
  v_accvgpr_read_b32 v2, a230
  v_accvgpr_read_b32 v3, a231
  s_waitcnt lgkmcnt(8)
  v_mfma_f32_32x32x16_bf16 v[160:175], v[84:87], v[228:231], 0
  s_mov_b32 s78, s60
  s_mul_i32 s78, s78, 96
  s_add_u32 m0, s85, 0
  s_nop 0
  buffer_load_dwordx4 v192, s[28:31], s78 offen offset:0 lds
  v_mfma_f32_32x32x16_bf16 v[144:159], v[80:83], v[228:231], 0
  buffer_load_dwordx4 v193, s[28:31], s78 offen offset:1056 lds
  s_waitcnt lgkmcnt(6)
  v_mfma_f32_32x32x16_bf16 v[160:175], v[92:95], v[232:235], v[160:175]
  buffer_load_dwordx4 v194, s[28:31], s78 offen offset:2112 lds
  v_mfma_f32_32x32x16_bf16 v[144:159], v[88:91], v[232:235], v[144:159]
  buffer_load_dwordx4 v195, s[28:31], s78 offen offset:3168 lds
  s_waitcnt lgkmcnt(4)
  v_mfma_f32_32x32x16_bf16 v[160:175], v[100:103], v[236:239], v[160:175]
  v_mfma_f32_32x32x16_bf16 v[144:159], v[96:99], v[236:239], v[144:159]
  s_add_u32 s78, s60, 1024
  s_and_b32 s78, s78, 0x3fff
  s_mul_i32 s78, s78, 96
  s_add_u32 m0, s85, 4224
  s_nop 0
  buffer_load_dwordx4 v192, s[28:31], s78 offen offset:0 lds
  s_waitcnt lgkmcnt(2)
  v_mfma_f32_32x32x16_bf16 v[160:175], v[108:111], v[240:243], v[160:175]
  buffer_load_dwordx4 v193, s[28:31], s78 offen offset:1056 lds
  v_mfma_f32_32x32x16_bf16 v[144:159], v[104:107], v[240:243], v[144:159]
  buffer_load_dwordx4 v194, s[28:31], s78 offen offset:2112 lds
  s_waitcnt lgkmcnt(0)
  v_mfma_f32_32x32x16_bf16 v[160:175], v[116:119], v[244:247], v[160:175]
  v_mfma_f32_32x32x16_bf16 v[144:159], v[112:115], v[244:247], v[144:159]
  buffer_load_dwordx4 v195, s[28:31], s78 offen offset:3168 lds
  s_nop 9
  v_add_f32 v8, 0x358637bd, v164
  v_rcp_f32 v8, v8
  s_nop 0
  v_pk_mul_f32 v[144:145], v[144:145], v[8:9] op_sel_hi:[1,0]
  s_nop 0
  v_cvt_pk_bf16_f32 v176, v144, v145
  v_pk_mul_f32 v[146:147], v[146:147], v[8:9] op_sel_hi:[1,0]
  s_nop 0
  v_cvt_pk_bf16_f32 v177, v146, v147
  v_pk_mul_f32 v[148:149], v[148:149], v[8:9] op_sel_hi:[1,0]
  s_nop 0
  v_cvt_pk_bf16_f32 v178, v148, v149
  v_pk_mul_f32 v[150:151], v[150:151], v[8:9] op_sel_hi:[1,0]
  s_nop 0
  v_cvt_pk_bf16_f32 v179, v150, v151
  v_pk_mul_f32 v[152:153], v[152:153], v[8:9] op_sel_hi:[1,0]
  s_nop 0
  v_cvt_pk_bf16_f32 v180, v152, v153
  v_pk_mul_f32 v[154:155], v[154:155], v[8:9] op_sel_hi:[1,0]
  s_nop 0
  v_cvt_pk_bf16_f32 v181, v154, v155
  v_pk_mul_f32 v[156:157], v[156:157], v[8:9] op_sel_hi:[1,0]
  s_nop 0
  v_cvt_pk_bf16_f32 v182, v156, v157
  v_pk_mul_f32 v[158:159], v[158:159], v[8:9] op_sel_hi:[1,0]
  s_nop 0
  v_cvt_pk_bf16_f32 v183, v158, v159
  v_pk_mul_f32 v[160:161], v[160:161], v[8:9] op_sel_hi:[1,0]
  s_nop 0
  v_cvt_pk_bf16_f32 v184, v160, v161
  v_pk_mul_f32 v[162:163], v[162:163], v[8:9] op_sel_hi:[1,0]
  s_nop 0
  v_cvt_pk_bf16_f32 v185, v162, v163
  buffer_store_dwordx4 v[176:179], v2, s[8:11], s94 offen sc1
  buffer_store_dwordx4 v[180:183], v2, s[8:11], s94 offen offset:256 sc1
  buffer_store_dwordx2 v[184:185], v3, s[8:11], s94 offen offset:512 sc1
  s_waitcnt vmcnt(11)
  v_subrev_u32 v14, s83, v14
  v_cmp_le_u32 vcc, 128, v14
  s_cbranch_vccnz FC25
FK26:
  v_accvgpr_read_b32 v236, a184
  v_accvgpr_read_b32 v237, a185
  v_accvgpr_read_b32 v238, a186
  v_accvgpr_read_b32 v239, a187
  v_accvgpr_read_b32 v240, a188
  v_accvgpr_read_b32 v241, a189
  v_accvgpr_read_b32 v242, a190
  v_accvgpr_read_b32 v243, a191
  v_accvgpr_read_b32 v244, a192
  v_accvgpr_read_b32 v245, a193
  s_mul_i32 s75, s59, 20480
  s_add_u32 s75, s75, 10092544
  v_lshrrev_b32 v4, 2, v1
  v_lshlrev_b32 v4, 5, v4
  v_and_b32 v5, 3, v1
  v_lshl_add_u32 v4, v5, 3, v4
  v_add_u32 v5, 61440, v4
  v_add_u32 v6, 106496, v4
  s_mov_b32 s82, 131072
  v_lshlrev_b32 v16, 16, v236
  v_and_b32 v17, 0xffff0000, v236
  v_lshlrev_b32 v18, 16, v237
  v_and_b32 v19, 0xffff0000, v237
  v_lshlrev_b32 v20, 16, v238
  v_and_b32 v21, 0xffff0000, v238
  v_lshlrev_b32 v22, 16, v239
  v_and_b32 v23, 0xffff0000, v239
  v_lshlrev_b32 v24, 16, v240
  v_and_b32 v25, 0xffff0000, v240
  v_lshlrev_b32 v26, 16, v241
  v_and_b32 v27, 0xffff0000, v241
  v_lshlrev_b32 v28, 16, v242
  v_and_b32 v29, 0xffff0000, v242
  v_lshlrev_b32 v30, 16, v243
  v_and_b32 v31, 0xffff0000, v243
  v_lshlrev_b32 v32, 16, v244
  v_and_b32 v33, 0xffff0000, v244
  v_lshlrev_b32 v34, 16, v245
  v_and_b32 v35, 0xffff0000, v245
  s_waitcnt vmcnt(3)
  ds_read_b64_tr_b16 a[0:1], v196 offset:0
  ds_read_b64_tr_b16 a[2:3], v196 offset:512
  ds_read_b64_tr_b16 a[4:5], v196 offset:32
  ds_read_b64_tr_b16 a[6:7], v196 offset:544
  ds_read_b64_tr_b16 a[8:9], v196 offset:64
  ds_read_b64_tr_b16 a[10:11], v196 offset:576
  ds_read_b64_tr_b16 a[12:13], v196 offset:96
  ds_read_b64_tr_b16 a[14:15], v196 offset:608
  ds_read_b64_tr_b16 a[16:17], v196 offset:4224
  ds_read_b64_tr_b16 a[18:19], v196 offset:4736
  ds_read_b64_tr_b16 a[20:21], v196 offset:4256
  ds_read_b64_tr_b16 a[22:23], v196 offset:4768
  ds_read_b64_tr_b16 a[24:25], v196 offset:4288
  ds_read_b64_tr_b16 a[26:27], v196 offset:4800
  ds_read_b64_tr_b16 a[28:29], v196 offset:4320
  ds_read_b64_tr_b16 a[30:31], v196 offset:4832
  s_waitcnt lgkmcnt(0)
  ds_read_b64_tr_b16 a[96:97], v4 offset:0
  ds_read_b64_tr_b16 a[98:99], v4 offset:512
  ds_read_b64_tr_b16 a[100:101], v4 offset:20480
  ds_read_b64_tr_b16 a[102:103], v4 offset:20992
  ds_read_b64_tr_b16 a[104:105], v4 offset:40960
  ds_read_b64_tr_b16 a[106:107], v4 offset:41472
  s_add_u32 s78, s60, 2048
  s_and_b32 s78, s78, 0x3fff
  s_mul_i32 s78, s78, 96
  s_add_u32 m0, s85, 0
  s_nop 0
  buffer_load_dwordx4 v192, s[28:31], s78 offen offset:0 lds
  ds_read_b64_tr_b16 a[108:109], v5 offset:0
  ds_read_b64_tr_b16 a[110:111], v5 offset:512
  ds_read_b64_tr_b16 a[112:113], v5 offset:20480
  ds_read_b64_tr_b16 a[114:115], v5 offset:20992
  ds_read_b64_tr_b16 a[116:117], v4 offset:1024
  ds_read_b64_tr_b16 a[118:119], v4 offset:1536
  buffer_load_dwordx4 v193, s[28:31], s78 offen offset:1056 lds
  ds_read_b64_tr_b16 a[120:121], v4 offset:21504
  ds_read_b64_tr_b16 a[122:123], v4 offset:22016
  ds_read_b64_tr_b16 a[124:125], v4 offset:41984
  ds_read_b64_tr_b16 a[126:127], v4 offset:42496
  ds_read_b64_tr_b16 a[128:129], v5 offset:1024
  ds_read_b64_tr_b16 a[130:131], v5 offset:1536
  buffer_load_dwordx4 v194, s[28:31], s78 offen offset:2112 lds
  ds_read_b64_tr_b16 a[132:133], v5 offset:21504
  ds_read_b64_tr_b16 a[134:135], v5 offset:22016
  ds_read_b64_tr_b16 a[136:137], v4 offset:2048
  ds_read_b64_tr_b16 a[138:139], v4 offset:2560
  ds_read_b64_tr_b16 a[140:141], v4 offset:22528
  ds_read_b64_tr_b16 a[142:143], v4 offset:23040
  buffer_load_dwordx4 v195, s[28:31], s78 offen offset:3168 lds
  ds_read_b64_tr_b16 a[144:145], v4 offset:43008
  ds_read_b64_tr_b16 a[146:147], v4 offset:43520
  ds_read_b64_tr_b16 a[148:149], v5 offset:2048
  ds_read_b64_tr_b16 a[150:151], v5 offset:2560
  ds_read_b64_tr_b16 a[152:153], v5 offset:22528
  ds_read_b64_tr_b16 a[154:155], v5 offset:23040
  s_add_u32 s78, s60, 3072
  s_and_b32 s78, s78, 0x3fff
  s_mul_i32 s78, s78, 96
  s_add_u32 m0, s85, 4224
  s_nop 0
  buffer_load_dwordx4 v192, s[28:31], s78 offen offset:0 lds
  ds_read_b64_tr_b16 a[156:157], v4 offset:3072
  ds_read_b64_tr_b16 a[158:159], v4 offset:3584
  ds_read_b64_tr_b16 a[160:161], v4 offset:23552
  ds_read_b64_tr_b16 a[162:163], v4 offset:24064
  ds_read_b64_tr_b16 a[164:165], v4 offset:44032
  ds_read_b64_tr_b16 a[166:167], v4 offset:44544
  buffer_load_dwordx4 v193, s[28:31], s78 offen offset:1056 lds
  ds_read_b64_tr_b16 a[168:169], v5 offset:3072
  ds_read_b64_tr_b16 a[170:171], v5 offset:3584
  ds_read_b64_tr_b16 a[172:173], v5 offset:23552
  ds_read_b64_tr_b16 a[174:175], v5 offset:24064
  ds_read_b64_tr_b16 a[176:177], v4 offset:4096
  ds_read_b64_tr_b16 a[178:179], v4 offset:4608
  buffer_load_dwordx4 v194, s[28:31], s78 offen offset:2112 lds
  ds_read_b64_tr_b16 a[180:181], v4 offset:24576
  ds_read_b64_tr_b16 a[182:183], v4 offset:25088
  ds_read_b64_tr_b16 a[184:185], v4 offset:45056
  ds_read_b64_tr_b16 a[186:187], v4 offset:45568
  ds_read_b64_tr_b16 a[188:189], v5 offset:4096
  ds_read_b64_tr_b16 a[190:191], v5 offset:4608
  buffer_load_dwordx4 v195, s[28:31], s78 offen offset:3168 lds
  ds_read_b64_tr_b16 a[192:193], v5 offset:24576
  ds_read_b64_tr_b16 a[194:195], v5 offset:25088
  ds_read_b64_tr_b16 a[196:197], v4 offset:5120
  ds_read_b64_tr_b16 a[198:199], v4 offset:5632
  ds_read_b64_tr_b16 a[200:201], v4 offset:25600
  ds_read_b64_tr_b16 a[202:203], v4 offset:26112
  s_add_u32 s77, s75, 0
  buffer_load_dwordx4 v[48:51], v13, s[8:11], s77 offen offset:0 sc1
  ds_read_b64_tr_b16 a[204:205], v4 offset:46080
  ds_read_b64_tr_b16 a[206:207], v4 offset:46592
  ds_read_b64_tr_b16 a[208:209], v5 offset:5120
  ds_read_b64_tr_b16 a[210:211], v5 offset:5632
  ds_read_b64_tr_b16 a[212:213], v5 offset:25600
  ds_read_b64_tr_b16 a[214:215], v5 offset:26112
  s_add_u32 s77, s75, 0
  buffer_load_dwordx4 v[52:55], v13, s[8:11], s77 offen offset:1024 sc1
  ds_read_b64_tr_b16 a[216:217], v4 offset:6144
  ds_read_b64_tr_b16 a[218:219], v4 offset:6656
  ds_read_b64_tr_b16 a[220:221], v4 offset:26624
  ds_read_b64_tr_b16 a[222:223], v4 offset:27136
  ds_read_b64_tr_b16 a[224:225], v4 offset:47104
  ds_read_b64_tr_b16 a[226:227], v4 offset:47616
  s_add_u32 s77, s75, 0
  buffer_load_dwordx4 v[56:59], v13, s[8:11], s77 offen offset:2048 sc1
  ds_read_b64_tr_b16 a[228:229], v5 offset:6144
  ds_read_b64_tr_b16 a[230:231], v5 offset:6656
  ds_read_b64_tr_b16 a[232:233], v5 offset:26624
  ds_read_b64_tr_b16 a[234:235], v5 offset:27136
  ds_read_b64_tr_b16 a[236:237], v4 offset:7168
  ds_read_b64_tr_b16 a[238:239], v4 offset:7680
  s_add_u32 s77, s75, 0
  buffer_load_dwordx4 v[60:63], v13, s[8:11], s77 offen offset:3072 sc1
  ds_read_b64_tr_b16 a[240:241], v4 offset:27648
  ds_read_b64_tr_b16 a[242:243], v4 offset:28160
  ds_read_b64_tr_b16 a[244:245], v4 offset:48128
  ds_read_b64_tr_b16 a[246:247], v4 offset:48640
  ds_read_b64_tr_b16 a[248:249], v5 offset:7168
  ds_read_b64_tr_b16 a[250:251], v5 offset:7680
  s_add_u32 s77, s75, 4096
  buffer_load_dwordx4 v[64:67], v13, s[8:11], s77 offen offset:0 sc1
  s_add_u32 s77, s75, 4096
  buffer_load_dwordx4 v[68:71], v13, s[8:11], s77 offen offset:1024 sc1
  s_add_u32 s77, s75, 4096
  buffer_load_dwordx4 v[72:75], v13, s[8:11], s77 offen offset:2048 sc1
  s_add_u32 s77, s75, 4096
  buffer_load_dwordx4 v[76:79], v13, s[8:11], s77 offen offset:3072 sc1
VC29:
  s_waitcnt vmcnt(6)
  v_max3_u32 v8, v48, v51, v52
  v_max_u32 v8, v8, v55
  v_cmp_eq_u32 vcc, -1, v8
  s_cbranch_vccnz VR30
VK31:
  ds_read_b64_tr_b16 v[156:157], v5 offset:27648
  ds_read_b64_tr_b16 v[158:159], v5 offset:28160
  ds_read_b64_tr_b16 v[160:161], v4 offset:8192
  ds_read_b64_tr_b16 v[162:163], v4 offset:8704
  ds_read_b64_tr_b16 v[164:165], v4 offset:28672
  ds_read_b64_tr_b16 v[166:167], v4 offset:29184
  ds_read_b64_tr_b16 v[168:169], v4 offset:49152
  ds_read_b64_tr_b16 v[170:171], v4 offset:49664
  ds_read_b64_tr_b16 v[172:173], v5 offset:8192
  ds_read_b64_tr_b16 v[174:175], v5 offset:8704
  ds_read_b64_tr_b16 v[176:177], v5 offset:28672
  ds_read_b64_tr_b16 v[178:179], v5 offset:29184
  ds_read_b64_tr_b16 v[180:181], v4 offset:9216
  ds_read_b64_tr_b16 v[182:183], v4 offset:9728
  ds_read_b64_tr_b16 v[184:185], v4 offset:29696
  ds_read_b64_tr_b16 v[186:187], v4 offset:30208
  ds_read_b64_tr_b16 v[188:189], v4 offset:50176
  ds_read_b64_tr_b16 v[190:191], v4 offset:50688
  ds_read_b64_tr_b16 v[128:129], v5 offset:9216
  ds_read_b64_tr_b16 v[130:131], v5 offset:9728
  ds_read_b64_tr_b16 v[132:133], v5 offset:29696
  ds_read_b64_tr_b16 v[134:135], v5 offset:30208
  ds_read_b64_tr_b16 v[136:137], v4 offset:10240
  ds_read_b64_tr_b16 v[138:139], v4 offset:10752
  ds_read_b64_tr_b16 v[140:141], v4 offset:30720
  ds_read_b64_tr_b16 v[142:143], v4 offset:31232
  ds_read_b64_tr_b16 v[144:145], v4 offset:51200
  ds_read_b64_tr_b16 v[146:147], v4 offset:51712
  s_waitcnt lgkmcnt(15)
  v_mfma_f32_16x16x32_bf16 v[16:19], a[96:99], v[48:51], v[16:19]
  s_add_u32 s77, s75, 8192
  buffer_load_dwordx4 v[80:83], v13, s[8:11], s77 offen offset:0 sc1
  v_mfma_f32_16x16x32_bf16 v[20:23], a[100:103], v[48:51], v[20:23]
  ds_read_b64_tr_b16 a[32:33], v196 offset:0
  v_mfma_f32_16x16x32_bf16 v[24:27], a[104:107], v[48:51], v[24:27]
  ds_read_b64_tr_b16 a[34:35], v196 offset:512
  v_mfma_f32_16x16x32_bf16 v[28:31], a[108:111], v[48:51], v[28:31]
  s_add_u32 s77, s75, 8192
  buffer_load_dwordx4 v[84:87], v13, s[8:11], s77 offen offset:1024 sc1
  v_mfma_f32_16x16x32_bf16 v[32:35], a[112:115], v[48:51], v[32:35]
  ds_read_b64_tr_b16 a[36:37], v196 offset:32
  v_mfma_f32_16x16x32_bf16 v[16:19], a[116:119], v[52:55], v[16:19]
  v_mfma_f32_16x16x32_bf16 v[20:23], a[120:123], v[52:55], v[20:23]
  s_add_u32 s77, s75, 8192
  buffer_load_dwordx4 v[88:91], v13, s[8:11], s77 offen offset:2048 sc1
  ds_read_b64_tr_b16 a[38:39], v196 offset:544
  v_mfma_f32_16x16x32_bf16 v[24:27], a[124:127], v[52:55], v[24:27]
  v_mfma_f32_16x16x32_bf16 v[28:31], a[128:131], v[52:55], v[28:31]
  ds_read_b64_tr_b16 a[40:41], v196 offset:64
  v_mfma_f32_16x16x32_bf16 v[32:35], a[132:135], v[52:55], v[32:35]
  s_add_u32 s77, s75, 8192
  buffer_load_dwordx4 v[92:95], v13, s[8:11], s77 offen offset:3072 sc1
VC32:
  s_waitcnt vmcnt(8)
  v_max3_u32 v8, v56, v59, v60
  v_max_u32 v8, v8, v63
  v_cmp_eq_u32 vcc, -1, v8
  s_cbranch_vccnz VR33
VK34:
  v_mfma_f32_16x16x32_bf16 v[16:19], a[136:139], v[56:59], v[16:19]
  ds_read_b64_tr_b16 a[42:43], v196 offset:576
  v_mfma_f32_16x16x32_bf16 v[20:23], a[140:143], v[56:59], v[20:23]
  v_mfma_f32_16x16x32_bf16 v[24:27], a[144:147], v[56:59], v[24:27]
  s_add_u32 s77, s75, 12288
  buffer_load_dwordx4 v[96:99], v13, s[8:11], s77 offen offset:0 sc1
  ds_read_b64_tr_b16 a[44:45], v196 offset:96
  v_mfma_f32_16x16x32_bf16 v[28:31], a[148:151], v[56:59], v[28:31]
  v_mfma_f32_16x16x32_bf16 v[32:35], a[152:155], v[56:59], v[32:35]
  ds_read_b64_tr_b16 a[46:47], v196 offset:608
  v_mfma_f32_16x16x32_bf16 v[16:19], a[156:159], v[60:63], v[16:19]
  s_add_u32 s77, s75, 12288
  buffer_load_dwordx4 v[100:103], v13, s[8:11], s77 offen offset:1024 sc1
  ds_read_b64_tr_b16 a[48:49], v196 offset:4224
  v_mfma_f32_16x16x32_bf16 v[20:23], a[160:163], v[60:63], v[20:23]
  v_mfma_f32_16x16x32_bf16 v[24:27], a[164:167], v[60:63], v[24:27]
  ds_read_b64_tr_b16 a[50:51], v196 offset:4736
  v_mfma_f32_16x16x32_bf16 v[28:31], a[168:171], v[60:63], v[28:31]
  s_add_u32 s77, s75, 12288
  buffer_load_dwordx4 v[104:107], v13, s[8:11], s77 offen offset:2048 sc1
  v_mfma_f32_16x16x32_bf16 v[32:35], a[172:175], v[60:63], v[32:35]
  ds_read_b64_tr_b16 a[52:53], v196 offset:4256
VC35:
  s_waitcnt vmcnt(9)
  v_max3_u32 v8, v64, v67, v68
  v_max_u32 v8, v8, v71
  v_cmp_eq_u32 vcc, -1, v8
  s_cbranch_vccnz VR36
VK37:
  v_mfma_f32_16x16x32_bf16 v[16:19], a[176:179], v[64:67], v[16:19]
  v_mfma_f32_16x16x32_bf16 v[20:23], a[180:183], v[64:67], v[20:23]
  s_add_u32 s77, s75, 12288
  buffer_load_dwordx4 v[108:111], v13, s[8:11], s77 offen offset:3072 sc1
  ds_read_b64_tr_b16 a[54:55], v196 offset:4768
  v_mfma_f32_16x16x32_bf16 v[24:27], a[184:187], v[64:67], v[24:27]
  v_mfma_f32_16x16x32_bf16 v[28:31], a[188:191], v[64:67], v[28:31]
  ds_read_b64_tr_b16 a[56:57], v196 offset:4288
  v_mfma_f32_16x16x32_bf16 v[32:35], a[192:195], v[64:67], v[32:35]
  s_add_u32 s77, s75, 16384
  buffer_load_dwordx4 v[112:115], v13, s[8:11], s77 offen offset:0 sc1
  v_mfma_f32_16x16x32_bf16 v[16:19], a[196:199], v[68:71], v[16:19]
  ds_read_b64_tr_b16 a[58:59], v196 offset:4800
  v_mfma_f32_16x16x32_bf16 v[20:23], a[200:203], v[68:71], v[20:23]
  v_mfma_f32_16x16x32_bf16 v[24:27], a[204:207], v[68:71], v[24:27]
  s_add_u32 s77, s75, 16384
  buffer_load_dwordx4 v[116:119], v13, s[8:11], s77 offen offset:1024 sc1
  ds_read_b64_tr_b16 a[60:61], v196 offset:4320
  v_mfma_f32_16x16x32_bf16 v[28:31], a[208:211], v[68:71], v[28:31]
  v_mfma_f32_16x16x32_bf16 v[32:35], a[212:215], v[68:71], v[32:35]
  ds_read_b64_tr_b16 a[62:63], v196 offset:4832
VC38:
  s_waitcnt vmcnt(10)
  v_max3_u32 v8, v72, v75, v76
  v_max_u32 v8, v8, v79
  v_cmp_eq_u32 vcc, -1, v8
  s_cbranch_vccnz VR39
VK40:
  v_mfma_f32_16x16x32_bf16 v[16:19], a[216:219], v[72:75], v[16:19]
  s_add_u32 s77, s75, 16384
  buffer_load_dwordx4 v[120:123], v13, s[8:11], s77 offen offset:2048 sc1
  v_mfma_f32_16x16x32_bf16 v[20:23], a[220:223], v[72:75], v[20:23]
  v_mfma_f32_16x16x32_bf16 v[24:27], a[224:227], v[72:75], v[24:27]
  v_mfma_f32_16x16x32_bf16 v[28:31], a[228:231], v[72:75], v[28:31]
  s_add_u32 s77, s75, 16384
  buffer_load_dwordx4 v[124:127], v13, s[8:11], s77 offen offset:3072 sc1
  v_mfma_f32_16x16x32_bf16 v[32:35], a[232:235], v[72:75], v[32:35]
  v_mfma_f32_16x16x32_bf16 v[16:19], a[236:239], v[76:79], v[16:19]
  v_mfma_f32_16x16x32_bf16 v[20:23], a[240:243], v[76:79], v[20:23]
  v_mfma_f32_16x16x32_bf16 v[24:27], a[244:247], v[76:79], v[24:27]
  s_waitcnt lgkmcnt(0)
  s_add_u32 s78, s60, 4096
  s_and_b32 s78, s78, 0x3fff
  s_mul_i32 s78, s78, 96
  s_add_u32 m0, s85, 0
  s_nop 0
  buffer_load_dwordx4 v192, s[28:31], s78 offen offset:0 lds
  v_mfma_f32_16x16x32_bf16 v[28:31], a[248:251], v[76:79], v[28:31]
  v_mfma_f32_16x16x32_bf16 v[32:35], v[156:159], v[76:79], v[32:35]
VC41:
  s_waitcnt vmcnt(11)
  v_max3_u32 v8, v80, v83, v84
  v_max_u32 v8, v8, v87
  v_cmp_eq_u32 vcc, -1, v8
  s_cbranch_vccnz VR42
VK43:
  v_mfma_f32_16x16x32_bf16 v[16:19], v[160:163], v[80:83], v[16:19]
  ds_read_b64_tr_b16 v[148:149], v5 offset:10240
  ds_read_b64_tr_b16 v[150:151], v5 offset:10752
  v_mfma_f32_16x16x32_bf16 v[20:23], v[164:167], v[80:83], v[20:23]
  buffer_load_dwordx4 v193, s[28:31], s78 offen offset:1056 lds
  ds_read_b64_tr_b16 v[152:153], v5 offset:30720
  ds_read_b64_tr_b16 v[154:155], v5 offset:31232
  v_mfma_f32_16x16x32_bf16 v[24:27], v[168:171], v[80:83], v[24:27]
  ds_read_b64_tr_b16 v[156:157], v4 offset:11264
  ds_read_b64_tr_b16 v[158:159], v4 offset:11776
  v_mfma_f32_16x16x32_bf16 v[28:31], v[172:175], v[80:83], v[28:31]
  ds_read_b64_tr_b16 v[160:161], v4 offset:31744
  ds_read_b64_tr_b16 v[162:163], v4 offset:32256
  v_mfma_f32_16x16x32_bf16 v[32:35], v[176:179], v[80:83], v[32:35]
  ds_read_b64_tr_b16 v[164:165], v4 offset:52224
  ds_read_b64_tr_b16 v[166:167], v4 offset:52736
  v_mfma_f32_16x16x32_bf16 v[16:19], v[180:183], v[84:87], v[16:19]
  ds_read_b64_tr_b16 v[168:169], v5 offset:11264
  ds_read_b64_tr_b16 v[170:171], v5 offset:11776
  v_mfma_f32_16x16x32_bf16 v[20:23], v[184:187], v[84:87], v[20:23]
  buffer_load_dwordx4 v194, s[28:31], s78 offen offset:2112 lds
  ds_read_b64_tr_b16 v[172:173], v5 offset:31744
  ds_read_b64_tr_b16 v[174:175], v5 offset:32256
  v_mfma_f32_16x16x32_bf16 v[24:27], v[188:191], v[84:87], v[24:27]
  ds_read_b64_tr_b16 v[176:177], v4 offset:12288
  ds_read_b64_tr_b16 v[178:179], v4 offset:12800
  v_mfma_f32_16x16x32_bf16 v[28:31], v[128:131], v[84:87], v[28:31]
  ds_read_b64_tr_b16 v[180:181], v4 offset:32768
  ds_read_b64_tr_b16 v[182:183], v4 offset:33280
  v_mfma_f32_16x16x32_bf16 v[32:35], v[132:135], v[84:87], v[32:35]
VC44:
  s_waitcnt vmcnt(11)
  v_max3_u32 v8, v88, v91, v92
  v_max_u32 v8, v8, v95
  v_cmp_eq_u32 vcc, -1, v8
  s_cbranch_vccnz VR45
VK46:
  ds_read_b64_tr_b16 v[184:185], v4 offset:53248
  ds_read_b64_tr_b16 v[186:187], v4 offset:53760
  v_mfma_f32_16x16x32_bf16 v[16:19], v[136:139], v[88:91], v[16:19]
  buffer_load_dwordx4 v195, s[28:31], s78 offen offset:3168 lds
  ds_read_b64_tr_b16 v[188:189], v5 offset:12288
  ds_read_b64_tr_b16 v[190:191], v5 offset:12800
  v_mfma_f32_16x16x32_bf16 v[20:23], v[140:143], v[88:91], v[20:23]
  ds_read_b64_tr_b16 v[128:129], v5 offset:32768
  ds_read_b64_tr_b16 v[130:131], v5 offset:33280
  v_mfma_f32_16x16x32_bf16 v[24:27], v[144:147], v[88:91], v[24:27]
  ds_read_b64_tr_b16 v[132:133], v4 offset:13312
  ds_read_b64_tr_b16 v[134:135], v4 offset:13824
  s_waitcnt lgkmcnt(15)
  v_mfma_f32_16x16x32_bf16 v[28:31], v[148:151], v[88:91], v[28:31]
  ds_read_b64_tr_b16 v[136:137], v4 offset:33792
  ds_read_b64_tr_b16 v[138:139], v4 offset:34304
  v_mfma_f32_16x16x32_bf16 v[32:35], v[152:155], v[88:91], v[32:35]
  ds_read_b64_tr_b16 v[140:141], v4 offset:54272
  ds_read_b64_tr_b16 v[142:143], v4 offset:54784
  v_mfma_f32_16x16x32_bf16 v[16:19], v[156:159], v[92:95], v[16:19]
  s_add_u32 s78, s60, 5120
  s_and_b32 s78, s78, 0x3fff
  s_mul_i32 s78, s78, 96
  s_add_u32 m0, s85, 4224
  s_nop 0
  buffer_load_dwordx4 v192, s[28:31], s78 offen offset:0 lds
  ds_read_b64_tr_b16 v[144:145], v5 offset:13312
  ds_read_b64_tr_b16 v[146:147], v5 offset:13824
  v_mfma_f32_16x16x32_bf16 v[20:23], v[160:163], v[92:95], v[20:23]
  ds_read_b64_tr_b16 v[148:149], v5 offset:33792
  ds_read_b64_tr_b16 v[150:151], v5 offset:34304
  v_mfma_f32_16x16x32_bf16 v[24:27], v[164:167], v[92:95], v[24:27]
  ds_read_b64_tr_b16 v[152:153], v4 offset:14336
  ds_read_b64_tr_b16 v[154:155], v4 offset:14848
  s_waitcnt lgkmcnt(15)
  v_mfma_f32_16x16x32_bf16 v[28:31], v[168:171], v[92:95], v[28:31]
  ds_read_b64_tr_b16 v[156:157], v4 offset:34816
  ds_read_b64_tr_b16 v[158:159], v4 offset:35328
  v_mfma_f32_16x16x32_bf16 v[32:35], v[172:175], v[92:95], v[32:35]
  buffer_load_dwordx4 v193, s[28:31], s78 offen offset:1056 lds
VC47:
  s_waitcnt vmcnt(12)
  v_max3_u32 v8, v96, v99, v100
  v_max_u32 v8, v8, v103
  v_cmp_eq_u32 vcc, -1, v8
  s_cbranch_vccnz VR48
VK49:
  ds_read_b64_tr_b16 v[160:161], v4 offset:55296
  ds_read_b64_tr_b16 v[162:163], v4 offset:55808
  v_mfma_f32_16x16x32_bf16 v[16:19], v[176:179], v[96:99], v[16:19]
  ds_read_b64_tr_b16 v[164:165], v5 offset:14336
  ds_read_b64_tr_b16 v[166:167], v5 offset:14848
  v_mfma_f32_16x16x32_bf16 v[20:23], v[180:183], v[96:99], v[20:23]
  ds_read_b64_tr_b16 v[168:169], v5 offset:34816
  ds_read_b64_tr_b16 v[170:171], v5 offset:35328
  v_mfma_f32_16x16x32_bf16 v[24:27], v[184:187], v[96:99], v[24:27]
  ds_read_b64_tr_b16 v[172:173], v4 offset:15360
  ds_read_b64_tr_b16 v[174:175], v4 offset:15872
  s_waitcnt lgkmcnt(15)
  v_mfma_f32_16x16x32_bf16 v[28:31], v[188:191], v[96:99], v[28:31]
  ds_read_b64_tr_b16 v[176:177], v4 offset:35840
  ds_read_b64_tr_b16 v[178:179], v4 offset:36352
  v_mfma_f32_16x16x32_bf16 v[32:35], v[128:131], v[96:99], v[32:35]
  buffer_load_dwordx4 v194, s[28:31], s78 offen offset:2112 lds
  ds_read_b64_tr_b16 v[180:181], v4 offset:56320
  ds_read_b64_tr_b16 v[182:183], v4 offset:56832
  v_mfma_f32_16x16x32_bf16 v[16:19], v[132:135], v[100:103], v[16:19]
  ds_read_b64_tr_b16 v[184:185], v5 offset:15360
  ds_read_b64_tr_b16 v[186:187], v5 offset:15872
  v_mfma_f32_16x16x32_bf16 v[20:23], v[136:139], v[100:103], v[20:23]
  ds_read_b64_tr_b16 v[188:189], v5 offset:35840
  ds_read_b64_tr_b16 v[190:191], v5 offset:36352
  v_mfma_f32_16x16x32_bf16 v[24:27], v[140:143], v[100:103], v[24:27]
  ds_read_b64_tr_b16 v[128:129], v4 offset:16384
  ds_read_b64_tr_b16 v[130:131], v4 offset:16896
  s_waitcnt lgkmcnt(15)
  v_mfma_f32_16x16x32_bf16 v[28:31], v[144:147], v[100:103], v[28:31]
  ds_read_b64_tr_b16 v[132:133], v4 offset:36864
  ds_read_b64_tr_b16 v[134:135], v4 offset:37376
  v_mfma_f32_16x16x32_bf16 v[32:35], v[148:151], v[100:103], v[32:35]
  buffer_load_dwordx4 v195, s[28:31], s78 offen offset:3168 lds
VC50:
  s_waitcnt vmcnt(12)
  v_max3_u32 v8, v104, v107, v108
  v_max_u32 v8, v8, v111
  v_cmp_eq_u32 vcc, -1, v8
  s_cbranch_vccnz VR51
VK52:
  ds_read_b64_tr_b16 v[136:137], v4 offset:57344
  ds_read_b64_tr_b16 v[138:139], v4 offset:57856
  v_mfma_f32_16x16x32_bf16 v[16:19], v[152:155], v[104:107], v[16:19]
  ds_read_b64_tr_b16 v[140:141], v5 offset:16384
  ds_read_b64_tr_b16 v[142:143], v5 offset:16896
  v_mfma_f32_16x16x32_bf16 v[20:23], v[156:159], v[104:107], v[20:23]
  ds_read_b64_tr_b16 v[144:145], v5 offset:36864
  ds_read_b64_tr_b16 v[146:147], v5 offset:37376
  v_mfma_f32_16x16x32_bf16 v[24:27], v[160:163], v[104:107], v[24:27]
  ds_read_b64_tr_b16 v[148:149], v4 offset:17408
  ds_read_b64_tr_b16 v[150:151], v4 offset:17920
  s_waitcnt lgkmcnt(15)
  v_mfma_f32_16x16x32_bf16 v[28:31], v[164:167], v[104:107], v[28:31]
  ds_read_b64_tr_b16 v[152:153], v4 offset:37888
  ds_read_b64_tr_b16 v[154:155], v4 offset:38400
  v_mfma_f32_16x16x32_bf16 v[32:35], v[168:171], v[104:107], v[32:35]
  ds_read_b64_tr_b16 v[156:157], v4 offset:58368
  ds_read_b64_tr_b16 v[158:159], v4 offset:58880
  v_mfma_f32_16x16x32_bf16 v[16:19], v[172:175], v[108:111], v[16:19]
  ds_read_b64_tr_b16 v[160:161], v5 offset:17408
  ds_read_b64_tr_b16 v[162:163], v5 offset:17920
  v_mfma_f32_16x16x32_bf16 v[20:23], v[176:179], v[108:111], v[20:23]
  ds_read_b64_tr_b16 v[164:165], v5 offset:37888
  ds_read_b64_tr_b16 v[166:167], v5 offset:38400
  v_mfma_f32_16x16x32_bf16 v[24:27], v[180:183], v[108:111], v[24:27]
  ds_read_b64_tr_b16 v[168:169], v4 offset:18432
  ds_read_b64_tr_b16 v[170:171], v4 offset:18944
  s_waitcnt lgkmcnt(15)
  v_mfma_f32_16x16x32_bf16 v[28:31], v[184:187], v[108:111], v[28:31]
  ds_read_b64_tr_b16 v[172:173], v4 offset:38912
  ds_read_b64_tr_b16 v[174:175], v4 offset:39424
  v_mfma_f32_16x16x32_bf16 v[32:35], v[188:191], v[108:111], v[32:35]
VC53:
  s_waitcnt vmcnt(10)
  v_max3_u32 v8, v112, v115, v116
  v_max_u32 v8, v8, v119
  v_cmp_eq_u32 vcc, -1, v8
  s_cbranch_vccnz VR54
VK55:
  ds_read_b64_tr_b16 v[176:177], v4 offset:59392
  ds_read_b64_tr_b16 v[178:179], v4 offset:59904
  v_mfma_f32_16x16x32_bf16 v[16:19], v[128:131], v[112:115], v[16:19]
  ds_read_b64_tr_b16 v[180:181], v5 offset:18432
  ds_read_b64_tr_b16 v[182:183], v5 offset:18944
  v_mfma_f32_16x16x32_bf16 v[20:23], v[132:135], v[112:115], v[20:23]
  ds_read_b64_tr_b16 v[184:185], v5 offset:38912
  ds_read_b64_tr_b16 v[186:187], v5 offset:39424
  v_mfma_f32_16x16x32_bf16 v[24:27], v[136:139], v[112:115], v[24:27]
  ds_read_b64_tr_b16 v[188:189], v4 offset:19456
  ds_read_b64_tr_b16 v[190:191], v4 offset:19968
  s_waitcnt lgkmcnt(15)
  v_mfma_f32_16x16x32_bf16 v[28:31], v[140:143], v[112:115], v[28:31]
  ds_read_b64_tr_b16 v[128:129], v4 offset:39936
  ds_read_b64_tr_b16 v[130:131], v4 offset:40448
  v_mfma_f32_16x16x32_bf16 v[32:35], v[144:147], v[112:115], v[32:35]
  ds_read_b64_tr_b16 v[132:133], v4 offset:60416
  ds_read_b64_tr_b16 v[134:135], v4 offset:60928
  v_mfma_f32_16x16x32_bf16 v[16:19], v[148:151], v[116:119], v[16:19]
  ds_read_b64_tr_b16 v[136:137], v5 offset:19456
  ds_read_b64_tr_b16 v[138:139], v5 offset:19968
  v_mfma_f32_16x16x32_bf16 v[20:23], v[152:155], v[116:119], v[20:23]
  ds_read_b64_tr_b16 v[140:141], v5 offset:39936
  ds_read_b64_tr_b16 v[142:143], v5 offset:40448
  v_mfma_f32_16x16x32_bf16 v[24:27], v[156:159], v[116:119], v[24:27]
  s_waitcnt lgkmcnt(15)
  v_mfma_f32_16x16x32_bf16 v[28:31], v[160:163], v[116:119], v[28:31]
  v_mfma_f32_16x16x32_bf16 v[32:35], v[164:167], v[116:119], v[32:35]
VC56:
  s_waitcnt vmcnt(8)
  v_max3_u32 v8, v120, v123, v124
  v_max_u32 v8, v8, v127
  v_cmp_eq_u32 vcc, -1, v8
  s_cbranch_vccnz VR57
VK58:
  v_mfma_f32_16x16x32_bf16 v[16:19], v[168:171], v[120:123], v[16:19]
  v_mfma_f32_16x16x32_bf16 v[20:23], v[172:175], v[120:123], v[20:23]
  s_waitcnt lgkmcnt(14)
  v_mfma_f32_16x16x32_bf16 v[24:27], v[176:179], v[120:123], v[24:27]
  s_waitcnt lgkmcnt(12)
  v_mfma_f32_16x16x32_bf16 v[28:31], v[180:183], v[120:123], v[28:31]
  s_waitcnt lgkmcnt(10)
  v_mfma_f32_16x16x32_bf16 v[32:35], v[184:187], v[120:123], v[32:35]
  s_waitcnt lgkmcnt(8)
  v_mfma_f32_16x16x32_bf16 v[16:19], v[188:191], v[124:127], v[16:19]
  s_waitcnt lgkmcnt(6)
  v_mfma_f32_16x16x32_bf16 v[20:23], v[128:131], v[124:127], v[20:23]
  s_waitcnt lgkmcnt(4)
  v_mfma_f32_16x16x32_bf16 v[24:27], v[132:135], v[124:127], v[24:27]
  s_waitcnt lgkmcnt(2)
  v_mfma_f32_16x16x32_bf16 v[28:31], v[136:139], v[124:127], v[28:31]
  s_waitcnt lgkmcnt(0)
  v_mfma_f32_16x16x32_bf16 v[32:35], v[140:143], v[124:127], v[32:35]
  v_cvt_pk_bf16_f32 v236, v16, v17
  v_cvt_pk_bf16_f32 v237, v18, v19
  v_cvt_pk_bf16_f32 v238, v20, v21
  v_cvt_pk_bf16_f32 v239, v22, v23
  v_cvt_pk_bf16_f32 v240, v24, v25
  v_cvt_pk_bf16_f32 v241, v26, v27
  v_cvt_pk_bf16_f32 v242, v28, v29
  v_cvt_pk_bf16_f32 v243, v30, v31
  v_cvt_pk_bf16_f32 v244, v32, v33
  v_cvt_pk_bf16_f32 v245, v34, v35
  v_lshlrev_b32 v16, 16, v236
  v_and_b32 v17, 0xffff0000, v236
  v_lshlrev_b32 v18, 16, v237
  v_and_b32 v19, 0xffff0000, v237
  v_lshlrev_b32 v20, 16, v238
  v_and_b32 v21, 0xffff0000, v238
  v_lshlrev_b32 v22, 16, v239
  v_and_b32 v23, 0xffff0000, v239
  v_lshlrev_b32 v24, 16, v240
  v_and_b32 v25, 0xffff0000, v240
  v_lshlrev_b32 v26, 16, v241
  v_and_b32 v27, 0xffff0000, v241
  v_lshlrev_b32 v28, 16, v242
  v_and_b32 v29, 0xffff0000, v242
  v_lshlrev_b32 v30, 16, v243
  v_and_b32 v31, 0xffff0000, v243
  v_lshlrev_b32 v32, 16, v244
  v_and_b32 v33, 0xffff0000, v244
  v_lshlrev_b32 v34, 16, v245
  v_and_b32 v35, 0xffff0000, v245
  v_pk_add_f32 v[8:9], v[16:17], v[18:19]
  v_pk_mul_f32 v[10:11], v[16:17], v[16:17]
  v_pk_fma_f32 v[10:11], v[18:19], v[18:19], v[10:11]
  v_pk_add_f32 v[8:9], v[8:9], v[20:21]
  v_pk_fma_f32 v[10:11], v[20:21], v[20:21], v[10:11]
  v_pk_add_f32 v[8:9], v[8:9], v[22:23]
  v_pk_fma_f32 v[10:11], v[22:23], v[22:23], v[10:11]
  v_pk_add_f32 v[8:9], v[8:9], v[24:25]
  v_pk_fma_f32 v[10:11], v[24:25], v[24:25], v[10:11]
  v_pk_add_f32 v[8:9], v[8:9], v[26:27]
  v_pk_fma_f32 v[10:11], v[26:27], v[26:27], v[10:11]
  v_pk_add_f32 v[8:9], v[8:9], v[28:29]
  v_pk_fma_f32 v[10:11], v[28:29], v[28:29], v[10:11]
  v_pk_add_f32 v[8:9], v[8:9], v[30:31]
  v_pk_fma_f32 v[10:11], v[30:31], v[30:31], v[10:11]
  v_pk_add_f32 v[8:9], v[8:9], v[32:33]
  v_pk_fma_f32 v[10:11], v[32:33], v[32:33], v[10:11]
  v_pk_add_f32 v[8:9], v[8:9], v[34:35]
  v_pk_fma_f32 v[10:11], v[34:35], v[34:35], v[10:11]
  v_add_f32 v8, v8, v9
  v_add_f32 v9, v10, v11
  v_mov_b32 v10, v8
  v_mov_b32 v11, v9
  s_nop 0
  v_permlane16_swap_b32 v8, v10
  v_permlane16_swap_b32 v9, v11
  v_add_f32 v8, v8, v10
  v_add_f32 v9, v9, v11
  v_mov_b32 v10, v8
  v_mov_b32 v11, v9
  s_nop 0
  v_permlane32_swap_b32 v8, v10
  v_permlane32_swap_b32 v9, v11
  v_add_f32 v8, v8, v10
  v_add_f32 v9, v9, v11
  v_lshlrev_b32 v12, 3, v1
  v_cmp_gt_u32 vcc, 16, v1
  v_mov_b32 v14, 1073741824
  s_nop 0
  v_cndmask_b32 v14, v14, v12, vcc
  s_lshl_b32 s76, s59, 10
  s_add_u32 s76, s76, 12713984
  s_lshl_b32 s77, s55, 7
  s_add_u32 s77, s77, s76
  buffer_store_dwordx2 v[8:9], v14, s[8:11], s77 offen sc1
  s_barrier
  s_add_u32 s78, s60, 6144
  s_and_b32 s78, s78, 0x3fff
  s_mul_i32 s78, s78, 96
  s_add_u32 m0, s84, 0
  s_nop 0
  buffer_load_dwordx4 v192, s[28:31], s78 offen offset:0 lds
  buffer_load_dwordx4 v193, s[28:31], s78 offen offset:1056 lds
  buffer_load_dwordx4 v194, s[28:31], s78 offen offset:2112 lds
  buffer_load_dwordx4 v195, s[28:31], s78 offen offset:3168 lds
  s_add_u32 s78, s60, 7168
  s_and_b32 s78, s78, 0x3fff
  s_mul_i32 s78, s78, 96
  s_add_u32 m0, s84, 4224
  s_nop 0
  buffer_load_dwordx4 v192, s[28:31], s78 offen offset:0 lds
  buffer_load_dwordx4 v193, s[28:31], s78 offen offset:1056 lds
  buffer_load_dwordx4 v194, s[28:31], s78 offen offset:2112 lds
  buffer_load_dwordx4 v195, s[28:31], s78 offen offset:3168 lds
  s_add_u32 s78, s60, 8192
  s_and_b32 s78, s78, 0x3fff
  s_mul_i32 s78, s78, 96
  s_add_u32 m0, s84, 8448
  s_nop 0
  buffer_load_dwordx4 v192, s[28:31], s78 offen offset:0 lds
  buffer_load_dwordx4 v193, s[28:31], s78 offen offset:1056 lds
  buffer_load_dwordx4 v194, s[28:31], s78 offen offset:2112 lds
  buffer_load_dwordx4 v195, s[28:31], s78 offen offset:3168 lds
  s_add_u32 s78, s60, 9216
  s_and_b32 s78, s78, 0x3fff
  s_mul_i32 s78, s78, 96
  s_add_u32 m0, s84, 12672
  s_nop 0
  buffer_load_dwordx4 v192, s[28:31], s78 offen offset:0 lds
  buffer_load_dwordx4 v193, s[28:31], s78 offen offset:1056 lds
  buffer_load_dwordx4 v194, s[28:31], s78 offen offset:2112 lds
  buffer_load_dwordx4 v195, s[28:31], s78 offen offset:3168 lds
  s_waitcnt vmcnt(17)
  ds_read_b64_tr_b16 a[64:65], v196 offset:0
  ds_read_b64_tr_b16 a[66:67], v196 offset:512
  ds_read_b64_tr_b16 a[68:69], v196 offset:32
  ds_read_b64_tr_b16 a[70:71], v196 offset:544
  ds_read_b64_tr_b16 a[72:73], v196 offset:64
  ds_read_b64_tr_b16 a[74:75], v196 offset:576
  ds_read_b64_tr_b16 a[76:77], v196 offset:96
  ds_read_b64_tr_b16 a[78:79], v196 offset:608
  ds_read_b64_tr_b16 a[80:81], v196 offset:4224
  ds_read_b64_tr_b16 a[82:83], v196 offset:4736
  ds_read_b64_tr_b16 a[84:85], v196 offset:4256
  ds_read_b64_tr_b16 a[86:87], v196 offset:4768
  ds_read_b64_tr_b16 a[88:89], v196 offset:4288
  ds_read_b64_tr_b16 a[90:91], v196 offset:4800
  ds_read_b64_tr_b16 a[92:93], v196 offset:4320
  ds_read_b64_tr_b16 a[94:95], v196 offset:4832
  v_and_b32 v12, 15, v1
  v_lshlrev_b32 v12, 3, v12
  v_lshrrev_b32 v14, 4, v1
  v_lshl_add_u32 v12, v14, 8, v12
  v_and_b32 v7, 15, v1
  v_lshlrev_b32 v7, 5, v7
  v_lshl_add_u32 v7, v14, 3, v7
  s_lshl_b32 s66, s52, 9
  s_add_u32 s66, s66, 106496
  v_add_u32 v7, s66, v7
  v_add_u32 v6, s87, v6
  s_mul_i32 s70, s55, 5
  s_lshr_b32 s68, s52, 1
  s_add_u32 s70, s70, s68
  s_lshl_b32 s70, s70, 16
  s_lshl_b32 s68, s56, 1
  s_and_b32 s69, s52, 1
  s_add_u32 s68, s68, s69
  s_lshl_b32 s68, s68, 10
  s_add_u32 s70, s70, s68
  s_add_u32 s70, s70, 12845056
  s_add_u32 s71, s70, 131072
  s_add_u32 s72, s70, 262144
  s_cmp_lt_u32 s52, 2
  s_cselect_b32 s72, s72, 1073741824
  s_mov_b32 s67, 262144
  buffer_load_dwordx2 v[48:49], v12, s[8:11], s76 offen sc1
  buffer_load_dwordx2 v[50:51], v12, s[8:11], s76 offen offset:128 sc1
  s_waitcnt vmcnt(1)
  v_cmp_eq_u32 vcc, -1, v48
  s_waitcnt vmcnt(0)
  v_cmp_eq_u32 s[68:69], -1, v50
  s_or_b64 vcc, vcc, s[68:69]
  s_cmp_eq_u64 vcc, 0
  s_cbranch_scc0 P59
PD60:
  v_add_f32 v8, v48, v50
  v_add_f32 v9, v49, v51
  v_mov_b32 v10, v8
  v_mov_b32 v11, v9
  s_nop 0
  v_permlane16_swap_b32 v8, v10
  v_permlane16_swap_b32 v9, v11
  v_add_f32 v8, v8, v10
  v_add_f32 v9, v9, v11
  v_mov_b32 v10, v8
  v_mov_b32 v11, v9
  s_nop 0
  v_permlane32_swap_b32 v8, v10
  v_permlane32_swap_b32 v9, v11
  v_add_f32 v8, v8, v10
  v_add_f32 v9, v9, v11
  v_mul_f32 v8, 0xbacccccd, v8
  v_mul_f32 v9, 0x3acccccd, v9
  v_fma_f32 v9, -v8, v8, v9
  v_max_f32 v9, 0, v9
  v_add_f32 v10, 0x3727c5ac, v9
  v_rsq_f32 v10, v10
  s_nop 0
  v_mul_f32 v9, v9, v10
  v_mov_b32 v11, 0x3727c5ac
  v_fma_f32 v9, v9, v10, v11
  v_rsq_f32 v9, v9
  s_nop 0
  v_mul_f32 v10, v10, v9
  v_mul_f32 v8, v8, v10
  v_pk_fma_f32 v[16:17], v[16:17], v[10:11], v[8:9] op_sel_hi:[1,0,0]
  s_nop 0
  v_cvt_pk_bf16_f32 v36, v16, v17
  v_pk_fma_f32 v[18:19], v[18:19], v[10:11], v[8:9] op_sel_hi:[1,0,0]
  s_nop 0
  v_cvt_pk_bf16_f32 v37, v18, v19
  v_pk_fma_f32 v[20:21], v[20:21], v[10:11], v[8:9] op_sel_hi:[1,0,0]
  s_nop 0
  v_cvt_pk_bf16_f32 v38, v20, v21
  v_pk_fma_f32 v[22:23], v[22:23], v[10:11], v[8:9] op_sel_hi:[1,0,0]
  s_nop 0
  v_cvt_pk_bf16_f32 v39, v22, v23
  v_pk_fma_f32 v[24:25], v[24:25], v[10:11], v[8:9] op_sel_hi:[1,0,0]
  s_nop 0
  v_cvt_pk_bf16_f32 v40, v24, v25
  v_pk_fma_f32 v[26:27], v[26:27], v[10:11], v[8:9] op_sel_hi:[1,0,0]
  s_nop 0
  v_cvt_pk_bf16_f32 v41, v26, v27
  v_pk_fma_f32 v[28:29], v[28:29], v[10:11], v[8:9] op_sel_hi:[1,0,0]
  s_nop 0
  v_cvt_pk_bf16_f32 v42, v28, v29
  v_pk_fma_f32 v[30:31], v[30:31], v[10:11], v[8:9] op_sel_hi:[1,0,0]
  s_nop 0
  v_cvt_pk_bf16_f32 v43, v30, v31
  v_pk_fma_f32 v[32:33], v[32:33], v[10:11], v[8:9] op_sel_hi:[1,0,0]
  s_nop 0
  v_cvt_pk_bf16_f32 v44, v32, v33
  v_pk_fma_f32 v[34:35], v[34:35], v[10:11], v[8:9] op_sel_hi:[1,0,0]
  s_nop 0
  v_cvt_pk_bf16_f32 v45, v34, v35
  ds_write_b64 v7, v[36:37] offset:0
  ds_write_b64 v7, v[38:39] offset:2048
  ds_write_b64 v7, v[40:41] offset:4096
  ds_write_b64 v7, v[42:43] offset:6144
  ds_write_b64 v7, v[44:45] offset:8192
  s_waitcnt lgkmcnt(0)
  s_barrier
  ds_read_b64_tr_b16 v[48:49], v6 offset:0
  ds_read_b64_tr_b16 v[50:51], v6 offset:512
  ds_read_b64_tr_b16 v[52:53], v6 offset:4096
  ds_read_b64_tr_b16 v[54:55], v6 offset:4608
  ds_read_b64_tr_b16 v[56:57], v6 offset:8192
  ds_read_b64_tr_b16 v[58:59], v6 offset:8704
  s_waitcnt lgkmcnt(4)
  buffer_store_dwordx4 v[48:51], v13, s[8:11], s70 offen sc1
  s_waitcnt lgkmcnt(2)
  buffer_store_dwordx4 v[52:55], v13, s[8:11], s71 offen sc1
  s_waitcnt lgkmcnt(0)
  buffer_store_dwordx4 v[56:59], v13, s[8:11], s72 offen sc1
  ds_read_b64_tr_b16 a[96:97], v197 offset:0
  ds_read_b64_tr_b16 a[98:99], v197 offset:512
  ds_read_b64_tr_b16 a[100:101], v197 offset:32
  ds_read_b64_tr_b16 a[102:103], v197 offset:544
  ds_read_b64_tr_b16 a[104:105], v197 offset:64
  ds_read_b64_tr_b16 a[106:107], v197 offset:576
  ds_read_b64_tr_b16 a[108:109], v197 offset:96
  ds_read_b64_tr_b16 a[110:111], v197 offset:608
  ds_read_b64_tr_b16 a[112:113], v197 offset:4224
  ds_read_b64_tr_b16 a[114:115], v197 offset:4736
  ds_read_b64_tr_b16 a[116:117], v197 offset:4256
  ds_read_b64_tr_b16 a[118:119], v197 offset:4768
  ds_read_b64_tr_b16 a[120:121], v197 offset:4288
  ds_read_b64_tr_b16 a[122:123], v197 offset:4800
  ds_read_b64_tr_b16 a[124:125], v197 offset:4320
  ds_read_b64_tr_b16 a[126:127], v197 offset:4832
  ds_read_b64_tr_b16 a[128:129], v197 offset:8448
  ds_read_b64_tr_b16 a[130:131], v197 offset:8960
  ds_read_b64_tr_b16 a[132:133], v197 offset:8480
  ds_read_b64_tr_b16 a[134:135], v197 offset:8992
  ds_read_b64_tr_b16 a[136:137], v197 offset:8512
  ds_read_b64_tr_b16 a[138:139], v197 offset:9024
  ds_read_b64_tr_b16 a[140:141], v197 offset:8544
  ds_read_b64_tr_b16 a[142:143], v197 offset:9056
  ds_read_b64_tr_b16 a[144:145], v197 offset:12672
  ds_read_b64_tr_b16 a[146:147], v197 offset:13184
  ds_read_b64_tr_b16 a[148:149], v197 offset:12704
  ds_read_b64_tr_b16 a[150:151], v197 offset:13216
  ds_read_b64_tr_b16 a[152:153], v197 offset:12736
  ds_read_b64_tr_b16 a[154:155], v197 offset:13248
  ds_read_b64_tr_b16 a[156:157], v197 offset:12768
  ds_read_b64_tr_b16 a[158:159], v197 offset:13280
  s_add_u32 s78, s60, 10240
  s_and_b32 s78, s78, 0x3fff
  s_mul_i32 s78, s78, 96
  s_add_u32 m0, s84, 16896
  s_nop 0
  buffer_load_dwordx4 v192, s[28:31], s78 offen offset:0 lds
  buffer_load_dwordx4 v193, s[28:31], s78 offen offset:1056 lds
  buffer_load_dwordx4 v194, s[28:31], s78 offen offset:2112 lds
  buffer_load_dwordx4 v195, s[28:31], s78 offen offset:3168 lds
  s_add_u32 s78, s60, 11264
  s_and_b32 s78, s78, 0x3fff
  s_mul_i32 s78, s78, 96
  s_add_u32 m0, s84, 21120
  s_nop 0
  buffer_load_dwordx4 v192, s[28:31], s78 offen offset:0 lds
  buffer_load_dwordx4 v193, s[28:31], s78 offen offset:1056 lds
  buffer_load_dwordx4 v194, s[28:31], s78 offen offset:2112 lds
  buffer_load_dwordx4 v195, s[28:31], s78 offen offset:3168 lds
  s_add_u32 s78, s60, 12288
  s_and_b32 s78, s78, 0x3fff
  s_mul_i32 s78, s78, 96
  s_add_u32 m0, s85, 0
  s_nop 0
  buffer_load_dwordx4 v192, s[28:31], s78 offen offset:0 lds
  buffer_load_dwordx4 v193, s[28:31], s78 offen offset:1056 lds
  buffer_load_dwordx4 v194, s[28:31], s78 offen offset:2112 lds
  buffer_load_dwordx4 v195, s[28:31], s78 offen offset:3168 lds
  s_add_u32 s78, s60, 13312
  s_and_b32 s78, s78, 0x3fff
  s_mul_i32 s78, s78, 96
  s_add_u32 m0, s85, 4224
  s_nop 0
  buffer_load_dwordx4 v192, s[28:31], s78 offen offset:0 lds
  buffer_load_dwordx4 v193, s[28:31], s78 offen offset:1056 lds
  buffer_load_dwordx4 v194, s[28:31], s78 offen offset:2112 lds
  buffer_load_dwordx4 v195, s[28:31], s78 offen offset:3168 lds
  s_waitcnt lgkmcnt(15)
  s_add_u32 s78, s60, 14336
  s_and_b32 s78, s78, 0x3fff
  s_mul_i32 s78, s78, 96
  s_add_u32 m0, s84, 0
  s_nop 0
  buffer_load_dwordx4 v192, s[28:31], s78 offen offset:0 lds
  buffer_load_dwordx4 v193, s[28:31], s78 offen offset:1056 lds
  buffer_load_dwordx4 v194, s[28:31], s78 offen offset:2112 lds
  buffer_load_dwordx4 v195, s[28:31], s78 offen offset:3168 lds
  s_add_u32 s78, s60, 15360
  s_and_b32 s78, s78, 0x3fff
  s_mul_i32 s78, s78, 96
  s_add_u32 m0, s84, 4224
  s_nop 0
  buffer_load_dwordx4 v192, s[28:31], s78 offen offset:0 lds
  buffer_load_dwordx4 v193, s[28:31], s78 offen offset:1056 lds
  buffer_load_dwordx4 v194, s[28:31], s78 offen offset:2112 lds
  buffer_load_dwordx4 v195, s[28:31], s78 offen offset:3168 lds
  v_lshrrev_b32 v6, 3, v1
  v_lshlrev_b32 v6, 14, v6
  v_and_b32 v7, 7, v1
  v_lshl_add_u32 v6, v7, 4, v6
  s_mul_i32 s66, s52, 1572864
  s_lshl_b32 s67, s56, 7
  s_add_u32 s66, s66, s67
  v_add_u32 v198, s66, v6
  v_add_u32 v199, 3040, v198
  v_add_u32 v200, 6080, v198
  v_add_u32 v201, 9120, v198
  v_subrev_u32 v6, s84, v197
  v_add_u32 v6, s86, v6
  s_add_u32 s66, s52, 0
  s_and_b32 s66, s66, 3
  s_lshl_b32 s66, s66, 5
  v_add_u32 v202, s66, v6
  s_add_u32 s66, s52, 1
  s_and_b32 s66, s66, 3
  s_lshl_b32 s66, s66, 5
  v_add_u32 v203, s66, v6
  s_add_u32 s66, s52, 2
  s_and_b32 s66, s66, 3
  s_lshl_b32 s66, s66, 5
  v_add_u32 v204, s66, v6
  s_add_u32 s66, s52, 3
  s_and_b32 s66, s66, 3
  s_lshl_b32 s66, s66, 5
  v_add_u32 v205, s66, v6
  s_mul_i32 s66, s55, 245760
  s_mul_i32 s67, s52, 12288
  s_add_u32 s66, s66, s67
  s_add_u32 s79, s66, 15466496
  v_add_u32 v210, s79, v13
  v_add_u32 v211, 49152, v210
  v_add_u32 v212, 98304, v210
  v_add_u32 v213, 147456, v210
  v_add_u32 v214, 196608, v210
  v_and_b32 v6, 15, v1
  v_lshlrev_b32 v6, 1, v6
  s_lshl_b32 s66, s59, 5
  buffer_load_ushort v246, v6, s[40:43], s66 offen
  s_cmp_eq_u32 s58, 100
  s_cbranch_scc1 ID61
  v_lshrrev_b32 v2, 4, v1
  v_lshlrev_b32 v2, 3, v2
  s_lshl_b32 s66, s57, 7
  buffer_load_dwordx2 v[184:185], v2, s[36:39], s66 offen offset:0
  buffer_load_dwordx2 v[186:187], v2, s[36:39], s66 offen offset:32
  buffer_load_dwordx2 v[188:189], v2, s[36:39], s66 offen offset:64
  buffer_load_dwordx2 v[190:191], v2, s[36:39], s66 offen offset:96
  s_lshl_b32 s74, s58, 18
  s_lshl_b32 s67, s52, 14
  s_add_u32 s74, s74, s67
  s_add_u32 s74, s74, 12845056
  s_mov_b32 s82, 131072
  s_add_u32 s66, s52, 0
  s_and_b32 s66, s66, 3
  s_mul_i32 s67, s66, 38016
  s_lshl_b32 s66, s66, 16
  s_add_u32 s66, s66, s74
  v_add_u32 v206, s66, v13
  v_add_u32 v2, s67, v13
  s_add_u32 s66, s52, 1
  s_and_b32 s66, s66, 3
  s_mul_i32 s67, s66, 38016
  s_lshl_b32 s66, s66, 16
  s_add_u32 s66, s66, s74
  v_add_u32 v207, s66, v13
  v_add_u32 v3, s67, v13
  s_add_u32 s66, s52, 2
  s_and_b32 s66, s66, 3
  s_mul_i32 s67, s66, 38016
  s_lshl_b32 s66, s66, 16
  s_add_u32 s66, s66, s74
  v_add_u32 v208, s66, v13
  v_add_u32 v4, s67, v13
  s_add_u32 s66, s52, 3
  s_and_b32 s66, s66, 3
  s_mul_i32 s67, s66, 38016
  s_lshl_b32 s66, s66, 16
  s_add_u32 s66, s66, s74
  v_add_u32 v209, s66, v13
  v_add_u32 v5, s67, v13
  s_lshl_b32 s66, s58, 2
  s_add_u32 s66, s66, s52
  s_mul_i32 s66, s66, 49152
  s_lshl_b32 s67, s57, 11
  s_add_u32 s66, s66, s67
  s_add_u32 s73, s66, 15466496
  v_mov_b32 v6, 0xbdd2d3e8
  v_mov_b32 v8, 0xc0135761
  v_mov_b32 v10, 1.0
  s_waitcnt vmcnt(25)
  ds_read_b64_tr_b16 a[160:161], v197 offset:16896
  ds_read_b64_tr_b16 a[162:163], v197 offset:17408
  ds_read_b64_tr_b16 a[164:165], v197 offset:16928
  ds_read_b64_tr_b16 a[166:167], v197 offset:17440
  ds_read_b64_tr_b16 a[168:169], v197 offset:16960
  ds_read_b64_tr_b16 a[170:171], v197 offset:17472
  ds_read_b64_tr_b16 a[172:173], v197 offset:16992
  ds_read_b64_tr_b16 a[174:175], v197 offset:17504
  s_waitcnt vmcnt(21)
  ds_read_b64_tr_b16 a[176:177], v197 offset:21120
  ds_read_b64_tr_b16 a[178:179], v197 offset:21632
  ds_read_b64_tr_b16 a[180:181], v197 offset:21152
  ds_read_b64_tr_b16 a[182:183], v197 offset:21664
  ds_read_b64_tr_b16 a[184:185], v197 offset:21184
  ds_read_b64_tr_b16 a[186:187], v197 offset:21696
  ds_read_b64_tr_b16 a[188:189], v197 offset:21216
  ds_read_b64_tr_b16 a[190:191], v197 offset:21728
  s_waitcnt vmcnt(17)
  ds_read_b64_tr_b16 a[192:193], v196 offset:0
  ds_read_b64_tr_b16 a[194:195], v196 offset:512
  ds_read_b64_tr_b16 a[196:197], v196 offset:32
  ds_read_b64_tr_b16 a[198:199], v196 offset:544
  ds_read_b64_tr_b16 a[200:201], v196 offset:64
  ds_read_b64_tr_b16 a[202:203], v196 offset:576
  ds_read_b64_tr_b16 a[204:205], v196 offset:96
  ds_read_b64_tr_b16 a[206:207], v196 offset:608
  s_waitcnt vmcnt(13)
  ds_read_b64_tr_b16 a[208:209], v196 offset:4224
  ds_read_b64_tr_b16 a[210:211], v196 offset:4736
  ds_read_b64_tr_b16 a[212:213], v196 offset:4256
  ds_read_b64_tr_b16 a[214:215], v196 offset:4768
  ds_read_b64_tr_b16 a[216:217], v196 offset:4288
  ds_read_b64_tr_b16 a[218:219], v196 offset:4800
  ds_read_b64_tr_b16 a[220:221], v196 offset:4320
  ds_read_b64_tr_b16 a[222:223], v196 offset:4832
  s_mov_b32 s81, s60
  buffer_load_dwordx4 v[80:83], v206, s[8:11], s81 offen sc1
  buffer_load_dwordx4 v[84:87], v207, s[8:11], s81 offen sc1
  buffer_load_dwordx4 v[88:91], v208, s[8:11], s81 offen sc1
  buffer_load_dwordx4 v[92:95], v209, s[8:11], s81 offen sc1
  s_add_u32 s81, s60, 1024
  s_and_b32 s81, s81, 0x3fff
  buffer_load_dwordx4 v[96:99], v206, s[8:11], s81 offen sc1
  buffer_load_dwordx4 v[100:103], v207, s[8:11], s81 offen sc1
  buffer_load_dwordx4 v[104:107], v208, s[8:11], s81 offen sc1
  buffer_load_dwordx4 v[108:111], v209, s[8:11], s81 offen sc1
  s_add_u32 s81, s60, 2048
  s_and_b32 s81, s81, 0x3fff
  buffer_load_dwordx4 v[112:115], v206, s[8:11], s81 offen sc1
  buffer_load_dwordx4 v[116:119], v207, s[8:11], s81 offen sc1
  buffer_load_dwordx4 v[120:123], v208, s[8:11], s81 offen sc1
  buffer_load_dwordx4 v[124:127], v209, s[8:11], s81 offen sc1
  s_add_u32 s81, s60, 3072
  s_and_b32 s81, s81, 0x3fff
  buffer_load_dwordx4 v[128:131], v206, s[8:11], s81 offen sc1
  buffer_load_dwordx4 v[132:135], v207, s[8:11], s81 offen sc1
  buffer_load_dwordx4 v[136:139], v208, s[8:11], s81 offen sc1
  buffer_load_dwordx4 v[140:143], v209, s[8:11], s81 offen sc1
  s_waitcnt vmcnt(19)
  v_lshlrev_b32 v176, 16, v184
  v_and_b32 v177, 0xffff0000, v184
  v_lshlrev_b32 v178, 16, v185
  v_and_b32 v179, 0xffff0000, v185
  s_waitcnt vmcnt(18)
  v_lshlrev_b32 v180, 16, v186
  v_and_b32 v181, 0xffff0000, v186
  v_lshlrev_b32 v182, 16, v187
  v_and_b32 v183, 0xffff0000, v187
  s_waitcnt vmcnt(17)
  v_lshlrev_b32 v184, 16, v188
  v_and_b32 v185, 0xffff0000, v188
  v_lshlrev_b32 v186, 16, v189
  v_and_b32 v187, 0xffff0000, v189
  s_waitcnt vmcnt(16)
  v_lshlrev_b32 v188, 16, v190
  v_and_b32 v189, 0xffff0000, v190
  v_lshlrev_b32 v190, 16, v191
  v_and_b32 v191, 0xffff0000, v191
VC63:
  s_waitcnt vmcnt(13)
  v_max3_u32 v12, v80, v84, v88
  s_waitcnt vmcnt(12)
  v_max_u32 v12, v12, v92
  v_cmp_eq_u32 vcc, -1, v12
  s_cbranch_vccnz VR64
VK65:
  v_mfma_f32_16x16x32_bf16 v[16:19], a[0:3], v[80:83], v[176:179]
  s_add_u32 s81, s60, 4096
  s_and_b32 s81, s81, 0x3fff
  buffer_load_dwordx4 v[144:147], v206, s[8:11], s81 offen sc1
  v_mfma_f32_16x16x32_bf16 v[20:23], a[4:7], v[80:83], v[180:183]
  ds_read_b64_tr_b16 a[224:225], v197 offset:0
  v_mfma_f32_16x16x32_bf16 v[24:27], a[8:11], v[80:83], v[184:187]
  v_mfma_f32_16x16x32_bf16 v[28:31], a[12:15], v[80:83], v[188:191]
  ds_read_b64_tr_b16 a[226:227], v197 offset:512
  v_mfma_f32_16x16x32_bf16 v[32:35], a[0:3], v[84:87], 0
  buffer_load_dwordx4 v[148:151], v207, s[8:11], s81 offen sc1
  v_mfma_f32_16x16x32_bf16 v[36:39], a[4:7], v[84:87], 0
  ds_read_b64_tr_b16 a[228:229], v197 offset:32
  v_mfma_f32_16x16x32_bf16 v[40:43], a[8:11], v[84:87], 0
  v_mfma_f32_16x16x32_bf16 v[44:47], a[12:15], v[84:87], 0
  ds_read_b64_tr_b16 a[230:231], v197 offset:544
  v_mfma_f32_16x16x32_bf16 v[48:51], a[0:3], v[88:91], 0
  buffer_load_dwordx4 v[152:155], v208, s[8:11], s81 offen sc1
  v_mfma_f32_16x16x32_bf16 v[52:55], a[4:7], v[88:91], 0
  ds_read_b64_tr_b16 a[232:233], v197 offset:64
  v_mfma_f32_16x16x32_bf16 v[56:59], a[8:11], v[88:91], 0
  v_mfma_f32_16x16x32_bf16 v[60:63], a[12:15], v[88:91], 0
  ds_read_b64_tr_b16 a[234:235], v197 offset:576
  v_mfma_f32_16x16x32_bf16 v[64:67], a[0:3], v[92:95], 0
  buffer_load_dwordx4 v[156:159], v209, s[8:11], s81 offen sc1
  v_mfma_f32_16x16x32_bf16 v[68:71], a[4:7], v[92:95], 0
  ds_read_b64_tr_b16 a[236:237], v197 offset:96
  v_mfma_f32_16x16x32_bf16 v[72:75], a[8:11], v[92:95], 0
  v_mfma_f32_16x16x32_bf16 v[76:79], a[12:15], v[92:95], 0
  ds_read_b64_tr_b16 a[238:239], v197 offset:608
VC66:
  s_waitcnt vmcnt(13)
  v_max3_u32 v12, v96, v100, v104
  s_waitcnt vmcnt(12)
  v_max_u32 v12, v12, v108
  v_cmp_eq_u32 vcc, -1, v12
  s_cbranch_vccnz VR67
VK68:
  v_mfma_f32_16x16x32_bf16 v[16:19], a[16:19], v[96:99], v[16:19]
  s_add_u32 s81, s60, 5120
  s_and_b32 s81, s81, 0x3fff
  buffer_load_dwordx4 v[80:83], v206, s[8:11], s81 offen sc1
  v_mfma_f32_16x16x32_bf16 v[20:23], a[20:23], v[96:99], v[20:23]
  ds_read_b64_tr_b16 a[240:241], v197 offset:4224
  v_mfma_f32_16x16x32_bf16 v[24:27], a[24:27], v[96:99], v[24:27]
  v_mfma_f32_16x16x32_bf16 v[28:31], a[28:31], v[96:99], v[28:31]
  ds_read_b64_tr_b16 a[242:243], v197 offset:4736
  v_mfma_f32_16x16x32_bf16 v[32:35], a[16:19], v[100:103], v[32:35]
  buffer_load_dwordx4 v[84:87], v207, s[8:11], s81 offen sc1
  v_mfma_f32_16x16x32_bf16 v[36:39], a[20:23], v[100:103], v[36:39]
  ds_read_b64_tr_b16 a[244:245], v197 offset:4256
  v_mfma_f32_16x16x32_bf16 v[40:43], a[24:27], v[100:103], v[40:43]
  v_mfma_f32_16x16x32_bf16 v[44:47], a[28:31], v[100:103], v[44:47]
  ds_read_b64_tr_b16 a[246:247], v197 offset:4768
  v_mfma_f32_16x16x32_bf16 v[48:51], a[16:19], v[104:107], v[48:51]
  buffer_load_dwordx4 v[88:91], v208, s[8:11], s81 offen sc1
  v_mfma_f32_16x16x32_bf16 v[52:55], a[20:23], v[104:107], v[52:55]
  ds_read_b64_tr_b16 a[248:249], v197 offset:4288
  v_mfma_f32_16x16x32_bf16 v[56:59], a[24:27], v[104:107], v[56:59]
  v_mfma_f32_16x16x32_bf16 v[60:63], a[28:31], v[104:107], v[60:63]
  ds_read_b64_tr_b16 a[250:251], v197 offset:4800
  v_mfma_f32_16x16x32_bf16 v[64:67], a[16:19], v[108:111], v[64:67]
  buffer_load_dwordx4 v[92:95], v209, s[8:11], s81 offen sc1
  v_mfma_f32_16x16x32_bf16 v[68:71], a[20:23], v[108:111], v[68:71]
  ds_read_b64_tr_b16 a[252:253], v197 offset:4320
  v_mfma_f32_16x16x32_bf16 v[72:75], a[24:27], v[108:111], v[72:75]
  v_mfma_f32_16x16x32_bf16 v[76:79], a[28:31], v[108:111], v[76:79]
  ds_read_b64_tr_b16 a[254:255], v197 offset:4832
VC69:
  s_waitcnt vmcnt(13)
  v_max3_u32 v12, v112, v116, v120
  s_waitcnt vmcnt(12)
  v_max_u32 v12, v12, v124
  v_cmp_eq_u32 vcc, -1, v12
  s_cbranch_vccnz VR70
VK71:
  v_mfma_f32_16x16x32_bf16 v[16:19], a[32:35], v[112:115], v[16:19]
  s_add_u32 s81, s60, 6144
  s_and_b32 s81, s81, 0x3fff
  buffer_load_dwordx4 v[96:99], v206, s[8:11], s81 offen sc1
  v_mfma_f32_16x16x32_bf16 v[20:23], a[36:39], v[112:115], v[20:23]
  v_mfma_f32_16x16x32_bf16 v[24:27], a[40:43], v[112:115], v[24:27]
  v_mfma_f32_16x16x32_bf16 v[28:31], a[44:47], v[112:115], v[28:31]
  v_mfma_f32_16x16x32_bf16 v[32:35], a[32:35], v[116:119], v[32:35]
  buffer_load_dwordx4 v[100:103], v207, s[8:11], s81 offen sc1
  v_mfma_f32_16x16x32_bf16 v[36:39], a[36:39], v[116:119], v[36:39]
  v_mfma_f32_16x16x32_bf16 v[40:43], a[40:43], v[116:119], v[40:43]
  v_mfma_f32_16x16x32_bf16 v[44:47], a[44:47], v[116:119], v[44:47]
  v_mfma_f32_16x16x32_bf16 v[48:51], a[32:35], v[120:123], v[48:51]
  buffer_load_dwordx4 v[104:107], v208, s[8:11], s81 offen sc1
  v_mfma_f32_16x16x32_bf16 v[52:55], a[36:39], v[120:123], v[52:55]
  v_mfma_f32_16x16x32_bf16 v[56:59], a[40:43], v[120:123], v[56:59]
  v_mfma_f32_16x16x32_bf16 v[60:63], a[44:47], v[120:123], v[60:63]
  v_mfma_f32_16x16x32_bf16 v[64:67], a[32:35], v[124:127], v[64:67]
  buffer_load_dwordx4 v[108:111], v209, s[8:11], s81 offen sc1
  v_mfma_f32_16x16x32_bf16 v[68:71], a[36:39], v[124:127], v[68:71]
  v_mfma_f32_16x16x32_bf16 v[72:75], a[40:43], v[124:127], v[72:75]
  v_mfma_f32_16x16x32_bf16 v[76:79], a[44:47], v[124:127], v[76:79]
  s_waitcnt lgkmcnt(0)
  s_barrier
VC72:
  s_waitcnt vmcnt(13)
  v_max3_u32 v12, v128, v132, v136
  s_waitcnt vmcnt(12)
  v_max_u32 v12, v12, v140
  v_cmp_eq_u32 vcc, -1, v12
  s_cbranch_vccnz VR73
VK74:
  v_mfma_f32_16x16x32_bf16 v[16:19], a[48:51], v[128:131], v[16:19]
  s_add_u32 s81, s60, 7168
  s_and_b32 s81, s81, 0x3fff
  buffer_load_dwordx4 v[112:115], v206, s[8:11], s81 offen sc1
  v_mfma_f32_16x16x32_bf16 v[20:23], a[52:55], v[128:131], v[20:23]
  v_mfma_f32_16x16x32_bf16 v[24:27], a[56:59], v[128:131], v[24:27]
  v_mfma_f32_16x16x32_bf16 v[28:31], a[60:63], v[128:131], v[28:31]
  v_mfma_f32_16x16x32_bf16 v[32:35], a[48:51], v[132:135], v[32:35]
  buffer_load_dwordx4 v[116:119], v207, s[8:11], s81 offen sc1
  v_mfma_f32_16x16x32_bf16 v[36:39], a[52:55], v[132:135], v[36:39]
  v_mfma_f32_16x16x32_bf16 v[40:43], a[56:59], v[132:135], v[40:43]
  v_mfma_f32_16x16x32_bf16 v[44:47], a[60:63], v[132:135], v[44:47]
  v_mfma_f32_16x16x32_bf16 v[48:51], a[48:51], v[136:139], v[48:51]
  buffer_load_dwordx4 v[120:123], v208, s[8:11], s81 offen sc1
  v_mfma_f32_16x16x32_bf16 v[52:55], a[52:55], v[136:139], v[52:55]
  v_mfma_f32_16x16x32_bf16 v[56:59], a[56:59], v[136:139], v[56:59]
  v_mfma_f32_16x16x32_bf16 v[60:63], a[60:63], v[136:139], v[60:63]
  v_mfma_f32_16x16x32_bf16 v[64:67], a[48:51], v[140:143], v[64:67]
  buffer_load_dwordx4 v[124:127], v209, s[8:11], s81 offen sc1
  v_mfma_f32_16x16x32_bf16 v[68:71], a[52:55], v[140:143], v[68:71]
  v_mfma_f32_16x16x32_bf16 v[72:75], a[56:59], v[140:143], v[72:75]
  v_mfma_f32_16x16x32_bf16 v[76:79], a[60:63], v[140:143], v[76:79]
VC75:
  s_waitcnt vmcnt(13)
  v_max3_u32 v12, v144, v148, v152
  s_waitcnt vmcnt(12)
  v_max_u32 v12, v12, v156
  v_cmp_eq_u32 vcc, -1, v12
  s_cbranch_vccnz VR76
VK77:
  v_mfma_f32_16x16x32_bf16 v[16:19], a[64:67], v[144:147], v[16:19]
  s_add_u32 s81, s60, 8192
  s_and_b32 s81, s81, 0x3fff
  buffer_load_dwordx4 v[128:131], v206, s[8:11], s81 offen sc1
  v_mfma_f32_16x16x32_bf16 v[20:23], a[68:71], v[144:147], v[20:23]
  v_mfma_f32_16x16x32_bf16 v[24:27], a[72:75], v[144:147], v[24:27]
  v_mfma_f32_16x16x32_bf16 v[28:31], a[76:79], v[144:147], v[28:31]
  v_mfma_f32_16x16x32_bf16 v[32:35], a[64:67], v[148:151], v[32:35]
  buffer_load_dwordx4 v[132:135], v207, s[8:11], s81 offen sc1
  v_mfma_f32_16x16x32_bf16 v[36:39], a[68:71], v[148:151], v[36:39]
  v_mfma_f32_16x16x32_bf16 v[40:43], a[72:75], v[148:151], v[40:43]
  v_mfma_f32_16x16x32_bf16 v[44:47], a[76:79], v[148:151], v[44:47]
  v_mfma_f32_16x16x32_bf16 v[48:51], a[64:67], v[152:155], v[48:51]
  buffer_load_dwordx4 v[136:139], v208, s[8:11], s81 offen sc1
  v_mfma_f32_16x16x32_bf16 v[52:55], a[68:71], v[152:155], v[52:55]
  v_mfma_f32_16x16x32_bf16 v[56:59], a[72:75], v[152:155], v[56:59]
  v_mfma_f32_16x16x32_bf16 v[60:63], a[76:79], v[152:155], v[60:63]
  v_mfma_f32_16x16x32_bf16 v[64:67], a[64:67], v[156:159], v[64:67]
  buffer_load_dwordx4 v[140:143], v209, s[8:11], s81 offen sc1
  v_mfma_f32_16x16x32_bf16 v[68:71], a[68:71], v[156:159], v[68:71]
  v_mfma_f32_16x16x32_bf16 v[72:75], a[72:75], v[156:159], v[72:75]
  v_mfma_f32_16x16x32_bf16 v[76:79], a[76:79], v[156:159], v[76:79]
VC78:
  s_waitcnt vmcnt(13)
  v_max3_u32 v12, v80, v84, v88
  s_waitcnt vmcnt(12)
  v_max_u32 v12, v12, v92
  v_cmp_eq_u32 vcc, -1, v12
  s_cbranch_vccnz VR79
VK80:
  v_mfma_f32_16x16x32_bf16 v[16:19], a[80:83], v[80:83], v[16:19]
  s_add_u32 s81, s60, 9216
  s_and_b32 s81, s81, 0x3fff
  buffer_load_dwordx4 v[144:147], v206, s[8:11], s81 offen sc1
  v_mfma_f32_16x16x32_bf16 v[20:23], a[84:87], v[80:83], v[20:23]
  v_mfma_f32_16x16x32_bf16 v[24:27], a[88:91], v[80:83], v[24:27]
  v_mfma_f32_16x16x32_bf16 v[28:31], a[92:95], v[80:83], v[28:31]
  v_mfma_f32_16x16x32_bf16 v[32:35], a[80:83], v[84:87], v[32:35]
  buffer_load_dwordx4 v[148:151], v207, s[8:11], s81 offen sc1
  v_mfma_f32_16x16x32_bf16 v[36:39], a[84:87], v[84:87], v[36:39]
  v_mfma_f32_16x16x32_bf16 v[40:43], a[88:91], v[84:87], v[40:43]
  v_mfma_f32_16x16x32_bf16 v[44:47], a[92:95], v[84:87], v[44:47]
  v_mfma_f32_16x16x32_bf16 v[48:51], a[80:83], v[88:91], v[48:51]
  buffer_load_dwordx4 v[152:155], v208, s[8:11], s81 offen sc1
  v_mfma_f32_16x16x32_bf16 v[52:55], a[84:87], v[88:91], v[52:55]
  v_mfma_f32_16x16x32_bf16 v[56:59], a[88:91], v[88:91], v[56:59]
  v_mfma_f32_16x16x32_bf16 v[60:63], a[92:95], v[88:91], v[60:63]
  v_mfma_f32_16x16x32_bf16 v[64:67], a[80:83], v[92:95], v[64:67]
  buffer_load_dwordx4 v[156:159], v209, s[8:11], s81 offen sc1
  v_mfma_f32_16x16x32_bf16 v[68:71], a[84:87], v[92:95], v[68:71]
  v_mfma_f32_16x16x32_bf16 v[72:75], a[88:91], v[92:95], v[72:75]
  v_mfma_f32_16x16x32_bf16 v[76:79], a[92:95], v[92:95], v[76:79]
VC81:
  s_waitcnt vmcnt(13)
  v_max3_u32 v12, v96, v100, v104
  s_waitcnt vmcnt(12)
  v_max_u32 v12, v12, v108
  v_cmp_eq_u32 vcc, -1, v12
  s_cbranch_vccnz VR82
VK83:
  v_mfma_f32_16x16x32_bf16 v[16:19], a[96:99], v[96:99], v[16:19]
  s_add_u32 s81, s60, 10240
  s_and_b32 s81, s81, 0x3fff
  buffer_load_dwordx4 v[80:83], v206, s[8:11], s81 offen sc1
  v_mfma_f32_16x16x32_bf16 v[20:23], a[100:103], v[96:99], v[20:23]
  v_mfma_f32_16x16x32_bf16 v[24:27], a[104:107], v[96:99], v[24:27]
  v_mfma_f32_16x16x32_bf16 v[28:31], a[108:111], v[96:99], v[28:31]
  v_mfma_f32_16x16x32_bf16 v[32:35], a[96:99], v[100:103], v[32:35]
  buffer_load_dwordx4 v[84:87], v207, s[8:11], s81 offen sc1
  v_mfma_f32_16x16x32_bf16 v[36:39], a[100:103], v[100:103], v[36:39]
  v_mfma_f32_16x16x32_bf16 v[40:43], a[104:107], v[100:103], v[40:43]
  v_mfma_f32_16x16x32_bf16 v[44:47], a[108:111], v[100:103], v[44:47]
  v_mfma_f32_16x16x32_bf16 v[48:51], a[96:99], v[104:107], v[48:51]
  buffer_load_dwordx4 v[88:91], v208, s[8:11], s81 offen sc1
  v_mfma_f32_16x16x32_bf16 v[52:55], a[100:103], v[104:107], v[52:55]
  v_mfma_f32_16x16x32_bf16 v[56:59], a[104:107], v[104:107], v[56:59]
  v_mfma_f32_16x16x32_bf16 v[60:63], a[108:111], v[104:107], v[60:63]
  v_mfma_f32_16x16x32_bf16 v[64:67], a[96:99], v[108:111], v[64:67]
  buffer_load_dwordx4 v[92:95], v209, s[8:11], s81 offen sc1
  v_mfma_f32_16x16x32_bf16 v[68:71], a[100:103], v[108:111], v[68:71]
  v_mfma_f32_16x16x32_bf16 v[72:75], a[104:107], v[108:111], v[72:75]
  v_mfma_f32_16x16x32_bf16 v[76:79], a[108:111], v[108:111], v[76:79]
VC84:
  s_waitcnt vmcnt(13)
  v_max3_u32 v12, v112, v116, v120
  s_waitcnt vmcnt(12)
  v_max_u32 v12, v12, v124
  v_cmp_eq_u32 vcc, -1, v12
  s_cbranch_vccnz VR85
VK86:
  v_mfma_f32_16x16x32_bf16 v[16:19], a[112:115], v[112:115], v[16:19]
  s_add_u32 s81, s60, 11264
  s_and_b32 s81, s81, 0x3fff
  buffer_load_dwordx4 v[96:99], v206, s[8:11], s81 offen sc1
  v_mfma_f32_16x16x32_bf16 v[20:23], a[116:119], v[112:115], v[20:23]
  v_mfma_f32_16x16x32_bf16 v[24:27], a[120:123], v[112:115], v[24:27]
  v_mfma_f32_16x16x32_bf16 v[28:31], a[124:127], v[112:115], v[28:31]
  v_mfma_f32_16x16x32_bf16 v[32:35], a[112:115], v[116:119], v[32:35]
  buffer_load_dwordx4 v[100:103], v207, s[8:11], s81 offen sc1
  v_mfma_f32_16x16x32_bf16 v[36:39], a[116:119], v[116:119], v[36:39]
  v_mfma_f32_16x16x32_bf16 v[40:43], a[120:123], v[116:119], v[40:43]
  v_mfma_f32_16x16x32_bf16 v[44:47], a[124:127], v[116:119], v[44:47]
  v_mfma_f32_16x16x32_bf16 v[48:51], a[112:115], v[120:123], v[48:51]
  buffer_load_dwordx4 v[104:107], v208, s[8:11], s81 offen sc1
  v_mfma_f32_16x16x32_bf16 v[52:55], a[116:119], v[120:123], v[52:55]
  v_mfma_f32_16x16x32_bf16 v[56:59], a[120:123], v[120:123], v[56:59]
  v_mfma_f32_16x16x32_bf16 v[60:63], a[124:127], v[120:123], v[60:63]
  v_mfma_f32_16x16x32_bf16 v[64:67], a[112:115], v[124:127], v[64:67]
  buffer_load_dwordx4 v[108:111], v209, s[8:11], s81 offen sc1
  v_mfma_f32_16x16x32_bf16 v[68:71], a[116:119], v[124:127], v[68:71]
  v_mfma_f32_16x16x32_bf16 v[72:75], a[120:123], v[124:127], v[72:75]
  v_mfma_f32_16x16x32_bf16 v[76:79], a[124:127], v[124:127], v[76:79]
VC87:
  s_waitcnt vmcnt(13)
  v_max3_u32 v12, v128, v132, v136
  s_waitcnt vmcnt(12)
  v_max_u32 v12, v12, v140
  v_cmp_eq_u32 vcc, -1, v12
  s_cbranch_vccnz VR88
VK89:
  v_mfma_f32_16x16x32_bf16 v[16:19], a[128:131], v[128:131], v[16:19]
  s_add_u32 s81, s60, 12288
  s_and_b32 s81, s81, 0x3fff
  buffer_load_dwordx4 v[112:115], v206, s[8:11], s81 offen sc1
  v_mfma_f32_16x16x32_bf16 v[20:23], a[132:135], v[128:131], v[20:23]
  v_mfma_f32_16x16x32_bf16 v[24:27], a[136:139], v[128:131], v[24:27]
  v_mfma_f32_16x16x32_bf16 v[28:31], a[140:143], v[128:131], v[28:31]
  v_mfma_f32_16x16x32_bf16 v[32:35], a[128:131], v[132:135], v[32:35]
  buffer_load_dwordx4 v[116:119], v207, s[8:11], s81 offen sc1
  v_mfma_f32_16x16x32_bf16 v[36:39], a[132:135], v[132:135], v[36:39]
  v_mfma_f32_16x16x32_bf16 v[40:43], a[136:139], v[132:135], v[40:43]
  v_mfma_f32_16x16x32_bf16 v[44:47], a[140:143], v[132:135], v[44:47]
  v_mfma_f32_16x16x32_bf16 v[48:51], a[128:131], v[136:139], v[48:51]
  buffer_load_dwordx4 v[120:123], v208, s[8:11], s81 offen sc1
  v_mfma_f32_16x16x32_bf16 v[52:55], a[132:135], v[136:139], v[52:55]
  v_mfma_f32_16x16x32_bf16 v[56:59], a[136:139], v[136:139], v[56:59]
  v_mfma_f32_16x16x32_bf16 v[60:63], a[140:143], v[136:139], v[60:63]
  v_mfma_f32_16x16x32_bf16 v[64:67], a[128:131], v[140:143], v[64:67]
  buffer_load_dwordx4 v[124:127], v209, s[8:11], s81 offen sc1
  v_mfma_f32_16x16x32_bf16 v[68:71], a[132:135], v[140:143], v[68:71]
  v_mfma_f32_16x16x32_bf16 v[72:75], a[136:139], v[140:143], v[72:75]
  v_mfma_f32_16x16x32_bf16 v[76:79], a[140:143], v[140:143], v[76:79]
VC90:
  s_waitcnt vmcnt(13)
  v_max3_u32 v12, v144, v148, v152
  s_waitcnt vmcnt(12)
  v_max_u32 v12, v12, v156
  v_cmp_eq_u32 vcc, -1, v12
  s_cbranch_vccnz VR91
VK92:
  v_mfma_f32_16x16x32_bf16 v[16:19], a[144:147], v[144:147], v[16:19]
  s_add_u32 s81, s60, 13312
  s_and_b32 s81, s81, 0x3fff
  buffer_load_dwordx4 v[128:131], v206, s[8:11], s81 offen sc1
  v_mfma_f32_16x16x32_bf16 v[20:23], a[148:151], v[144:147], v[20:23]
  v_mfma_f32_16x16x32_bf16 v[24:27], a[152:155], v[144:147], v[24:27]
  v_mfma_f32_16x16x32_bf16 v[28:31], a[156:159], v[144:147], v[28:31]
  v_mfma_f32_16x16x32_bf16 v[32:35], a[144:147], v[148:151], v[32:35]
  buffer_load_dwordx4 v[132:135], v207, s[8:11], s81 offen sc1
  v_mfma_f32_16x16x32_bf16 v[36:39], a[148:151], v[148:151], v[36:39]
  v_mfma_f32_16x16x32_bf16 v[40:43], a[152:155], v[148:151], v[40:43]
  v_mfma_f32_16x16x32_bf16 v[44:47], a[156:159], v[148:151], v[44:47]
  v_mfma_f32_16x16x32_bf16 v[48:51], a[144:147], v[152:155], v[48:51]
  buffer_load_dwordx4 v[136:139], v208, s[8:11], s81 offen sc1
  v_mfma_f32_16x16x32_bf16 v[52:55], a[148:151], v[152:155], v[52:55]
  v_mfma_f32_16x16x32_bf16 v[56:59], a[152:155], v[152:155], v[56:59]
  v_mfma_f32_16x16x32_bf16 v[60:63], a[156:159], v[152:155], v[60:63]
  v_mfma_f32_16x16x32_bf16 v[64:67], a[144:147], v[156:159], v[64:67]
  buffer_load_dwordx4 v[140:143], v209, s[8:11], s81 offen sc1
  v_mfma_f32_16x16x32_bf16 v[68:71], a[148:151], v[156:159], v[68:71]
  v_mfma_f32_16x16x32_bf16 v[72:75], a[152:155], v[156:159], v[72:75]
  v_mfma_f32_16x16x32_bf16 v[76:79], a[156:159], v[156:159], v[76:79]
VC93:
  s_waitcnt vmcnt(13)
  v_max3_u32 v12, v80, v84, v88
  s_waitcnt vmcnt(12)
  v_max_u32 v12, v12, v92
  v_cmp_eq_u32 vcc, -1, v12
  s_cbranch_vccnz VR94
VK95:
  v_mfma_f32_16x16x32_bf16 v[16:19], a[160:163], v[80:83], v[16:19]
  s_add_u32 s81, s60, 14336
  s_and_b32 s81, s81, 0x3fff
  buffer_load_dwordx4 v[144:147], v206, s[8:11], s81 offen sc1
  v_mfma_f32_16x16x32_bf16 v[20:23], a[164:167], v[80:83], v[20:23]
  v_mfma_f32_16x16x32_bf16 v[24:27], a[168:171], v[80:83], v[24:27]
  v_mfma_f32_16x16x32_bf16 v[28:31], a[172:175], v[80:83], v[28:31]
  v_mfma_f32_16x16x32_bf16 v[32:35], a[160:163], v[84:87], v[32:35]
  buffer_load_dwordx4 v[148:151], v207, s[8:11], s81 offen sc1
  v_mfma_f32_16x16x32_bf16 v[36:39], a[164:167], v[84:87], v[36:39]
  v_mfma_f32_16x16x32_bf16 v[40:43], a[168:171], v[84:87], v[40:43]
  v_mfma_f32_16x16x32_bf16 v[44:47], a[172:175], v[84:87], v[44:47]
  v_mfma_f32_16x16x32_bf16 v[48:51], a[160:163], v[88:91], v[48:51]
  buffer_load_dwordx4 v[152:155], v208, s[8:11], s81 offen sc1
  v_mfma_f32_16x16x32_bf16 v[52:55], a[164:167], v[88:91], v[52:55]
  v_mfma_f32_16x16x32_bf16 v[56:59], a[168:171], v[88:91], v[56:59]
  v_mfma_f32_16x16x32_bf16 v[60:63], a[172:175], v[88:91], v[60:63]
  v_mfma_f32_16x16x32_bf16 v[64:67], a[160:163], v[92:95], v[64:67]
  buffer_load_dwordx4 v[156:159], v209, s[8:11], s81 offen sc1
  v_mfma_f32_16x16x32_bf16 v[68:71], a[164:167], v[92:95], v[68:71]
  v_mfma_f32_16x16x32_bf16 v[72:75], a[168:171], v[92:95], v[72:75]
  v_mfma_f32_16x16x32_bf16 v[76:79], a[172:175], v[92:95], v[76:79]
VC96:
  s_waitcnt vmcnt(13)
  v_max3_u32 v12, v96, v100, v104
  s_waitcnt vmcnt(12)
  v_max_u32 v12, v12, v108
  v_cmp_eq_u32 vcc, -1, v12
  s_cbranch_vccnz VR97
VK98:
  v_mfma_f32_16x16x32_bf16 v[16:19], a[176:179], v[96:99], v[16:19]
  s_add_u32 s81, s60, 15360
  s_and_b32 s81, s81, 0x3fff
  buffer_load_dwordx4 v[80:83], v206, s[8:11], s81 offen sc1
  v_mfma_f32_16x16x32_bf16 v[20:23], a[180:183], v[96:99], v[20:23]
  v_mfma_f32_16x16x32_bf16 v[24:27], a[184:187], v[96:99], v[24:27]
  v_mfma_f32_16x16x32_bf16 v[28:31], a[188:191], v[96:99], v[28:31]
  v_mfma_f32_16x16x32_bf16 v[32:35], a[176:179], v[100:103], v[32:35]
  buffer_load_dwordx4 v[84:87], v207, s[8:11], s81 offen sc1
  v_mfma_f32_16x16x32_bf16 v[36:39], a[180:183], v[100:103], v[36:39]
  v_mfma_f32_16x16x32_bf16 v[40:43], a[184:187], v[100:103], v[40:43]
  v_mfma_f32_16x16x32_bf16 v[44:47], a[188:191], v[100:103], v[44:47]
  v_mfma_f32_16x16x32_bf16 v[48:51], a[176:179], v[104:107], v[48:51]
  buffer_load_dwordx4 v[88:91], v208, s[8:11], s81 offen sc1
  v_mfma_f32_16x16x32_bf16 v[52:55], a[180:183], v[104:107], v[52:55]
  v_mfma_f32_16x16x32_bf16 v[56:59], a[184:187], v[104:107], v[56:59]
  v_mfma_f32_16x16x32_bf16 v[60:63], a[188:191], v[104:107], v[60:63]
  v_mfma_f32_16x16x32_bf16 v[64:67], a[176:179], v[108:111], v[64:67]
  buffer_load_dwordx4 v[92:95], v209, s[8:11], s81 offen sc1
  v_mfma_f32_16x16x32_bf16 v[68:71], a[180:183], v[108:111], v[68:71]
  v_mfma_f32_16x16x32_bf16 v[72:75], a[184:187], v[108:111], v[72:75]
  v_mfma_f32_16x16x32_bf16 v[76:79], a[188:191], v[108:111], v[76:79]
VC99:
  s_waitcnt vmcnt(13)
  v_max3_u32 v12, v112, v116, v120
  s_waitcnt vmcnt(12)
  v_max_u32 v12, v12, v124
  v_cmp_eq_u32 vcc, -1, v12
  s_cbranch_vccnz VR100
VK101:
  v_mfma_f32_16x16x32_bf16 v[16:19], a[192:195], v[112:115], v[16:19]
  s_mov_b32 s78, s61
  s_mul_i32 s78, s78, 128
  s_add_u32 m0, s86, 12672
  s_nop 0
  buffer_load_dwordx4 v198, s[32:35], s78 offen offset:0 lds
  v_mfma_f32_16x16x32_bf16 v[20:23], a[196:199], v[112:115], v[20:23]
  v_mfma_f32_16x16x32_bf16 v[24:27], a[200:203], v[112:115], v[24:27]
  v_mfma_f32_16x16x32_bf16 v[28:31], a[204:207], v[112:115], v[28:31]
  v_mfma_f32_16x16x32_bf16 v[32:35], a[192:195], v[116:119], v[32:35]
  buffer_load_dwordx4 v199, s[32:35], s78 offen offset:1056 lds
  v_mfma_f32_16x16x32_bf16 v[36:39], a[196:199], v[116:119], v[36:39]
  v_mfma_f32_16x16x32_bf16 v[40:43], a[200:203], v[116:119], v[40:43]
  v_mfma_f32_16x16x32_bf16 v[44:47], a[204:207], v[116:119], v[44:47]
  v_mfma_f32_16x16x32_bf16 v[48:51], a[192:195], v[120:123], v[48:51]
  buffer_load_dwordx4 v200, s[32:35], s78 offen offset:2112 lds
  v_mfma_f32_16x16x32_bf16 v[52:55], a[196:199], v[120:123], v[52:55]
  v_mfma_f32_16x16x32_bf16 v[56:59], a[200:203], v[120:123], v[56:59]
  v_mfma_f32_16x16x32_bf16 v[60:63], a[204:207], v[120:123], v[60:63]
  v_mfma_f32_16x16x32_bf16 v[64:67], a[192:195], v[124:127], v[64:67]
  buffer_load_dwordx4 v201, s[32:35], s78 offen offset:3168 lds
  v_mfma_f32_16x16x32_bf16 v[68:71], a[196:199], v[124:127], v[68:71]
  v_mfma_f32_16x16x32_bf16 v[72:75], a[200:203], v[124:127], v[72:75]
  v_mfma_f32_16x16x32_bf16 v[76:79], a[204:207], v[124:127], v[76:79]
VC102:
  s_waitcnt vmcnt(13)
  v_max3_u32 v12, v128, v132, v136
  s_waitcnt vmcnt(12)
  v_max_u32 v12, v12, v140
  v_cmp_eq_u32 vcc, -1, v12
  s_cbranch_vccnz VR103
VK104:
  v_mfma_f32_16x16x32_bf16 v[16:19], a[208:211], v[128:131], v[16:19]
  s_add_u32 s78, s61, 1024
  s_sub_u32 s68, s78, 12288
  s_cselect_b32 s78, s78, s68
  s_mul_i32 s78, s78, 128
  s_add_u32 m0, s86, 16896
  s_nop 0
  buffer_load_dwordx4 v198, s[32:35], s78 offen offset:0 lds
  v_mfma_f32_16x16x32_bf16 v[20:23], a[212:215], v[128:131], v[20:23]
  v_mfma_f32_16x16x32_bf16 v[24:27], a[216:219], v[128:131], v[24:27]
  v_mfma_f32_16x16x32_bf16 v[28:31], a[220:223], v[128:131], v[28:31]
  v_mfma_f32_16x16x32_bf16 v[32:35], a[208:211], v[132:135], v[32:35]
  buffer_load_dwordx4 v199, s[32:35], s78 offen offset:1056 lds
  v_mfma_f32_16x16x32_bf16 v[36:39], a[212:215], v[132:135], v[36:39]
  v_mfma_f32_16x16x32_bf16 v[40:43], a[216:219], v[132:135], v[40:43]
  v_mfma_f32_16x16x32_bf16 v[44:47], a[220:223], v[132:135], v[44:47]
  v_mfma_f32_16x16x32_bf16 v[48:51], a[208:211], v[136:139], v[48:51]
  buffer_load_dwordx4 v200, s[32:35], s78 offen offset:2112 lds
  v_mfma_f32_16x16x32_bf16 v[52:55], a[212:215], v[136:139], v[52:55]
  v_mfma_f32_16x16x32_bf16 v[56:59], a[216:219], v[136:139], v[56:59]
  v_mfma_f32_16x16x32_bf16 v[60:63], a[220:223], v[136:139], v[60:63]
  v_mfma_f32_16x16x32_bf16 v[64:67], a[208:211], v[140:143], v[64:67]
  buffer_load_dwordx4 v201, s[32:35], s78 offen offset:3168 lds
  v_mfma_f32_16x16x32_bf16 v[68:71], a[212:215], v[140:143], v[68:71]
  v_mfma_f32_16x16x32_bf16 v[72:75], a[216:219], v[140:143], v[72:75]
  v_mfma_f32_16x16x32_bf16 v[76:79], a[220:223], v[140:143], v[76:79]
VC105:
  s_waitcnt vmcnt(13)
  v_max3_u32 v12, v144, v148, v152
  s_waitcnt vmcnt(12)
  v_max_u32 v12, v12, v156
  v_cmp_eq_u32 vcc, -1, v12
  s_cbranch_vccnz VR106
VK107:
  v_mfma_f32_16x16x32_bf16 v[16:19], a[224:227], v[144:147], v[16:19]
  s_add_u32 s78, s61, 2048
  s_sub_u32 s68, s78, 12288
  s_cselect_b32 s78, s78, s68
  s_mul_i32 s78, s78, 128
  s_add_u32 m0, s86, 21120
  s_nop 0
  buffer_load_dwordx4 v198, s[32:35], s78 offen offset:0 lds
  v_mfma_f32_16x16x32_bf16 v[20:23], a[228:231], v[144:147], v[20:23]
  v_mfma_f32_16x16x32_bf16 v[24:27], a[232:235], v[144:147], v[24:27]
  v_mfma_f32_16x16x32_bf16 v[28:31], a[236:239], v[144:147], v[28:31]
  v_mfma_f32_16x16x32_bf16 v[32:35], a[224:227], v[148:151], v[32:35]
  buffer_load_dwordx4 v199, s[32:35], s78 offen offset:1056 lds
  v_mfma_f32_16x16x32_bf16 v[36:39], a[228:231], v[148:151], v[36:39]
  v_mfma_f32_16x16x32_bf16 v[40:43], a[232:235], v[148:151], v[40:43]
  v_mfma_f32_16x16x32_bf16 v[44:47], a[236:239], v[148:151], v[44:47]
  v_mfma_f32_16x16x32_bf16 v[48:51], a[224:227], v[152:155], v[48:51]
  buffer_load_dwordx4 v200, s[32:35], s78 offen offset:2112 lds
  v_mfma_f32_16x16x32_bf16 v[52:55], a[228:231], v[152:155], v[52:55]
  v_mfma_f32_16x16x32_bf16 v[56:59], a[232:235], v[152:155], v[56:59]
  v_mfma_f32_16x16x32_bf16 v[60:63], a[236:239], v[152:155], v[60:63]
  v_mfma_f32_16x16x32_bf16 v[64:67], a[224:227], v[156:159], v[64:67]
  buffer_load_dwordx4 v201, s[32:35], s78 offen offset:3168 lds
  v_mfma_f32_16x16x32_bf16 v[68:71], a[228:231], v[156:159], v[68:71]
  v_mfma_f32_16x16x32_bf16 v[72:75], a[232:235], v[156:159], v[72:75]
  v_mfma_f32_16x16x32_bf16 v[76:79], a[236:239], v[156:159], v[76:79]
VC108:
  s_waitcnt vmcnt(13)
  v_max3_u32 v12, v80, v84, v88
  s_waitcnt vmcnt(12)
  v_max_u32 v12, v12, v92
  v_cmp_eq_u32 vcc, -1, v12
  s_cbranch_vccnz VR109
VK110:
  v_mfma_f32_16x16x32_bf16 v[32:35], a[240:243], v[84:87], v[32:35]
  s_add_u32 s78, s61, 3072
  s_sub_u32 s68, s78, 12288
  s_cselect_b32 s78, s78, s68
  s_mul_i32 s78, s78, 128
  s_add_u32 m0, s86, 25344
  s_nop 0
  buffer_load_dwordx4 v198, s[32:35], s78 offen offset:0 lds
  v_mfma_f32_16x16x32_bf16 v[36:39], a[244:247], v[84:87], v[36:39]
  v_mfma_f32_16x16x32_bf16 v[40:43], a[248:251], v[84:87], v[40:43]
  v_mfma_f32_16x16x32_bf16 v[44:47], a[252:255], v[84:87], v[44:47]
  v_mfma_f32_16x16x32_bf16 v[48:51], a[240:243], v[88:91], v[48:51]
  buffer_load_dwordx4 v199, s[32:35], s78 offen offset:1056 lds
  v_mfma_f32_16x16x32_bf16 v[52:55], a[244:247], v[88:91], v[52:55]
  ds_write_b128 v3, v[32:35] offset:0
  v_mfma_f32_16x16x32_bf16 v[56:59], a[248:251], v[88:91], v[56:59]
  s_nop 0
  ds_write_b128 v3, v[36:39] offset:1024
  v_mfma_f32_16x16x32_bf16 v[60:63], a[252:255], v[88:91], v[60:63]
  ds_write_b128 v3, v[40:43] offset:2048
  v_mfma_f32_16x16x32_bf16 v[64:67], a[240:243], v[92:95], v[64:67]
  buffer_load_dwordx4 v200, s[32:35], s78 offen offset:2112 lds
  ds_write_b128 v3, v[44:47] offset:3072
  v_mfma_f32_16x16x32_bf16 v[68:71], a[244:247], v[92:95], v[68:71]
  ds_write_b128 v4, v[48:51] offset:4096
  v_mfma_f32_16x16x32_bf16 v[72:75], a[248:251], v[92:95], v[72:75]
  ds_write_b128 v4, v[52:55] offset:5120
  v_mfma_f32_16x16x32_bf16 v[76:79], a[252:255], v[92:95], v[76:79]
  ds_write_b128 v4, v[56:59] offset:6144
  v_mfma_f32_16x16x32_bf16 v[16:19], a[240:243], v[80:83], v[16:19]
  buffer_load_dwordx4 v201, s[32:35], s78 offen offset:3168 lds
  ds_write_b128 v4, v[60:63] offset:7168
  v_mfma_f32_16x16x32_bf16 v[20:23], a[244:247], v[80:83], v[20:23]
  ds_write_b128 v5, v[64:67] offset:8192
  v_mfma_f32_16x16x32_bf16 v[24:27], a[248:251], v[80:83], v[24:27]
  ds_write_b128 v5, v[68:71] offset:9216
  v_mfma_f32_16x16x32_bf16 v[28:31], a[252:255], v[80:83], v[28:31]
  ds_write_b128 v5, v[72:75] offset:10240
  ds_write_b128 v5, v[76:79] offset:11264
  s_add_u32 s78, s61, 4096
  s_sub_u32 s68, s78, 12288
  s_cselect_b32 s78, s78, s68
  s_mul_i32 s78, s78, 128
  s_add_u32 m0, s86, 29568
  s_nop 0
  buffer_load_dwordx4 v198, s[32:35], s78 offen offset:0 lds
  buffer_load_dwordx4 v199, s[32:35], s78 offen offset:1056 lds
  buffer_load_dwordx4 v200, s[32:35], s78 offen offset:2112 lds
  buffer_load_dwordx4 v201, s[32:35], s78 offen offset:3168 lds
  s_waitcnt lgkmcnt(0)
  s_barrier
  ds_read_b128 v[80:83], v2 offset:0
  ds_read_b128 v[96:99], v2 offset:4096
  ds_read_b128 v[112:115], v2 offset:8192
  ds_read_b128 v[84:87], v2 offset:1024
  ds_read_b128 v[100:103], v2 offset:5120
  ds_read_b128 v[116:119], v2 offset:9216
  ds_read_b128 v[88:91], v2 offset:2048
  ds_read_b128 v[104:107], v2 offset:6144
  ds_read_b128 v[120:123], v2 offset:10240
  ds_read_b128 v[92:95], v2 offset:3072
  ds_read_b128 v[108:111], v2 offset:7168
  ds_read_b128 v[124:127], v2 offset:11264
  s_add_u32 s78, s61, 5120
  s_sub_u32 s68, s78, 12288
  s_cselect_b32 s78, s78, s68
  s_mul_i32 s78, s78, 128
  s_add_u32 m0, s86, 33792
  s_nop 0
  buffer_load_dwordx4 v198, s[32:35], s78 offen offset:0 lds
  buffer_load_dwordx4 v199, s[32:35], s78 offen offset:1056 lds
  buffer_load_dwordx4 v200, s[32:35], s78 offen offset:2112 lds
  buffer_load_dwordx4 v201, s[32:35], s78 offen offset:3168 lds
  s_waitcnt lgkmcnt(11)
  v_pk_add_f32 v[16:17], v[16:17], v[80:81]
  v_pk_add_f32 v[18:19], v[18:19], v[82:83]
  s_waitcnt lgkmcnt(8)
  v_pk_add_f32 v[20:21], v[20:21], v[84:85]
  v_pk_add_f32 v[22:23], v[22:23], v[86:87]
  v_pk_add_f32 v[16:17], v[16:17], v[96:97]
  v_pk_add_f32 v[18:19], v[18:19], v[98:99]
  s_waitcnt lgkmcnt(7)
  v_pk_add_f32 v[20:21], v[20:21], v[100:101]
  v_pk_add_f32 v[22:23], v[22:23], v[102:103]
  v_pk_add_f32 v[16:17], v[16:17], v[112:113]
  v_pk_add_f32 v[18:19], v[18:19], v[114:115]
  s_waitcnt lgkmcnt(6)
  v_pk_add_f32 v[20:21], v[20:21], v[116:117]
  v_pk_add_f32 v[22:23], v[22:23], v[118:119]
  v_pk_mul_f32 v[128:129], v[16:17], v[16:17]
  v_pk_mul_f32 v[130:131], v[18:19], v[18:19]
  v_pk_mul_f32 v[132:133], v[20:21], v[20:21]
  v_pk_mul_f32 v[134:135], v[22:23], v[22:23]
  v_pk_fma_f32 v[128:129], v[128:129], v[6:7], v[8:9] op_sel_hi:[1,0,0]
  v_pk_fma_f32 v[130:131], v[130:131], v[6:7], v[8:9] op_sel_hi:[1,0,0]
  v_pk_fma_f32 v[132:133], v[132:133], v[6:7], v[8:9] op_sel_hi:[1,0,0]
  v_pk_fma_f32 v[134:135], v[134:135], v[6:7], v[8:9] op_sel_hi:[1,0,0]
  v_pk_mul_f32 v[128:129], v[128:129], v[16:17]
  v_pk_mul_f32 v[130:131], v[130:131], v[18:19]
  v_pk_mul_f32 v[132:133], v[132:133], v[20:21]
  v_pk_mul_f32 v[134:135], v[134:135], v[22:23]
  v_exp_f32 v128, v128
  v_exp_f32 v129, v129
  v_exp_f32 v130, v130
  v_exp_f32 v131, v131
  v_exp_f32 v132, v132
  v_exp_f32 v133, v133
  v_exp_f32 v134, v134
  v_exp_f32 v135, v135
  v_pk_add_f32 v[128:129], v[128:129], v[10:11] op_sel_hi:[1,0]
  v_pk_add_f32 v[130:131], v[130:131], v[10:11] op_sel_hi:[1,0]
  v_pk_add_f32 v[132:133], v[132:133], v[10:11] op_sel_hi:[1,0]
  v_pk_add_f32 v[134:135], v[134:135], v[10:11] op_sel_hi:[1,0]
  v_rcp_f32 v128, v128
  v_rcp_f32 v129, v129
  v_rcp_f32 v130, v130
  v_rcp_f32 v131, v131
  v_rcp_f32 v132, v132
  v_rcp_f32 v133, v133
  v_rcp_f32 v134, v134
  v_rcp_f32 v135, v135
  v_pk_mul_f32 v[128:129], v[128:129], v[16:17]
  v_pk_mul_f32 v[130:131], v[130:131], v[18:19]
  v_pk_mul_f32 v[132:133], v[132:133], v[20:21]
  v_pk_mul_f32 v[134:135], v[134:135], v[22:23]
  v_cvt_pk_bf16_f32 v144, v128, v129
  v_cvt_pk_bf16_f32 v145, v130, v131
  v_cvt_pk_bf16_f32 v146, v132, v133
  v_cvt_pk_bf16_f32 v147, v134, v135
  buffer_store_dwordx4 v[144:147], v13, s[8:11], s73 offen offset:0 sc1
  s_waitcnt lgkmcnt(5)
  v_pk_add_f32 v[24:25], v[24:25], v[88:89]
  v_pk_add_f32 v[26:27], v[26:27], v[90:91]
  s_waitcnt lgkmcnt(2)
  v_pk_add_f32 v[28:29], v[28:29], v[92:93]
  v_pk_add_f32 v[30:31], v[30:31], v[94:95]
  v_pk_add_f32 v[24:25], v[24:25], v[104:105]
  v_pk_add_f32 v[26:27], v[26:27], v[106:107]
  s_waitcnt lgkmcnt(1)
  v_pk_add_f32 v[28:29], v[28:29], v[108:109]
  v_pk_add_f32 v[30:31], v[30:31], v[110:111]
  v_pk_add_f32 v[24:25], v[24:25], v[120:121]
  v_pk_add_f32 v[26:27], v[26:27], v[122:123]
  s_waitcnt lgkmcnt(0)
  v_pk_add_f32 v[28:29], v[28:29], v[124:125]
  v_pk_add_f32 v[30:31], v[30:31], v[126:127]
  v_pk_mul_f32 v[136:137], v[24:25], v[24:25]
  v_pk_mul_f32 v[138:139], v[26:27], v[26:27]
  v_pk_mul_f32 v[140:141], v[28:29], v[28:29]
  v_pk_mul_f32 v[142:143], v[30:31], v[30:31]
  v_pk_fma_f32 v[136:137], v[136:137], v[6:7], v[8:9] op_sel_hi:[1,0,0]
  v_pk_fma_f32 v[138:139], v[138:139], v[6:7], v[8:9] op_sel_hi:[1,0,0]
  v_pk_fma_f32 v[140:141], v[140:141], v[6:7], v[8:9] op_sel_hi:[1,0,0]
  v_pk_fma_f32 v[142:143], v[142:143], v[6:7], v[8:9] op_sel_hi:[1,0,0]
  v_pk_mul_f32 v[136:137], v[136:137], v[24:25]
  v_pk_mul_f32 v[138:139], v[138:139], v[26:27]
  v_pk_mul_f32 v[140:141], v[140:141], v[28:29]
  v_pk_mul_f32 v[142:143], v[142:143], v[30:31]
  v_exp_f32 v136, v136
  v_exp_f32 v137, v137
  v_exp_f32 v138, v138
  v_exp_f32 v139, v139
  v_exp_f32 v140, v140
  v_exp_f32 v141, v141
  v_exp_f32 v142, v142
  v_exp_f32 v143, v143
  v_pk_add_f32 v[136:137], v[136:137], v[10:11] op_sel_hi:[1,0]
  v_pk_add_f32 v[138:139], v[138:139], v[10:11] op_sel_hi:[1,0]
  v_pk_add_f32 v[140:141], v[140:141], v[10:11] op_sel_hi:[1,0]
  v_pk_add_f32 v[142:143], v[142:143], v[10:11] op_sel_hi:[1,0]
  v_rcp_f32 v136, v136
  v_rcp_f32 v137, v137
  v_rcp_f32 v138, v138
  v_rcp_f32 v139, v139
  v_rcp_f32 v140, v140
  v_rcp_f32 v141, v141
  v_rcp_f32 v142, v142
  v_rcp_f32 v143, v143
  v_pk_mul_f32 v[136:137], v[136:137], v[24:25]
  v_pk_mul_f32 v[138:139], v[138:139], v[26:27]
  v_pk_mul_f32 v[140:141], v[140:141], v[28:29]
  v_pk_mul_f32 v[142:143], v[142:143], v[30:31]
  v_cvt_pk_bf16_f32 v148, v136, v137
  v_cvt_pk_bf16_f32 v149, v138, v139
  v_cvt_pk_bf16_f32 v150, v140, v141
  v_cvt_pk_bf16_f32 v151, v142, v143
  buffer_store_dwordx4 v[148:151], v13, s[8:11], s73 offen offset:1024 sc1
  s_barrier
JN62:
  s_waitcnt vmcnt(22)
  ds_read_b64_tr_b16 a[0:1], v202 offset:12672
  ds_read_b64_tr_b16 a[2:3], v202 offset:13184
  ds_read_b64_tr_b16 a[4:5], v203 offset:12672
  ds_read_b64_tr_b16 a[6:7], v203 offset:13184
  ds_read_b64_tr_b16 a[8:9], v204 offset:12672
  ds_read_b64_tr_b16 a[10:11], v204 offset:13184
  ds_read_b64_tr_b16 a[12:13], v205 offset:12672
  ds_read_b64_tr_b16 a[14:15], v205 offset:13184
  s_waitcnt vmcnt(18)
  ds_read_b64_tr_b16 a[16:17], v202 offset:16896
  ds_read_b64_tr_b16 a[18:19], v202 offset:17408
  ds_read_b64_tr_b16 a[20:21], v203 offset:16896
  ds_read_b64_tr_b16 a[22:23], v203 offset:17408
  ds_read_b64_tr_b16 a[24:25], v204 offset:16896
  ds_read_b64_tr_b16 a[26:27], v204 offset:17408
  ds_read_b64_tr_b16 a[28:29], v205 offset:16896
  ds_read_b64_tr_b16 a[30:31], v205 offset:17408
  s_waitcnt vmcnt(14)
  ds_read_b64_tr_b16 a[32:33], v202 offset:21120
  ds_read_b64_tr_b16 a[34:35], v202 offset:21632
  ds_read_b64_tr_b16 a[36:37], v203 offset:21120
  ds_read_b64_tr_b16 a[38:39], v203 offset:21632
  ds_read_b64_tr_b16 a[40:41], v204 offset:21120
  ds_read_b64_tr_b16 a[42:43], v204 offset:21632
  ds_read_b64_tr_b16 a[44:45], v205 offset:21120
  ds_read_b64_tr_b16 a[46:47], v205 offset:21632
  s_waitcnt vmcnt(10)
  ds_read_b64_tr_b16 a[48:49], v202 offset:25344
  ds_read_b64_tr_b16 a[50:51], v202 offset:25856
  ds_read_b64_tr_b16 a[52:53], v203 offset:25344
  ds_read_b64_tr_b16 a[54:55], v203 offset:25856
  ds_read_b64_tr_b16 a[56:57], v204 offset:25344
  ds_read_b64_tr_b16 a[58:59], v204 offset:25856
  ds_read_b64_tr_b16 a[60:61], v205 offset:25344
  ds_read_b64_tr_b16 a[62:63], v205 offset:25856
  s_add_u32 s78, s61, 6144
  s_sub_u32 s68, s78, 12288
  s_cselect_b32 s78, s78, s68
  s_mul_i32 s78, s78, 128
  s_add_u32 m0, s86, 0
  s_nop 0
  buffer_load_dwordx4 v198, s[32:35], s78 offen offset:0 lds
  s_mov_b32 s82, 131072
  s_add_u32 s66, s52, 1
  buffer_load_dwordx4 v199, s[32:35], s78 offen offset:1056 lds
  s_and_b32 s66, s66, 3
  s_mul_i32 s66, s66, 15360
  buffer_load_dwordx4 v200, s[32:35], s78 offen offset:2112 lds
  s_add_u32 s66, s66, 92160
  v_add_u32 v5, s66, v13
  buffer_load_dwordx4 v201, s[32:35], s78 offen offset:3168 lds
  s_add_u32 s66, s52, 2
  s_and_b32 s66, s66, 3
  s_add_u32 s78, s61, 7168
  s_sub_u32 s68, s78, 12288
  s_cselect_b32 s78, s78, s68
  s_mul_i32 s78, s78, 128
  s_add_u32 m0, s86, 4224
  s_nop 0
  buffer_load_dwordx4 v198, s[32:35], s78 offen offset:0 lds
  s_mul_i32 s66, s66, 15360
  s_add_u32 s66, s66, 92160
  buffer_load_dwordx4 v199, s[32:35], s78 offen offset:1056 lds
  v_add_u32 v6, s66, v13
  s_add_u32 s66, s52, 3
  buffer_load_dwordx4 v200, s[32:35], s78 offen offset:2112 lds
  s_and_b32 s66, s66, 3
  s_mul_i32 s66, s66, 15360
  buffer_load_dwordx4 v201, s[32:35], s78 offen offset:3168 lds
  s_add_u32 s66, s66, 92160
  v_add_u32 v7, s66, v13
  s_add_u32 s78, s61, 8192
  s_sub_u32 s68, s78, 12288
  s_cselect_b32 s78, s78, s68
  s_mul_i32 s78, s78, 128
  s_add_u32 m0, s86, 8448
  s_nop 0
  buffer_load_dwordx4 v198, s[32:35], s78 offen offset:0 lds
  s_mul_i32 s66, s52, 15360
  s_add_u32 s66, s66, 92160
  buffer_load_dwordx4 v199, s[32:35], s78 offen offset:1056 lds
  v_add_u32 v215, s66, v13
  v_lshrrev_b32 v4, 4, v1
  buffer_load_dwordx4 v200, s[32:35], s78 offen offset:2112 lds
  v_and_b32 v3, 15, v1
  v_lshlrev_b32 v3, 4, v3
  buffer_load_dwordx4 v201, s[32:35], s78 offen offset:3168 lds
  v_lshl_add_u32 v2, v4, 9, v3
  v_lshrrev_b32 v4, 5, v1
  s_waitcnt lgkmcnt(0)
  v_lshl_add_u32 v3, v4, 9, v3
  v_bfe_u32 v4, v1, 4, 1
  s_add_u32 s78, s61, 9216
  s_sub_u32 s68, s78, 12288
  s_cselect_b32 s78, s78, s68
  s_mul_i32 s78, s78, 128
  s_add_u32 m0, s86, 12672
  s_nop 0
  buffer_load_dwordx4 v198, s[32:35], s78 offen offset:0 lds
  v_lshl_add_u32 v3, v4, 3, v3
  s_lshr_b32 s74, s59, 1
  buffer_load_dwordx4 v199, s[32:35], s78 offen offset:1056 lds
  s_mul_i32 s74, s74, 40960
  s_mul_i32 s66, s55, 5120
  buffer_load_dwordx4 v200, s[32:35], s78 offen offset:2112 lds
  s_add_u32 s74, s74, s66
  s_and_b32 s66, s59, 1
  buffer_load_dwordx4 v201, s[32:35], s78 offen offset:3168 lds
  s_lshl_b32 s66, s66, 8
  s_add_u32 s74, s74, s66
  s_add_u32 s74, s74, 17432576
  s_add_u32 s75, s74, 4096
  s_add_u32 s78, s61, 10240
  s_sub_u32 s68, s78, 12288
  s_cselect_b32 s78, s78, s68
  s_mul_i32 s78, s78, 128
  s_add_u32 m0, s86, 16896
  s_nop 0
  buffer_load_dwordx4 v198, s[32:35], s78 offen offset:0 lds
  buffer_load_dwordx4 v199, s[32:35], s78 offen offset:1056 lds
  buffer_load_dwordx4 v200, s[32:35], s78 offen offset:2112 lds
  buffer_load_dwordx4 v201, s[32:35], s78 offen offset:3168 lds
  s_add_u32 s78, s61, 11264
  s_sub_u32 s68, s78, 12288
  s_cselect_b32 s78, s78, s68
  s_mul_i32 s78, s78, 128
  s_add_u32 m0, s86, 21120
  s_nop 0
  buffer_load_dwordx4 v198, s[32:35], s78 offen offset:0 lds
  buffer_load_dwordx4 v199, s[32:35], s78 offen offset:1056 lds
  buffer_load_dwordx4 v200, s[32:35], s78 offen offset:2112 lds
  buffer_load_dwordx4 v201, s[32:35], s78 offen offset:3168 lds
  s_mov_b32 s81, s61
  buffer_load_dwordx4 v[96:99], v210, s[8:11], s81 offen sc1
  buffer_load_dwordx4 v[100:103], v211, s[8:11], s81 offen sc1
  buffer_load_dwordx4 v[104:107], v212, s[8:11], s81 offen sc1
  buffer_load_dwordx4 v[108:111], v213, s[8:11], s81 offen sc1
  buffer_load_dwordx4 v[112:115], v214, s[8:11], s81 offen sc1
  s_add_u32 s81, s61, 1024
  s_sub_u32 s68, s81, 12288
  s_cselect_b32 s81, s81, s68
  buffer_load_dwordx4 v[116:119], v210, s[8:11], s81 offen sc1
  buffer_load_dwordx4 v[120:123], v211, s[8:11], s81 offen sc1
  buffer_load_dwordx4 v[124:127], v212, s[8:11], s81 offen sc1
  buffer_load_dwordx4 v[128:131], v213, s[8:11], s81 offen sc1
  buffer_load_dwordx4 v[132:135], v214, s[8:11], s81 offen sc1
  s_add_u32 s81, s61, 2048
  s_sub_u32 s68, s81, 12288
  s_cselect_b32 s81, s81, s68
  buffer_load_dwordx4 v[136:139], v210, s[8:11], s81 offen sc1
  buffer_load_dwordx4 v[140:143], v211, s[8:11], s81 offen sc1
  buffer_load_dwordx4 v[144:147], v212, s[8:11], s81 offen sc1
  buffer_load_dwordx4 v[148:151], v213, s[8:11], s81 offen sc1
  buffer_load_dwordx4 v[152:155], v214, s[8:11], s81 offen sc1
VC111:
  s_waitcnt vmcnt(12)
  v_max3_u32 v8, v96, v100, v104
  s_waitcnt vmcnt(10)
  v_max3_u32 v8, v8, v108, v112
  v_cmp_eq_u32 vcc, -1, v8
  s_cbranch_vccnz VR112
VK113:
  v_mfma_f32_16x16x32_bf16 v[16:19], v[96:99], a[0:3], 0
  s_add_u32 s81, s61, 3072
  s_sub_u32 s68, s81, 12288
  s_cselect_b32 s81, s81, s68
  buffer_load_dwordx4 v[156:159], v210, s[8:11], s81 offen sc1
  v_mfma_f32_16x16x32_bf16 v[36:39], v[96:99], a[4:7], 0
  ds_read_b64_tr_b16 a[64:65], v202 offset:29568
  v_mfma_f32_16x16x32_bf16 v[56:59], v[96:99], a[8:11], 0
  v_mfma_f32_16x16x32_bf16 v[76:79], v[96:99], a[12:15], 0
  ds_read_b64_tr_b16 a[66:67], v202 offset:30080
  v_mfma_f32_16x16x32_bf16 v[20:23], v[100:103], a[0:3], 0
  buffer_load_dwordx4 v[160:163], v211, s[8:11], s81 offen sc1
  v_mfma_f32_16x16x32_bf16 v[40:43], v[100:103], a[4:7], 0
  ds_read_b64_tr_b16 a[68:69], v203 offset:29568
  v_mfma_f32_16x16x32_bf16 v[60:63], v[100:103], a[8:11], 0
  v_mfma_f32_16x16x32_bf16 v[80:83], v[100:103], a[12:15], 0
  ds_read_b64_tr_b16 a[70:71], v203 offset:30080
  v_mfma_f32_16x16x32_bf16 v[24:27], v[104:107], a[0:3], 0
  buffer_load_dwordx4 v[164:167], v212, s[8:11], s81 offen sc1
  v_mfma_f32_16x16x32_bf16 v[44:47], v[104:107], a[4:7], 0
  v_mfma_f32_16x16x32_bf16 v[64:67], v[104:107], a[8:11], 0
  ds_read_b64_tr_b16 a[72:73], v204 offset:29568
  v_mfma_f32_16x16x32_bf16 v[84:87], v[104:107], a[12:15], 0
  v_mfma_f32_16x16x32_bf16 v[28:31], v[108:111], a[0:3], 0
  buffer_load_dwordx4 v[168:171], v213, s[8:11], s81 offen sc1
  ds_read_b64_tr_b16 a[74:75], v204 offset:30080
  v_mfma_f32_16x16x32_bf16 v[48:51], v[108:111], a[4:7], 0
  v_mfma_f32_16x16x32_bf16 v[68:71], v[108:111], a[8:11], 0
  ds_read_b64_tr_b16 a[76:77], v205 offset:29568
  v_mfma_f32_16x16x32_bf16 v[88:91], v[108:111], a[12:15], 0
  v_mfma_f32_16x16x32_bf16 v[32:35], v[112:115], a[0:3], 0
  buffer_load_dwordx4 v[172:175], v214, s[8:11], s81 offen sc1
  v_mfma_f32_16x16x32_bf16 v[52:55], v[112:115], a[4:7], 0
  ds_read_b64_tr_b16 a[78:79], v205 offset:30080
  v_mfma_f32_16x16x32_bf16 v[72:75], v[112:115], a[8:11], 0
  v_mfma_f32_16x16x32_bf16 v[92:95], v[112:115], a[12:15], 0
VC114:
  s_waitcnt vmcnt(12)
  v_max3_u32 v8, v116, v120, v124
  s_waitcnt vmcnt(10)
  v_max3_u32 v8, v8, v128, v132
  v_cmp_eq_u32 vcc, -1, v8
  s_cbranch_vccnz VR115
VK116:
  v_mfma_f32_16x16x32_bf16 v[16:19], v[116:119], a[16:19], v[16:19]
  s_add_u32 s81, s61, 4096
  s_sub_u32 s68, s81, 12288
  s_cselect_b32 s81, s81, s68
  buffer_load_dwordx4 v[96:99], v210, s[8:11], s81 offen sc1
  v_mfma_f32_16x16x32_bf16 v[36:39], v[116:119], a[20:23], v[36:39]
  ds_read_b64_tr_b16 a[80:81], v202 offset:33792
  v_mfma_f32_16x16x32_bf16 v[56:59], v[116:119], a[24:27], v[56:59]
  v_mfma_f32_16x16x32_bf16 v[76:79], v[116:119], a[28:31], v[76:79]
  ds_read_b64_tr_b16 a[82:83], v202 offset:34304
  v_mfma_f32_16x16x32_bf16 v[20:23], v[120:123], a[16:19], v[20:23]
  buffer_load_dwordx4 v[100:103], v211, s[8:11], s81 offen sc1
  v_mfma_f32_16x16x32_bf16 v[40:43], v[120:123], a[20:23], v[40:43]
  ds_read_b64_tr_b16 a[84:85], v203 offset:33792
  v_mfma_f32_16x16x32_bf16 v[60:63], v[120:123], a[24:27], v[60:63]
  v_mfma_f32_16x16x32_bf16 v[80:83], v[120:123], a[28:31], v[80:83]
  ds_read_b64_tr_b16 a[86:87], v203 offset:34304
  v_mfma_f32_16x16x32_bf16 v[24:27], v[124:127], a[16:19], v[24:27]
  buffer_load_dwordx4 v[104:107], v212, s[8:11], s81 offen sc1
  v_mfma_f32_16x16x32_bf16 v[44:47], v[124:127], a[20:23], v[44:47]
  v_mfma_f32_16x16x32_bf16 v[64:67], v[124:127], a[24:27], v[64:67]
  ds_read_b64_tr_b16 a[88:89], v204 offset:33792
  v_mfma_f32_16x16x32_bf16 v[84:87], v[124:127], a[28:31], v[84:87]
  v_mfma_f32_16x16x32_bf16 v[28:31], v[128:131], a[16:19], v[28:31]
  buffer_load_dwordx4 v[108:111], v213, s[8:11], s81 offen sc1
  ds_read_b64_tr_b16 a[90:91], v204 offset:34304
  v_mfma_f32_16x16x32_bf16 v[48:51], v[128:131], a[20:23], v[48:51]
  v_mfma_f32_16x16x32_bf16 v[68:71], v[128:131], a[24:27], v[68:71]
  ds_read_b64_tr_b16 a[92:93], v205 offset:33792
  v_mfma_f32_16x16x32_bf16 v[88:91], v[128:131], a[28:31], v[88:91]
  v_mfma_f32_16x16x32_bf16 v[32:35], v[132:135], a[16:19], v[32:35]
  buffer_load_dwordx4 v[112:115], v214, s[8:11], s81 offen sc1
  v_mfma_f32_16x16x32_bf16 v[52:55], v[132:135], a[20:23], v[52:55]
  ds_read_b64_tr_b16 a[94:95], v205 offset:34304
  v_mfma_f32_16x16x32_bf16 v[72:75], v[132:135], a[24:27], v[72:75]
  v_mfma_f32_16x16x32_bf16 v[92:95], v[132:135], a[28:31], v[92:95]
VC117:
  s_waitcnt vmcnt(12)
  v_max3_u32 v8, v136, v140, v144
  s_waitcnt vmcnt(10)
  v_max3_u32 v8, v8, v148, v152
  v_cmp_eq_u32 vcc, -1, v8
  s_cbranch_vccnz VR118
VK119:
  v_mfma_f32_16x16x32_bf16 v[16:19], v[136:139], a[32:35], v[16:19]
  s_add_u32 s81, s61, 5120
  s_sub_u32 s68, s81, 12288
  s_cselect_b32 s81, s81, s68
  buffer_load_dwordx4 v[116:119], v210, s[8:11], s81 offen sc1
  v_mfma_f32_16x16x32_bf16 v[36:39], v[136:139], a[36:39], v[36:39]
  ds_read_b64_tr_b16 a[96:97], v202 offset:0
  v_mfma_f32_16x16x32_bf16 v[56:59], v[136:139], a[40:43], v[56:59]
  v_mfma_f32_16x16x32_bf16 v[76:79], v[136:139], a[44:47], v[76:79]
  ds_read_b64_tr_b16 a[98:99], v202 offset:512
  v_mfma_f32_16x16x32_bf16 v[20:23], v[140:143], a[32:35], v[20:23]
  buffer_load_dwordx4 v[120:123], v211, s[8:11], s81 offen sc1
  v_mfma_f32_16x16x32_bf16 v[40:43], v[140:143], a[36:39], v[40:43]
  ds_read_b64_tr_b16 a[100:101], v203 offset:0
  v_mfma_f32_16x16x32_bf16 v[60:63], v[140:143], a[40:43], v[60:63]
  v_mfma_f32_16x16x32_bf16 v[80:83], v[140:143], a[44:47], v[80:83]
  ds_read_b64_tr_b16 a[102:103], v203 offset:512
  v_mfma_f32_16x16x32_bf16 v[24:27], v[144:147], a[32:35], v[24:27]
  buffer_load_dwordx4 v[124:127], v212, s[8:11], s81 offen sc1
  v_mfma_f32_16x16x32_bf16 v[44:47], v[144:147], a[36:39], v[44:47]
  v_mfma_f32_16x16x32_bf16 v[64:67], v[144:147], a[40:43], v[64:67]
  ds_read_b64_tr_b16 a[104:105], v204 offset:0
  v_mfma_f32_16x16x32_bf16 v[84:87], v[144:147], a[44:47], v[84:87]
  v_mfma_f32_16x16x32_bf16 v[28:31], v[148:151], a[32:35], v[28:31]
  buffer_load_dwordx4 v[128:131], v213, s[8:11], s81 offen sc1
  ds_read_b64_tr_b16 a[106:107], v204 offset:512
  v_mfma_f32_16x16x32_bf16 v[48:51], v[148:151], a[36:39], v[48:51]
  v_mfma_f32_16x16x32_bf16 v[68:71], v[148:151], a[40:43], v[68:71]
  ds_read_b64_tr_b16 a[108:109], v205 offset:0
  v_mfma_f32_16x16x32_bf16 v[88:91], v[148:151], a[44:47], v[88:91]
  v_mfma_f32_16x16x32_bf16 v[32:35], v[152:155], a[32:35], v[32:35]
  buffer_load_dwordx4 v[132:135], v214, s[8:11], s81 offen sc1
  v_mfma_f32_16x16x32_bf16 v[52:55], v[152:155], a[36:39], v[52:55]
  ds_read_b64_tr_b16 a[110:111], v205 offset:512
  v_mfma_f32_16x16x32_bf16 v[72:75], v[152:155], a[40:43], v[72:75]
  v_mfma_f32_16x16x32_bf16 v[92:95], v[152:155], a[44:47], v[92:95]
VC120:
  s_waitcnt vmcnt(12)
  v_max3_u32 v8, v156, v160, v164
  s_waitcnt vmcnt(10)
  v_max3_u32 v8, v8, v168, v172
  v_cmp_eq_u32 vcc, -1, v8
  s_cbranch_vccnz VR121
VK122:
  v_mfma_f32_16x16x32_bf16 v[16:19], v[156:159], a[48:51], v[16:19]
  s_add_u32 s81, s61, 6144
  s_sub_u32 s68, s81, 12288
  s_cselect_b32 s81, s81, s68
  buffer_load_dwordx4 v[136:139], v210, s[8:11], s81 offen sc1
  v_mfma_f32_16x16x32_bf16 v[36:39], v[156:159], a[52:55], v[36:39]
  ds_read_b64_tr_b16 a[112:113], v202 offset:4224
  v_mfma_f32_16x16x32_bf16 v[56:59], v[156:159], a[56:59], v[56:59]
  v_mfma_f32_16x16x32_bf16 v[76:79], v[156:159], a[60:63], v[76:79]
  ds_read_b64_tr_b16 a[114:115], v202 offset:4736
  v_mfma_f32_16x16x32_bf16 v[20:23], v[160:163], a[48:51], v[20:23]
  buffer_load_dwordx4 v[140:143], v211, s[8:11], s81 offen sc1
  v_mfma_f32_16x16x32_bf16 v[40:43], v[160:163], a[52:55], v[40:43]
  ds_read_b64_tr_b16 a[116:117], v203 offset:4224
  v_mfma_f32_16x16x32_bf16 v[60:63], v[160:163], a[56:59], v[60:63]
  v_mfma_f32_16x16x32_bf16 v[80:83], v[160:163], a[60:63], v[80:83]
  ds_read_b64_tr_b16 a[118:119], v203 offset:4736
  v_mfma_f32_16x16x32_bf16 v[24:27], v[164:167], a[48:51], v[24:27]
  buffer_load_dwordx4 v[144:147], v212, s[8:11], s81 offen sc1
  v_mfma_f32_16x16x32_bf16 v[44:47], v[164:167], a[52:55], v[44:47]
  v_mfma_f32_16x16x32_bf16 v[64:67], v[164:167], a[56:59], v[64:67]
  ds_read_b64_tr_b16 a[120:121], v204 offset:4224
  v_mfma_f32_16x16x32_bf16 v[84:87], v[164:167], a[60:63], v[84:87]
  v_mfma_f32_16x16x32_bf16 v[28:31], v[168:171], a[48:51], v[28:31]
  buffer_load_dwordx4 v[148:151], v213, s[8:11], s81 offen sc1
  ds_read_b64_tr_b16 a[122:123], v204 offset:4736
  v_mfma_f32_16x16x32_bf16 v[48:51], v[168:171], a[52:55], v[48:51]
  v_mfma_f32_16x16x32_bf16 v[68:71], v[168:171], a[56:59], v[68:71]
  ds_read_b64_tr_b16 a[124:125], v205 offset:4224
  v_mfma_f32_16x16x32_bf16 v[88:91], v[168:171], a[60:63], v[88:91]
  v_mfma_f32_16x16x32_bf16 v[32:35], v[172:175], a[48:51], v[32:35]
  buffer_load_dwordx4 v[152:155], v214, s[8:11], s81 offen sc1
  v_mfma_f32_16x16x32_bf16 v[52:55], v[172:175], a[52:55], v[52:55]
  ds_read_b64_tr_b16 a[126:127], v205 offset:4736
  v_mfma_f32_16x16x32_bf16 v[72:75], v[172:175], a[56:59], v[72:75]
  v_mfma_f32_16x16x32_bf16 v[92:95], v[172:175], a[60:63], v[92:95]
VC123:
  s_waitcnt vmcnt(12)
  v_max3_u32 v8, v96, v100, v104
  s_waitcnt vmcnt(10)
  v_max3_u32 v8, v8, v108, v112
  v_cmp_eq_u32 vcc, -1, v8
  s_cbranch_vccnz VR124
VK125:
  s_waitcnt lgkmcnt(15)
  v_mfma_f32_16x16x32_bf16 v[16:19], v[96:99], a[64:67], v[16:19]
  s_add_u32 s81, s61, 7168
  s_sub_u32 s68, s81, 12288
  s_cselect_b32 s81, s81, s68
  buffer_load_dwordx4 v[156:159], v210, s[8:11], s81 offen sc1
  v_mfma_f32_16x16x32_bf16 v[36:39], v[96:99], a[68:71], v[36:39]
  ds_read_b64_tr_b16 a[128:129], v202 offset:8448
  v_mfma_f32_16x16x32_bf16 v[56:59], v[96:99], a[72:75], v[56:59]
  v_mfma_f32_16x16x32_bf16 v[76:79], v[96:99], a[76:79], v[76:79]
  ds_read_b64_tr_b16 a[130:131], v202 offset:8960
  v_mfma_f32_16x16x32_bf16 v[20:23], v[100:103], a[64:67], v[20:23]
  buffer_load_dwordx4 v[160:163], v211, s[8:11], s81 offen sc1
  v_mfma_f32_16x16x32_bf16 v[40:43], v[100:103], a[68:71], v[40:43]
  ds_read_b64_tr_b16 a[132:133], v203 offset:8448
  v_mfma_f32_16x16x32_bf16 v[60:63], v[100:103], a[72:75], v[60:63]
  v_mfma_f32_16x16x32_bf16 v[80:83], v[100:103], a[76:79], v[80:83]
  ds_read_b64_tr_b16 a[134:135], v203 offset:8960
  v_mfma_f32_16x16x32_bf16 v[24:27], v[104:107], a[64:67], v[24:27]
  buffer_load_dwordx4 v[164:167], v212, s[8:11], s81 offen sc1
  v_mfma_f32_16x16x32_bf16 v[44:47], v[104:107], a[68:71], v[44:47]
  v_mfma_f32_16x16x32_bf16 v[64:67], v[104:107], a[72:75], v[64:67]
  ds_read_b64_tr_b16 a[136:137], v204 offset:8448
  v_mfma_f32_16x16x32_bf16 v[84:87], v[104:107], a[76:79], v[84:87]
  v_mfma_f32_16x16x32_bf16 v[28:31], v[108:111], a[64:67], v[28:31]
  buffer_load_dwordx4 v[168:171], v213, s[8:11], s81 offen sc1
  ds_read_b64_tr_b16 a[138:139], v204 offset:8960
  v_mfma_f32_16x16x32_bf16 v[48:51], v[108:111], a[68:71], v[48:51]
  v_mfma_f32_16x16x32_bf16 v[68:71], v[108:111], a[72:75], v[68:71]
  ds_read_b64_tr_b16 a[140:141], v205 offset:8448
  v_mfma_f32_16x16x32_bf16 v[88:91], v[108:111], a[76:79], v[88:91]
  v_mfma_f32_16x16x32_bf16 v[32:35], v[112:115], a[64:67], v[32:35]
  buffer_load_dwordx4 v[172:175], v214, s[8:11], s81 offen sc1
  v_mfma_f32_16x16x32_bf16 v[52:55], v[112:115], a[68:71], v[52:55]
  ds_read_b64_tr_b16 a[142:143], v205 offset:8960
  v_mfma_f32_16x16x32_bf16 v[72:75], v[112:115], a[72:75], v[72:75]
  v_mfma_f32_16x16x32_bf16 v[92:95], v[112:115], a[76:79], v[92:95]
VC126:
  s_waitcnt vmcnt(12)
  v_max3_u32 v8, v116, v120, v124
  s_waitcnt vmcnt(10)
  v_max3_u32 v8, v8, v128, v132
  v_cmp_eq_u32 vcc, -1, v8
  s_cbranch_vccnz VR127
VK128:
  v_mfma_f32_16x16x32_bf16 v[16:19], v[116:119], a[80:83], v[16:19]
  s_add_u32 s81, s61, 8192
  s_sub_u32 s68, s81, 12288
  s_cselect_b32 s81, s81, s68
  buffer_load_dwordx4 v[96:99], v210, s[8:11], s81 offen sc1
  v_mfma_f32_16x16x32_bf16 v[36:39], v[116:119], a[84:87], v[36:39]
  ds_read_b64_tr_b16 a[144:145], v202 offset:12672
  v_mfma_f32_16x16x32_bf16 v[56:59], v[116:119], a[88:91], v[56:59]
  v_mfma_f32_16x16x32_bf16 v[76:79], v[116:119], a[92:95], v[76:79]
  ds_read_b64_tr_b16 a[146:147], v202 offset:13184
  v_mfma_f32_16x16x32_bf16 v[20:23], v[120:123], a[80:83], v[20:23]
  buffer_load_dwordx4 v[100:103], v211, s[8:11], s81 offen sc1
  v_mfma_f32_16x16x32_bf16 v[40:43], v[120:123], a[84:87], v[40:43]
  ds_read_b64_tr_b16 a[148:149], v203 offset:12672
  v_mfma_f32_16x16x32_bf16 v[60:63], v[120:123], a[88:91], v[60:63]
  v_mfma_f32_16x16x32_bf16 v[80:83], v[120:123], a[92:95], v[80:83]
  ds_read_b64_tr_b16 a[150:151], v203 offset:13184
  v_mfma_f32_16x16x32_bf16 v[24:27], v[124:127], a[80:83], v[24:27]
  buffer_load_dwordx4 v[104:107], v212, s[8:11], s81 offen sc1
  v_mfma_f32_16x16x32_bf16 v[44:47], v[124:127], a[84:87], v[44:47]
  v_mfma_f32_16x16x32_bf16 v[64:67], v[124:127], a[88:91], v[64:67]
  ds_read_b64_tr_b16 a[152:153], v204 offset:12672
  v_mfma_f32_16x16x32_bf16 v[84:87], v[124:127], a[92:95], v[84:87]
  v_mfma_f32_16x16x32_bf16 v[28:31], v[128:131], a[80:83], v[28:31]
  buffer_load_dwordx4 v[108:111], v213, s[8:11], s81 offen sc1
  ds_read_b64_tr_b16 a[154:155], v204 offset:13184
  v_mfma_f32_16x16x32_bf16 v[48:51], v[128:131], a[84:87], v[48:51]
  v_mfma_f32_16x16x32_bf16 v[68:71], v[128:131], a[88:91], v[68:71]
  ds_read_b64_tr_b16 a[156:157], v205 offset:12672
  v_mfma_f32_16x16x32_bf16 v[88:91], v[128:131], a[92:95], v[88:91]
  v_mfma_f32_16x16x32_bf16 v[32:35], v[132:135], a[80:83], v[32:35]
  buffer_load_dwordx4 v[112:115], v214, s[8:11], s81 offen sc1
  v_mfma_f32_16x16x32_bf16 v[52:55], v[132:135], a[84:87], v[52:55]
  ds_read_b64_tr_b16 a[158:159], v205 offset:13184
  v_mfma_f32_16x16x32_bf16 v[72:75], v[132:135], a[88:91], v[72:75]
  v_mfma_f32_16x16x32_bf16 v[92:95], v[132:135], a[92:95], v[92:95]
VC129:
  s_waitcnt vmcnt(12)
  v_max3_u32 v8, v136, v140, v144
  s_waitcnt vmcnt(10)
  v_max3_u32 v8, v8, v148, v152
  v_cmp_eq_u32 vcc, -1, v8
  s_cbranch_vccnz VR130
VK131:
  s_waitcnt lgkmcnt(15)
  v_mfma_f32_16x16x32_bf16 v[16:19], v[136:139], a[96:99], v[16:19]
  s_add_u32 s81, s61, 9216
  s_sub_u32 s68, s81, 12288
  s_cselect_b32 s81, s81, s68
  buffer_load_dwordx4 v[116:119], v210, s[8:11], s81 offen sc1
  v_mfma_f32_16x16x32_bf16 v[36:39], v[136:139], a[100:103], v[36:39]
  ds_read_b64_tr_b16 a[160:161], v202 offset:16896
  v_mfma_f32_16x16x32_bf16 v[56:59], v[136:139], a[104:107], v[56:59]
  v_mfma_f32_16x16x32_bf16 v[76:79], v[136:139], a[108:111], v[76:79]
  ds_read_b64_tr_b16 a[162:163], v202 offset:17408
  v_mfma_f32_16x16x32_bf16 v[20:23], v[140:143], a[96:99], v[20:23]
  buffer_load_dwordx4 v[120:123], v211, s[8:11], s81 offen sc1
  v_mfma_f32_16x16x32_bf16 v[40:43], v[140:143], a[100:103], v[40:43]
  ds_read_b64_tr_b16 a[164:165], v203 offset:16896
  v_mfma_f32_16x16x32_bf16 v[60:63], v[140:143], a[104:107], v[60:63]
  v_mfma_f32_16x16x32_bf16 v[80:83], v[140:143], a[108:111], v[80:83]
  ds_read_b64_tr_b16 a[166:167], v203 offset:17408
  v_mfma_f32_16x16x32_bf16 v[24:27], v[144:147], a[96:99], v[24:27]
  buffer_load_dwordx4 v[124:127], v212, s[8:11], s81 offen sc1
  v_mfma_f32_16x16x32_bf16 v[44:47], v[144:147], a[100:103], v[44:47]
  v_mfma_f32_16x16x32_bf16 v[64:67], v[144:147], a[104:107], v[64:67]
  ds_read_b64_tr_b16 a[168:169], v204 offset:16896
  v_mfma_f32_16x16x32_bf16 v[84:87], v[144:147], a[108:111], v[84:87]
  v_mfma_f32_16x16x32_bf16 v[28:31], v[148:151], a[96:99], v[28:31]
  buffer_load_dwordx4 v[128:131], v213, s[8:11], s81 offen sc1
  ds_read_b64_tr_b16 a[170:171], v204 offset:17408
  v_mfma_f32_16x16x32_bf16 v[48:51], v[148:151], a[100:103], v[48:51]
  v_mfma_f32_16x16x32_bf16 v[68:71], v[148:151], a[104:107], v[68:71]
  ds_read_b64_tr_b16 a[172:173], v205 offset:16896
  v_mfma_f32_16x16x32_bf16 v[88:91], v[148:151], a[108:111], v[88:91]
  v_mfma_f32_16x16x32_bf16 v[32:35], v[152:155], a[96:99], v[32:35]
  buffer_load_dwordx4 v[132:135], v214, s[8:11], s81 offen sc1
  v_mfma_f32_16x16x32_bf16 v[52:55], v[152:155], a[100:103], v[52:55]
  ds_read_b64_tr_b16 a[174:175], v205 offset:17408
  v_mfma_f32_16x16x32_bf16 v[72:75], v[152:155], a[104:107], v[72:75]
  v_mfma_f32_16x16x32_bf16 v[92:95], v[152:155], a[108:111], v[92:95]
VC132:
  s_waitcnt vmcnt(12)
  v_max3_u32 v8, v156, v160, v164
  s_waitcnt vmcnt(10)
  v_max3_u32 v8, v8, v168, v172
  v_cmp_eq_u32 vcc, -1, v8
  s_cbranch_vccnz VR133
VK134:
  v_mfma_f32_16x16x32_bf16 v[16:19], v[156:159], a[112:115], v[16:19]
  s_add_u32 s81, s61, 10240
  s_sub_u32 s68, s81, 12288
  s_cselect_b32 s81, s81, s68
  buffer_load_dwordx4 v[136:139], v210, s[8:11], s81 offen sc1
  v_mfma_f32_16x16x32_bf16 v[36:39], v[156:159], a[116:119], v[36:39]
  ds_read_b64_tr_b16 a[176:177], v202 offset:21120
  v_mfma_f32_16x16x32_bf16 v[56:59], v[156:159], a[120:123], v[56:59]
  v_mfma_f32_16x16x32_bf16 v[76:79], v[156:159], a[124:127], v[76:79]
  ds_read_b64_tr_b16 a[178:179], v202 offset:21632
  v_mfma_f32_16x16x32_bf16 v[20:23], v[160:163], a[112:115], v[20:23]
  buffer_load_dwordx4 v[140:143], v211, s[8:11], s81 offen sc1
  v_mfma_f32_16x16x32_bf16 v[40:43], v[160:163], a[116:119], v[40:43]
  ds_read_b64_tr_b16 a[180:181], v203 offset:21120
  v_mfma_f32_16x16x32_bf16 v[60:63], v[160:163], a[120:123], v[60:63]
  v_mfma_f32_16x16x32_bf16 v[80:83], v[160:163], a[124:127], v[80:83]
  ds_read_b64_tr_b16 a[182:183], v203 offset:21632
  v_mfma_f32_16x16x32_bf16 v[24:27], v[164:167], a[112:115], v[24:27]
  buffer_load_dwordx4 v[144:147], v212, s[8:11], s81 offen sc1
  v_mfma_f32_16x16x32_bf16 v[44:47], v[164:167], a[116:119], v[44:47]
  v_mfma_f32_16x16x32_bf16 v[64:67], v[164:167], a[120:123], v[64:67]
  ds_read_b64_tr_b16 a[184:185], v204 offset:21120
  v_mfma_f32_16x16x32_bf16 v[84:87], v[164:167], a[124:127], v[84:87]
  v_mfma_f32_16x16x32_bf16 v[28:31], v[168:171], a[112:115], v[28:31]
  buffer_load_dwordx4 v[148:151], v213, s[8:11], s81 offen sc1
  ds_read_b64_tr_b16 a[186:187], v204 offset:21632
  v_mfma_f32_16x16x32_bf16 v[48:51], v[168:171], a[116:119], v[48:51]
  v_mfma_f32_16x16x32_bf16 v[68:71], v[168:171], a[120:123], v[68:71]
  ds_read_b64_tr_b16 a[188:189], v205 offset:21120
  v_mfma_f32_16x16x32_bf16 v[88:91], v[168:171], a[124:127], v[88:91]
  v_mfma_f32_16x16x32_bf16 v[32:35], v[172:175], a[112:115], v[32:35]
  buffer_load_dwordx4 v[152:155], v214, s[8:11], s81 offen sc1
  v_mfma_f32_16x16x32_bf16 v[52:55], v[172:175], a[116:119], v[52:55]
  ds_read_b64_tr_b16 a[190:191], v205 offset:21632
  v_mfma_f32_16x16x32_bf16 v[72:75], v[172:175], a[120:123], v[72:75]
  v_mfma_f32_16x16x32_bf16 v[92:95], v[172:175], a[124:127], v[92:95]
VC135:
  s_waitcnt vmcnt(12)
  v_max3_u32 v8, v96, v100, v104
  s_waitcnt vmcnt(10)
  v_max3_u32 v8, v8, v108, v112
  v_cmp_eq_u32 vcc, -1, v8
  s_cbranch_vccnz VR136
VK137:
  s_waitcnt lgkmcnt(15)
  v_mfma_f32_16x16x32_bf16 v[16:19], v[96:99], a[128:131], v[16:19]
  s_add_u32 s81, s61, 11264
  s_sub_u32 s68, s81, 12288
  s_cselect_b32 s81, s81, s68
  buffer_load_dwordx4 v[156:159], v210, s[8:11], s81 offen sc1
  v_mfma_f32_16x16x32_bf16 v[36:39], v[96:99], a[132:135], v[36:39]
  v_mfma_f32_16x16x32_bf16 v[56:59], v[96:99], a[136:139], v[56:59]
  v_mfma_f32_16x16x32_bf16 v[76:79], v[96:99], a[140:143], v[76:79]
  v_mfma_f32_16x16x32_bf16 v[20:23], v[100:103], a[128:131], v[20:23]
  buffer_load_dwordx4 v[160:163], v211, s[8:11], s81 offen sc1
  v_mfma_f32_16x16x32_bf16 v[40:43], v[100:103], a[132:135], v[40:43]
  s_waitcnt lgkmcnt(0)
  s_barrier
  v_mfma_f32_16x16x32_bf16 v[60:63], v[100:103], a[136:139], v[60:63]
  v_mfma_f32_16x16x32_bf16 v[80:83], v[100:103], a[140:143], v[80:83]
  v_mfma_f32_16x16x32_bf16 v[24:27], v[104:107], a[128:131], v[24:27]
  buffer_load_dwordx4 v[164:167], v212, s[8:11], s81 offen sc1
  v_mfma_f32_16x16x32_bf16 v[44:47], v[104:107], a[132:135], v[44:47]
  v_mfma_f32_16x16x32_bf16 v[64:67], v[104:107], a[136:139], v[64:67]
  v_mfma_f32_16x16x32_bf16 v[84:87], v[104:107], a[140:143], v[84:87]
  v_mfma_f32_16x16x32_bf16 v[28:31], v[108:111], a[128:131], v[28:31]
  buffer_load_dwordx4 v[168:171], v213, s[8:11], s81 offen sc1
  v_mfma_f32_16x16x32_bf16 v[48:51], v[108:111], a[132:135], v[48:51]
  v_mfma_f32_16x16x32_bf16 v[68:71], v[108:111], a[136:139], v[68:71]
  v_mfma_f32_16x16x32_bf16 v[88:91], v[108:111], a[140:143], v[88:91]
  v_mfma_f32_16x16x32_bf16 v[32:35], v[112:115], a[128:131], v[32:35]
  buffer_load_dwordx4 v[172:175], v214, s[8:11], s81 offen sc1
  v_mfma_f32_16x16x32_bf16 v[52:55], v[112:115], a[132:135], v[52:55]
  v_mfma_f32_16x16x32_bf16 v[72:75], v[112:115], a[136:139], v[72:75]
  v_mfma_f32_16x16x32_bf16 v[92:95], v[112:115], a[140:143], v[92:95]
VC138:
  s_waitcnt vmcnt(12)
  v_max3_u32 v8, v116, v120, v124
  s_waitcnt vmcnt(10)
  v_max3_u32 v8, v8, v128, v132
  v_cmp_eq_u32 vcc, -1, v8
  s_cbranch_vccnz VR139
VK140:
  v_mfma_f32_16x16x32_bf16 v[16:19], v[116:119], a[144:147], v[16:19]
  s_add_u32 m0, s87, 0
  s_add_u32 s69, s88, 0
  buffer_load_dwordx4 v13, s[8:11], s69 offen sc1 lds
  v_mfma_f32_16x16x32_bf16 v[36:39], v[116:119], a[148:151], v[36:39]
  v_mfma_f32_16x16x32_bf16 v[56:59], v[116:119], a[152:155], v[56:59]
  v_mfma_f32_16x16x32_bf16 v[76:79], v[116:119], a[156:159], v[76:79]
  v_mfma_f32_16x16x32_bf16 v[20:23], v[120:123], a[144:147], v[20:23]
  v_mfma_f32_16x16x32_bf16 v[40:43], v[120:123], a[148:151], v[40:43]
  s_add_u32 m0, s87, 4096
  s_add_u32 s69, s88, 4096
  buffer_load_dwordx4 v13, s[8:11], s69 offen sc1 lds
  v_mfma_f32_16x16x32_bf16 v[60:63], v[120:123], a[152:155], v[60:63]
  v_mfma_f32_16x16x32_bf16 v[80:83], v[120:123], a[156:159], v[80:83]
  v_mfma_f32_16x16x32_bf16 v[24:27], v[124:127], a[144:147], v[24:27]
  v_mfma_f32_16x16x32_bf16 v[44:47], v[124:127], a[148:151], v[44:47]
  v_mfma_f32_16x16x32_bf16 v[64:67], v[124:127], a[152:155], v[64:67]
  s_add_u32 m0, s87, 8192
  s_add_u32 s69, s88, 8192
  buffer_load_dwordx4 v13, s[8:11], s69 offen sc1 lds
  v_mfma_f32_16x16x32_bf16 v[84:87], v[124:127], a[156:159], v[84:87]
  v_mfma_f32_16x16x32_bf16 v[28:31], v[128:131], a[144:147], v[28:31]
  v_mfma_f32_16x16x32_bf16 v[48:51], v[128:131], a[148:151], v[48:51]
  v_mfma_f32_16x16x32_bf16 v[68:71], v[128:131], a[152:155], v[68:71]
  v_mfma_f32_16x16x32_bf16 v[88:91], v[128:131], a[156:159], v[88:91]
  s_add_u32 m0, s87, 12288
  s_add_u32 s69, s88, 12288
  buffer_load_dwordx4 v13, s[8:11], s69 offen sc1 lds
  v_mfma_f32_16x16x32_bf16 v[32:35], v[132:135], a[144:147], v[32:35]
  v_mfma_f32_16x16x32_bf16 v[52:55], v[132:135], a[148:151], v[52:55]
  v_mfma_f32_16x16x32_bf16 v[72:75], v[132:135], a[152:155], v[72:75]
  v_mfma_f32_16x16x32_bf16 v[92:95], v[132:135], a[156:159], v[92:95]
VC141:
  s_waitcnt vmcnt(11)
  v_max3_u32 v8, v136, v140, v144
  s_waitcnt vmcnt(9)
  v_max3_u32 v8, v8, v148, v152
  v_cmp_eq_u32 vcc, -1, v8
  s_cbranch_vccnz VR142
VK143:
  v_mfma_f32_16x16x32_bf16 v[16:19], v[136:139], a[160:163], v[16:19]
  s_add_u32 m0, s87, 16384
  s_add_u32 s69, s88, 16384
  buffer_load_dwordx4 v13, s[8:11], s69 offen sc1 lds
  v_mfma_f32_16x16x32_bf16 v[36:39], v[136:139], a[164:167], v[36:39]
  v_mfma_f32_16x16x32_bf16 v[56:59], v[136:139], a[168:171], v[56:59]
  v_mfma_f32_16x16x32_bf16 v[76:79], v[136:139], a[172:175], v[76:79]
  v_mfma_f32_16x16x32_bf16 v[20:23], v[140:143], a[160:163], v[20:23]
  v_mfma_f32_16x16x32_bf16 v[40:43], v[140:143], a[164:167], v[40:43]
  s_add_u32 m0, s87, 20480
  s_add_u32 s69, s88, 20480
  buffer_load_dwordx4 v13, s[8:11], s69 offen sc1 lds
  v_mfma_f32_16x16x32_bf16 v[60:63], v[140:143], a[168:171], v[60:63]
  v_mfma_f32_16x16x32_bf16 v[80:83], v[140:143], a[172:175], v[80:83]
  v_mfma_f32_16x16x32_bf16 v[24:27], v[144:147], a[160:163], v[24:27]
  v_mfma_f32_16x16x32_bf16 v[44:47], v[144:147], a[164:167], v[44:47]
  v_mfma_f32_16x16x32_bf16 v[64:67], v[144:147], a[168:171], v[64:67]
  v_mfma_f32_16x16x32_bf16 v[84:87], v[144:147], a[172:175], v[84:87]
  s_add_u32 m0, s87, 24576
  s_add_u32 s69, s88, 24576
  buffer_load_dwordx4 v13, s[8:11], s69 offen sc1 lds
  v_mfma_f32_16x16x32_bf16 v[28:31], v[148:151], a[160:163], v[28:31]
  v_mfma_f32_16x16x32_bf16 v[48:51], v[148:151], a[164:167], v[48:51]
  v_mfma_f32_16x16x32_bf16 v[68:71], v[148:151], a[168:171], v[68:71]
  v_mfma_f32_16x16x32_bf16 v[88:91], v[148:151], a[172:175], v[88:91]
  v_mfma_f32_16x16x32_bf16 v[32:35], v[152:155], a[160:163], v[32:35]
  s_add_u32 m0, s87, 28672
  s_add_u32 s69, s88, 28672
  buffer_load_dwordx4 v13, s[8:11], s69 offen sc1 lds
  v_mfma_f32_16x16x32_bf16 v[52:55], v[152:155], a[164:167], v[52:55]
  v_mfma_f32_16x16x32_bf16 v[72:75], v[152:155], a[168:171], v[72:75]
  v_mfma_f32_16x16x32_bf16 v[92:95], v[152:155], a[172:175], v[92:95]
VC144:
  s_waitcnt vmcnt(10)
  v_max3_u32 v8, v156, v160, v164
  s_waitcnt vmcnt(8)
  v_max3_u32 v8, v8, v168, v172
  v_cmp_eq_u32 vcc, -1, v8
  s_cbranch_vccnz VR145
VK146:
  v_mfma_f32_16x16x32_bf16 v[36:39], v[156:159], a[180:183], v[36:39]
  v_mfma_f32_16x16x32_bf16 v[56:59], v[156:159], a[184:187], v[56:59]
  s_add_u32 m0, s87, 32768
  s_add_u32 s69, s88, 32768
  buffer_load_dwordx4 v13, s[8:11], s69 offen sc1 lds
  v_mfma_f32_16x16x32_bf16 v[76:79], v[156:159], a[188:191], v[76:79]
  v_mfma_f32_16x16x32_bf16 v[16:19], v[156:159], a[176:179], v[16:19]
  v_mfma_f32_16x16x32_bf16 v[40:43], v[160:163], a[180:183], v[40:43]
  v_mfma_f32_16x16x32_bf16 v[60:63], v[160:163], a[184:187], v[60:63]
  ds_write_b128 v5, v[36:39] offset:0
  v_mfma_f32_16x16x32_bf16 v[80:83], v[160:163], a[188:191], v[80:83]
  s_add_u32 m0, s87, 36864
  s_add_u32 s69, s88, 36864
  buffer_load_dwordx4 v13, s[8:11], s69 offen sc1 lds
  ds_write_b128 v6, v[56:59] offset:5120
  v_mfma_f32_16x16x32_bf16 v[20:23], v[160:163], a[176:179], v[20:23]
  ds_write_b128 v7, v[76:79] offset:10240
  v_mfma_f32_16x16x32_bf16 v[44:47], v[164:167], a[180:183], v[44:47]
  v_mfma_f32_16x16x32_bf16 v[64:67], v[164:167], a[184:187], v[64:67]
  ds_write_b128 v5, v[40:43] offset:1024
  v_mfma_f32_16x16x32_bf16 v[84:87], v[164:167], a[188:191], v[84:87]
  ds_write_b128 v6, v[60:63] offset:6144
  v_mfma_f32_16x16x32_bf16 v[24:27], v[164:167], a[176:179], v[24:27]
  s_add_u32 m0, s87, 40960
  s_add_u32 s69, s88, 40960
  buffer_load_dwordx4 v13, s[8:11], s69 offen sc1 lds
  ds_write_b128 v7, v[80:83] offset:11264
  v_mfma_f32_16x16x32_bf16 v[48:51], v[168:171], a[180:183], v[48:51]
  v_mfma_f32_16x16x32_bf16 v[68:71], v[168:171], a[184:187], v[68:71]
  ds_write_b128 v5, v[44:47] offset:2048
  v_mfma_f32_16x16x32_bf16 v[88:91], v[168:171], a[188:191], v[88:91]
  ds_write_b128 v6, v[64:67] offset:7168
  v_mfma_f32_16x16x32_bf16 v[28:31], v[168:171], a[176:179], v[28:31]
  ds_write_b128 v7, v[84:87] offset:12288
  v_mfma_f32_16x16x32_bf16 v[52:55], v[172:175], a[180:183], v[52:55]
  v_mfma_f32_16x16x32_bf16 v[72:75], v[172:175], a[184:187], v[72:75]
  s_add_u32 m0, s87, 45056
  s_add_u32 s69, s88, 45056
  buffer_load_dwordx4 v13, s[8:11], s69 offen sc1 lds
  ds_write_b128 v5, v[48:51] offset:3072
  v_mfma_f32_16x16x32_bf16 v[92:95], v[172:175], a[188:191], v[92:95]
  ds_write_b128 v6, v[68:71] offset:8192
  v_mfma_f32_16x16x32_bf16 v[32:35], v[172:175], a[176:179], v[32:35]
  ds_write_b128 v7, v[88:91] offset:13312
  ds_write_b128 v5, v[52:55] offset:4096
  ds_write_b128 v6, v[72:75] offset:9216
  s_nop 2
  ds_write_b128 v7, v[92:95] offset:14336
  v_lshlrev_b32 v156, 16, v236
  v_and_b32 v157, 0xffff0000, v236
  v_lshlrev_b32 v158, 16, v237
  v_and_b32 v159, 0xffff0000, v237
  v_lshlrev_b32 v160, 16, v238
  v_and_b32 v161, 0xffff0000, v238
  v_lshlrev_b32 v162, 16, v239
  v_and_b32 v163, 0xffff0000, v239
  v_lshlrev_b32 v164, 16, v240
  v_and_b32 v165, 0xffff0000, v240
  v_lshlrev_b32 v166, 16, v241
  v_and_b32 v167, 0xffff0000, v241
  v_lshlrev_b32 v168, 16, v242
  v_and_b32 v169, 0xffff0000, v242
  v_lshlrev_b32 v170, 16, v243
  v_and_b32 v171, 0xffff0000, v243
  v_lshlrev_b32 v172, 16, v244
  v_and_b32 v173, 0xffff0000, v244
  v_lshlrev_b32 v174, 16, v245
  v_and_b32 v175, 0xffff0000, v245
  v_lshlrev_b32 v10, 16, v246
  v_pk_add_f32 v[16:17], v[16:17], v[10:11] op_sel_hi:[1,0]
  v_pk_add_f32 v[18:19], v[18:19], v[10:11] op_sel_hi:[1,0]
  v_pk_add_f32 v[20:21], v[20:21], v[10:11] op_sel_hi:[1,0]
  v_pk_add_f32 v[22:23], v[22:23], v[10:11] op_sel_hi:[1,0]
  v_pk_add_f32 v[24:25], v[24:25], v[10:11] op_sel_hi:[1,0]
  v_pk_add_f32 v[26:27], v[26:27], v[10:11] op_sel_hi:[1,0]
  v_pk_add_f32 v[28:29], v[28:29], v[10:11] op_sel_hi:[1,0]
  v_pk_add_f32 v[30:31], v[30:31], v[10:11] op_sel_hi:[1,0]
  v_pk_add_f32 v[32:33], v[32:33], v[10:11] op_sel_hi:[1,0]
  v_pk_add_f32 v[34:35], v[34:35], v[10:11] op_sel_hi:[1,0]
  v_pk_add_f32 v[16:17], v[16:17], v[156:157]
  v_pk_add_f32 v[18:19], v[18:19], v[158:159]
  v_pk_add_f32 v[20:21], v[20:21], v[160:161]
  v_pk_add_f32 v[22:23], v[22:23], v[162:163]
  v_pk_add_f32 v[24:25], v[24:25], v[164:165]
  v_pk_add_f32 v[26:27], v[26:27], v[166:167]
  v_pk_add_f32 v[28:29], v[28:29], v[168:169]
  v_pk_add_f32 v[30:31], v[30:31], v[170:171]
  v_pk_add_f32 v[32:33], v[32:33], v[172:173]
  v_pk_add_f32 v[34:35], v[34:35], v[174:175]
  s_waitcnt lgkmcnt(0)
  s_barrier
  ds_read_b128 v[96:99], v215 offset:0
  ds_read_b128 v[116:119], v215 offset:5120
  ds_read_b128 v[136:139], v215 offset:10240
  ds_read_b128 v[100:103], v215 offset:1024
  ds_read_b128 v[120:123], v215 offset:6144
  ds_read_b128 v[140:143], v215 offset:11264
  ds_read_b128 v[104:107], v215 offset:2048
  ds_read_b128 v[124:127], v215 offset:7168
  ds_read_b128 v[144:147], v215 offset:12288
  ds_read_b128 v[108:111], v215 offset:3072
  ds_read_b128 v[128:131], v215 offset:8192
  ds_read_b128 v[148:151], v215 offset:13312
  ds_read_b128 v[112:115], v215 offset:4096
  ds_read_b128 v[132:135], v215 offset:9216
  ds_read_b128 v[152:155], v215 offset:14336
  s_waitcnt lgkmcnt(14)
  v_pk_add_f32 v[16:17], v[16:17], v[96:97]
  v_pk_add_f32 v[18:19], v[18:19], v[98:99]
  s_waitcnt lgkmcnt(13)
  v_pk_add_f32 v[16:17], v[16:17], v[116:117]
  v_pk_add_f32 v[18:19], v[18:19], v[118:119]
  s_waitcnt lgkmcnt(12)
  v_pk_add_f32 v[16:17], v[16:17], v[136:137]
  v_pk_add_f32 v[18:19], v[18:19], v[138:139]
  v_cvt_pk_bf16_f32 v236, v16, v17
  v_cvt_pk_bf16_f32 v237, v18, v19
  s_waitcnt lgkmcnt(11)
  v_pk_add_f32 v[20:21], v[20:21], v[100:101]
  v_pk_add_f32 v[22:23], v[22:23], v[102:103]
  s_waitcnt lgkmcnt(10)
  v_pk_add_f32 v[20:21], v[20:21], v[120:121]
  v_pk_add_f32 v[22:23], v[22:23], v[122:123]
  s_waitcnt lgkmcnt(9)
  v_pk_add_f32 v[20:21], v[20:21], v[140:141]
  v_pk_add_f32 v[22:23], v[22:23], v[142:143]
  v_cvt_pk_bf16_f32 v238, v20, v21
  v_cvt_pk_bf16_f32 v239, v22, v23
  buffer_store_dwordx4 v[236:239], v2, s[8:11], s74 offen sc1
  s_waitcnt lgkmcnt(8)
  v_pk_add_f32 v[24:25], v[24:25], v[104:105]
  v_pk_add_f32 v[26:27], v[26:27], v[106:107]
  s_waitcnt lgkmcnt(7)
  v_pk_add_f32 v[24:25], v[24:25], v[124:125]
  v_pk_add_f32 v[26:27], v[26:27], v[126:127]
  s_waitcnt lgkmcnt(6)
  v_pk_add_f32 v[24:25], v[24:25], v[144:145]
  v_pk_add_f32 v[26:27], v[26:27], v[146:147]
  v_cvt_pk_bf16_f32 v240, v24, v25
  v_cvt_pk_bf16_f32 v241, v26, v27
  s_waitcnt lgkmcnt(5)
  v_pk_add_f32 v[28:29], v[28:29], v[108:109]
  v_pk_add_f32 v[30:31], v[30:31], v[110:111]
  s_waitcnt lgkmcnt(4)
  v_pk_add_f32 v[28:29], v[28:29], v[128:129]
  v_pk_add_f32 v[30:31], v[30:31], v[130:131]
  s_waitcnt lgkmcnt(3)
  v_pk_add_f32 v[28:29], v[28:29], v[148:149]
  v_pk_add_f32 v[30:31], v[30:31], v[150:151]
  v_cvt_pk_bf16_f32 v242, v28, v29
  v_cvt_pk_bf16_f32 v243, v30, v31
  buffer_store_dwordx4 v[240:243], v2, s[8:11], s74 offen offset:2048 sc1
  s_waitcnt lgkmcnt(2)
  v_pk_add_f32 v[32:33], v[32:33], v[112:113]
  v_pk_add_f32 v[34:35], v[34:35], v[114:115]
  s_waitcnt lgkmcnt(1)
  v_pk_add_f32 v[32:33], v[32:33], v[132:133]
  v_pk_add_f32 v[34:35], v[34:35], v[134:135]
  s_waitcnt lgkmcnt(0)
  v_pk_add_f32 v[32:33], v[32:33], v[152:153]
  v_pk_add_f32 v[34:35], v[34:35], v[154:155]
  v_cvt_pk_bf16_f32 v244, v32, v33
  v_cvt_pk_bf16_f32 v245, v34, v35
  buffer_store_dwordx2 v[244:245], v3, s[8:11], s75 offen sc1
  v_lshlrev_b32 v16, 16, v236
  v_and_b32 v17, 0xffff0000, v236
  v_lshlrev_b32 v18, 16, v237
  v_and_b32 v19, 0xffff0000, v237
  v_lshlrev_b32 v20, 16, v238
  v_and_b32 v21, 0xffff0000, v238
  v_lshlrev_b32 v22, 16, v239
  v_and_b32 v23, 0xffff0000, v239
  v_lshlrev_b32 v24, 16, v240
  v_and_b32 v25, 0xffff0000, v240
  v_lshlrev_b32 v26, 16, v241
  v_and_b32 v27, 0xffff0000, v241
  v_lshlrev_b32 v28, 16, v242
  v_and_b32 v29, 0xffff0000, v242
  v_lshlrev_b32 v30, 16, v243
  v_and_b32 v31, 0xffff0000, v243
  v_lshlrev_b32 v32, 16, v244
  v_and_b32 v33, 0xffff0000, v244
  v_lshlrev_b32 v34, 16, v245
  v_and_b32 v35, 0xffff0000, v245
  v_pk_add_f32 v[8:9], v[16:17], v[18:19]
  v_pk_mul_f32 v[10:11], v[16:17], v[16:17]
  v_pk_fma_f32 v[10:11], v[18:19], v[18:19], v[10:11]
  v_pk_add_f32 v[8:9], v[8:9], v[20:21]
  v_pk_fma_f32 v[10:11], v[20:21], v[20:21], v[10:11]
  v_pk_add_f32 v[8:9], v[8:9], v[22:23]
  v_pk_fma_f32 v[10:11], v[22:23], v[22:23], v[10:11]
  v_pk_add_f32 v[8:9], v[8:9], v[24:25]
  v_pk_fma_f32 v[10:11], v[24:25], v[24:25], v[10:11]
  v_pk_add_f32 v[8:9], v[8:9], v[26:27]
  v_pk_fma_f32 v[10:11], v[26:27], v[26:27], v[10:11]
  v_pk_add_f32 v[8:9], v[8:9], v[28:29]
  v_pk_fma_f32 v[10:11], v[28:29], v[28:29], v[10:11]
  v_pk_add_f32 v[8:9], v[8:9], v[30:31]
  v_pk_fma_f32 v[10:11], v[30:31], v[30:31], v[10:11]
  v_pk_add_f32 v[8:9], v[8:9], v[32:33]
  v_pk_fma_f32 v[10:11], v[32:33], v[32:33], v[10:11]
  v_pk_add_f32 v[8:9], v[8:9], v[34:35]
  v_pk_fma_f32 v[10:11], v[34:35], v[34:35], v[10:11]
  v_add_f32 v8, v8, v9
  v_add_f32 v9, v10, v11
  v_mov_b32 v10, v8
  v_mov_b32 v11, v9
  s_nop 0
  v_permlane16_swap_b32 v8, v10
  v_permlane16_swap_b32 v9, v11
  v_add_f32 v8, v8, v10
  v_add_f32 v9, v9, v11
  v_mov_b32 v10, v8
  v_mov_b32 v11, v9
  s_nop 0
  v_permlane32_swap_b32 v8, v10
  v_permlane32_swap_b32 v9, v11
  v_add_f32 v8, v8, v10
  v_add_f32 v9, v9, v11
  v_lshlrev_b32 v12, 3, v1
  v_cmp_gt_u32 vcc, 16, v1
  v_mov_b32 v14, 1073741824
  s_nop 0
  v_cndmask_b32 v14, v14, v12, vcc
  s_lshl_b32 s76, s59, 10
  s_add_u32 s76, s76, 20054016
  s_lshl_b32 s77, s55, 7
  s_add_u32 s77, s77, s76
  buffer_store_dwordx2 v[8:9], v14, s[8:11], s77 offen sc1
  v_accvgpr_write_b32 a184, v236
  v_accvgpr_write_b32 a185, v237
  v_accvgpr_write_b32 a186, v238
  v_accvgpr_write_b32 a187, v239
  v_accvgpr_write_b32 a188, v240
  v_accvgpr_write_b32 a189, v241
  v_accvgpr_write_b32 a190, v242
  v_accvgpr_write_b32 a191, v243
  v_accvgpr_write_b32 a192, v244
  v_accvgpr_write_b32 a193, v245
  s_barrier
  s_add_u32 m0, s87, 49152
  s_add_u32 s69, s88, 49152
  buffer_load_dwordx4 v13, s[8:11], s69 offen sc1 lds
  s_add_u32 m0, s87, 53248
  s_add_u32 s69, s88, 53248
  buffer_load_dwordx4 v13, s[8:11], s69 offen sc1 lds
  s_add_u32 m0, s87, 57344
  s_add_u32 s69, s88, 57344
  buffer_load_dwordx4 v13, s[8:11], s69 offen sc1 lds
  v_and_b32 v48, 31, v1
  v_lshlrev_b32 v48, 5, v48
  v_lshrrev_b32 v49, 5, v1
  v_mul_u32_u24 v49, 20480, v49
  s_lshl_b32 s66, s52, 10
  v_add3_u32 v48, v48, v49, s66
  v_accvgpr_write_b32 a194, v48
  s_add_u32 m0, s87, 61440
  s_add_u32 s69, s88, 61440
  buffer_load_dwordx4 v13, s[8:11], s69 offen sc1 lds
  s_add_u32 m0, s87, 65536
  s_add_u32 s69, s88, 65536
  buffer_load_dwordx4 v13, s[8:11], s69 offen sc1 lds
  s_add_u32 m0, s87, 69632
  s_add_u32 s69, s88, 69632
  buffer_load_dwordx4 v13, s[8:11], s69 offen sc1 lds
  s_add_u32 m0, s87, 73728
  s_add_u32 s69, s88, 73728
  buffer_load_dwordx4 v13, s[8:11], s69 offen sc1 lds
  v_lshrrev_b32 v48, 2, v1
  v_lshlrev_b32 v48, 5, v48
  v_and_b32 v49, 3, v1
  v_lshl_add_u32 v48, v49, 3, v48
  s_lshr_b32 s66, s52, 1
  s_mul_i32 s66, s66, 20480
  s_add_u32 s66, s66, 0
  v_add_u32 v48, s66, v48
  s_and_b32 s67, s52, 1
  s_lshl_b32 s67, s67, 12
  s_add_u32 s67, s67, 12288
  v_add_u32 v49, s67, v48
  v_accvgpr_write_b32 a195, v48
  v_accvgpr_write_b32 a196, v49
  s_add_u32 m0, s87, 77824
  s_add_u32 s69, s88, 77824
  buffer_load_dwordx4 v13, s[8:11], s69 offen sc1 lds
  s_add_u32 m0, s87, 81920
  s_add_u32 s69, s88, 81920
  buffer_load_dwordx4 v13, s[8:11], s69 offen sc1 lds
  s_add_u32 m0, s87, 86016
  s_add_u32 s69, s88, 86016
  buffer_load_dwordx4 v13, s[8:11], s69 offen sc1 lds
  s_add_u32 m0, s87, 90112
  s_add_u32 s69, s88, 90112
  buffer_load_dwordx4 v13, s[8:11], s69 offen sc1 lds
  v_and_b32 v48, 15, v1
  s_and_b32 s67, s52, 1
  s_lshl_b32 s67, s67, 4
  v_add_u32 v48, s67, v48
  v_cmp_gt_u32 vcc, 21, v48
  s_lshr_b32 s66, s52, 1
  s_mul_i32 s66, s66, 21
  v_add_u32 v48, s66, v48
  v_mul_u32_u24 v48, 80, v48
  v_mov_b32 v49, 1073741824
  v_cndmask_b32 v48, v49, v48, vcc
  v_lshrrev_b32 v50, 4, v1
  v_lshl_add_u32 v51, v50, 3, v48
  v_lshl_add_u32 v48, v50, 4, v48
  v_cmp_gt_u32 vcc, 2, v50
  s_nop 1
  v_cndmask_b32 v51, v49, v51, vcc
  s_lshl_b32 s66, s54, 4
  s_add_u32 s66, s66, s53
  s_lshl_b32 s66, s66, 12
  s_add_u32 s92, s66, 20185088
  s_lshl_b32 s93, s2, 4
  s_cmp_eq_u32 s52, 0
  s_cselect_b32 s93, s93, 1073741824
  s_add_u32 s83, s63, 3
  v_mov_b32 v52, s83
  v_cmp_eq_u32 vcc, 0, v1
  s_nop 1
  v_cndmask_b32 v53, v49, v1, vcc
  v_accvgpr_write_b32 a197, v48
  v_accvgpr_write_b32 a198, v51
  v_accvgpr_write_b32 a199, v52
  v_accvgpr_write_b32 a200, v53
  s_add_u32 m0, s87, 94208
  s_add_u32 s69, s88, 94208
  buffer_load_dwordx4 v13, s[8:11], s69 offen sc1 lds
  s_add_u32 m0, s87, 98304
  s_add_u32 s69, s88, 98304
  buffer_load_dwordx4 v13, s[8:11], s69 offen sc1 lds
  s_add_u32 m0, s87, 102400
  s_add_u32 s69, s88, 102400
  buffer_load_dwordx4 v13, s[8:11], s69 offen sc1 lds
  s_add_u32 m0, s87, 106496
  s_add_u32 s69, s88, 106496
  buffer_load_dwordx4 v13, s[8:11], s69 offen sc1 lds
  v_and_b32 v48, 15, v1
  s_lshr_b32 s66, s56, 1
  v_mov_b32 v49, s66
  v_and_b32 v50, 3, v49
  v_lshlrev_b32 v50, 3, v50
  v_and_b32 v51, 7, v48
  v_add_u32 v50, v50, v51
  v_lshlrev_b32 v50, 3, v50
  v_lshrrev_b32 v51, 2, v49
  v_lshl_add_u32 v50, v51, 1, v50
  v_lshrrev_b32 v51, 3, v48
  v_add_u32 v50, v50, v51
  v_lshlrev_b32 v50, 4, v50
  v_lshlrev_b32 v49, 4, v0
  v_cmp_gt_u32 vcc, 210, v0
  v_mov_b32 v51, 1073741824
  s_nop 0
  v_cndmask_b32 v51, v51, v49, vcc
  v_add_u32 v49, 102400, v49
  v_accvgpr_write_b32 a201, v49
  v_accvgpr_write_b32 a202, v50
  v_accvgpr_write_b32 a203, v51
  s_add_u32 m0, s87, 110592
  s_add_u32 s69, s88, 110592
  buffer_load_dwordx4 v13, s[8:11], s69 offen sc1 lds
  s_add_u32 m0, s87, 114688
  s_add_u32 s69, s88, 114688
  buffer_load_dwordx4 v13, s[8:11], s69 offen sc1 lds
  s_add_u32 m0, s87, 118784
  s_add_u32 s69, s88, 118784
  buffer_load_dwordx4 v13, s[8:11], s69 offen sc1 lds
  s_add_u32 m0, s87, 122880
  s_add_u32 s69, s88, 122880
  buffer_load_dwordx4 v13, s[8:11], s69 offen sc1 lds
  v_lshrrev_b32 v48, 3, v1
  v_mul_u32_u24 v48, 12288, v48
  v_and_b32 v49, 7, v1
  v_lshl_add_u32 v48, v49, 4, v48
  s_mul_i32 s66, s52, 1572864
  s_lshl_b32 s67, s57, 7
  s_add_u32 s66, s66, s67
  s_cmp_eq_u32 s58, 100
  s_cselect_b32 s66, 1073741824, s66
  v_add_u32 v50, s66, v48
  v_add_u32 v51, 2016, v50
  v_add_u32 v52, 4032, v50
  v_add_u32 v53, 6048, v50
  v_bfe_u32 v48, v1, 2, 2
  v_mul_u32_u24 v48, 1056, v48
  v_lshrrev_b32 v49, 4, v1
  v_lshl_add_u32 v48, v49, 7, v48
  v_and_b32 v49, 3, v1
  v_lshl_add_u32 v48, v49, 3, v48
  v_add_u32 v54, s85, v48
  v_add_u32 v55, s84, v48
  v_accvgpr_write_b32 a224, v50
  v_accvgpr_write_b32 a225, v51
  v_accvgpr_write_b32 a226, v52
  v_accvgpr_write_b32 a227, v53
  v_accvgpr_write_b32 a228, v54
  v_accvgpr_write_b32 a229, v55
  s_add_u32 m0, s87, 126976
  s_add_u32 s69, s88, 126976
  buffer_load_dwordx4 v13, s[8:11], s69 offen sc1 lds
  s_add_u32 m0, s87, 131072
  s_add_u32 s69, s88, 131072
  buffer_load_dwordx4 v13, s[8:11], s69 offen sc1 lds
  s_add_u32 m0, s87, 135168
  s_add_u32 s69, s88, 135168
  buffer_load_dwordx4 v13, s[8:11], s69 offen sc1 lds
  s_add_u32 m0, s87, 139264
  s_add_u32 s69, s88, 139264
  buffer_load_dwordx4 v13, s[8:11], s69 offen sc1 lds
  v_lshrrev_b32 v48, 5, v1
  v_bfe_u32 v49, v1, 4, 1
  v_mul_u32_u24 v49, 20480, v49
  v_and_b32 v50, 15, v1
  v_lshl_add_u32 v49, v50, 4, v49
  v_lshl_add_u32 v50, v48, 3, v49
  v_mul_u32_u24 v48, 768, v48
  v_add_u32 v49, v49, v48
  s_lshl_b32 s94, s53, 2
  s_add_u32 s94, s94, s52
  s_mul_i32 s94, s94, 40960
  s_mul_i32 s67, s54, 1280
  s_add_u32 s94, s94, s67
  s_add_u32 s94, s94, 21233664
  v_accvgpr_write_b32 a230, v49
  v_accvgpr_write_b32 a231, v50
  s_add_u32 m0, s87, 143360
  s_add_u32 s69, s88, 143360
  buffer_load_dwordx4 v13, s[8:11], s69 offen sc1 lds
  s_add_u32 m0, s87, 147456
  s_add_u32 s69, s88, 147456
  buffer_load_dwordx4 v13, s[8:11], s69 offen sc1 lds
  s_add_u32 m0, s87, 149504
  s_add_u32 s69, s88, 149504
  buffer_load_dwordx4 v13, s[8:11], s69 offen sc1 lds
  s_lshl_b32 s66, s53, 2
  s_add_u32 s66, s66, s52
  s_lshl_b32 s72, s66, 11
  s_add_u32 s72, s72, 20054016
  s_mul_i32 s73, s66, 40960
  s_add_u32 s73, s73, 17432576
  v_and_b32 v14, 15, v1
  v_lshlrev_b32 v14, 3, v14
  v_bfe_u32 v15, v1, 4, 1
  v_lshl_add_u32 v14, v15, 10, v14
  v_lshrrev_b32 v15, 5, v1
  v_lshl_add_u32 v14, v15, 9, v14
  s_mov_b32 s82, 131072
  v_bfe_u32 v16, v1, 4, 1
  v_and_b32 v17, 3, v1
  v_lshl_add_u32 v16, v16, 2, v17
  v_lshlrev_b32 v16, 2, v16
  v_lshrrev_b32 v17, 5, v1
  v_lshlrev_b32 v17, 3, v17
  v_bfe_u32 v18, v1, 2, 2
  v_add_u32 v17, v17, v18
  v_mov_b32 v18, 1935823168
  v_bfe_u32 v18, v18, v16, 4
  v_lshlrev_b32 v18, 3, v18
  v_mad_u32_u24 v18, v17, 64, v18
  v_add_u32 v2, 0, v18
  v_mov_b32 v18, 1985167888
  v_bfe_u32 v18, v18, v16, 4
  v_lshlrev_b32 v18, 3, v18
  v_mad_u32_u24 v18, v17, 64, v18
  v_add_u32 v3, 40960, v18
  v_mov_b32 v18, 1969500448
  v_bfe_u32 v18, v18, v16, 4
  v_lshlrev_b32 v18, 3, v18
  v_mad_u32_u24 v18, v17, 64, v18
  v_add_u32 v4, 81920, v18
  v_mov_b32 v18, 1414803744
  v_bfe_u32 v18, v18, v16, 4
  v_lshlrev_b32 v18, 3, v18
  v_mad_u32_u24 v18, v17, 48, v18
  v_add_u32 v5, 122880, v18
  v_accvgpr_write_b32 a240, -1
  v_accvgpr_write_b32 a241, -1
  v_accvgpr_write_b32 a242, -1
  v_accvgpr_write_b32 a243, -1
  v_lshrrev_b32 v7, 5, v1
  v_bfe_u32 v224, v1, 4, 1
  v_mul_u32_u24 v224, 20480, v224
  v_and_b32 v225, 15, v1
  v_lshl_add_u32 v224, v225, 4, v224
  v_lshl_add_u32 v225, v7, 3, v224
  v_mul_u32_u24 v7, 768, v7
  v_add_u32 v224, v224, v7
  s_lshl_b32 s74, s53, 2
  s_add_u32 s74, s74, s52
  s_mul_i32 s74, s74, 40960
  s_mul_i32 s67, s54, 1280
  s_add_u32 s74, s74, s67
  s_add_u32 s74, s74, 21233664
  s_add_u32 s77, s73, 0
  buffer_load_dwordx4 a[0:3], v13, s[8:11], s77 offen offset:0 sc1
  s_add_u32 s77, s73, 0
  buffer_load_dwordx4 a[4:7], v13, s[8:11], s77 offen offset:1024 sc1
  s_add_u32 s77, s73, 0
  buffer_load_dwordx4 a[8:11], v13, s[8:11], s77 offen offset:2048 sc1
  s_add_u32 s77, s73, 0
  buffer_load_dwordx4 a[12:15], v13, s[8:11], s77 offen offset:3072 sc1
  s_add_u32 s77, s73, 4096
  buffer_load_dwordx4 a[16:19], v13, s[8:11], s77 offen offset:0 sc1
  s_add_u32 s77, s73, 4096
  buffer_load_dwordx4 a[20:23], v13, s[8:11], s77 offen offset:1024 sc1
  s_add_u32 s77, s73, 4096
  buffer_load_dwordx4 a[24:27], v13, s[8:11], s77 offen offset:2048 sc1
  s_add_u32 s77, s73, 4096
  buffer_load_dwordx4 a[28:31], v13, s[8:11], s77 offen offset:3072 sc1
  s_add_u32 s77, s73, 8192
  buffer_load_dwordx4 a[32:35], v13, s[8:11], s77 offen offset:0 sc1
  s_add_u32 s77, s73, 8192
  buffer_load_dwordx4 a[36:39], v13, s[8:11], s77 offen offset:1024 sc1
  s_add_u32 s77, s73, 8192
  buffer_load_dwordx4 a[40:43], v13, s[8:11], s77 offen offset:2048 sc1
  s_add_u32 s77, s73, 8192
  buffer_load_dwordx4 a[44:47], v13, s[8:11], s77 offen offset:3072 sc1
  v_add_u32 v6, 153600, v13
  ds_read_b128 a[160:163], v6 offset:0
  ds_read_b128 a[164:167], v6 offset:1024
  ds_read_b128 a[168:171], v6 offset:2048
  ds_read_b128 a[172:175], v6 offset:3072
  ds_read_b128 a[176:179], v6 offset:4096
  ds_read_b128 a[180:183], v6 offset:5120
  s_waitcnt vmcnt(30)
  s_barrier
  v_lshrrev_b32 v6, 5, v1
  v_lshlrev_b32 v6, 6, v6
  v_add_u32 v6, 159744, v6
  ds_read_b128 v[144:147], v6 offset:0
  ds_read_b128 v[48:51], v6 offset:512
  ds_read_b128 v[148:151], v6 offset:16
  ds_read_b128 v[52:55], v6 offset:528
  ds_read_b128 v[152:155], v6 offset:32
  ds_read_b128 v[56:59], v6 offset:544
  ds_read_b128 v[156:159], v6 offset:48
  ds_read_b128 v[60:63], v6 offset:560
  ds_read_b128 v[160:163], v6 offset:128
  ds_read_b128 v[64:67], v6 offset:640
  ds_read_b128 v[164:167], v6 offset:144
  ds_read_b128 v[68:71], v6 offset:656
  ds_read_b128 v[168:171], v6 offset:160
  ds_read_b128 v[72:75], v6 offset:672
  ds_read_b128 v[172:175], v6 offset:176
  ds_read_b128 v[76:79], v6 offset:688
VC147:
  s_waitcnt vmcnt(11)
  v_accvgpr_read_b32 v7, a0
  s_waitcnt vmcnt(10)
  v_accvgpr_read_b32 v8, a4
  v_max_u32 v6, v7, v8
  v_cmp_eq_u32 vcc, -1, v6
  s_cbranch_vccnz VR148
VK149:
  ds_read_b64_tr_b16 v[80:81], v2 offset:0
  ds_read_b64_tr_b16 v[82:83], v2 offset:256
  ds_read_b64_tr_b16 v[84:85], v3 offset:0
  ds_read_b64_tr_b16 v[86:87], v3 offset:256
  ds_read_b64_tr_b16 v[88:89], v2 offset:1024
  ds_read_b64_tr_b16 v[90:91], v2 offset:1280
  ds_read_b64_tr_b16 v[92:93], v3 offset:1024
  ds_read_b64_tr_b16 v[94:95], v3 offset:1280
  ds_read_b64_tr_b16 v[96:97], v2 offset:2048
  ds_read_b64_tr_b16 v[98:99], v2 offset:2304
  ds_read_b64_tr_b16 v[100:101], v3 offset:2048
  ds_read_b64_tr_b16 v[102:103], v3 offset:2304
  ds_read_b64_tr_b16 v[104:105], v2 offset:3072
  ds_read_b64_tr_b16 v[106:107], v2 offset:3328
  s_waitcnt lgkmcnt(12)
  v_mfma_f32_32x32x16_bf16 v[16:31], v[80:83], a[0:3], 0
  s_add_u32 s77, s73, 12288
  buffer_load_dwordx4 a[48:51], v13, s[8:11], s77 offen offset:0 sc1
  ds_read_b64_tr_b16 v[108:109], v3 offset:3072
  ds_read_b64_tr_b16 v[110:111], v3 offset:3328
  s_waitcnt lgkmcnt(12)
  v_mfma_f32_32x32x16_bf16 v[32:47], v[84:87], a[0:3], 0
  ds_read_b64_tr_b16 v[112:113], v2 offset:4096
  ds_read_b64_tr_b16 v[114:115], v2 offset:4352
  s_waitcnt lgkmcnt(12)
  v_mfma_f32_32x32x16_bf16 v[16:31], v[88:91], a[4:7], v[16:31]
  s_add_u32 s77, s73, 12288
  buffer_load_dwordx4 a[52:55], v13, s[8:11], s77 offen offset:1024 sc1
  ds_read_b64_tr_b16 v[116:117], v3 offset:4096
  ds_read_b64_tr_b16 v[118:119], v3 offset:4352
  s_waitcnt lgkmcnt(12)
  v_mfma_f32_32x32x16_bf16 v[32:47], v[92:95], a[4:7], v[32:47]
  v_add_f32 v144, v144, v48
  v_add_f32 v145, v145, v49
VC150:
  s_waitcnt vmcnt(11)
  v_accvgpr_read_b32 v7, a8
  s_waitcnt vmcnt(10)
  v_accvgpr_read_b32 v8, a12
  v_max_u32 v6, v7, v8
  v_cmp_eq_u32 vcc, -1, v6
  s_cbranch_vccnz VR151
VK152:
  ds_read_b64_tr_b16 v[120:121], v2 offset:5120
  ds_read_b64_tr_b16 v[122:123], v2 offset:5376
  s_waitcnt lgkmcnt(12)
  v_mfma_f32_32x32x16_bf16 v[16:31], v[96:99], a[8:11], v[16:31]
  s_add_u32 s77, s73, 12288
  buffer_load_dwordx4 a[56:59], v13, s[8:11], s77 offen offset:2048 sc1
  v_add_f32 v146, v146, v50
  v_add_f32 v147, v147, v51
  ds_read_b64_tr_b16 v[124:125], v3 offset:5120
  ds_read_b64_tr_b16 v[126:127], v3 offset:5376
  s_waitcnt lgkmcnt(12)
  v_mfma_f32_32x32x16_bf16 v[32:47], v[100:103], a[8:11], v[32:47]
  v_add_f32 v148, v148, v52
  v_add_f32 v149, v149, v53
  ds_read_b64_tr_b16 v[128:129], v2 offset:6144
  ds_read_b64_tr_b16 v[130:131], v2 offset:6400
  s_waitcnt lgkmcnt(12)
  v_mfma_f32_32x32x16_bf16 v[16:31], v[104:107], a[12:15], v[16:31]
  s_add_u32 s77, s73, 12288
  buffer_load_dwordx4 a[60:63], v13, s[8:11], s77 offen offset:3072 sc1
  v_add_f32 v150, v150, v54
  v_add_f32 v151, v151, v55
  ds_read_b64_tr_b16 v[132:133], v3 offset:6144
  ds_read_b64_tr_b16 v[134:135], v3 offset:6400
  s_waitcnt lgkmcnt(12)
  v_mfma_f32_32x32x16_bf16 v[32:47], v[108:111], a[12:15], v[32:47]
  v_add_f32 v152, v152, v56
  v_add_f32 v153, v153, v57
VC153:
  s_waitcnt vmcnt(11)
  v_accvgpr_read_b32 v7, a16
  s_waitcnt vmcnt(10)
  v_accvgpr_read_b32 v8, a20
  v_accvgpr_read_b32 v9, a18
  v_max3_u32 v6, v7, v8, v9
  v_cmp_eq_u32 vcc, -1, v6
  s_cbranch_vccnz VR154
VK155:
  ds_read_b64_tr_b16 v[136:137], v2 offset:7168
  ds_read_b64_tr_b16 v[138:139], v2 offset:7424
  s_waitcnt lgkmcnt(12)
  v_mfma_f32_32x32x16_bf16 v[16:31], v[112:115], a[16:19], v[16:31]
  s_add_u32 s77, s73, 16384
  buffer_load_dwordx4 a[64:67], v13, s[8:11], s77 offen offset:0 sc1
  v_add_f32 v154, v154, v58
  v_add_f32 v155, v155, v59
  ds_read_b64_tr_b16 v[140:141], v3 offset:7168
  ds_read_b64_tr_b16 v[142:143], v3 offset:7424
  s_waitcnt lgkmcnt(12)
  v_mfma_f32_32x32x16_bf16 v[32:47], v[116:119], a[16:19], v[32:47]
  v_add_f32 v156, v156, v60
  v_add_f32 v157, v157, v61
  ds_read_b64_tr_b16 v[80:81], v2 offset:8192
  ds_read_b64_tr_b16 v[82:83], v2 offset:8448
  s_waitcnt lgkmcnt(12)
  v_mfma_f32_32x32x16_bf16 v[16:31], v[120:123], a[20:23], v[16:31]
  s_add_u32 s77, s73, 16384
  buffer_load_dwordx4 a[68:71], v13, s[8:11], s77 offen offset:1024 sc1
  v_add_f32 v158, v158, v62
  v_add_f32 v159, v159, v63
  ds_read_b64_tr_b16 v[84:85], v3 offset:8192
  ds_read_b64_tr_b16 v[86:87], v3 offset:8448
  s_waitcnt lgkmcnt(12)
  v_mfma_f32_32x32x16_bf16 v[32:47], v[124:127], a[20:23], v[32:47]
  v_add_f32 v160, v160, v64
  v_add_f32 v161, v161, v65
VC156:
  s_waitcnt vmcnt(11)
  v_accvgpr_read_b32 v7, a24
  s_waitcnt vmcnt(10)
  v_accvgpr_read_b32 v8, a28
  v_max_u32 v6, v7, v8
  v_cmp_eq_u32 vcc, -1, v6
  s_cbranch_vccnz VR157
VK158:
  ds_read_b64_tr_b16 v[88:89], v2 offset:9216
  ds_read_b64_tr_b16 v[90:91], v2 offset:9472
  s_waitcnt lgkmcnt(12)
  v_mfma_f32_32x32x16_bf16 v[16:31], v[128:131], a[24:27], v[16:31]
  s_add_u32 s77, s73, 16384
  buffer_load_dwordx4 a[72:75], v13, s[8:11], s77 offen offset:2048 sc1
  v_add_f32 v162, v162, v66
  v_add_f32 v163, v163, v67
  ds_read_b64_tr_b16 v[92:93], v3 offset:9216
  ds_read_b64_tr_b16 v[94:95], v3 offset:9472
  s_waitcnt lgkmcnt(12)
  v_mfma_f32_32x32x16_bf16 v[32:47], v[132:135], a[24:27], v[32:47]
  v_add_f32 v164, v164, v68
  v_add_f32 v165, v165, v69
  ds_read_b64_tr_b16 v[96:97], v2 offset:10240
  ds_read_b64_tr_b16 v[98:99], v2 offset:10496
  s_waitcnt lgkmcnt(12)
  v_mfma_f32_32x32x16_bf16 v[16:31], v[136:139], a[28:31], v[16:31]
  s_add_u32 s77, s73, 16384
  buffer_load_dwordx4 a[76:79], v13, s[8:11], s77 offen offset:3072 sc1
  v_add_f32 v166, v166, v70
  v_add_f32 v167, v167, v71
  ds_read_b64_tr_b16 v[100:101], v3 offset:10240
  ds_read_b64_tr_b16 v[102:103], v3 offset:10496
  s_waitcnt lgkmcnt(12)
  v_mfma_f32_32x32x16_bf16 v[32:47], v[140:143], a[28:31], v[32:47]
  v_add_f32 v168, v168, v72
  v_add_f32 v169, v169, v73
VC159:
  s_waitcnt vmcnt(11)
  v_accvgpr_read_b32 v7, a32
  s_waitcnt vmcnt(10)
  v_accvgpr_read_b32 v8, a36
  v_accvgpr_read_b32 v9, a38
  v_max3_u32 v6, v7, v8, v9
  v_cmp_eq_u32 vcc, -1, v6
  s_cbranch_vccnz VR160
VK161:
  ds_read_b64_tr_b16 v[104:105], v2 offset:11264
  ds_read_b64_tr_b16 v[106:107], v2 offset:11520
  s_waitcnt lgkmcnt(12)
  v_mfma_f32_32x32x16_bf16 v[16:31], v[80:83], a[32:35], v[16:31]
  s_add_u32 s77, s73, 20480
  buffer_load_dwordx4 a[80:83], v13, s[8:11], s77 offen offset:0 sc1
  v_add_f32 v170, v170, v74
  v_add_f32 v171, v171, v75
  ds_read_b64_tr_b16 v[108:109], v3 offset:11264
  ds_read_b64_tr_b16 v[110:111], v3 offset:11520
  s_waitcnt lgkmcnt(12)
  v_mfma_f32_32x32x16_bf16 v[32:47], v[84:87], a[32:35], v[32:47]
  v_add_f32 v172, v172, v76
  v_add_f32 v173, v173, v77
  ds_read_b64_tr_b16 v[112:113], v2 offset:12288
  ds_read_b64_tr_b16 v[114:115], v2 offset:12544
  s_waitcnt lgkmcnt(12)
  v_mfma_f32_32x32x16_bf16 v[16:31], v[88:91], a[36:39], v[16:31]
  s_add_u32 s77, s73, 20480
  buffer_load_dwordx4 a[84:87], v13, s[8:11], s77 offen offset:1024 sc1
  v_add_f32 v174, v174, v78
  v_add_f32 v175, v175, v79
  ds_read_b64_tr_b16 v[116:117], v3 offset:12288
  ds_read_b64_tr_b16 v[118:119], v3 offset:12544
  s_waitcnt lgkmcnt(12)
  v_mfma_f32_32x32x16_bf16 v[32:47], v[92:95], a[36:39], v[32:47]
VC162:
  s_waitcnt vmcnt(11)
  v_accvgpr_read_b32 v7, a40
  s_waitcnt vmcnt(10)
  v_accvgpr_read_b32 v8, a44
  v_max_u32 v6, v7, v8
  v_cmp_eq_u32 vcc, -1, v6
  s_cbranch_vccnz VR163
VK164:
  ds_read_b64_tr_b16 v[120:121], v2 offset:13312
  ds_read_b64_tr_b16 v[122:123], v2 offset:13568
  s_waitcnt lgkmcnt(12)
  v_mfma_f32_32x32x16_bf16 v[16:31], v[96:99], a[40:43], v[16:31]
  s_add_u32 s77, s73, 20480
  buffer_load_dwordx4 a[88:91], v13, s[8:11], s77 offen offset:2048 sc1
  ds_read_b64_tr_b16 v[124:125], v3 offset:13312
  ds_read_b64_tr_b16 v[126:127], v3 offset:13568
  s_waitcnt lgkmcnt(12)
  v_mfma_f32_32x32x16_bf16 v[32:47], v[100:103], a[40:43], v[32:47]
  ds_read_b64_tr_b16 v[128:129], v2 offset:14336
  ds_read_b64_tr_b16 v[130:131], v2 offset:14592
  s_waitcnt lgkmcnt(12)
  v_mfma_f32_32x32x16_bf16 v[16:31], v[104:107], a[44:47], v[16:31]
  s_add_u32 s77, s73, 20480
  buffer_load_dwordx4 a[92:95], v13, s[8:11], s77 offen offset:3072 sc1
  ds_read_b64_tr_b16 v[132:133], v3 offset:14336
  ds_read_b64_tr_b16 v[134:135], v3 offset:14592
  s_waitcnt lgkmcnt(12)
  v_mfma_f32_32x32x16_bf16 v[32:47], v[108:111], a[44:47], v[32:47]
VC165:
  s_waitcnt vmcnt(11)
  v_accvgpr_read_b32 v7, a48
  s_waitcnt vmcnt(10)
  v_accvgpr_read_b32 v8, a52
  v_max_u32 v6, v7, v8
  v_cmp_eq_u32 vcc, -1, v6
  s_cbranch_vccnz VR166
VK167:
  ds_read_b64_tr_b16 v[136:137], v2 offset:15360
  ds_read_b64_tr_b16 v[138:139], v2 offset:15616
  s_waitcnt lgkmcnt(12)
  v_mfma_f32_32x32x16_bf16 v[16:31], v[112:115], a[48:51], v[16:31]
  s_add_u32 s77, s73, 24576
  buffer_load_dwordx4 a[96:99], v13, s[8:11], s77 offen offset:0 sc1
  ds_read_b64_tr_b16 v[140:141], v3 offset:15360
  ds_read_b64_tr_b16 v[142:143], v3 offset:15616
  s_waitcnt lgkmcnt(12)
  v_mfma_f32_32x32x16_bf16 v[32:47], v[116:119], a[48:51], v[32:47]
  ds_read_b64_tr_b16 v[80:81], v2 offset:16384
  ds_read_b64_tr_b16 v[82:83], v2 offset:16640
  s_waitcnt lgkmcnt(12)
  v_mfma_f32_32x32x16_bf16 v[16:31], v[120:123], a[52:55], v[16:31]
  s_add_u32 s77, s73, 24576
  buffer_load_dwordx4 a[100:103], v13, s[8:11], s77 offen offset:1024 sc1
  ds_read_b64_tr_b16 v[84:85], v3 offset:16384
  ds_read_b64_tr_b16 v[86:87], v3 offset:16640
  s_waitcnt lgkmcnt(12)
  v_mfma_f32_32x32x16_bf16 v[32:47], v[124:127], a[52:55], v[32:47]
VC168:
  s_waitcnt vmcnt(11)
  v_accvgpr_read_b32 v7, a56
  s_waitcnt vmcnt(10)
  v_accvgpr_read_b32 v8, a60
  v_accvgpr_read_b32 v9, a58
  v_max3_u32 v6, v7, v8, v9
  v_cmp_eq_u32 vcc, -1, v6
  s_cbranch_vccnz VR169
VK170:
  ds_read_b64_tr_b16 v[88:89], v2 offset:17408
  ds_read_b64_tr_b16 v[90:91], v2 offset:17664
  s_waitcnt lgkmcnt(12)
  v_mfma_f32_32x32x16_bf16 v[16:31], v[128:131], a[56:59], v[16:31]
  s_add_u32 s77, s73, 24576
  buffer_load_dwordx4 a[104:107], v13, s[8:11], s77 offen offset:2048 sc1
  ds_read_b64_tr_b16 v[92:93], v3 offset:17408
  ds_read_b64_tr_b16 v[94:95], v3 offset:17664
  s_waitcnt lgkmcnt(12)
  v_mfma_f32_32x32x16_bf16 v[32:47], v[132:135], a[56:59], v[32:47]
  ds_read_b64_tr_b16 v[96:97], v2 offset:18432
  ds_read_b64_tr_b16 v[98:99], v2 offset:18688
  s_waitcnt lgkmcnt(12)
  v_mfma_f32_32x32x16_bf16 v[16:31], v[136:139], a[60:63], v[16:31]
  s_add_u32 s77, s73, 24576
  buffer_load_dwordx4 a[108:111], v13, s[8:11], s77 offen offset:3072 sc1
  ds_read_b64_tr_b16 v[100:101], v3 offset:18432
  ds_read_b64_tr_b16 v[102:103], v3 offset:18688
  s_waitcnt lgkmcnt(12)
  v_mfma_f32_32x32x16_bf16 v[32:47], v[140:143], a[60:63], v[32:47]
VC171:
  s_waitcnt vmcnt(11)
  v_accvgpr_read_b32 v7, a64
  s_waitcnt vmcnt(10)
  v_accvgpr_read_b32 v8, a68
  v_max_u32 v6, v7, v8
  v_cmp_eq_u32 vcc, -1, v6
  s_cbranch_vccnz VR172
VK173:
  ds_read_b64_tr_b16 v[104:105], v2 offset:19456
  ds_read_b64_tr_b16 v[106:107], v2 offset:19712
  s_waitcnt lgkmcnt(12)
  v_mfma_f32_32x32x16_bf16 v[16:31], v[80:83], a[64:67], v[16:31]
  s_add_u32 s77, s73, 28672
  buffer_load_dwordx4 a[112:115], v13, s[8:11], s77 offen offset:0 sc1
  ds_read_b64_tr_b16 v[108:109], v3 offset:19456
  ds_read_b64_tr_b16 v[110:111], v3 offset:19712
  s_waitcnt lgkmcnt(12)
  v_mfma_f32_32x32x16_bf16 v[32:47], v[84:87], a[64:67], v[32:47]
  ds_read_b64_tr_b16 v[112:113], v2 offset:20480
  ds_read_b64_tr_b16 v[114:115], v2 offset:20736
  s_waitcnt lgkmcnt(12)
  v_mfma_f32_32x32x16_bf16 v[16:31], v[88:91], a[68:71], v[16:31]
  s_add_u32 s77, s73, 28672
  buffer_load_dwordx4 a[116:119], v13, s[8:11], s77 offen offset:1024 sc1
  ds_read_b64_tr_b16 v[116:117], v3 offset:20480
  ds_read_b64_tr_b16 v[118:119], v3 offset:20736
  s_waitcnt lgkmcnt(12)
  v_mfma_f32_32x32x16_bf16 v[32:47], v[92:95], a[68:71], v[32:47]
VC174:
  s_waitcnt vmcnt(11)
  v_accvgpr_read_b32 v7, a72
  s_waitcnt vmcnt(10)
  v_accvgpr_read_b32 v8, a76
  v_accvgpr_read_b32 v9, a78
  v_max3_u32 v6, v7, v8, v9
  v_cmp_eq_u32 vcc, -1, v6
  s_cbranch_vccnz VR175
VK176:
  ds_read_b64_tr_b16 v[120:121], v2 offset:21504
  ds_read_b64_tr_b16 v[122:123], v2 offset:21760
  s_waitcnt lgkmcnt(12)
  v_mfma_f32_32x32x16_bf16 v[16:31], v[96:99], a[72:75], v[16:31]
  s_add_u32 s77, s73, 28672
  buffer_load_dwordx4 a[120:123], v13, s[8:11], s77 offen offset:2048 sc1
  ds_read_b64_tr_b16 v[124:125], v3 offset:21504
  ds_read_b64_tr_b16 v[126:127], v3 offset:21760
  s_waitcnt lgkmcnt(12)
  v_mfma_f32_32x32x16_bf16 v[32:47], v[100:103], a[72:75], v[32:47]
  ds_read_b64_tr_b16 v[128:129], v2 offset:22528
  ds_read_b64_tr_b16 v[130:131], v2 offset:22784
  s_waitcnt lgkmcnt(12)
  v_mfma_f32_32x32x16_bf16 v[16:31], v[104:107], a[76:79], v[16:31]
  s_add_u32 s77, s73, 28672
  buffer_load_dwordx4 a[124:127], v13, s[8:11], s77 offen offset:3072 sc1
  ds_read_b64_tr_b16 v[132:133], v3 offset:22528
  ds_read_b64_tr_b16 v[134:135], v3 offset:22784
  s_waitcnt lgkmcnt(12)
  v_mfma_f32_32x32x16_bf16 v[32:47], v[108:111], a[76:79], v[32:47]
VC177:
  s_waitcnt vmcnt(11)
  v_accvgpr_read_b32 v7, a80
  s_waitcnt vmcnt(10)
  v_accvgpr_read_b32 v8, a84
  v_max_u32 v6, v7, v8
  v_cmp_eq_u32 vcc, -1, v6
  s_cbranch_vccnz VR178
VK179:
  ds_read_b64_tr_b16 v[136:137], v2 offset:23552
  ds_read_b64_tr_b16 v[138:139], v2 offset:23808
  s_waitcnt lgkmcnt(12)
  v_mfma_f32_32x32x16_bf16 v[16:31], v[112:115], a[80:83], v[16:31]
  s_add_u32 s77, s73, 32768
  buffer_load_dwordx4 a[128:131], v13, s[8:11], s77 offen offset:0 sc1
  ds_read_b64_tr_b16 v[140:141], v3 offset:23552
  ds_read_b64_tr_b16 v[142:143], v3 offset:23808
  s_waitcnt lgkmcnt(12)
  v_mfma_f32_32x32x16_bf16 v[32:47], v[116:119], a[80:83], v[32:47]
  ds_read_b64_tr_b16 v[80:81], v2 offset:24576
  ds_read_b64_tr_b16 v[82:83], v2 offset:24832
  s_waitcnt lgkmcnt(12)
  v_mfma_f32_32x32x16_bf16 v[16:31], v[120:123], a[84:87], v[16:31]
  s_add_u32 s77, s73, 32768
  buffer_load_dwordx4 a[132:135], v13, s[8:11], s77 offen offset:1024 sc1
  ds_read_b64_tr_b16 v[84:85], v3 offset:24576
  ds_read_b64_tr_b16 v[86:87], v3 offset:24832
  s_waitcnt lgkmcnt(12)
  v_mfma_f32_32x32x16_bf16 v[32:47], v[124:127], a[84:87], v[32:47]
VC180:
  s_waitcnt vmcnt(11)
  v_accvgpr_read_b32 v7, a88
  s_waitcnt vmcnt(10)
  v_accvgpr_read_b32 v8, a92
  v_max_u32 v6, v7, v8
  v_cmp_eq_u32 vcc, -1, v6
  s_cbranch_vccnz VR181
VK182:
  ds_read_b64_tr_b16 v[88:89], v2 offset:25600
  ds_read_b64_tr_b16 v[90:91], v2 offset:25856
  s_waitcnt lgkmcnt(12)
  v_mfma_f32_32x32x16_bf16 v[16:31], v[128:131], a[88:91], v[16:31]
  s_add_u32 s77, s73, 32768
  buffer_load_dwordx4 a[136:139], v13, s[8:11], s77 offen offset:2048 sc1
  ds_read_b64_tr_b16 v[92:93], v3 offset:25600
  ds_read_b64_tr_b16 v[94:95], v3 offset:25856
  s_waitcnt lgkmcnt(12)
  v_mfma_f32_32x32x16_bf16 v[32:47], v[132:135], a[88:91], v[32:47]
  ds_read_b64_tr_b16 v[96:97], v2 offset:26624
  ds_read_b64_tr_b16 v[98:99], v2 offset:26880
  s_waitcnt lgkmcnt(12)
  v_mfma_f32_32x32x16_bf16 v[16:31], v[136:139], a[92:95], v[16:31]
  s_add_u32 s77, s73, 32768
  buffer_load_dwordx4 a[140:143], v13, s[8:11], s77 offen offset:3072 sc1
  ds_read_b64_tr_b16 v[100:101], v3 offset:26624
  ds_read_b64_tr_b16 v[102:103], v3 offset:26880
  s_waitcnt lgkmcnt(12)
  v_mfma_f32_32x32x16_bf16 v[32:47], v[140:143], a[92:95], v[32:47]
VC183:
  s_waitcnt vmcnt(11)
  v_accvgpr_read_b32 v7, a96
  s_waitcnt vmcnt(10)
  v_accvgpr_read_b32 v8, a100
  v_accvgpr_read_b32 v9, a98
  v_max3_u32 v6, v7, v8, v9
  v_cmp_eq_u32 vcc, -1, v6
  s_cbranch_vccnz VR184
VK185:
  ds_read_b64_tr_b16 v[104:105], v2 offset:27648
  ds_read_b64_tr_b16 v[106:107], v2 offset:27904
  s_waitcnt lgkmcnt(12)
  v_mfma_f32_32x32x16_bf16 v[16:31], v[80:83], a[96:99], v[16:31]
  s_add_u32 s77, s73, 36864
  buffer_load_dwordx4 a[144:147], v13, s[8:11], s77 offen offset:0 sc1
  ds_read_b64_tr_b16 v[108:109], v3 offset:27648
  ds_read_b64_tr_b16 v[110:111], v3 offset:27904
  s_waitcnt lgkmcnt(12)
  v_mfma_f32_32x32x16_bf16 v[32:47], v[84:87], a[96:99], v[32:47]
  ds_read_b64_tr_b16 v[112:113], v2 offset:28672
  ds_read_b64_tr_b16 v[114:115], v2 offset:28928
  s_waitcnt lgkmcnt(12)
  v_mfma_f32_32x32x16_bf16 v[16:31], v[88:91], a[100:103], v[16:31]
  s_add_u32 s77, s73, 36864
  buffer_load_dwordx4 a[148:151], v13, s[8:11], s77 offen offset:1024 sc1
  ds_read_b64_tr_b16 v[116:117], v3 offset:28672
  ds_read_b64_tr_b16 v[118:119], v3 offset:28928
  s_waitcnt lgkmcnt(12)
  v_mfma_f32_32x32x16_bf16 v[32:47], v[92:95], a[100:103], v[32:47]
VC186:
  s_waitcnt vmcnt(11)
  v_accvgpr_read_b32 v7, a104
  s_waitcnt vmcnt(10)
  v_accvgpr_read_b32 v8, a108
  v_max_u32 v6, v7, v8
  v_cmp_eq_u32 vcc, -1, v6
  s_cbranch_vccnz VR187
VK188:
  ds_read_b64_tr_b16 v[120:121], v2 offset:29696
  ds_read_b64_tr_b16 v[122:123], v2 offset:29952
  s_waitcnt lgkmcnt(12)
  v_mfma_f32_32x32x16_bf16 v[16:31], v[96:99], a[104:107], v[16:31]
  s_add_u32 s77, s73, 36864
  buffer_load_dwordx4 a[152:155], v13, s[8:11], s77 offen offset:2048 sc1
  ds_read_b64_tr_b16 v[124:125], v3 offset:29696
  ds_read_b64_tr_b16 v[126:127], v3 offset:29952
  s_waitcnt lgkmcnt(12)
  v_mfma_f32_32x32x16_bf16 v[32:47], v[100:103], a[104:107], v[32:47]
  ds_read_b64_tr_b16 v[128:129], v2 offset:30720
  ds_read_b64_tr_b16 v[130:131], v2 offset:30976
  s_waitcnt lgkmcnt(12)
  v_mfma_f32_32x32x16_bf16 v[16:31], v[104:107], a[108:111], v[16:31]
  s_add_u32 s77, s73, 36864
  buffer_load_dwordx4 a[156:159], v13, s[8:11], s77 offen offset:3072 sc1
  ds_read_b64_tr_b16 v[132:133], v3 offset:30720
  ds_read_b64_tr_b16 v[134:135], v3 offset:30976
  s_waitcnt lgkmcnt(12)
  v_mfma_f32_32x32x16_bf16 v[32:47], v[108:111], a[108:111], v[32:47]
  buffer_load_dwordx2 v[188:189], v14, s[8:11], s72 offen offset:0 sc1
  buffer_load_dwordx2 v[190:191], v14, s[8:11], s72 offen offset:128 sc1
  buffer_load_dwordx2 v[192:193], v14, s[8:11], s72 offen offset:256 sc1
  buffer_load_dwordx2 v[194:195], v14, s[8:11], s72 offen offset:384 sc1
VC189:
  s_waitcnt vmcnt(15)
  v_accvgpr_read_b32 v7, a112
  s_waitcnt vmcnt(14)
  v_accvgpr_read_b32 v8, a116
  v_accvgpr_read_b32 v9, a118
  v_max3_u32 v6, v7, v8, v9
  v_cmp_eq_u32 vcc, -1, v6
  s_cbranch_vccnz VR190
VK191:
  ds_read_b64_tr_b16 v[136:137], v2 offset:31744
  ds_read_b64_tr_b16 v[138:139], v2 offset:32000
  s_waitcnt lgkmcnt(12)
  v_mfma_f32_32x32x16_bf16 v[16:31], v[112:115], a[112:115], v[16:31]
  ds_read_b64_tr_b16 v[140:141], v3 offset:31744
  ds_read_b64_tr_b16 v[142:143], v3 offset:32000
  s_waitcnt lgkmcnt(12)
  v_mfma_f32_32x32x16_bf16 v[32:47], v[116:119], a[112:115], v[32:47]
  buffer_store_dwordx4 a[240:243], v224, s[8:11], s74 offen sc1
  ds_read_b64_tr_b16 v[80:81], v2 offset:32768
  ds_read_b64_tr_b16 v[82:83], v2 offset:33024
  s_waitcnt lgkmcnt(12)
  v_mfma_f32_32x32x16_bf16 v[16:31], v[120:123], a[116:119], v[16:31]
  ds_read_b64_tr_b16 v[84:85], v3 offset:32768
  ds_read_b64_tr_b16 v[86:87], v3 offset:33024
  s_waitcnt lgkmcnt(12)
  v_mfma_f32_32x32x16_bf16 v[32:47], v[124:127], a[116:119], v[32:47]
VC192:
  s_waitcnt vmcnt(14)
  v_accvgpr_read_b32 v7, a120
  s_waitcnt vmcnt(13)
  v_accvgpr_read_b32 v8, a124
  v_max_u32 v6, v7, v8
  v_cmp_eq_u32 vcc, -1, v6
  s_cbranch_vccnz VR193
VK194:
  ds_read_b64_tr_b16 v[88:89], v2 offset:33792
  ds_read_b64_tr_b16 v[90:91], v2 offset:34048
  s_waitcnt lgkmcnt(12)
  v_mfma_f32_32x32x16_bf16 v[16:31], v[128:131], a[120:123], v[16:31]
  ds_read_b64_tr_b16 v[92:93], v3 offset:33792
  ds_read_b64_tr_b16 v[94:95], v3 offset:34048
  s_waitcnt lgkmcnt(12)
  v_mfma_f32_32x32x16_bf16 v[32:47], v[132:135], a[120:123], v[32:47]
  buffer_store_dwordx4 a[240:243], v224, s[8:11], s74 offen offset:256 sc1
  ds_read_b64_tr_b16 v[96:97], v2 offset:34816
  ds_read_b64_tr_b16 v[98:99], v2 offset:35072
  s_waitcnt lgkmcnt(12)
  v_mfma_f32_32x32x16_bf16 v[16:31], v[136:139], a[124:127], v[16:31]
  ds_read_b64_tr_b16 v[100:101], v3 offset:34816
  ds_read_b64_tr_b16 v[102:103], v3 offset:35072
  s_waitcnt lgkmcnt(12)
  v_mfma_f32_32x32x16_bf16 v[32:47], v[140:143], a[124:127], v[32:47]
VC195:
  s_waitcnt vmcnt(13)
  v_accvgpr_read_b32 v7, a128
  s_waitcnt vmcnt(12)
  v_accvgpr_read_b32 v8, a132
  v_max_u32 v6, v7, v8
  v_cmp_eq_u32 vcc, -1, v6
  s_cbranch_vccnz VR196
VK197:
  ds_read_b64_tr_b16 v[104:105], v2 offset:35840
  ds_read_b64_tr_b16 v[106:107], v2 offset:36096
  s_waitcnt lgkmcnt(12)
  v_mfma_f32_32x32x16_bf16 v[16:31], v[80:83], a[128:131], v[16:31]
  ds_read_b64_tr_b16 v[108:109], v3 offset:35840
  ds_read_b64_tr_b16 v[110:111], v3 offset:36096
  s_waitcnt lgkmcnt(12)
  v_mfma_f32_32x32x16_bf16 v[32:47], v[84:87], a[128:131], v[32:47]
  ds_read_b64_tr_b16 v[112:113], v2 offset:36864
  ds_read_b64_tr_b16 v[114:115], v2 offset:37120
  s_waitcnt lgkmcnt(12)
  v_mfma_f32_32x32x16_bf16 v[16:31], v[88:91], a[132:135], v[16:31]
  buffer_store_dwordx2 a[240:241], v225, s[8:11], s74 offen offset:512 sc1
  ds_read_b64_tr_b16 v[116:117], v3 offset:36864
  ds_read_b64_tr_b16 v[118:119], v3 offset:37120
  s_waitcnt lgkmcnt(12)
  v_mfma_f32_32x32x16_bf16 v[32:47], v[92:95], a[132:135], v[32:47]
VC198:
  s_waitcnt vmcnt(12)
  v_accvgpr_read_b32 v7, a136
  s_waitcnt vmcnt(11)
  v_accvgpr_read_b32 v8, a140
  v_accvgpr_read_b32 v9, a138
  v_max3_u32 v6, v7, v8, v9
  v_cmp_eq_u32 vcc, -1, v6
  s_cbranch_vccnz VR199
VK200:
  ds_read_b64_tr_b16 v[120:121], v2 offset:37888
  ds_read_b64_tr_b16 v[122:123], v2 offset:38144
  s_waitcnt lgkmcnt(12)
  v_mfma_f32_32x32x16_bf16 v[16:31], v[96:99], a[136:139], v[16:31]
  ds_read_b64_tr_b16 v[124:125], v3 offset:37888
  ds_read_b64_tr_b16 v[126:127], v3 offset:38144
  s_waitcnt lgkmcnt(12)
  v_mfma_f32_32x32x16_bf16 v[32:47], v[100:103], a[136:139], v[32:47]
  ds_read_b64_tr_b16 v[128:129], v2 offset:38912
  ds_read_b64_tr_b16 v[130:131], v2 offset:39168
  s_waitcnt lgkmcnt(12)
  v_mfma_f32_32x32x16_bf16 v[16:31], v[104:107], a[140:143], v[16:31]
  s_add_u32 s75, s62, 11141120
  buffer_store_dwordx4 a[240:243], v13, s[8:11], s75 offen sc1
  ds_read_b64_tr_b16 v[132:133], v3 offset:38912
  ds_read_b64_tr_b16 v[134:135], v3 offset:39168
  s_waitcnt lgkmcnt(12)
  v_mfma_f32_32x32x16_bf16 v[32:47], v[108:111], a[140:143], v[32:47]
VC201:
  s_waitcnt vmcnt(11)
  v_accvgpr_read_b32 v7, a144
  s_waitcnt vmcnt(10)
  v_accvgpr_read_b32 v8, a148
  v_max_u32 v6, v7, v8
  v_cmp_eq_u32 vcc, -1, v6
  s_cbranch_vccnz VR202
VK203:
  ds_read_b64_tr_b16 v[136:137], v2 offset:39936
  ds_read_b64_tr_b16 v[138:139], v2 offset:40192
  s_waitcnt lgkmcnt(12)
  v_mfma_f32_32x32x16_bf16 v[16:31], v[112:115], a[144:147], v[16:31]
  ds_read_b64_tr_b16 v[140:141], v3 offset:39936
  ds_read_b64_tr_b16 v[142:143], v3 offset:40192
  s_waitcnt lgkmcnt(12)
  v_mfma_f32_32x32x16_bf16 v[32:47], v[116:119], a[144:147], v[32:47]
  s_waitcnt lgkmcnt(10)
  v_mfma_f32_32x32x16_bf16 v[16:31], v[120:123], a[148:151], v[16:31]
  s_waitcnt lgkmcnt(8)
  v_mfma_f32_32x32x16_bf16 v[32:47], v[124:127], a[148:151], v[32:47]
  s_add_u32 s75, s62, 12189696
  buffer_store_dwordx4 a[240:243], v13, s[8:11], s75 offen sc1
VC204:
  s_waitcnt vmcnt(10)
  v_accvgpr_read_b32 v7, a152
  s_waitcnt vmcnt(9)
  v_accvgpr_read_b32 v8, a156
  v_accvgpr_read_b32 v9, a158
  v_max3_u32 v6, v7, v8, v9
  v_cmp_eq_u32 vcc, -1, v6
  s_cbranch_vccnz VR205
VK206:
VC207:
  s_waitcnt vmcnt(6)
  v_max3_u32 v6, v188, v190, v192
  s_waitcnt vmcnt(5)
  v_max_u32 v6, v6, v194
  v_cmp_eq_u32 vcc, -1, v6
  s_cbranch_vccnz VR208
VK209:
  v_add_f32 v188, v188, v190
  v_add_f32 v189, v189, v191
  v_add_f32 v192, v192, v194
  v_add_f32 v193, v193, v195
  v_add_f32 v188, v188, v192
  v_add_f32 v189, v189, v193
  v_mov_b32 v190, v188
  v_mov_b32 v191, v189
  s_nop 0
  v_permlane32_swap_b32 v188, v190
  v_permlane32_swap_b32 v189, v191
  v_add_f32 v188, v188, v190
  v_add_f32 v189, v189, v191
  v_mul_f32 v12, 0xbacccccd, v188
  v_mul_f32 v189, 0x3acccccd, v189
  v_fma_f32 v189, -v12, v12, v189
  v_max_f32 v189, 0, v189
  v_add_f32 v189, 0x3727c5ac, v189
  v_rsq_f32 v11, v189
  s_nop 0
  v_mul_f32 v10, 0x3fb8aa3b, v11
  s_waitcnt lgkmcnt(6)
  v_mfma_f32_32x32x16_bf16 v[16:31], v[128:131], a[152:155], v[16:31]
  s_waitcnt lgkmcnt(4)
  v_mfma_f32_32x32x16_bf16 v[32:47], v[132:135], a[152:155], v[32:47]
  s_waitcnt lgkmcnt(2)
  v_mfma_f32_32x32x16_bf16 v[16:31], v[136:139], a[156:159], v[16:31]
  s_waitcnt lgkmcnt(0)
  v_mfma_f32_32x32x16_bf16 v[32:47], v[140:143], a[156:159], v[32:47]
  s_nop 9
  v_pk_fma_f32 v[16:17], v[144:145], v[12:13], v[16:17] op_sel_hi:[1,0,1]
  v_pk_fma_f32 v[18:19], v[146:147], v[12:13], v[18:19] op_sel_hi:[1,0,1]
  v_pk_fma_f32 v[20:21], v[148:149], v[12:13], v[20:21] op_sel_hi:[1,0,1]
  v_pk_fma_f32 v[22:23], v[150:151], v[12:13], v[22:23] op_sel_hi:[1,0,1]
  v_pk_fma_f32 v[24:25], v[152:153], v[12:13], v[24:25] op_sel_hi:[1,0,1]
  v_pk_fma_f32 v[26:27], v[154:155], v[12:13], v[26:27] op_sel_hi:[1,0,1]
  v_pk_fma_f32 v[28:29], v[156:157], v[12:13], v[28:29] op_sel_hi:[1,0,1]
  v_pk_fma_f32 v[30:31], v[158:159], v[12:13], v[30:31] op_sel_hi:[1,0,1]
  v_pk_fma_f32 v[32:33], v[160:161], v[12:13], v[32:33] op_sel_hi:[1,0,1]
  v_pk_fma_f32 v[34:35], v[162:163], v[12:13], v[34:35] op_sel_hi:[1,0,1]
  v_pk_fma_f32 v[36:37], v[164:165], v[12:13], v[36:37] op_sel_hi:[1,0,1]
  v_pk_fma_f32 v[38:39], v[166:167], v[12:13], v[38:39] op_sel_hi:[1,0,1]
  v_pk_fma_f32 v[40:41], v[168:169], v[12:13], v[40:41] op_sel_hi:[1,0,1]
  v_pk_fma_f32 v[42:43], v[170:171], v[12:13], v[42:43] op_sel_hi:[1,0,1]
  v_pk_fma_f32 v[44:45], v[172:173], v[12:13], v[44:45] op_sel_hi:[1,0,1]
  v_pk_fma_f32 v[46:47], v[174:175], v[12:13], v[46:47] op_sel_hi:[1,0,1]
  s_barrier
  v_cvt_pk_bf16_f32 v176, v16, v17
  v_cvt_pk_bf16_f32 v177, v18, v19
  v_cvt_pk_bf16_f32 v178, v20, v21
  v_cvt_pk_bf16_f32 v179, v22, v23
  v_cvt_pk_bf16_f32 v180, v24, v25
  v_cvt_pk_bf16_f32 v181, v26, v27
  v_cvt_pk_bf16_f32 v182, v28, v29
  v_cvt_pk_bf16_f32 v183, v30, v31
  v_cvt_pk_bf16_f32 v184, v32, v33
  v_cvt_pk_bf16_f32 v185, v34, v35
  v_mov_b32 v186, 0
  v_mov_b32 v187, 0
  ds_read_b64_tr_b16 v[80:81], v4 offset:0
  ds_read_b64_tr_b16 v[82:83], v4 offset:256
  ds_read_b64_tr_b16 v[84:85], v4 offset:1024
  ds_read_b64_tr_b16 v[86:87], v4 offset:1280
  ds_read_b64_tr_b16 v[88:89], v4 offset:2048
  ds_read_b64_tr_b16 v[90:91], v4 offset:2304
  ds_read_b64_tr_b16 v[92:93], v4 offset:3072
  ds_read_b64_tr_b16 v[94:95], v4 offset:3328
  ds_read_b64_tr_b16 v[96:97], v4 offset:4096
  ds_read_b64_tr_b16 v[98:99], v4 offset:4352
  s_waitcnt lgkmcnt(8)
  v_mfma_f32_32x32x16_bf16 v[48:63], v[80:83], a[0:3], 0
  s_add_u32 s75, s62, 13238272
  buffer_store_dwordx4 a[240:243], v13, s[8:11], s75 offen sc1
  v_mfma_f32_32x32x16_bf16 v[144:159], a[160:163], v[176:179], 0
  v_mfma_f32_32x32x16_bf16 v[160:175], a[172:175], v[176:179], 0
  ds_read_b64_tr_b16 v[100:101], v4 offset:5120
  ds_read_b64_tr_b16 v[102:103], v4 offset:5376
  s_waitcnt lgkmcnt(8)
  v_mfma_f32_32x32x16_bf16 v[48:63], v[84:87], a[4:7], v[48:63]
  v_mfma_f32_32x32x16_bf16 v[144:159], a[164:167], v[180:183], v[144:159]
  v_mfma_f32_32x32x16_bf16 v[160:175], a[176:179], v[180:183], v[160:175]
  ds_read_b64_tr_b16 v[104:105], v4 offset:6144
  ds_read_b64_tr_b16 v[106:107], v4 offset:6400
  s_waitcnt lgkmcnt(8)
  v_mfma_f32_32x32x16_bf16 v[48:63], v[88:91], a[8:11], v[48:63]
  v_mfma_f32_32x32x16_bf16 v[144:159], a[168:171], v[184:187], v[144:159]
  v_mfma_f32_32x32x16_bf16 v[160:175], a[180:183], v[184:187], v[160:175]
  ds_read_b64_tr_b16 v[108:109], v4 offset:7168
  ds_read_b64_tr_b16 v[110:111], v4 offset:7424
  s_waitcnt lgkmcnt(8)
  v_mfma_f32_32x32x16_bf16 v[48:63], v[92:95], a[12:15], v[48:63]
  s_add_u32 s75, s62, 14286848
  buffer_store_dwordx4 a[240:243], v13, s[8:11], s75 offen sc1
  ds_read_b64_tr_b16 v[112:113], v4 offset:8192
  ds_read_b64_tr_b16 v[114:115], v4 offset:8448
  s_waitcnt lgkmcnt(8)
  v_mfma_f32_32x32x16_bf16 v[48:63], v[96:99], a[16:19], v[48:63]
  s_nop 0
  v_max3_f32 v6, v144, v145, v146
  v_min3_f32 v8, v144, v145, v146
  v_max3_f32 v6, v6, v147, v148
  v_min3_f32 v8, v8, v147, v148
  v_max3_f32 v6, v6, v149, v150
  v_min3_f32 v8, v8, v149, v150
  ds_read_b64_tr_b16 v[116:117], v4 offset:9216
  ds_read_b64_tr_b16 v[118:119], v4 offset:9472
  s_waitcnt lgkmcnt(8)
  v_mfma_f32_32x32x16_bf16 v[48:63], v[100:103], a[20:23], v[48:63]
  v_max3_f32 v6, v6, v151, v152
  v_min3_f32 v8, v8, v151, v152
  v_max3_f32 v6, v6, v153, v154
  v_min3_f32 v8, v8, v153, v154
  v_max3_f32 v6, v6, v155, v156
  v_min3_f32 v8, v8, v155, v156
  ds_read_b64_tr_b16 v[120:121], v4 offset:10240
  ds_read_b64_tr_b16 v[122:123], v4 offset:10496
  s_waitcnt lgkmcnt(8)
  v_mfma_f32_32x32x16_bf16 v[48:63], v[104:107], a[24:27], v[48:63]
  v_max3_f32 v6, v6, v157, v158
  v_min3_f32 v8, v8, v157, v158
  v_max3_f32 v6, v6, v159, v160
  v_min3_f32 v8, v8, v159, v160
  v_max3_f32 v6, v6, v161, v162
  v_min3_f32 v8, v8, v161, v162
  ds_read_b64_tr_b16 v[124:125], v4 offset:11264
  ds_read_b64_tr_b16 v[126:127], v4 offset:11520
  s_waitcnt lgkmcnt(8)
  v_mfma_f32_32x32x16_bf16 v[48:63], v[108:111], a[28:31], v[48:63]
  v_max_f32 v6, v6, v163
  v_min_f32 v8, v8, v163
  v_mul_f32 v6, v6, v10
  v_mul_f32 v8, v8, v10
  v_fma_f32 v188, v144, v10, -v6
  v_fma_f32 v208, v144, -v10, v8
  ds_read_b64_tr_b16 v[128:129], v4 offset:12288
  ds_read_b64_tr_b16 v[130:131], v4 offset:12544
  s_waitcnt lgkmcnt(8)
  v_mfma_f32_32x32x16_bf16 v[48:63], v[112:115], a[32:35], v[48:63]
  v_fma_f32 v189, v145, v10, -v6
  v_fma_f32 v209, v145, -v10, v8
  v_exp_f32 v188, v188
  v_exp_f32 v208, v208
  v_fma_f32 v190, v146, v10, -v6
  v_fma_f32 v210, v146, -v10, v8
  ds_read_b64_tr_b16 v[132:133], v4 offset:13312
  ds_read_b64_tr_b16 v[134:135], v4 offset:13568
  s_waitcnt lgkmcnt(8)
  v_mfma_f32_32x32x16_bf16 v[48:63], v[116:119], a[36:39], v[48:63]
  v_exp_f32 v189, v189
  v_exp_f32 v209, v209
  v_fma_f32 v191, v147, v10, -v6
  v_fma_f32 v211, v147, -v10, v8
  v_exp_f32 v190, v190
  v_exp_f32 v210, v210
  ds_read_b64_tr_b16 v[136:137], v4 offset:14336
  ds_read_b64_tr_b16 v[138:139], v4 offset:14592
  s_waitcnt lgkmcnt(8)
  v_mfma_f32_32x32x16_bf16 v[48:63], v[120:123], a[40:43], v[48:63]
  v_add_f32 v7, v188, v189
  v_add_f32 v9, v208, v209
  v_fma_f32 v192, v148, v10, -v6
  v_fma_f32 v212, v148, -v10, v8
  v_exp_f32 v191, v191
  v_exp_f32 v211, v211
  ds_read_b64_tr_b16 v[140:141], v4 offset:15360
  ds_read_b64_tr_b16 v[142:143], v4 offset:15616
  s_waitcnt lgkmcnt(8)
  v_mfma_f32_32x32x16_bf16 v[48:63], v[124:127], a[44:47], v[48:63]
  v_add_f32 v7, v7, v190
  v_add_f32 v9, v9, v210
  v_fma_f32 v193, v149, v10, -v6
  v_fma_f32 v213, v149, -v10, v8
  v_exp_f32 v192, v192
  v_exp_f32 v212, v212
  ds_read_b64_tr_b16 v[80:81], v4 offset:16384
  ds_read_b64_tr_b16 v[82:83], v4 offset:16640
  s_waitcnt lgkmcnt(8)
  v_mfma_f32_32x32x16_bf16 v[48:63], v[128:131], a[48:51], v[48:63]
  v_add_f32 v7, v7, v191
  v_add_f32 v9, v9, v211
  v_fma_f32 v194, v150, v10, -v6
  v_fma_f32 v214, v150, -v10, v8
  v_exp_f32 v193, v193
  v_exp_f32 v213, v213
  ds_read_b64_tr_b16 v[84:85], v4 offset:17408
  ds_read_b64_tr_b16 v[86:87], v4 offset:17664
  s_waitcnt lgkmcnt(8)
  v_mfma_f32_32x32x16_bf16 v[48:63], v[132:135], a[52:55], v[48:63]
  v_add_f32 v7, v7, v192
  v_add_f32 v9, v9, v212
  v_fma_f32 v195, v151, v10, -v6
  v_fma_f32 v215, v151, -v10, v8
  v_exp_f32 v194, v194
  v_exp_f32 v214, v214
  s_add_u32 s75, s62, 15335424
  buffer_store_dwordx4 a[240:243], v13, s[8:11], s75 offen sc1
  ds_read_b64_tr_b16 v[88:89], v4 offset:18432
  ds_read_b64_tr_b16 v[90:91], v4 offset:18688
  s_waitcnt lgkmcnt(8)
  v_mfma_f32_32x32x16_bf16 v[48:63], v[136:139], a[56:59], v[48:63]
  v_add_f32 v7, v7, v193
  v_add_f32 v9, v9, v213
  v_fma_f32 v196, v152, v10, -v6
  v_fma_f32 v216, v152, -v10, v8
  v_exp_f32 v195, v195
  v_exp_f32 v215, v215
  ds_read_b64_tr_b16 v[92:93], v4 offset:19456
  ds_read_b64_tr_b16 v[94:95], v4 offset:19712
  s_waitcnt lgkmcnt(8)
  v_mfma_f32_32x32x16_bf16 v[48:63], v[140:143], a[60:63], v[48:63]
  v_add_f32 v7, v7, v194
  v_add_f32 v9, v9, v214
  v_fma_f32 v197, v153, v10, -v6
  v_fma_f32 v217, v153, -v10, v8
  v_exp_f32 v196, v196
  v_exp_f32 v216, v216
  s_lshr_b32 s79, s2, 3
  s_lshl_b32 s79, s79, 2
  s_add_u32 s79, s79, s52
  s_mul_i32 s79, s79, 49152
  s_bfe_u32 s78, s2, 0x20001
  s_mul_i32 s78, s78, 768
  s_add_u32 s79, s79, s78
  v_lshrrev_b32 v252, 1, v1
  v_mul_u32_u24 v252, 24, v252
  v_and_or_b32 v252, v1, 1, v252
  v_lshlrev_b32 v252, 7, v252
  v_lshrrev_b32 v253, 5, v1
  v_lshl_or_b32 v252, v253, 30, v252
  buffer_load_dword a255, v252, s[28:31], s79 offen offset:0
  ds_read_b64_tr_b16 v[96:97], v4 offset:20480
  ds_read_b64_tr_b16 v[98:99], v4 offset:20736
  s_waitcnt lgkmcnt(8)
  v_mfma_f32_32x32x16_bf16 v[48:63], v[80:83], a[64:67], v[48:63]
  v_add_f32 v7, v7, v195
  v_add_f32 v9, v9, v215
  v_fma_f32 v198, v154, v10, -v6
  v_fma_f32 v218, v154, -v10, v8
  v_exp_f32 v197, v197
  v_exp_f32 v217, v217
  ds_read_b64_tr_b16 v[100:101], v4 offset:21504
  ds_read_b64_tr_b16 v[102:103], v4 offset:21760
  s_waitcnt lgkmcnt(8)
  v_mfma_f32_32x32x16_bf16 v[48:63], v[84:87], a[68:71], v[48:63]
  v_add_f32 v7, v7, v196
  v_add_f32 v9, v9, v216
  v_fma_f32 v199, v155, v10, -v6
  v_fma_f32 v219, v155, -v10, v8
  v_exp_f32 v198, v198
  v_exp_f32 v218, v218
  ds_read_b64_tr_b16 v[104:105], v4 offset:22528
  ds_read_b64_tr_b16 v[106:107], v4 offset:22784
  s_waitcnt lgkmcnt(8)
  v_mfma_f32_32x32x16_bf16 v[48:63], v[88:91], a[72:75], v[48:63]
  v_add_f32 v7, v7, v197
  v_add_f32 v9, v9, v217
  v_fma_f32 v200, v156, v10, -v6
  v_fma_f32 v220, v156, -v10, v8
  v_exp_f32 v199, v199
  v_exp_f32 v219, v219
  ds_read_b64_tr_b16 v[108:109], v4 offset:23552
  ds_read_b64_tr_b16 v[110:111], v4 offset:23808
  s_waitcnt lgkmcnt(8)
  v_mfma_f32_32x32x16_bf16 v[48:63], v[92:95], a[76:79], v[48:63]
  v_add_f32 v7, v7, v198
  v_add_f32 v9, v9, v218
  v_fma_f32 v201, v157, v10, -v6
  v_fma_f32 v221, v157, -v10, v8
  v_exp_f32 v200, v200
  v_exp_f32 v220, v220
  ds_read_b64_tr_b16 v[112:113], v4 offset:24576
  ds_read_b64_tr_b16 v[114:115], v4 offset:24832
  s_waitcnt lgkmcnt(8)
  v_mfma_f32_32x32x16_bf16 v[48:63], v[96:99], a[80:83], v[48:63]
  v_add_f32 v7, v7, v199
  v_add_f32 v9, v9, v219
  v_fma_f32 v202, v158, v10, -v6
  v_fma_f32 v222, v158, -v10, v8
  v_exp_f32 v201, v201
  v_exp_f32 v221, v221
  ds_read_b64_tr_b16 v[116:117], v4 offset:25600
  ds_read_b64_tr_b16 v[118:119], v4 offset:25856
  s_waitcnt lgkmcnt(8)
  v_mfma_f32_32x32x16_bf16 v[48:63], v[100:103], a[84:87], v[48:63]
  v_add_f32 v7, v7, v200
  v_add_f32 v9, v9, v220
  v_fma_f32 v203, v159, v10, -v6
  v_fma_f32 v223, v159, -v10, v8
  v_exp_f32 v202, v202
  v_exp_f32 v222, v222
  ds_read_b64_tr_b16 v[120:121], v4 offset:26624
  ds_read_b64_tr_b16 v[122:123], v4 offset:26880
  s_waitcnt lgkmcnt(8)
  v_mfma_f32_32x32x16_bf16 v[48:63], v[104:107], a[88:91], v[48:63]
  v_add_f32 v7, v7, v201
  v_add_f32 v9, v9, v221
  v_fma_f32 v204, v160, v10, -v6
  v_fma_f32 v224, v160, -v10, v8
  v_exp_f32 v203, v203
  v_exp_f32 v223, v223
  ds_read_b64_tr_b16 v[124:125], v4 offset:27648
  ds_read_b64_tr_b16 v[126:127], v4 offset:27904
  s_waitcnt lgkmcnt(8)
  v_mfma_f32_32x32x16_bf16 v[48:63], v[108:111], a[92:95], v[48:63]
  v_add_f32 v7, v7, v202
  v_add_f32 v9, v9, v222
  v_fma_f32 v205, v161, v10, -v6
  v_fma_f32 v225, v161, -v10, v8
  v_exp_f32 v204, v204
  v_exp_f32 v224, v224
  ds_read_b64_tr_b16 v[128:129], v4 offset:28672
  ds_read_b64_tr_b16 v[130:131], v4 offset:28928
  s_waitcnt lgkmcnt(8)
  v_mfma_f32_32x32x16_bf16 v[48:63], v[112:115], a[96:99], v[48:63]
  v_add_f32 v7, v7, v203
  v_add_f32 v9, v9, v223
  v_fma_f32 v206, v162, v10, -v6
  v_fma_f32 v226, v162, -v10, v8
  v_exp_f32 v205, v205
  v_exp_f32 v225, v225
  ds_read_b64_tr_b16 v[132:133], v4 offset:29696
  ds_read_b64_tr_b16 v[134:135], v4 offset:29952
  s_waitcnt lgkmcnt(8)
  v_mfma_f32_32x32x16_bf16 v[48:63], v[116:119], a[100:103], v[48:63]
  v_add_f32 v7, v7, v204
  v_add_f32 v9, v9, v224
  v_fma_f32 v207, v163, v10, -v6
  v_fma_f32 v227, v163, -v10, v8
  v_exp_f32 v206, v206
  v_exp_f32 v226, v226
  ds_read_b64_tr_b16 v[136:137], v4 offset:30720
  ds_read_b64_tr_b16 v[138:139], v4 offset:30976
  s_waitcnt lgkmcnt(8)
  v_mfma_f32_32x32x16_bf16 v[48:63], v[120:123], a[104:107], v[48:63]
  v_add_f32 v7, v7, v205
  v_add_f32 v9, v9, v225
  v_exp_f32 v207, v207
  v_exp_f32 v227, v227
  v_add_f32 v7, v7, v206
  v_add_f32 v9, v9, v226
  ds_read_b64_tr_b16 v[140:141], v4 offset:31744
  ds_read_b64_tr_b16 v[142:143], v4 offset:32000
  s_waitcnt lgkmcnt(8)
  v_mfma_f32_32x32x16_bf16 v[48:63], v[124:127], a[108:111], v[48:63]
  v_mov_b32 v6, v207
  v_mov_b32 v8, v227
  v_add_f32 v6, v6, v7
  v_add_f32 v8, v8, v9
  v_rcp_f32 v6, v6
  v_rcp_f32 v8, v8
  ds_read_b64_tr_b16 v[80:81], v4 offset:32768
  ds_read_b64_tr_b16 v[82:83], v4 offset:33024
  s_waitcnt lgkmcnt(8)
  v_mfma_f32_32x32x16_bf16 v[48:63], v[128:131], a[112:115], v[48:63]
  v_mul_f32 v188, v188, v6
  v_mul_f32 v189, v189, v6
  v_mul_f32 v190, v190, v6
  v_mul_f32 v191, v191, v6
  v_cvt_pk_bf16_f32 v228, v188, v189
  v_mul_f32 v192, v192, v6
  ds_read_b64_tr_b16 v[84:85], v4 offset:33792
  ds_read_b64_tr_b16 v[86:87], v4 offset:34048
  s_waitcnt lgkmcnt(8)
  v_mfma_f32_32x32x16_bf16 v[48:63], v[132:135], a[116:119], v[48:63]
  v_mul_f32 v193, v193, v6
  v_cvt_pk_bf16_f32 v229, v190, v191
  v_mul_f32 v194, v194, v6
  v_mul_f32 v195, v195, v6
  v_cvt_pk_bf16_f32 v236, v192, v193
  v_mul_f32 v196, v196, v6
  ds_read_b64_tr_b16 v[88:89], v4 offset:34816
  ds_read_b64_tr_b16 v[90:91], v4 offset:35072
  s_waitcnt lgkmcnt(8)
  v_mfma_f32_32x32x16_bf16 v[48:63], v[136:139], a[120:123], v[48:63]
  v_mul_f32 v197, v197, v6
  v_cvt_pk_bf16_f32 v237, v194, v195
  v_mul_f32 v198, v198, v6
  v_mul_f32 v199, v199, v6
  v_cvt_pk_bf16_f32 v230, v196, v197
  v_mul_f32 v200, v200, v6
  ds_read_b64_tr_b16 v[92:93], v4 offset:35840
  ds_read_b64_tr_b16 v[94:95], v4 offset:36096
  s_waitcnt lgkmcnt(8)
  v_mfma_f32_32x32x16_bf16 v[48:63], v[140:143], a[124:127], v[48:63]
  v_mul_f32 v201, v201, v6
  v_cvt_pk_bf16_f32 v231, v198, v199
  v_mul_f32 v202, v202, v6
  v_mul_f32 v203, v203, v6
  v_cvt_pk_bf16_f32 v238, v200, v201
  v_mul_f32 v204, v204, v6
  ds_read_b64_tr_b16 v[96:97], v4 offset:36864
  ds_read_b64_tr_b16 v[98:99], v4 offset:37120
  s_waitcnt lgkmcnt(8)
  v_mfma_f32_32x32x16_bf16 v[48:63], v[80:83], a[128:131], v[48:63]
  v_mul_f32 v205, v205, v6
  v_cvt_pk_bf16_f32 v239, v202, v203
  v_mul_f32 v206, v206, v6
  v_mul_f32 v207, v207, v6
  v_cvt_pk_bf16_f32 v232, v204, v205
  v_mul_f32 v208, v208, v8
  ds_read_b64_tr_b16 v[100:101], v4 offset:37888
  ds_read_b64_tr_b16 v[102:103], v4 offset:38144
  s_waitcnt lgkmcnt(8)
  v_mfma_f32_32x32x16_bf16 v[48:63], v[84:87], a[132:135], v[48:63]
  v_mul_f32 v209, v209, v8
  v_cvt_pk_bf16_f32 v233, v206, v207
  v_lshrrev_b32 v68, 5, v1
  v_lshlrev_b32 v68, 6, v68
  v_add_u32 v68, 159744, v68
  ds_read_b128 v[144:147], v68 offset:256
  ds_read_b64_tr_b16 v[104:105], v4 offset:38912
  ds_read_b64_tr_b16 v[106:107], v4 offset:39168
  s_waitcnt lgkmcnt(9)
  v_mfma_f32_32x32x16_bf16 v[48:63], v[88:91], a[136:139], v[48:63]
  ds_read_b128 v[160:163], v68 offset:768
  ds_read_b128 v[148:151], v68 offset:272
  ds_read_b128 v[164:167], v68 offset:784
  ds_read_b128 v[152:155], v68 offset:288
  ds_read_b128 v[168:171], v68 offset:800
  ds_read_b128 v[156:159], v68 offset:304
  ds_read_b64_tr_b16 v[108:109], v4 offset:39936
  ds_read_b64_tr_b16 v[110:111], v4 offset:40192
  s_waitcnt lgkmcnt(15)
  v_mfma_f32_32x32x16_bf16 v[48:63], v[92:95], a[140:143], v[48:63]
  ds_read_b128 v[172:175], v68 offset:816
  v_mul_f32 v210, v210, v8
  v_mul_f32 v211, v211, v8
  v_cvt_pk_bf16_f32 v240, v208, v209
  v_mul_f32 v212, v212, v8
  v_mul_f32 v213, v213, v8
  s_waitcnt lgkmcnt(14)
  v_mfma_f32_32x32x16_bf16 v[48:63], v[96:99], a[144:147], v[48:63]
  v_cvt_pk_bf16_f32 v241, v210, v211
  v_mul_f32 v214, v214, v8
  v_mul_f32 v215, v215, v8
  v_cvt_pk_bf16_f32 v234, v212, v213
  v_mul_f32 v216, v216, v8
  v_mul_f32 v217, v217, v8
  s_waitcnt lgkmcnt(12)
  v_mfma_f32_32x32x16_bf16 v[48:63], v[100:103], a[148:151], v[48:63]
  v_cvt_pk_bf16_f32 v235, v214, v215
  v_mul_f32 v218, v218, v8
  v_mul_f32 v219, v219, v8
  v_cvt_pk_bf16_f32 v242, v216, v217
  v_mul_f32 v220, v220, v8
  v_mul_f32 v221, v221, v8
  s_waitcnt lgkmcnt(9)
  v_mfma_f32_32x32x16_bf16 v[48:63], v[104:107], a[152:155], v[48:63]
  v_cvt_pk_bf16_f32 v243, v218, v219
  v_mul_f32 v222, v222, v8
  v_mul_f32 v223, v223, v8
  v_cvt_pk_bf16_f32 v244, v220, v221
  v_mul_f32 v224, v224, v8
  v_mul_f32 v225, v225, v8
  s_waitcnt lgkmcnt(1)
  v_mfma_f32_32x32x16_bf16 v[48:63], v[108:111], a[156:159], v[48:63]
  v_cvt_pk_bf16_f32 v245, v222, v223
  v_mul_f32 v226, v226, v8
  v_mul_f32 v227, v227, v8
  v_cvt_pk_bf16_f32 v246, v224, v225
  v_cvt_pk_bf16_f32 v247, v226, v227
  v_mul_f32 v36, v36, v11
  s_waitcnt vmcnt(0)
  buffer_load_dword a255, v252, s[28:31], s79 offen offset:256
  v_mul_f32 v37, v37, v11
  v_mul_f32 v38, v38, v11
  v_mul_f32 v39, v39, v11
  v_mul_f32 v40, v40, v11
  v_mul_f32 v41, v41, v11
  v_mul_f32 v42, v42, v11
  v_mul_f32 v43, v43, v11
  v_mul_f32 v44, v44, v11
  v_mul_f32 v45, v45, v11
  v_mul_f32 v46, v46, v11
  v_mul_f32 v47, v47, v11
  v_pk_add_f32 v[144:145], v[144:145], v[160:161]
  v_pk_add_f32 v[146:147], v[146:147], v[162:163]
  v_pk_add_f32 v[148:149], v[148:149], v[164:165]
  v_pk_add_f32 v[150:151], v[150:151], v[166:167]
  v_pk_add_f32 v[152:153], v[152:153], v[168:169]
  v_pk_add_f32 v[154:155], v[154:155], v[170:171]
  s_waitcnt lgkmcnt(0)
  v_pk_add_f32 v[156:157], v[156:157], v[172:173]
  v_pk_add_f32 v[158:159], v[158:159], v[174:175]
  v_pk_fma_f32 v[48:49], v[144:145], v[12:13], v[48:49] op_sel_hi:[1,0,1]
  v_pk_fma_f32 v[50:51], v[146:147], v[12:13], v[50:51] op_sel_hi:[1,0,1]
  v_pk_fma_f32 v[52:53], v[148:149], v[12:13], v[52:53] op_sel_hi:[1,0,1]
  v_pk_fma_f32 v[54:55], v[150:151], v[12:13], v[54:55] op_sel_hi:[1,0,1]
  v_pk_fma_f32 v[56:57], v[152:153], v[12:13], v[56:57] op_sel_hi:[1,0,1]
  v_pk_fma_f32 v[58:59], v[154:155], v[12:13], v[58:59] op_sel_hi:[1,0,1]
  v_pk_fma_f32 v[60:61], v[156:157], v[12:13], v[60:61] op_sel_hi:[1,0,1]
  v_pk_fma_f32 v[62:63], v[158:159], v[12:13], v[62:63] op_sel_hi:[1,0,1]
  v_mul_f32 v48, v48, v11
  v_mul_f32 v49, v49, v11
  v_mul_f32 v50, v50, v11
  v_mul_f32 v51, v51, v11
  v_mul_f32 v52, v52, v11
  v_mul_f32 v53, v53, v11
  v_mul_f32 v54, v54, v11
  v_mul_f32 v55, v55, v11
  v_cvt_pk_bf16_f32 v176, v36, v37
  v_cvt_pk_bf16_f32 v177, v38, v39
  v_cvt_pk_bf16_f32 v178, v40, v41
  v_cvt_pk_bf16_f32 v179, v42, v43
  v_cvt_pk_bf16_f32 v180, v48, v49
  v_cvt_pk_bf16_f32 v181, v50, v51
  v_cvt_pk_bf16_f32 v182, v52, v53
  v_cvt_pk_bf16_f32 v183, v54, v55
  v_cvt_pk_bf16_f32 v184, v44, v45
  v_cvt_pk_bf16_f32 v185, v46, v47
  v_mov_b32 v186, 0x3f80
  v_mov_b32 v187, 0
  v_accvgpr_read_b32 v6, a194
  ds_write_b128 v6, v[228:231] offset:0
  ds_write_b128 v6, v[232:235] offset:16
  ds_write_b128 v6, v[236:239] offset:4096
  ds_write_b128 v6, v[240:243] offset:4112
  ds_write_b128 v6, v[244:247] offset:8192
  ds_write_b128 v6, v[176:179] offset:12288
  ds_write_b128 v6, v[180:183] offset:12304
  ds_write_b128 v6, v[184:187] offset:16384
  s_nop 1
  v_accvgpr_read_b32 v6, a195
  v_accvgpr_read_b32 v7, a196
  s_waitcnt lgkmcnt(0)
  s_barrier
  ds_read_b64_tr_b16 v[80:81], v7 offset:0
  ds_read_b64_tr_b16 v[82:83], v7 offset:512
  ds_read_b64_tr_b16 v[84:85], v6 offset:0
  ds_read_b64_tr_b16 v[86:87], v6 offset:512
  ds_read_b64_tr_b16 v[88:89], v6 offset:4096
  ds_read_b64_tr_b16 v[90:91], v6 offset:4608
  ds_read_b64_tr_b16 v[92:93], v6 offset:8192
  ds_read_b64_tr_b16 v[94:95], v6 offset:8704
  ds_read_b64_tr_b16 v[96:97], v7 offset:1024
  ds_read_b64_tr_b16 v[98:99], v7 offset:1536
  ds_read_b64_tr_b16 v[100:101], v6 offset:1024
  ds_read_b64_tr_b16 v[102:103], v6 offset:1536
  ds_read_b64_tr_b16 v[104:105], v6 offset:5120
  ds_read_b64_tr_b16 v[106:107], v6 offset:5632
  ds_read_b64_tr_b16 v[108:109], v6 offset:9216
  ds_read_b64_tr_b16 v[110:111], v6 offset:9728
  ds_read_b64_tr_b16 v[112:113], v7 offset:2048
  ds_read_b64_tr_b16 v[114:115], v7 offset:2560
  ds_read_b64_tr_b16 v[116:117], v6 offset:2048
  ds_read_b64_tr_b16 v[118:119], v6 offset:2560
  ds_read_b64_tr_b16 v[120:121], v6 offset:6144
  ds_read_b64_tr_b16 v[122:123], v6 offset:6656
  ds_read_b64_tr_b16 v[124:125], v6 offset:10240
  ds_read_b64_tr_b16 v[126:127], v6 offset:10752
  ds_read_b64_tr_b16 v[128:129], v7 offset:3072
  ds_read_b64_tr_b16 v[130:131], v7 offset:3584
  ds_read_b64_tr_b16 v[132:133], v6 offset:3072
  ds_read_b64_tr_b16 v[134:135], v6 offset:3584
  ds_read_b64_tr_b16 v[136:137], v6 offset:7168
  ds_read_b64_tr_b16 v[138:139], v6 offset:7680
  ds_read_b64_tr_b16 v[140:141], v6 offset:11264
  ds_read_b64_tr_b16 v[142:143], v6 offset:11776
  v_mov_b32 v8, v68
  ds_read_b128 v[64:67], v8 offset:384
  ds_read_b128 v[160:163], v8 offset:896
  ds_read_b128 v[68:71], v8 offset:400
  ds_read_b128 v[164:167], v8 offset:912
  ds_read_b128 v[72:75], v8 offset:416
  ds_read_b128 v[168:171], v8 offset:928
  ds_read_b128 v[76:79], v8 offset:432
  ds_read_b128 v[172:175], v8 offset:944
  v_accvgpr_read_b32 v6, a197
  v_accvgpr_read_b32 v9, a198
  v_accvgpr_read_b32 v14, a199
  v_accvgpr_read_b32 v15, a200
  s_waitcnt lgkmcnt(15)
  v_mfma_f32_16x16x32_bf16 v[144:147], v[84:87], v[80:83], 0
  v_mfma_f32_16x16x32_bf16 v[148:151], v[88:91], v[80:83], 0
  v_mfma_f32_16x16x32_bf16 v[152:155], v[92:95], v[80:83], 0
  v_mfma_f32_16x16x32_bf16 v[144:147], v[100:103], v[96:99], v[144:147]
  v_mfma_f32_16x16x32_bf16 v[148:151], v[104:107], v[96:99], v[148:151]
  v_mfma_f32_16x16x32_bf16 v[152:155], v[108:111], v[96:99], v[152:155]
  v_mfma_f32_16x16x32_bf16 v[144:147], v[116:119], v[112:115], v[144:147]
  v_mfma_f32_16x16x32_bf16 v[148:151], v[120:123], v[112:115], v[148:151]
  v_mfma_f32_16x16x32_bf16 v[152:155], v[124:127], v[112:115], v[152:155]
  s_waitcnt lgkmcnt(12)
  v_mfma_f32_16x16x32_bf16 v[144:147], v[132:135], v[128:131], v[144:147]
  s_waitcnt lgkmcnt(10)
  v_mfma_f32_16x16x32_bf16 v[148:151], v[136:139], v[128:131], v[148:151]
  s_waitcnt lgkmcnt(8)
  v_mfma_f32_16x16x32_bf16 v[152:155], v[140:143], v[128:131], v[152:155]
  s_nop 3
  v_cvt_pk_bf16_f32 v176, v144, v145
  v_cvt_pk_bf16_f32 v177, v146, v147
  v_cvt_pk_bf16_f32 v178, v148, v149
  v_cvt_pk_bf16_f32 v179, v150, v151
  v_cvt_pk_bf16_f32 v180, v152, v153
  v_cvt_pk_bf16_f32 v181, v154, v155
  buffer_store_dwordx4 v[176:179], v6, s[8:11], s92 offen sc1
  buffer_store_dwordx2 v[180:181], v9, s[8:11], s92 offen offset:64 sc1
  s_waitcnt lgkmcnt(6)
  v_pk_add_f32 v[64:65], v[64:65], v[160:161]
  v_pk_add_f32 v[66:67], v[66:67], v[162:163]
  s_waitcnt lgkmcnt(4)
  v_pk_add_f32 v[68:69], v[68:69], v[164:165]
  v_pk_add_f32 v[70:71], v[70:71], v[166:167]
  s_waitcnt lgkmcnt(2)
  v_pk_add_f32 v[72:73], v[72:73], v[168:169]
  v_pk_add_f32 v[74:75], v[74:75], v[170:171]
  s_waitcnt lgkmcnt(0)
  v_pk_add_f32 v[76:77], v[76:77], v[172:173]
  v_pk_add_f32 v[78:79], v[78:79], v[174:175]
  v_pk_mul_f32 v[64:65], v[64:65], v[12:13] op_sel_hi:[1,0]
  v_pk_mul_f32 v[66:67], v[66:67], v[12:13] op_sel_hi:[1,0]
  v_pk_mul_f32 v[68:69], v[68:69], v[12:13] op_sel_hi:[1,0]
  v_pk_mul_f32 v[70:71], v[70:71], v[12:13] op_sel_hi:[1,0]
  v_pk_mul_f32 v[72:73], v[72:73], v[12:13] op_sel_hi:[1,0]
  v_pk_mul_f32 v[74:75], v[74:75], v[12:13] op_sel_hi:[1,0]
  v_pk_mul_f32 v[76:77], v[76:77], v[12:13] op_sel_hi:[1,0]
  v_pk_mul_f32 v[78:79], v[78:79], v[12:13] op_sel_hi:[1,0]
  s_barrier
  buffer_store_dword v14, v15, s[8:11], s93 offen sc1
  s_add_u32 m0, s87, 0
  s_add_u32 s69, s89, 0
  buffer_load_dwordx4 v13, s[8:11], s69 offen sc1 lds
  ds_read_b64_tr_b16 v[80:81], v5 offset:0
  ds_read_b64_tr_b16 v[82:83], v5 offset:192
  ds_read_b64_tr_b16 v[84:85], v5 offset:768
  ds_read_b64_tr_b16 v[86:87], v5 offset:960
  ds_read_b64_tr_b16 v[88:89], v5 offset:1536
  ds_read_b64_tr_b16 v[90:91], v5 offset:1728
  ds_read_b64_tr_b16 v[92:93], v5 offset:2304
  ds_read_b64_tr_b16 v[94:95], v5 offset:2496
  ds_read_b64_tr_b16 v[96:97], v5 offset:3072
  ds_read_b64_tr_b16 v[98:99], v5 offset:3264
  s_waitcnt lgkmcnt(8)
  v_mfma_f32_32x32x16_bf16 v[64:79], v[80:83], a[0:3], v[64:79]
  s_add_u32 m0, s87, 4096
  s_add_u32 s69, s89, 4096
  buffer_load_dwordx4 v13, s[8:11], s69 offen sc1 lds
  ds_read_b64_tr_b16 v[100:101], v5 offset:3840
  ds_read_b64_tr_b16 v[102:103], v5 offset:4032
  s_waitcnt lgkmcnt(8)
  v_mfma_f32_32x32x16_bf16 v[64:79], v[84:87], a[4:7], v[64:79]
  ds_read_b64_tr_b16 v[104:105], v5 offset:4608
  ds_read_b64_tr_b16 v[106:107], v5 offset:4800
  s_waitcnt lgkmcnt(8)
  v_mfma_f32_32x32x16_bf16 v[64:79], v[88:91], a[8:11], v[64:79]
  s_add_u32 m0, s87, 8192
  s_add_u32 s69, s89, 8192
  buffer_load_dwordx4 v13, s[8:11], s69 offen sc1 lds
  ds_read_b64_tr_b16 v[108:109], v5 offset:5376
  ds_read_b64_tr_b16 v[110:111], v5 offset:5568
  s_waitcnt lgkmcnt(8)
  v_mfma_f32_32x32x16_bf16 v[64:79], v[92:95], a[12:15], v[64:79]
  ds_read_b64_tr_b16 v[112:113], v5 offset:6144
  ds_read_b64_tr_b16 v[114:115], v5 offset:6336
  s_waitcnt lgkmcnt(8)
  v_mfma_f32_32x32x16_bf16 v[64:79], v[96:99], a[16:19], v[64:79]
  s_add_u32 m0, s87, 12288
  s_add_u32 s69, s89, 12288
  buffer_load_dwordx4 v13, s[8:11], s69 offen sc1 lds
  ds_read_b64_tr_b16 v[116:117], v5 offset:6912
  ds_read_b64_tr_b16 v[118:119], v5 offset:7104
  s_waitcnt lgkmcnt(8)
  v_mfma_f32_32x32x16_bf16 v[64:79], v[100:103], a[20:23], v[64:79]
  ds_read_b64_tr_b16 v[120:121], v5 offset:7680
  ds_read_b64_tr_b16 v[122:123], v5 offset:7872
  s_waitcnt lgkmcnt(8)
  v_mfma_f32_32x32x16_bf16 v[64:79], v[104:107], a[24:27], v[64:79]
  s_add_u32 m0, s87, 16384
  s_add_u32 s69, s89, 16384
  buffer_load_dwordx4 v13, s[8:11], s69 offen sc1 lds
  ds_read_b64_tr_b16 v[124:125], v5 offset:8448
  ds_read_b64_tr_b16 v[126:127], v5 offset:8640
  s_waitcnt lgkmcnt(8)
  v_mfma_f32_32x32x16_bf16 v[64:79], v[108:111], a[28:31], v[64:79]
  ds_read_b64_tr_b16 v[128:129], v5 offset:9216
  ds_read_b64_tr_b16 v[130:131], v5 offset:9408
  s_waitcnt lgkmcnt(8)
  v_mfma_f32_32x32x16_bf16 v[64:79], v[112:115], a[32:35], v[64:79]
  s_add_u32 m0, s87, 20480
  s_add_u32 s69, s89, 20480
  buffer_load_dwordx4 v13, s[8:11], s69 offen sc1 lds
  ds_read_b64_tr_b16 v[132:133], v5 offset:9984
  ds_read_b64_tr_b16 v[134:135], v5 offset:10176
  s_waitcnt lgkmcnt(8)
  v_mfma_f32_32x32x16_bf16 v[64:79], v[116:119], a[36:39], v[64:79]
  ds_read_b64_tr_b16 v[136:137], v5 offset:10752
  ds_read_b64_tr_b16 v[138:139], v5 offset:10944
  s_waitcnt lgkmcnt(8)
  v_mfma_f32_32x32x16_bf16 v[64:79], v[120:123], a[40:43], v[64:79]
  s_add_u32 m0, s87, 24576
  s_add_u32 s69, s89, 24576
  buffer_load_dwordx4 v13, s[8:11], s69 offen sc1 lds
  ds_read_b64_tr_b16 v[140:141], v5 offset:11520
  ds_read_b64_tr_b16 v[142:143], v5 offset:11712
  s_waitcnt lgkmcnt(8)
  v_mfma_f32_32x32x16_bf16 v[64:79], v[124:127], a[44:47], v[64:79]
  s_add_u32 m0, s87, 28672
  s_add_u32 s69, s89, 28672
  buffer_load_dwordx4 v13, s[8:11], s69 offen sc1 lds
  ds_read_b64_tr_b16 v[80:81], v5 offset:12288
  ds_read_b64_tr_b16 v[82:83], v5 offset:12480
  s_waitcnt lgkmcnt(8)
  v_mfma_f32_32x32x16_bf16 v[64:79], v[128:131], a[48:51], v[64:79]
  ds_read_b64_tr_b16 v[84:85], v5 offset:13056
  ds_read_b64_tr_b16 v[86:87], v5 offset:13248
  s_waitcnt lgkmcnt(8)
  v_mfma_f32_32x32x16_bf16 v[64:79], v[132:135], a[52:55], v[64:79]
  s_add_u32 m0, s87, 32768
  s_add_u32 s69, s89, 32768
  buffer_load_dwordx4 v13, s[8:11], s69 offen sc1 lds
  ds_read_b64_tr_b16 v[88:89], v5 offset:13824
  ds_read_b64_tr_b16 v[90:91], v5 offset:14016
  s_waitcnt lgkmcnt(8)
  v_mfma_f32_32x32x16_bf16 v[64:79], v[136:139], a[56:59], v[64:79]
  ds_read_b64_tr_b16 v[92:93], v5 offset:14592
  ds_read_b64_tr_b16 v[94:95], v5 offset:14784
  s_waitcnt lgkmcnt(8)
  v_mfma_f32_32x32x16_bf16 v[64:79], v[140:143], a[60:63], v[64:79]
  s_add_u32 m0, s87, 36864
  s_add_u32 s69, s89, 36864
  buffer_load_dwordx4 v13, s[8:11], s69 offen sc1 lds
  ds_read_b64_tr_b16 v[96:97], v5 offset:15360
  ds_read_b64_tr_b16 v[98:99], v5 offset:15552
  s_waitcnt lgkmcnt(8)
  v_mfma_f32_32x32x16_bf16 v[64:79], v[80:83], a[64:67], v[64:79]
  ds_read_b64_tr_b16 v[100:101], v5 offset:16128
  ds_read_b64_tr_b16 v[102:103], v5 offset:16320
  s_waitcnt lgkmcnt(8)
  v_mfma_f32_32x32x16_bf16 v[64:79], v[84:87], a[68:71], v[64:79]
  s_add_u32 m0, s87, 40960
  s_add_u32 s69, s89, 40960
  buffer_load_dwordx4 v13, s[8:11], s69 offen sc1 lds
  ds_read_b64_tr_b16 v[104:105], v5 offset:16896
  ds_read_b64_tr_b16 v[106:107], v5 offset:17088
  s_waitcnt lgkmcnt(8)
  v_mfma_f32_32x32x16_bf16 v[64:79], v[88:91], a[72:75], v[64:79]
  ds_read_b64_tr_b16 v[108:109], v5 offset:17664
  ds_read_b64_tr_b16 v[110:111], v5 offset:17856
  s_waitcnt lgkmcnt(8)
  v_mfma_f32_32x32x16_bf16 v[64:79], v[92:95], a[76:79], v[64:79]
  s_add_u32 m0, s87, 45056
  s_add_u32 s69, s89, 45056
  buffer_load_dwordx4 v13, s[8:11], s69 offen sc1 lds
  ds_read_b64_tr_b16 v[112:113], v5 offset:18432
  ds_read_b64_tr_b16 v[114:115], v5 offset:18624
  s_waitcnt lgkmcnt(8)
  v_mfma_f32_32x32x16_bf16 v[64:79], v[96:99], a[80:83], v[64:79]
  ds_read_b64_tr_b16 v[116:117], v5 offset:19200
  ds_read_b64_tr_b16 v[118:119], v5 offset:19392
  s_waitcnt lgkmcnt(8)
  v_mfma_f32_32x32x16_bf16 v[64:79], v[100:103], a[84:87], v[64:79]
  s_add_u32 m0, s87, 49152
  s_add_u32 s69, s89, 49152
  buffer_load_dwordx4 v13, s[8:11], s69 offen sc1 lds
  ds_read_b64_tr_b16 v[120:121], v5 offset:19968
  ds_read_b64_tr_b16 v[122:123], v5 offset:20160
  s_waitcnt lgkmcnt(8)
  v_mfma_f32_32x32x16_bf16 v[64:79], v[104:107], a[88:91], v[64:79]
  s_add_u32 m0, s87, 53248
  s_add_u32 s69, s89, 53248
  buffer_load_dwordx4 v13, s[8:11], s69 offen sc1 lds
  ds_read_b64_tr_b16 v[124:125], v5 offset:20736
  ds_read_b64_tr_b16 v[126:127], v5 offset:20928
  s_waitcnt lgkmcnt(8)
  v_mfma_f32_32x32x16_bf16 v[64:79], v[108:111], a[92:95], v[64:79]
  ds_read_b64_tr_b16 v[128:129], v5 offset:21504
  ds_read_b64_tr_b16 v[130:131], v5 offset:21696
  s_waitcnt lgkmcnt(8)
  v_mfma_f32_32x32x16_bf16 v[64:79], v[112:115], a[96:99], v[64:79]
  s_add_u32 m0, s87, 57344
  s_add_u32 s69, s89, 57344
  buffer_load_dwordx4 v13, s[8:11], s69 offen sc1 lds
  ds_read_b64_tr_b16 v[132:133], v5 offset:22272
  ds_read_b64_tr_b16 v[134:135], v5 offset:22464
  s_waitcnt lgkmcnt(8)
  v_mfma_f32_32x32x16_bf16 v[64:79], v[116:119], a[100:103], v[64:79]
  ds_read_b64_tr_b16 v[136:137], v5 offset:23040
  ds_read_b64_tr_b16 v[138:139], v5 offset:23232
  s_waitcnt lgkmcnt(8)
  v_mfma_f32_32x32x16_bf16 v[64:79], v[120:123], a[104:107], v[64:79]
  s_add_u32 m0, s87, 61440
  s_add_u32 s69, s89, 61440
  buffer_load_dwordx4 v13, s[8:11], s69 offen sc1 lds
  ds_read_b64_tr_b16 v[140:141], v5 offset:23808
  ds_read_b64_tr_b16 v[142:143], v5 offset:24000
  s_waitcnt lgkmcnt(8)
  v_mfma_f32_32x32x16_bf16 v[64:79], v[124:127], a[108:111], v[64:79]
  ds_read_b64_tr_b16 v[80:81], v5 offset:24576
  ds_read_b64_tr_b16 v[82:83], v5 offset:24768
  s_waitcnt lgkmcnt(8)
  v_mfma_f32_32x32x16_bf16 v[64:79], v[128:131], a[112:115], v[64:79]
  s_add_u32 m0, s87, 65536
  s_add_u32 s69, s89, 65536
  buffer_load_dwordx4 v13, s[8:11], s69 offen sc1 lds
  ds_read_b64_tr_b16 v[84:85], v5 offset:25344
  ds_read_b64_tr_b16 v[86:87], v5 offset:25536
  s_waitcnt lgkmcnt(8)
  v_mfma_f32_32x32x16_bf16 v[64:79], v[132:135], a[116:119], v[64:79]
  s_waitcnt vmcnt(20)
  buffer_load_dword a255, v252, s[28:31], s79 offen offset:512
  ds_read_b64_tr_b16 v[88:89], v5 offset:26112
  ds_read_b64_tr_b16 v[90:91], v5 offset:26304
  s_waitcnt lgkmcnt(8)
  v_mfma_f32_32x32x16_bf16 v[64:79], v[136:139], a[120:123], v[64:79]
  s_add_u32 m0, s87, 69632
  s_add_u32 s69, s89, 69632
  buffer_load_dwordx4 v13, s[8:11], s69 offen sc1 lds
  ds_read_b64_tr_b16 v[92:93], v5 offset:26880
  ds_read_b64_tr_b16 v[94:95], v5 offset:27072
  s_waitcnt lgkmcnt(8)
  v_mfma_f32_32x32x16_bf16 v[64:79], v[140:143], a[124:127], v[64:79]
  ds_read_b64_tr_b16 v[96:97], v5 offset:27648
  ds_read_b64_tr_b16 v[98:99], v5 offset:27840
  s_waitcnt lgkmcnt(8)
  v_mfma_f32_32x32x16_bf16 v[64:79], v[80:83], a[128:131], v[64:79]
  s_add_u32 m0, s87, 73728
  s_add_u32 s69, s89, 73728
  buffer_load_dwordx4 v13, s[8:11], s69 offen sc1 lds
  ds_read_b64_tr_b16 v[100:101], v5 offset:28416
  ds_read_b64_tr_b16 v[102:103], v5 offset:28608
  s_waitcnt lgkmcnt(8)
  v_mfma_f32_32x32x16_bf16 v[64:79], v[84:87], a[132:135], v[64:79]
  s_add_u32 m0, s87, 77824
  s_add_u32 s69, s89, 77824
  buffer_load_dwordx4 v13, s[8:11], s69 offen sc1 lds
  ds_read_b64_tr_b16 v[104:105], v5 offset:29184
  ds_read_b64_tr_b16 v[106:107], v5 offset:29376
  s_waitcnt lgkmcnt(8)
  v_mfma_f32_32x32x16_bf16 v[64:79], v[88:91], a[136:139], v[64:79]
  ds_read_b64_tr_b16 v[108:109], v5 offset:29952
  ds_read_b64_tr_b16 v[110:111], v5 offset:30144
  s_waitcnt lgkmcnt(8)
  v_mfma_f32_32x32x16_bf16 v[64:79], v[92:95], a[140:143], v[64:79]
  s_add_u32 m0, s87, 81920
  s_add_u32 s69, s89, 81920
  buffer_load_dwordx4 v13, s[8:11], s69 offen sc1 lds
  s_waitcnt lgkmcnt(6)
  v_mfma_f32_32x32x16_bf16 v[64:79], v[96:99], a[144:147], v[64:79]
  s_waitcnt lgkmcnt(4)
  v_mfma_f32_32x32x16_bf16 v[64:79], v[100:103], a[148:151], v[64:79]
  s_add_u32 m0, s87, 86016
  s_add_u32 s69, s89, 86016
  buffer_load_dwordx4 v13, s[8:11], s69 offen sc1 lds
  s_waitcnt lgkmcnt(2)
  v_mfma_f32_32x32x16_bf16 v[64:79], v[104:107], a[152:155], v[64:79]
  s_waitcnt lgkmcnt(0)
  v_mfma_f32_32x32x16_bf16 v[64:79], v[108:111], a[156:159], v[64:79]
  s_add_u32 m0, s87, 90112
  s_add_u32 s69, s89, 90112
  buffer_load_dwordx4 v13, s[8:11], s69 offen sc1 lds
  v_cvt_pk_bf16_f32 v176, v56, v57
  v_cvt_pk_bf16_f32 v177, v58, v59
  v_cvt_pk_bf16_f32 v178, v60, v61
  v_cvt_pk_bf16_f32 v179, v62, v63
  s_nop 4
  v_cvt_pk_bf16_f32 v180, v64, v65
  v_cvt_pk_bf16_f32 v181, v66, v67
  v_cvt_pk_bf16_f32 v182, v68, v69
  v_cvt_pk_bf16_f32 v183, v70, v71
  v_cvt_pk_bf16_f32 v184, v72, v73
  v_cvt_pk_bf16_f32 v185, v74, v75
  v_mov_b32 v186, 0
  v_mov_b32 v187, 0
  v_mfma_f32_32x32x16_bf16 v[144:159], a[160:163], v[176:179], 0
  v_mfma_f32_32x32x16_bf16 v[160:175], a[172:175], v[176:179], 0
  s_add_u32 m0, s87, 94208
  s_add_u32 s69, s89, 94208
  buffer_load_dwordx4 v13, s[8:11], s69 offen sc1 lds
  v_mfma_f32_32x32x16_bf16 v[144:159], a[164:167], v[180:183], v[144:159]
  v_mfma_f32_32x32x16_bf16 v[160:175], a[176:179], v[180:183], v[160:175]
  s_add_u32 m0, s87, 98304
  s_add_u32 s69, s89, 98304
  buffer_load_dwordx4 v13, s[8:11], s69 offen sc1 lds
  v_mfma_f32_32x32x16_bf16 v[144:159], a[168:171], v[184:187], v[144:159]
  v_mfma_f32_32x32x16_bf16 v[160:175], a[180:183], v[184:187], v[160:175]
  v_accvgpr_read_b32 v3, a201
  v_accvgpr_read_b32 v4, a202
  v_accvgpr_read_b32 v5, a203
  s_lshl_b32 s72, s54, 16
  s_add_u32 s72, s72, 20185088
  s_mov_b32 s82, 131072
  s_nop 4
  v_max3_f32 v6, v144, v145, v146
  v_min3_f32 v8, v144, v145, v146
  v_max3_f32 v6, v6, v147, v148
  v_min3_f32 v8, v8, v147, v148
  v_max3_f32 v6, v6, v149, v150
  v_min3_f32 v8, v8, v149, v150
  v_max3_f32 v6, v6, v151, v152
  v_min3_f32 v8, v8, v151, v152
  v_max3_f32 v6, v6, v153, v154
  v_min3_f32 v8, v8, v153, v154
  v_max3_f32 v6, v6, v155, v156
  v_min3_f32 v8, v8, v155, v156
  v_max3_f32 v6, v6, v157, v158
  v_min3_f32 v8, v8, v157, v158
  v_max3_f32 v6, v6, v159, v160
  v_min3_f32 v8, v8, v159, v160
  v_max3_f32 v6, v6, v161, v162
  v_min3_f32 v8, v8, v161, v162
  v_max_f32 v6, v6, v163
  v_min_f32 v8, v8, v163
  v_mul_f32 v6, v6, v10
  v_mul_f32 v8, v8, v10
  v_pk_fma_f32 v[188:189], v[144:145], v[10:11], v[6:7] op_sel_hi:[1,0,0] neg_lo:[0,0,1] neg_hi:[0,0,1]
  v_pk_fma_f32 v[208:209], v[144:145], v[10:11], v[8:9] op_sel_hi:[1,0,0] neg_lo:[0,1,0] neg_hi:[0,1,0]
  v_pk_fma_f32 v[190:191], v[146:147], v[10:11], v[6:7] op_sel_hi:[1,0,0] neg_lo:[0,0,1] neg_hi:[0,0,1]
  v_pk_fma_f32 v[210:211], v[146:147], v[10:11], v[8:9] op_sel_hi:[1,0,0] neg_lo:[0,1,0] neg_hi:[0,1,0]
  v_pk_fma_f32 v[192:193], v[148:149], v[10:11], v[6:7] op_sel_hi:[1,0,0] neg_lo:[0,0,1] neg_hi:[0,0,1]
  v_pk_fma_f32 v[212:213], v[148:149], v[10:11], v[8:9] op_sel_hi:[1,0,0] neg_lo:[0,1,0] neg_hi:[0,1,0]
  v_pk_fma_f32 v[194:195], v[150:151], v[10:11], v[6:7] op_sel_hi:[1,0,0] neg_lo:[0,0,1] neg_hi:[0,0,1]
  v_pk_fma_f32 v[214:215], v[150:151], v[10:11], v[8:9] op_sel_hi:[1,0,0] neg_lo:[0,1,0] neg_hi:[0,1,0]
  v_pk_fma_f32 v[196:197], v[152:153], v[10:11], v[6:7] op_sel_hi:[1,0,0] neg_lo:[0,0,1] neg_hi:[0,0,1]
  v_pk_fma_f32 v[216:217], v[152:153], v[10:11], v[8:9] op_sel_hi:[1,0,0] neg_lo:[0,1,0] neg_hi:[0,1,0]
  v_pk_fma_f32 v[198:199], v[154:155], v[10:11], v[6:7] op_sel_hi:[1,0,0] neg_lo:[0,0,1] neg_hi:[0,0,1]
  v_pk_fma_f32 v[218:219], v[154:155], v[10:11], v[8:9] op_sel_hi:[1,0,0] neg_lo:[0,1,0] neg_hi:[0,1,0]
  v_pk_fma_f32 v[200:201], v[156:157], v[10:11], v[6:7] op_sel_hi:[1,0,0] neg_lo:[0,0,1] neg_hi:[0,0,1]
  v_pk_fma_f32 v[220:221], v[156:157], v[10:11], v[8:9] op_sel_hi:[1,0,0] neg_lo:[0,1,0] neg_hi:[0,1,0]
  v_pk_fma_f32 v[202:203], v[158:159], v[10:11], v[6:7] op_sel_hi:[1,0,0] neg_lo:[0,0,1] neg_hi:[0,0,1]
  v_pk_fma_f32 v[222:223], v[158:159], v[10:11], v[8:9] op_sel_hi:[1,0,0] neg_lo:[0,1,0] neg_hi:[0,1,0]
  v_pk_fma_f32 v[204:205], v[160:161], v[10:11], v[6:7] op_sel_hi:[1,0,0] neg_lo:[0,0,1] neg_hi:[0,0,1]
  v_pk_fma_f32 v[224:225], v[160:161], v[10:11], v[8:9] op_sel_hi:[1,0,0] neg_lo:[0,1,0] neg_hi:[0,1,0]
  v_pk_fma_f32 v[206:207], v[162:163], v[10:11], v[6:7] op_sel_hi:[1,0,0] neg_lo:[0,0,1] neg_hi:[0,0,1]
  v_pk_fma_f32 v[226:227], v[162:163], v[10:11], v[8:9] op_sel_hi:[1,0,0] neg_lo:[0,1,0] neg_hi:[0,1,0]
  v_exp_f32 v188, v188
  v_exp_f32 v189, v189
  v_exp_f32 v190, v190
  v_exp_f32 v191, v191
  v_exp_f32 v192, v192
  v_exp_f32 v193, v193
  v_exp_f32 v194, v194
  v_exp_f32 v195, v195
  v_exp_f32 v196, v196
  v_exp_f32 v197, v197
  v_exp_f32 v198, v198
  v_exp_f32 v199, v199
  v_exp_f32 v200, v200
  v_exp_f32 v201, v201
  v_exp_f32 v202, v202
  v_exp_f32 v203, v203
  v_exp_f32 v204, v204
  v_exp_f32 v205, v205
  v_exp_f32 v206, v206
  v_exp_f32 v207, v207
  v_exp_f32 v208, v208
  v_exp_f32 v209, v209
  v_exp_f32 v210, v210
  v_exp_f32 v211, v211
  v_exp_f32 v212, v212
  v_exp_f32 v213, v213
  v_exp_f32 v214, v214
  v_exp_f32 v215, v215
  v_exp_f32 v216, v216
  v_exp_f32 v217, v217
  v_exp_f32 v218, v218
  v_exp_f32 v219, v219
  v_exp_f32 v220, v220
  v_exp_f32 v221, v221
  v_exp_f32 v222, v222
  v_exp_f32 v223, v223
  v_exp_f32 v224, v224
  v_exp_f32 v225, v225
  v_exp_f32 v226, v226
  v_exp_f32 v227, v227
  v_pk_add_f32 v[6:7], v[188:189], v[190:191]
  v_pk_add_f32 v[8:9], v[208:209], v[210:211]
  v_pk_add_f32 v[6:7], v[6:7], v[192:193]
  v_pk_add_f32 v[8:9], v[8:9], v[212:213]
  v_pk_add_f32 v[6:7], v[6:7], v[194:195]
  v_pk_add_f32 v[8:9], v[8:9], v[214:215]
  v_pk_add_f32 v[6:7], v[6:7], v[196:197]
  v_pk_add_f32 v[8:9], v[8:9], v[216:217]
  v_pk_add_f32 v[6:7], v[6:7], v[198:199]
  v_pk_add_f32 v[8:9], v[8:9], v[218:219]
  v_pk_add_f32 v[6:7], v[6:7], v[200:201]
  v_pk_add_f32 v[8:9], v[8:9], v[220:221]
  v_pk_add_f32 v[6:7], v[6:7], v[202:203]
  v_pk_add_f32 v[8:9], v[8:9], v[222:223]
  v_pk_add_f32 v[6:7], v[6:7], v[204:205]
  v_pk_add_f32 v[8:9], v[8:9], v[224:225]
  v_pk_add_f32 v[6:7], v[6:7], v[206:207]
  v_pk_add_f32 v[8:9], v[8:9], v[226:227]
  v_add_f32 v6, v6, v7
  v_add_f32 v8, v8, v9
  v_rcp_f32 v6, v6
  v_rcp_f32 v8, v8
  v_pk_mul_f32 v[188:189], v[188:189], v[6:7] op_sel_hi:[1,0]
  v_pk_mul_f32 v[190:191], v[190:191], v[6:7] op_sel_hi:[1,0]
  v_pk_mul_f32 v[192:193], v[192:193], v[6:7] op_sel_hi:[1,0]
  v_pk_mul_f32 v[194:195], v[194:195], v[6:7] op_sel_hi:[1,0]
  v_pk_mul_f32 v[196:197], v[196:197], v[6:7] op_sel_hi:[1,0]
  v_pk_mul_f32 v[198:199], v[198:199], v[6:7] op_sel_hi:[1,0]
  v_pk_mul_f32 v[200:201], v[200:201], v[6:7] op_sel_hi:[1,0]
  v_pk_mul_f32 v[202:203], v[202:203], v[6:7] op_sel_hi:[1,0]
  v_pk_mul_f32 v[204:205], v[204:205], v[6:7] op_sel_hi:[1,0]
  v_pk_mul_f32 v[206:207], v[206:207], v[6:7] op_sel_hi:[1,0]
  v_pk_mul_f32 v[208:209], v[208:209], v[8:9] op_sel_hi:[1,0]
  v_pk_mul_f32 v[210:211], v[210:211], v[8:9] op_sel_hi:[1,0]
  v_pk_mul_f32 v[212:213], v[212:213], v[8:9] op_sel_hi:[1,0]
  v_pk_mul_f32 v[214:215], v[214:215], v[8:9] op_sel_hi:[1,0]
  v_pk_mul_f32 v[216:217], v[216:217], v[8:9] op_sel_hi:[1,0]
  v_pk_mul_f32 v[218:219], v[218:219], v[8:9] op_sel_hi:[1,0]
  v_pk_mul_f32 v[220:221], v[220:221], v[8:9] op_sel_hi:[1,0]
  v_pk_mul_f32 v[222:223], v[222:223], v[8:9] op_sel_hi:[1,0]
  v_pk_mul_f32 v[224:225], v[224:225], v[8:9] op_sel_hi:[1,0]
  v_pk_mul_f32 v[226:227], v[226:227], v[8:9] op_sel_hi:[1,0]
  v_cvt_pk_bf16_f32 v228, v188, v189
  v_cvt_pk_bf16_f32 v229, v190, v191
  v_cvt_pk_bf16_f32 v230, v192, v193
  v_cvt_pk_bf16_f32 v231, v194, v195
  v_cvt_pk_bf16_f32 v232, v196, v197
  v_cvt_pk_bf16_f32 v233, v198, v199
  v_cvt_pk_bf16_f32 v234, v200, v201
  v_cvt_pk_bf16_f32 v235, v202, v203
  v_cvt_pk_bf16_f32 v236, v204, v205
  v_cvt_pk_bf16_f32 v237, v206, v207
  v_cvt_pk_bf16_f32 v238, v208, v209
  v_cvt_pk_bf16_f32 v239, v210, v211
  v_cvt_pk_bf16_f32 v240, v212, v213
  v_cvt_pk_bf16_f32 v241, v214, v215
  v_cvt_pk_bf16_f32 v242, v216, v217
  v_cvt_pk_bf16_f32 v243, v218, v219
  v_cvt_pk_bf16_f32 v244, v220, v221
  v_cvt_pk_bf16_f32 v245, v222, v223
  v_cvt_pk_bf16_f32 v246, v224, v225
  v_cvt_pk_bf16_f32 v247, v226, v227
  v_accvgpr_read_b32 v192, a224
  v_accvgpr_read_b32 v193, a225
  v_accvgpr_read_b32 v194, a226
  v_accvgpr_read_b32 v195, a227
  v_accvgpr_read_b32 v196, a228
  v_accvgpr_read_b32 v197, a229
  s_add_u32 s66, s72, 0
  buffer_load_dwordx4 v[80:83], v5, s[8:11], s66 offen sc1
  s_add_u32 s66, s72, 4096
  buffer_load_dwordx4 v[84:87], v5, s[8:11], s66 offen sc1
  s_add_u32 s66, s72, 8192
  buffer_load_dwordx4 v[88:91], v5, s[8:11], s66 offen sc1
  s_add_u32 s66, s72, 12288
  buffer_load_dwordx4 v[92:95], v5, s[8:11], s66 offen sc1
  s_add_u32 s66, s72, 16384
  buffer_load_dwordx4 v[96:99], v5, s[8:11], s66 offen sc1
  s_add_u32 s66, s72, 20480
  buffer_load_dwordx4 v[100:103], v5, s[8:11], s66 offen sc1
  s_add_u32 s66, s72, 24576
  buffer_load_dwordx4 v[104:107], v5, s[8:11], s66 offen sc1
  s_add_u32 s66, s72, 28672
  buffer_load_dwordx4 v[108:111], v5, s[8:11], s66 offen sc1
  s_add_u32 s66, s72, 32768
  buffer_load_dwordx4 v[112:115], v5, s[8:11], s66 offen sc1
  s_add_u32 s66, s72, 36864
  buffer_load_dwordx4 v[116:119], v5, s[8:11], s66 offen sc1
  s_add_u32 s66, s72, 40960
  buffer_load_dwordx4 v[120:123], v5, s[8:11], s66 offen sc1
  s_add_u32 s66, s72, 45056
  buffer_load_dwordx4 v[124:127], v5, s[8:11], s66 offen sc1
  s_add_u32 s66, s72, 49152
  buffer_load_dwordx4 v[128:131], v5, s[8:11], s66 offen sc1
  s_add_u32 s66, s72, 53248
  buffer_load_dwordx4 v[132:135], v5, s[8:11], s66 offen sc1
  s_add_u32 s66, s72, 57344
  buffer_load_dwordx4 v[136:139], v5, s[8:11], s66 offen sc1
  s_add_u32 s66, s72, 61440
  buffer_load_dwordx4 v[140:143], v5, s[8:11], s66 offen sc1
  buffer_load_dword v14, v4, s[8:11], 0 offen sc1
  v_and_b32 v6, 31, v1
  v_lshrrev_b32 v7, 5, v1
  v_bfe_u32 v8, v6, 2, 1
  v_and_b32 v9, 3, v6
  v_lshrrev_b32 v6, 3, v6
  v_lshl_add_u32 v9, v6, 2, v9
  v_mad_u32_u24 v6, v7, 21, v9
  v_mul_u32_u24 v6, 80, v6
  v_cmp_eq_u32 vcc, v7, v8
  v_mov_b32 v8, 3360
  s_nop 0
  v_cndmask_b32 v6, v8, v6, vcc
  v_cmp_gt_u32 s[66:67], 5, v9
  s_and_b64 vcc, vcc, s[66:67]
  v_add_u32 v9, 1280, v6
  v_cndmask_b32 v9, v8, v9, vcc
  v_add_u32 v6, 102400, v6
  v_add_u32 v9, 102400, v9
VC210:
  s_waitcnt vmcnt(15)
  v_max3_u32 v2, v80, v83, v84
  s_waitcnt vmcnt(14)
  v_max3_u32 v2, v2, v87, v88
  s_waitcnt vmcnt(13)
  v_max3_u32 v2, v2, v91, v92
  v_max_u32 v2, v2, v95
  v_cmp_eq_u32 vcc, -1, v2
  s_cbranch_vccnz VR211
VK212:
  v_mfma_f32_32x32x16_bf16 v[144:159], v[248:251], v[80:83], 0
  v_mfma_f32_32x32x16_bf16 v[160:175], v[248:251], v[84:87], 0
  v_mfma_f32_32x32x16_bf16 v[144:159], v[248:251], v[88:91], v[144:159]
  v_mfma_f32_32x32x16_bf16 v[160:175], v[248:251], v[92:95], v[160:175]
VC213:
  s_waitcnt vmcnt(11)
  v_max3_u32 v2, v96, v99, v100
  s_waitcnt vmcnt(10)
  v_max3_u32 v2, v2, v103, v104
  s_waitcnt vmcnt(9)
  v_max3_u32 v2, v2, v107, v108
  v_max_u32 v2, v2, v111
  v_cmp_eq_u32 vcc, -1, v2
  s_cbranch_vccnz VR214
VK215:
  v_mfma_f32_32x32x16_bf16 v[144:159], v[248:251], v[96:99], v[144:159]
  v_mfma_f32_32x32x16_bf16 v[160:175], v[248:251], v[100:103], v[160:175]
  v_mfma_f32_32x32x16_bf16 v[144:159], v[248:251], v[104:107], v[144:159]
  v_mfma_f32_32x32x16_bf16 v[160:175], v[248:251], v[108:111], v[160:175]
VC216:
  s_waitcnt vmcnt(7)
  v_max3_u32 v2, v112, v115, v116
  s_waitcnt vmcnt(6)
  v_max3_u32 v2, v2, v119, v120
  s_waitcnt vmcnt(5)
  v_max3_u32 v2, v2, v123, v124
  v_max_u32 v2, v2, v127
  v_cmp_eq_u32 vcc, -1, v2
  s_cbranch_vccnz VR217
VK218:
  v_mfma_f32_32x32x16_bf16 v[144:159], v[248:251], v[112:115], v[144:159]
  v_mfma_f32_32x32x16_bf16 v[160:175], v[248:251], v[116:119], v[160:175]
  v_mfma_f32_32x32x16_bf16 v[144:159], v[248:251], v[120:123], v[144:159]
  v_mfma_f32_32x32x16_bf16 v[160:175], v[248:251], v[124:127], v[160:175]
VC219:
  s_waitcnt vmcnt(3)
  v_max3_u32 v2, v128, v131, v132
  s_waitcnt vmcnt(2)
  v_max3_u32 v2, v2, v135, v136
  s_waitcnt vmcnt(1)
  v_max3_u32 v2, v2, v139, v140
  v_max_u32 v2, v2, v143
  v_cmp_eq_u32 vcc, -1, v2
  s_cbranch_vccnz VR220
VK221:
  v_mfma_f32_32x32x16_bf16 v[144:159], v[248:251], v[128:131], v[144:159]
  v_mfma_f32_32x32x16_bf16 v[160:175], v[248:251], v[132:135], v[160:175]
  v_mfma_f32_32x32x16_bf16 v[144:159], v[248:251], v[136:139], v[144:159]
  v_mfma_f32_32x32x16_bf16 v[160:175], v[248:251], v[140:143], v[160:175]
  s_nop 11
  v_pk_add_f32 v[144:145], v[144:145], v[160:161]
  v_pk_add_f32 v[146:147], v[146:147], v[162:163]
  v_pk_add_f32 v[148:149], v[148:149], v[164:165]
  v_pk_add_f32 v[150:151], v[150:151], v[166:167]
  v_cvt_pk_bf16_f32 v176, v144, v145
  v_cvt_pk_bf16_f32 v177, v146, v147
  v_cvt_pk_bf16_f32 v178, v148, v149
  v_cvt_pk_bf16_f32 v179, v150, v151
  ds_write_b128 v3, v[176:179]
  s_waitcnt lgkmcnt(0)
  s_barrier
  ds_read_b128 v[80:83], v6 offset:0
  ds_read_b128 v[84:87], v9 offset:0
  ds_read_b128 v[88:91], v6 offset:16
  ds_read_b128 v[92:95], v9 offset:16
  ds_read_b128 v[96:99], v6 offset:32
  ds_read_b128 v[100:103], v9 offset:32
  ds_read_b128 v[104:107], v6 offset:48
  ds_read_b128 v[108:111], v9 offset:48
  ds_read_b128 v[112:115], v6 offset:64
  ds_read_b128 v[116:119], v9 offset:64
  v_accvgpr_read_b32 v2, a230
  v_accvgpr_read_b32 v3, a231
  s_waitcnt lgkmcnt(8)
  v_mfma_f32_32x32x16_bf16 v[160:175], v[84:87], v[228:231], 0
  s_mov_b32 s78, s60
  s_mul_i32 s78, s78, 96
  s_add_u32 m0, s85, 0
  s_nop 0
  buffer_load_dwordx4 v192, s[28:31], s78 offen offset:0 lds
  v_mfma_f32_32x32x16_bf16 v[144:159], v[80:83], v[228:231], 0
  buffer_load_dwordx4 v193, s[28:31], s78 offen offset:1056 lds
  s_waitcnt lgkmcnt(6)
  v_mfma_f32_32x32x16_bf16 v[160:175], v[92:95], v[232:235], v[160:175]
  buffer_load_dwordx4 v194, s[28:31], s78 offen offset:2112 lds
  v_mfma_f32_32x32x16_bf16 v[144:159], v[88:91], v[232:235], v[144:159]
  buffer_load_dwordx4 v195, s[28:31], s78 offen offset:3168 lds
  s_waitcnt lgkmcnt(4)
  v_mfma_f32_32x32x16_bf16 v[160:175], v[100:103], v[236:239], v[160:175]
  v_mfma_f32_32x32x16_bf16 v[144:159], v[96:99], v[236:239], v[144:159]
  s_add_u32 s78, s60, 1024
  s_and_b32 s78, s78, 0x3fff
  s_mul_i32 s78, s78, 96
  s_add_u32 m0, s85, 4224
  s_nop 0
  buffer_load_dwordx4 v192, s[28:31], s78 offen offset:0 lds
  s_waitcnt lgkmcnt(2)
  v_mfma_f32_32x32x16_bf16 v[160:175], v[108:111], v[240:243], v[160:175]
  buffer_load_dwordx4 v193, s[28:31], s78 offen offset:1056 lds
  v_mfma_f32_32x32x16_bf16 v[144:159], v[104:107], v[240:243], v[144:159]
  buffer_load_dwordx4 v194, s[28:31], s78 offen offset:2112 lds
  s_waitcnt lgkmcnt(0)
  v_mfma_f32_32x32x16_bf16 v[160:175], v[116:119], v[244:247], v[160:175]
  v_mfma_f32_32x32x16_bf16 v[144:159], v[112:115], v[244:247], v[144:159]
  buffer_load_dwordx4 v195, s[28:31], s78 offen offset:3168 lds
  s_nop 9
  v_add_f32 v8, 0x358637bd, v164
  v_rcp_f32 v8, v8
  s_nop 0
  v_pk_mul_f32 v[144:145], v[144:145], v[8:9] op_sel_hi:[1,0]
  s_nop 0
  v_cvt_pk_bf16_f32 v176, v144, v145
  v_pk_mul_f32 v[146:147], v[146:147], v[8:9] op_sel_hi:[1,0]
  s_nop 0
  v_cvt_pk_bf16_f32 v177, v146, v147
  v_pk_mul_f32 v[148:149], v[148:149], v[8:9] op_sel_hi:[1,0]
  s_nop 0
  v_cvt_pk_bf16_f32 v178, v148, v149
  v_pk_mul_f32 v[150:151], v[150:151], v[8:9] op_sel_hi:[1,0]
  s_nop 0
  v_cvt_pk_bf16_f32 v179, v150, v151
  v_pk_mul_f32 v[152:153], v[152:153], v[8:9] op_sel_hi:[1,0]
  s_nop 0
  v_cvt_pk_bf16_f32 v180, v152, v153
  v_pk_mul_f32 v[154:155], v[154:155], v[8:9] op_sel_hi:[1,0]
  s_nop 0
  v_cvt_pk_bf16_f32 v181, v154, v155
  v_pk_mul_f32 v[156:157], v[156:157], v[8:9] op_sel_hi:[1,0]
  s_nop 0
  v_cvt_pk_bf16_f32 v182, v156, v157
  v_pk_mul_f32 v[158:159], v[158:159], v[8:9] op_sel_hi:[1,0]
  s_nop 0
  v_cvt_pk_bf16_f32 v183, v158, v159
  v_pk_mul_f32 v[160:161], v[160:161], v[8:9] op_sel_hi:[1,0]
  s_nop 0
  v_cvt_pk_bf16_f32 v184, v160, v161
  v_pk_mul_f32 v[162:163], v[162:163], v[8:9] op_sel_hi:[1,0]
  s_nop 0
  v_cvt_pk_bf16_f32 v185, v162, v163
  buffer_store_dwordx4 v[176:179], v2, s[8:11], s94 offen sc1
  buffer_store_dwordx4 v[180:183], v2, s[8:11], s94 offen offset:256 sc1
  buffer_store_dwordx2 v[184:185], v3, s[8:11], s94 offen offset:512 sc1
  s_waitcnt vmcnt(11)
  v_subrev_u32 v14, s83, v14
  v_cmp_le_u32 vcc, 128, v14
  s_cbranch_vccnz FC222
FK223:
  v_accvgpr_read_b32 v236, a184
  v_accvgpr_read_b32 v237, a185
  v_accvgpr_read_b32 v238, a186
  v_accvgpr_read_b32 v239, a187
  v_accvgpr_read_b32 v240, a188
  v_accvgpr_read_b32 v241, a189
  v_accvgpr_read_b32 v242, a190
  v_accvgpr_read_b32 v243, a191
  v_accvgpr_read_b32 v244, a192
  v_accvgpr_read_b32 v245, a193
  s_mul_i32 s75, s59, 20480
  s_add_u32 s75, s75, 21233664
  v_lshrrev_b32 v4, 2, v1
  v_lshlrev_b32 v4, 5, v4
  v_and_b32 v5, 3, v1
  v_lshl_add_u32 v4, v5, 3, v4
  v_add_u32 v5, 61440, v4
  v_add_u32 v6, 106496, v4
  s_mov_b32 s82, 131072
  v_lshlrev_b32 v16, 16, v236
  v_and_b32 v17, 0xffff0000, v236
  v_lshlrev_b32 v18, 16, v237
  v_and_b32 v19, 0xffff0000, v237
  v_lshlrev_b32 v20, 16, v238
  v_and_b32 v21, 0xffff0000, v238
  v_lshlrev_b32 v22, 16, v239
  v_and_b32 v23, 0xffff0000, v239
  v_lshlrev_b32 v24, 16, v240
  v_and_b32 v25, 0xffff0000, v240
  v_lshlrev_b32 v26, 16, v241
  v_and_b32 v27, 0xffff0000, v241
  v_lshlrev_b32 v28, 16, v242
  v_and_b32 v29, 0xffff0000, v242
  v_lshlrev_b32 v30, 16, v243
  v_and_b32 v31, 0xffff0000, v243
  v_lshlrev_b32 v32, 16, v244
  v_and_b32 v33, 0xffff0000, v244
  v_lshlrev_b32 v34, 16, v245
  v_and_b32 v35, 0xffff0000, v245
  s_waitcnt vmcnt(3)
  ds_read_b64_tr_b16 a[0:1], v196 offset:0
  ds_read_b64_tr_b16 a[2:3], v196 offset:512
  ds_read_b64_tr_b16 a[4:5], v196 offset:32
  ds_read_b64_tr_b16 a[6:7], v196 offset:544
  ds_read_b64_tr_b16 a[8:9], v196 offset:64
  ds_read_b64_tr_b16 a[10:11], v196 offset:576
  ds_read_b64_tr_b16 a[12:13], v196 offset:96
  ds_read_b64_tr_b16 a[14:15], v196 offset:608
  ds_read_b64_tr_b16 a[16:17], v196 offset:4224
  ds_read_b64_tr_b16 a[18:19], v196 offset:4736
  ds_read_b64_tr_b16 a[20:21], v196 offset:4256
  ds_read_b64_tr_b16 a[22:23], v196 offset:4768
  ds_read_b64_tr_b16 a[24:25], v196 offset:4288
  ds_read_b64_tr_b16 a[26:27], v196 offset:4800
  ds_read_b64_tr_b16 a[28:29], v196 offset:4320
  ds_read_b64_tr_b16 a[30:31], v196 offset:4832
  s_waitcnt lgkmcnt(0)
  ds_read_b64_tr_b16 a[96:97], v4 offset:0
  ds_read_b64_tr_b16 a[98:99], v4 offset:512
  ds_read_b64_tr_b16 a[100:101], v4 offset:20480
  ds_read_b64_tr_b16 a[102:103], v4 offset:20992
  ds_read_b64_tr_b16 a[104:105], v4 offset:40960
  ds_read_b64_tr_b16 a[106:107], v4 offset:41472
  s_add_u32 s78, s60, 2048
  s_and_b32 s78, s78, 0x3fff
  s_mul_i32 s78, s78, 96
  s_add_u32 m0, s85, 0
  s_nop 0
  buffer_load_dwordx4 v192, s[28:31], s78 offen offset:0 lds
  ds_read_b64_tr_b16 a[108:109], v5 offset:0
  ds_read_b64_tr_b16 a[110:111], v5 offset:512
  ds_read_b64_tr_b16 a[112:113], v5 offset:20480
  ds_read_b64_tr_b16 a[114:115], v5 offset:20992
  ds_read_b64_tr_b16 a[116:117], v4 offset:1024
  ds_read_b64_tr_b16 a[118:119], v4 offset:1536
  buffer_load_dwordx4 v193, s[28:31], s78 offen offset:1056 lds
  ds_read_b64_tr_b16 a[120:121], v4 offset:21504
  ds_read_b64_tr_b16 a[122:123], v4 offset:22016
  ds_read_b64_tr_b16 a[124:125], v4 offset:41984
  ds_read_b64_tr_b16 a[126:127], v4 offset:42496
  ds_read_b64_tr_b16 a[128:129], v5 offset:1024
  ds_read_b64_tr_b16 a[130:131], v5 offset:1536
  buffer_load_dwordx4 v194, s[28:31], s78 offen offset:2112 lds
  ds_read_b64_tr_b16 a[132:133], v5 offset:21504
  ds_read_b64_tr_b16 a[134:135], v5 offset:22016
  ds_read_b64_tr_b16 a[136:137], v4 offset:2048
  ds_read_b64_tr_b16 a[138:139], v4 offset:2560
  ds_read_b64_tr_b16 a[140:141], v4 offset:22528
  ds_read_b64_tr_b16 a[142:143], v4 offset:23040
  buffer_load_dwordx4 v195, s[28:31], s78 offen offset:3168 lds
  ds_read_b64_tr_b16 a[144:145], v4 offset:43008
  ds_read_b64_tr_b16 a[146:147], v4 offset:43520
  ds_read_b64_tr_b16 a[148:149], v5 offset:2048
  ds_read_b64_tr_b16 a[150:151], v5 offset:2560
  ds_read_b64_tr_b16 a[152:153], v5 offset:22528
  ds_read_b64_tr_b16 a[154:155], v5 offset:23040
  s_add_u32 s78, s60, 3072
  s_and_b32 s78, s78, 0x3fff
  s_mul_i32 s78, s78, 96
  s_add_u32 m0, s85, 4224
  s_nop 0
  buffer_load_dwordx4 v192, s[28:31], s78 offen offset:0 lds
  ds_read_b64_tr_b16 a[156:157], v4 offset:3072
  ds_read_b64_tr_b16 a[158:159], v4 offset:3584
  ds_read_b64_tr_b16 a[160:161], v4 offset:23552
  ds_read_b64_tr_b16 a[162:163], v4 offset:24064
  ds_read_b64_tr_b16 a[164:165], v4 offset:44032
  ds_read_b64_tr_b16 a[166:167], v4 offset:44544
  buffer_load_dwordx4 v193, s[28:31], s78 offen offset:1056 lds
  ds_read_b64_tr_b16 a[168:169], v5 offset:3072
  ds_read_b64_tr_b16 a[170:171], v5 offset:3584
  ds_read_b64_tr_b16 a[172:173], v5 offset:23552
  ds_read_b64_tr_b16 a[174:175], v5 offset:24064
  ds_read_b64_tr_b16 a[176:177], v4 offset:4096
  ds_read_b64_tr_b16 a[178:179], v4 offset:4608
  buffer_load_dwordx4 v194, s[28:31], s78 offen offset:2112 lds
  ds_read_b64_tr_b16 a[180:181], v4 offset:24576
  ds_read_b64_tr_b16 a[182:183], v4 offset:25088
  ds_read_b64_tr_b16 a[184:185], v4 offset:45056
  ds_read_b64_tr_b16 a[186:187], v4 offset:45568
  ds_read_b64_tr_b16 a[188:189], v5 offset:4096
  ds_read_b64_tr_b16 a[190:191], v5 offset:4608
  buffer_load_dwordx4 v195, s[28:31], s78 offen offset:3168 lds
  ds_read_b64_tr_b16 a[192:193], v5 offset:24576
  ds_read_b64_tr_b16 a[194:195], v5 offset:25088
  ds_read_b64_tr_b16 a[196:197], v4 offset:5120
  ds_read_b64_tr_b16 a[198:199], v4 offset:5632
  ds_read_b64_tr_b16 a[200:201], v4 offset:25600
  ds_read_b64_tr_b16 a[202:203], v4 offset:26112
  s_add_u32 s77, s75, 0
  buffer_load_dwordx4 v[48:51], v13, s[8:11], s77 offen offset:0 sc1
  ds_read_b64_tr_b16 a[204:205], v4 offset:46080
  ds_read_b64_tr_b16 a[206:207], v4 offset:46592
  ds_read_b64_tr_b16 a[208:209], v5 offset:5120
  ds_read_b64_tr_b16 a[210:211], v5 offset:5632
  ds_read_b64_tr_b16 a[212:213], v5 offset:25600
  ds_read_b64_tr_b16 a[214:215], v5 offset:26112
  s_add_u32 s77, s75, 0
  buffer_load_dwordx4 v[52:55], v13, s[8:11], s77 offen offset:1024 sc1
  ds_read_b64_tr_b16 a[216:217], v4 offset:6144
  ds_read_b64_tr_b16 a[218:219], v4 offset:6656
  ds_read_b64_tr_b16 a[220:221], v4 offset:26624
  ds_read_b64_tr_b16 a[222:223], v4 offset:27136
  ds_read_b64_tr_b16 a[224:225], v4 offset:47104
  ds_read_b64_tr_b16 a[226:227], v4 offset:47616
  s_add_u32 s77, s75, 0
  buffer_load_dwordx4 v[56:59], v13, s[8:11], s77 offen offset:2048 sc1
  ds_read_b64_tr_b16 a[228:229], v5 offset:6144
  ds_read_b64_tr_b16 a[230:231], v5 offset:6656
  ds_read_b64_tr_b16 a[232:233], v5 offset:26624
  ds_read_b64_tr_b16 a[234:235], v5 offset:27136
  ds_read_b64_tr_b16 a[236:237], v4 offset:7168
  ds_read_b64_tr_b16 a[238:239], v4 offset:7680
  s_add_u32 s77, s75, 0
  buffer_load_dwordx4 v[60:63], v13, s[8:11], s77 offen offset:3072 sc1
  ds_read_b64_tr_b16 a[240:241], v4 offset:27648
  ds_read_b64_tr_b16 a[242:243], v4 offset:28160
  ds_read_b64_tr_b16 a[244:245], v4 offset:48128
  ds_read_b64_tr_b16 a[246:247], v4 offset:48640
  ds_read_b64_tr_b16 a[248:249], v5 offset:7168
  ds_read_b64_tr_b16 a[250:251], v5 offset:7680
  s_add_u32 s77, s75, 4096
  buffer_load_dwordx4 v[64:67], v13, s[8:11], s77 offen offset:0 sc1
  s_add_u32 s77, s75, 4096
  buffer_load_dwordx4 v[68:71], v13, s[8:11], s77 offen offset:1024 sc1
  s_add_u32 s77, s75, 4096
  buffer_load_dwordx4 v[72:75], v13, s[8:11], s77 offen offset:2048 sc1
  s_add_u32 s77, s75, 4096
  buffer_load_dwordx4 v[76:79], v13, s[8:11], s77 offen offset:3072 sc1
VC226:
  s_waitcnt vmcnt(6)
  v_max3_u32 v8, v48, v51, v52
  v_max_u32 v8, v8, v55
  v_cmp_eq_u32 vcc, -1, v8
  s_cbranch_vccnz VR227
VK228:
  ds_read_b64_tr_b16 v[156:157], v5 offset:27648
  ds_read_b64_tr_b16 v[158:159], v5 offset:28160
  ds_read_b64_tr_b16 v[160:161], v4 offset:8192
  ds_read_b64_tr_b16 v[162:163], v4 offset:8704
  ds_read_b64_tr_b16 v[164:165], v4 offset:28672
  ds_read_b64_tr_b16 v[166:167], v4 offset:29184
  ds_read_b64_tr_b16 v[168:169], v4 offset:49152
  ds_read_b64_tr_b16 v[170:171], v4 offset:49664
  ds_read_b64_tr_b16 v[172:173], v5 offset:8192
  ds_read_b64_tr_b16 v[174:175], v5 offset:8704
  ds_read_b64_tr_b16 v[176:177], v5 offset:28672
  ds_read_b64_tr_b16 v[178:179], v5 offset:29184
  ds_read_b64_tr_b16 v[180:181], v4 offset:9216
  ds_read_b64_tr_b16 v[182:183], v4 offset:9728
  ds_read_b64_tr_b16 v[184:185], v4 offset:29696
  ds_read_b64_tr_b16 v[186:187], v4 offset:30208
  ds_read_b64_tr_b16 v[188:189], v4 offset:50176
  ds_read_b64_tr_b16 v[190:191], v4 offset:50688
  ds_read_b64_tr_b16 v[128:129], v5 offset:9216
  ds_read_b64_tr_b16 v[130:131], v5 offset:9728
  ds_read_b64_tr_b16 v[132:133], v5 offset:29696
  ds_read_b64_tr_b16 v[134:135], v5 offset:30208
  ds_read_b64_tr_b16 v[136:137], v4 offset:10240
  ds_read_b64_tr_b16 v[138:139], v4 offset:10752
  ds_read_b64_tr_b16 v[140:141], v4 offset:30720
  ds_read_b64_tr_b16 v[142:143], v4 offset:31232
  ds_read_b64_tr_b16 v[144:145], v4 offset:51200
  ds_read_b64_tr_b16 v[146:147], v4 offset:51712
  s_waitcnt lgkmcnt(15)
  v_mfma_f32_16x16x32_bf16 v[16:19], a[96:99], v[48:51], v[16:19]
  s_add_u32 s77, s75, 8192
  buffer_load_dwordx4 v[80:83], v13, s[8:11], s77 offen offset:0 sc1
  v_mfma_f32_16x16x32_bf16 v[20:23], a[100:103], v[48:51], v[20:23]
  ds_read_b64_tr_b16 a[32:33], v196 offset:0
  v_mfma_f32_16x16x32_bf16 v[24:27], a[104:107], v[48:51], v[24:27]
  ds_read_b64_tr_b16 a[34:35], v196 offset:512
  v_mfma_f32_16x16x32_bf16 v[28:31], a[108:111], v[48:51], v[28:31]
  s_add_u32 s77, s75, 8192
  buffer_load_dwordx4 v[84:87], v13, s[8:11], s77 offen offset:1024 sc1
  v_mfma_f32_16x16x32_bf16 v[32:35], a[112:115], v[48:51], v[32:35]
  ds_read_b64_tr_b16 a[36:37], v196 offset:32
  v_mfma_f32_16x16x32_bf16 v[16:19], a[116:119], v[52:55], v[16:19]
  v_mfma_f32_16x16x32_bf16 v[20:23], a[120:123], v[52:55], v[20:23]
  s_add_u32 s77, s75, 8192
  buffer_load_dwordx4 v[88:91], v13, s[8:11], s77 offen offset:2048 sc1
  ds_read_b64_tr_b16 a[38:39], v196 offset:544
  v_mfma_f32_16x16x32_bf16 v[24:27], a[124:127], v[52:55], v[24:27]
  v_mfma_f32_16x16x32_bf16 v[28:31], a[128:131], v[52:55], v[28:31]
  ds_read_b64_tr_b16 a[40:41], v196 offset:64
  v_mfma_f32_16x16x32_bf16 v[32:35], a[132:135], v[52:55], v[32:35]
  s_add_u32 s77, s75, 8192
  buffer_load_dwordx4 v[92:95], v13, s[8:11], s77 offen offset:3072 sc1
VC229:
  s_waitcnt vmcnt(8)
  v_max3_u32 v8, v56, v59, v60
  v_max_u32 v8, v8, v63
  v_cmp_eq_u32 vcc, -1, v8
  s_cbranch_vccnz VR230
VK231:
  v_mfma_f32_16x16x32_bf16 v[16:19], a[136:139], v[56:59], v[16:19]
  ds_read_b64_tr_b16 a[42:43], v196 offset:576
  v_mfma_f32_16x16x32_bf16 v[20:23], a[140:143], v[56:59], v[20:23]
  v_mfma_f32_16x16x32_bf16 v[24:27], a[144:147], v[56:59], v[24:27]
  s_add_u32 s77, s75, 12288
  buffer_load_dwordx4 v[96:99], v13, s[8:11], s77 offen offset:0 sc1
  ds_read_b64_tr_b16 a[44:45], v196 offset:96
  v_mfma_f32_16x16x32_bf16 v[28:31], a[148:151], v[56:59], v[28:31]
  v_mfma_f32_16x16x32_bf16 v[32:35], a[152:155], v[56:59], v[32:35]
  ds_read_b64_tr_b16 a[46:47], v196 offset:608
  v_mfma_f32_16x16x32_bf16 v[16:19], a[156:159], v[60:63], v[16:19]
  s_add_u32 s77, s75, 12288
  buffer_load_dwordx4 v[100:103], v13, s[8:11], s77 offen offset:1024 sc1
  ds_read_b64_tr_b16 a[48:49], v196 offset:4224
  v_mfma_f32_16x16x32_bf16 v[20:23], a[160:163], v[60:63], v[20:23]
  v_mfma_f32_16x16x32_bf16 v[24:27], a[164:167], v[60:63], v[24:27]
  ds_read_b64_tr_b16 a[50:51], v196 offset:4736
  v_mfma_f32_16x16x32_bf16 v[28:31], a[168:171], v[60:63], v[28:31]
  s_add_u32 s77, s75, 12288
  buffer_load_dwordx4 v[104:107], v13, s[8:11], s77 offen offset:2048 sc1
  v_mfma_f32_16x16x32_bf16 v[32:35], a[172:175], v[60:63], v[32:35]
  ds_read_b64_tr_b16 a[52:53], v196 offset:4256
VC232:
  s_waitcnt vmcnt(9)
  v_max3_u32 v8, v64, v67, v68
  v_max_u32 v8, v8, v71
  v_cmp_eq_u32 vcc, -1, v8
  s_cbranch_vccnz VR233
VK234:
  v_mfma_f32_16x16x32_bf16 v[16:19], a[176:179], v[64:67], v[16:19]
  v_mfma_f32_16x16x32_bf16 v[20:23], a[180:183], v[64:67], v[20:23]
  s_add_u32 s77, s75, 12288
  buffer_load_dwordx4 v[108:111], v13, s[8:11], s77 offen offset:3072 sc1
  ds_read_b64_tr_b16 a[54:55], v196 offset:4768
  v_mfma_f32_16x16x32_bf16 v[24:27], a[184:187], v[64:67], v[24:27]
  v_mfma_f32_16x16x32_bf16 v[28:31], a[188:191], v[64:67], v[28:31]
  ds_read_b64_tr_b16 a[56:57], v196 offset:4288
  v_mfma_f32_16x16x32_bf16 v[32:35], a[192:195], v[64:67], v[32:35]
  s_add_u32 s77, s75, 16384
  buffer_load_dwordx4 v[112:115], v13, s[8:11], s77 offen offset:0 sc1
  v_mfma_f32_16x16x32_bf16 v[16:19], a[196:199], v[68:71], v[16:19]
  ds_read_b64_tr_b16 a[58:59], v196 offset:4800
  v_mfma_f32_16x16x32_bf16 v[20:23], a[200:203], v[68:71], v[20:23]
  v_mfma_f32_16x16x32_bf16 v[24:27], a[204:207], v[68:71], v[24:27]
  s_add_u32 s77, s75, 16384
  buffer_load_dwordx4 v[116:119], v13, s[8:11], s77 offen offset:1024 sc1
  ds_read_b64_tr_b16 a[60:61], v196 offset:4320
  v_mfma_f32_16x16x32_bf16 v[28:31], a[208:211], v[68:71], v[28:31]
  v_mfma_f32_16x16x32_bf16 v[32:35], a[212:215], v[68:71], v[32:35]
  ds_read_b64_tr_b16 a[62:63], v196 offset:4832
VC235:
  s_waitcnt vmcnt(10)
  v_max3_u32 v8, v72, v75, v76
  v_max_u32 v8, v8, v79
  v_cmp_eq_u32 vcc, -1, v8
  s_cbranch_vccnz VR236
VK237:
  v_mfma_f32_16x16x32_bf16 v[16:19], a[216:219], v[72:75], v[16:19]
  s_add_u32 s77, s75, 16384
  buffer_load_dwordx4 v[120:123], v13, s[8:11], s77 offen offset:2048 sc1
  v_mfma_f32_16x16x32_bf16 v[20:23], a[220:223], v[72:75], v[20:23]
  v_mfma_f32_16x16x32_bf16 v[24:27], a[224:227], v[72:75], v[24:27]
  v_mfma_f32_16x16x32_bf16 v[28:31], a[228:231], v[72:75], v[28:31]
  s_add_u32 s77, s75, 16384
  buffer_load_dwordx4 v[124:127], v13, s[8:11], s77 offen offset:3072 sc1
  v_mfma_f32_16x16x32_bf16 v[32:35], a[232:235], v[72:75], v[32:35]
  v_mfma_f32_16x16x32_bf16 v[16:19], a[236:239], v[76:79], v[16:19]
  v_mfma_f32_16x16x32_bf16 v[20:23], a[240:243], v[76:79], v[20:23]
  v_mfma_f32_16x16x32_bf16 v[24:27], a[244:247], v[76:79], v[24:27]
  s_waitcnt lgkmcnt(0)
  s_add_u32 s78, s60, 4096
  s_and_b32 s78, s78, 0x3fff
  s_mul_i32 s78, s78, 96
  s_add_u32 m0, s85, 0
  s_nop 0
  buffer_load_dwordx4 v192, s[28:31], s78 offen offset:0 lds
  v_mfma_f32_16x16x32_bf16 v[28:31], a[248:251], v[76:79], v[28:31]
  v_mfma_f32_16x16x32_bf16 v[32:35], v[156:159], v[76:79], v[32:35]
VC238:
  s_waitcnt vmcnt(11)
  v_max3_u32 v8, v80, v83, v84
  v_max_u32 v8, v8, v87
  v_cmp_eq_u32 vcc, -1, v8
  s_cbranch_vccnz VR239
VK240:
  v_mfma_f32_16x16x32_bf16 v[16:19], v[160:163], v[80:83], v[16:19]
  ds_read_b64_tr_b16 v[148:149], v5 offset:10240
  ds_read_b64_tr_b16 v[150:151], v5 offset:10752
  v_mfma_f32_16x16x32_bf16 v[20:23], v[164:167], v[80:83], v[20:23]
  buffer_load_dwordx4 v193, s[28:31], s78 offen offset:1056 lds
  ds_read_b64_tr_b16 v[152:153], v5 offset:30720
  ds_read_b64_tr_b16 v[154:155], v5 offset:31232
  v_mfma_f32_16x16x32_bf16 v[24:27], v[168:171], v[80:83], v[24:27]
  ds_read_b64_tr_b16 v[156:157], v4 offset:11264
  ds_read_b64_tr_b16 v[158:159], v4 offset:11776
  v_mfma_f32_16x16x32_bf16 v[28:31], v[172:175], v[80:83], v[28:31]
  ds_read_b64_tr_b16 v[160:161], v4 offset:31744
  ds_read_b64_tr_b16 v[162:163], v4 offset:32256
  v_mfma_f32_16x16x32_bf16 v[32:35], v[176:179], v[80:83], v[32:35]
  ds_read_b64_tr_b16 v[164:165], v4 offset:52224
  ds_read_b64_tr_b16 v[166:167], v4 offset:52736
  v_mfma_f32_16x16x32_bf16 v[16:19], v[180:183], v[84:87], v[16:19]
  ds_read_b64_tr_b16 v[168:169], v5 offset:11264
  ds_read_b64_tr_b16 v[170:171], v5 offset:11776
  v_mfma_f32_16x16x32_bf16 v[20:23], v[184:187], v[84:87], v[20:23]
  buffer_load_dwordx4 v194, s[28:31], s78 offen offset:2112 lds
  ds_read_b64_tr_b16 v[172:173], v5 offset:31744
  ds_read_b64_tr_b16 v[174:175], v5 offset:32256
  v_mfma_f32_16x16x32_bf16 v[24:27], v[188:191], v[84:87], v[24:27]
  ds_read_b64_tr_b16 v[176:177], v4 offset:12288
  ds_read_b64_tr_b16 v[178:179], v4 offset:12800
  v_mfma_f32_16x16x32_bf16 v[28:31], v[128:131], v[84:87], v[28:31]
  ds_read_b64_tr_b16 v[180:181], v4 offset:32768
  ds_read_b64_tr_b16 v[182:183], v4 offset:33280
  v_mfma_f32_16x16x32_bf16 v[32:35], v[132:135], v[84:87], v[32:35]
VC241:
  s_waitcnt vmcnt(11)
  v_max3_u32 v8, v88, v91, v92
  v_max_u32 v8, v8, v95
  v_cmp_eq_u32 vcc, -1, v8
  s_cbranch_vccnz VR242
VK243:
  ds_read_b64_tr_b16 v[184:185], v4 offset:53248
  ds_read_b64_tr_b16 v[186:187], v4 offset:53760
  v_mfma_f32_16x16x32_bf16 v[16:19], v[136:139], v[88:91], v[16:19]
  buffer_load_dwordx4 v195, s[28:31], s78 offen offset:3168 lds
  ds_read_b64_tr_b16 v[188:189], v5 offset:12288
  ds_read_b64_tr_b16 v[190:191], v5 offset:12800
  v_mfma_f32_16x16x32_bf16 v[20:23], v[140:143], v[88:91], v[20:23]
  ds_read_b64_tr_b16 v[128:129], v5 offset:32768
  ds_read_b64_tr_b16 v[130:131], v5 offset:33280
  v_mfma_f32_16x16x32_bf16 v[24:27], v[144:147], v[88:91], v[24:27]
  ds_read_b64_tr_b16 v[132:133], v4 offset:13312
  ds_read_b64_tr_b16 v[134:135], v4 offset:13824
  s_waitcnt lgkmcnt(15)
  v_mfma_f32_16x16x32_bf16 v[28:31], v[148:151], v[88:91], v[28:31]
  ds_read_b64_tr_b16 v[136:137], v4 offset:33792
  ds_read_b64_tr_b16 v[138:139], v4 offset:34304
  v_mfma_f32_16x16x32_bf16 v[32:35], v[152:155], v[88:91], v[32:35]
  ds_read_b64_tr_b16 v[140:141], v4 offset:54272
  ds_read_b64_tr_b16 v[142:143], v4 offset:54784
  v_mfma_f32_16x16x32_bf16 v[16:19], v[156:159], v[92:95], v[16:19]
  s_add_u32 s78, s60, 5120
  s_and_b32 s78, s78, 0x3fff
  s_mul_i32 s78, s78, 96
  s_add_u32 m0, s85, 4224
  s_nop 0
  buffer_load_dwordx4 v192, s[28:31], s78 offen offset:0 lds
  ds_read_b64_tr_b16 v[144:145], v5 offset:13312
  ds_read_b64_tr_b16 v[146:147], v5 offset:13824
  v_mfma_f32_16x16x32_bf16 v[20:23], v[160:163], v[92:95], v[20:23]
  ds_read_b64_tr_b16 v[148:149], v5 offset:33792
  ds_read_b64_tr_b16 v[150:151], v5 offset:34304
  v_mfma_f32_16x16x32_bf16 v[24:27], v[164:167], v[92:95], v[24:27]
  ds_read_b64_tr_b16 v[152:153], v4 offset:14336
  ds_read_b64_tr_b16 v[154:155], v4 offset:14848
  s_waitcnt lgkmcnt(15)
  v_mfma_f32_16x16x32_bf16 v[28:31], v[168:171], v[92:95], v[28:31]
  ds_read_b64_tr_b16 v[156:157], v4 offset:34816
  ds_read_b64_tr_b16 v[158:159], v4 offset:35328
  v_mfma_f32_16x16x32_bf16 v[32:35], v[172:175], v[92:95], v[32:35]
  buffer_load_dwordx4 v193, s[28:31], s78 offen offset:1056 lds
VC244:
  s_waitcnt vmcnt(12)
  v_max3_u32 v8, v96, v99, v100
  v_max_u32 v8, v8, v103
  v_cmp_eq_u32 vcc, -1, v8
  s_cbranch_vccnz VR245
VK246:
  ds_read_b64_tr_b16 v[160:161], v4 offset:55296
  ds_read_b64_tr_b16 v[162:163], v4 offset:55808
  v_mfma_f32_16x16x32_bf16 v[16:19], v[176:179], v[96:99], v[16:19]
  ds_read_b64_tr_b16 v[164:165], v5 offset:14336
  ds_read_b64_tr_b16 v[166:167], v5 offset:14848
  v_mfma_f32_16x16x32_bf16 v[20:23], v[180:183], v[96:99], v[20:23]
  ds_read_b64_tr_b16 v[168:169], v5 offset:34816
  ds_read_b64_tr_b16 v[170:171], v5 offset:35328
  v_mfma_f32_16x16x32_bf16 v[24:27], v[184:187], v[96:99], v[24:27]
  ds_read_b64_tr_b16 v[172:173], v4 offset:15360
  ds_read_b64_tr_b16 v[174:175], v4 offset:15872
  s_waitcnt lgkmcnt(15)
  v_mfma_f32_16x16x32_bf16 v[28:31], v[188:191], v[96:99], v[28:31]
  ds_read_b64_tr_b16 v[176:177], v4 offset:35840
  ds_read_b64_tr_b16 v[178:179], v4 offset:36352
  v_mfma_f32_16x16x32_bf16 v[32:35], v[128:131], v[96:99], v[32:35]
  buffer_load_dwordx4 v194, s[28:31], s78 offen offset:2112 lds
  ds_read_b64_tr_b16 v[180:181], v4 offset:56320
  ds_read_b64_tr_b16 v[182:183], v4 offset:56832
  v_mfma_f32_16x16x32_bf16 v[16:19], v[132:135], v[100:103], v[16:19]
  ds_read_b64_tr_b16 v[184:185], v5 offset:15360
  ds_read_b64_tr_b16 v[186:187], v5 offset:15872
  v_mfma_f32_16x16x32_bf16 v[20:23], v[136:139], v[100:103], v[20:23]
  ds_read_b64_tr_b16 v[188:189], v5 offset:35840
  ds_read_b64_tr_b16 v[190:191], v5 offset:36352
  v_mfma_f32_16x16x32_bf16 v[24:27], v[140:143], v[100:103], v[24:27]
  ds_read_b64_tr_b16 v[128:129], v4 offset:16384
  ds_read_b64_tr_b16 v[130:131], v4 offset:16896
  s_waitcnt lgkmcnt(15)
  v_mfma_f32_16x16x32_bf16 v[28:31], v[144:147], v[100:103], v[28:31]
  ds_read_b64_tr_b16 v[132:133], v4 offset:36864
  ds_read_b64_tr_b16 v[134:135], v4 offset:37376
  v_mfma_f32_16x16x32_bf16 v[32:35], v[148:151], v[100:103], v[32:35]
  buffer_load_dwordx4 v195, s[28:31], s78 offen offset:3168 lds
VC247:
  s_waitcnt vmcnt(12)
  v_max3_u32 v8, v104, v107, v108
  v_max_u32 v8, v8, v111
  v_cmp_eq_u32 vcc, -1, v8
  s_cbranch_vccnz VR248
VK249:
  ds_read_b64_tr_b16 v[136:137], v4 offset:57344
  ds_read_b64_tr_b16 v[138:139], v4 offset:57856
  v_mfma_f32_16x16x32_bf16 v[16:19], v[152:155], v[104:107], v[16:19]
  ds_read_b64_tr_b16 v[140:141], v5 offset:16384
  ds_read_b64_tr_b16 v[142:143], v5 offset:16896
  v_mfma_f32_16x16x32_bf16 v[20:23], v[156:159], v[104:107], v[20:23]
  ds_read_b64_tr_b16 v[144:145], v5 offset:36864
  ds_read_b64_tr_b16 v[146:147], v5 offset:37376
  v_mfma_f32_16x16x32_bf16 v[24:27], v[160:163], v[104:107], v[24:27]
  ds_read_b64_tr_b16 v[148:149], v4 offset:17408
  ds_read_b64_tr_b16 v[150:151], v4 offset:17920
  s_waitcnt lgkmcnt(15)
  v_mfma_f32_16x16x32_bf16 v[28:31], v[164:167], v[104:107], v[28:31]
  ds_read_b64_tr_b16 v[152:153], v4 offset:37888
  ds_read_b64_tr_b16 v[154:155], v4 offset:38400
  v_mfma_f32_16x16x32_bf16 v[32:35], v[168:171], v[104:107], v[32:35]
  ds_read_b64_tr_b16 v[156:157], v4 offset:58368
  ds_read_b64_tr_b16 v[158:159], v4 offset:58880
  v_mfma_f32_16x16x32_bf16 v[16:19], v[172:175], v[108:111], v[16:19]
  ds_read_b64_tr_b16 v[160:161], v5 offset:17408
  ds_read_b64_tr_b16 v[162:163], v5 offset:17920
  v_mfma_f32_16x16x32_bf16 v[20:23], v[176:179], v[108:111], v[20:23]
  ds_read_b64_tr_b16 v[164:165], v5 offset:37888
  ds_read_b64_tr_b16 v[166:167], v5 offset:38400
  v_mfma_f32_16x16x32_bf16 v[24:27], v[180:183], v[108:111], v[24:27]
  ds_read_b64_tr_b16 v[168:169], v4 offset:18432
  ds_read_b64_tr_b16 v[170:171], v4 offset:18944
  s_waitcnt lgkmcnt(15)
  v_mfma_f32_16x16x32_bf16 v[28:31], v[184:187], v[108:111], v[28:31]
  ds_read_b64_tr_b16 v[172:173], v4 offset:38912
  ds_read_b64_tr_b16 v[174:175], v4 offset:39424
  v_mfma_f32_16x16x32_bf16 v[32:35], v[188:191], v[108:111], v[32:35]
VC250:
  s_waitcnt vmcnt(10)
  v_max3_u32 v8, v112, v115, v116
  v_max_u32 v8, v8, v119
  v_cmp_eq_u32 vcc, -1, v8
  s_cbranch_vccnz VR251
VK252:
  ds_read_b64_tr_b16 v[176:177], v4 offset:59392
  ds_read_b64_tr_b16 v[178:179], v4 offset:59904
  v_mfma_f32_16x16x32_bf16 v[16:19], v[128:131], v[112:115], v[16:19]
  ds_read_b64_tr_b16 v[180:181], v5 offset:18432
  ds_read_b64_tr_b16 v[182:183], v5 offset:18944
  v_mfma_f32_16x16x32_bf16 v[20:23], v[132:135], v[112:115], v[20:23]
  ds_read_b64_tr_b16 v[184:185], v5 offset:38912
  ds_read_b64_tr_b16 v[186:187], v5 offset:39424
  v_mfma_f32_16x16x32_bf16 v[24:27], v[136:139], v[112:115], v[24:27]
  ds_read_b64_tr_b16 v[188:189], v4 offset:19456
  ds_read_b64_tr_b16 v[190:191], v4 offset:19968
  s_waitcnt lgkmcnt(15)
  v_mfma_f32_16x16x32_bf16 v[28:31], v[140:143], v[112:115], v[28:31]
  ds_read_b64_tr_b16 v[128:129], v4 offset:39936
  ds_read_b64_tr_b16 v[130:131], v4 offset:40448
  v_mfma_f32_16x16x32_bf16 v[32:35], v[144:147], v[112:115], v[32:35]
  ds_read_b64_tr_b16 v[132:133], v4 offset:60416
  ds_read_b64_tr_b16 v[134:135], v4 offset:60928
  v_mfma_f32_16x16x32_bf16 v[16:19], v[148:151], v[116:119], v[16:19]
  ds_read_b64_tr_b16 v[136:137], v5 offset:19456
  ds_read_b64_tr_b16 v[138:139], v5 offset:19968
  v_mfma_f32_16x16x32_bf16 v[20:23], v[152:155], v[116:119], v[20:23]
  ds_read_b64_tr_b16 v[140:141], v5 offset:39936
  ds_read_b64_tr_b16 v[142:143], v5 offset:40448
  v_mfma_f32_16x16x32_bf16 v[24:27], v[156:159], v[116:119], v[24:27]
  s_waitcnt lgkmcnt(15)
  v_mfma_f32_16x16x32_bf16 v[28:31], v[160:163], v[116:119], v[28:31]
  v_mfma_f32_16x16x32_bf16 v[32:35], v[164:167], v[116:119], v[32:35]
VC253:
  s_waitcnt vmcnt(8)
  v_max3_u32 v8, v120, v123, v124
  v_max_u32 v8, v8, v127
  v_cmp_eq_u32 vcc, -1, v8
  s_cbranch_vccnz VR254
VK255:
  v_mfma_f32_16x16x32_bf16 v[16:19], v[168:171], v[120:123], v[16:19]
  v_mfma_f32_16x16x32_bf16 v[20:23], v[172:175], v[120:123], v[20:23]
  s_waitcnt lgkmcnt(14)
  v_mfma_f32_16x16x32_bf16 v[24:27], v[176:179], v[120:123], v[24:27]
  s_waitcnt lgkmcnt(12)
  v_mfma_f32_16x16x32_bf16 v[28:31], v[180:183], v[120:123], v[28:31]
  s_waitcnt lgkmcnt(10)
  v_mfma_f32_16x16x32_bf16 v[32:35], v[184:187], v[120:123], v[32:35]
  s_waitcnt lgkmcnt(8)
  v_mfma_f32_16x16x32_bf16 v[16:19], v[188:191], v[124:127], v[16:19]
  s_waitcnt lgkmcnt(6)
  v_mfma_f32_16x16x32_bf16 v[20:23], v[128:131], v[124:127], v[20:23]
  s_waitcnt lgkmcnt(4)
  v_mfma_f32_16x16x32_bf16 v[24:27], v[132:135], v[124:127], v[24:27]
  s_waitcnt lgkmcnt(2)
  v_mfma_f32_16x16x32_bf16 v[28:31], v[136:139], v[124:127], v[28:31]
  s_waitcnt lgkmcnt(0)
  v_mfma_f32_16x16x32_bf16 v[32:35], v[140:143], v[124:127], v[32:35]
  v_cvt_pk_bf16_f32 v236, v16, v17
  v_cvt_pk_bf16_f32 v237, v18, v19
  v_cvt_pk_bf16_f32 v238, v20, v21
  v_cvt_pk_bf16_f32 v239, v22, v23
  v_cvt_pk_bf16_f32 v240, v24, v25
  v_cvt_pk_bf16_f32 v241, v26, v27
  v_cvt_pk_bf16_f32 v242, v28, v29
  v_cvt_pk_bf16_f32 v243, v30, v31
  v_cvt_pk_bf16_f32 v244, v32, v33
  v_cvt_pk_bf16_f32 v245, v34, v35
  v_lshlrev_b32 v16, 16, v236
  v_and_b32 v17, 0xffff0000, v236
  v_lshlrev_b32 v18, 16, v237
  v_and_b32 v19, 0xffff0000, v237
  v_lshlrev_b32 v20, 16, v238
  v_and_b32 v21, 0xffff0000, v238
  v_lshlrev_b32 v22, 16, v239
  v_and_b32 v23, 0xffff0000, v239
  v_lshlrev_b32 v24, 16, v240
  v_and_b32 v25, 0xffff0000, v240
  v_lshlrev_b32 v26, 16, v241
  v_and_b32 v27, 0xffff0000, v241
  v_lshlrev_b32 v28, 16, v242
  v_and_b32 v29, 0xffff0000, v242
  v_lshlrev_b32 v30, 16, v243
  v_and_b32 v31, 0xffff0000, v243
  v_lshlrev_b32 v32, 16, v244
  v_and_b32 v33, 0xffff0000, v244
  v_lshlrev_b32 v34, 16, v245
  v_and_b32 v35, 0xffff0000, v245
  v_pk_add_f32 v[8:9], v[16:17], v[18:19]
  v_pk_mul_f32 v[10:11], v[16:17], v[16:17]
  v_pk_fma_f32 v[10:11], v[18:19], v[18:19], v[10:11]
  v_pk_add_f32 v[8:9], v[8:9], v[20:21]
  v_pk_fma_f32 v[10:11], v[20:21], v[20:21], v[10:11]
  v_pk_add_f32 v[8:9], v[8:9], v[22:23]
  v_pk_fma_f32 v[10:11], v[22:23], v[22:23], v[10:11]
  v_pk_add_f32 v[8:9], v[8:9], v[24:25]
  v_pk_fma_f32 v[10:11], v[24:25], v[24:25], v[10:11]
  v_pk_add_f32 v[8:9], v[8:9], v[26:27]
  v_pk_fma_f32 v[10:11], v[26:27], v[26:27], v[10:11]
  v_pk_add_f32 v[8:9], v[8:9], v[28:29]
  v_pk_fma_f32 v[10:11], v[28:29], v[28:29], v[10:11]
  v_pk_add_f32 v[8:9], v[8:9], v[30:31]
  v_pk_fma_f32 v[10:11], v[30:31], v[30:31], v[10:11]
  v_pk_add_f32 v[8:9], v[8:9], v[32:33]
  v_pk_fma_f32 v[10:11], v[32:33], v[32:33], v[10:11]
  v_pk_add_f32 v[8:9], v[8:9], v[34:35]
  v_pk_fma_f32 v[10:11], v[34:35], v[34:35], v[10:11]
  v_add_f32 v8, v8, v9
  v_add_f32 v9, v10, v11
  v_mov_b32 v10, v8
  v_mov_b32 v11, v9
  s_nop 0
  v_permlane16_swap_b32 v8, v10
  v_permlane16_swap_b32 v9, v11
  v_add_f32 v8, v8, v10
  v_add_f32 v9, v9, v11
  v_mov_b32 v10, v8
  v_mov_b32 v11, v9
  s_nop 0
  v_permlane32_swap_b32 v8, v10
  v_permlane32_swap_b32 v9, v11
  v_add_f32 v8, v8, v10
  v_add_f32 v9, v9, v11
  v_lshlrev_b32 v12, 3, v1
  v_cmp_gt_u32 vcc, 16, v1
  v_mov_b32 v14, 1073741824
  s_nop 0
  v_cndmask_b32 v14, v14, v12, vcc
  s_lshl_b32 s76, s59, 10
  s_add_u32 s76, s76, 23855104
  s_lshl_b32 s77, s55, 7
  s_add_u32 s77, s77, s76
  buffer_store_dwordx2 v[8:9], v14, s[8:11], s77 offen sc1
  s_barrier
  s_or_b32 s66, s2, s52
  s_cmp_eq_u32 s66, 0
  s_cselect_b32 s66, 0, 1073741824
  v_mov_b32 v14, 0
  buffer_store_dword v14, off, s[48:51], s66 sc1
  s_add_u32 s78, s60, 6144
  s_and_b32 s78, s78, 0x3fff
  s_mul_i32 s78, s78, 96
  s_add_u32 m0, s84, 0
  s_nop 0
  buffer_load_dwordx4 v192, s[28:31], s78 offen offset:0 lds
  buffer_load_dwordx4 v193, s[28:31], s78 offen offset:1056 lds
  buffer_load_dwordx4 v194, s[28:31], s78 offen offset:2112 lds
  buffer_load_dwordx4 v195, s[28:31], s78 offen offset:3168 lds
  s_add_u32 s78, s60, 7168
  s_and_b32 s78, s78, 0x3fff
  s_mul_i32 s78, s78, 96
  s_add_u32 m0, s84, 4224
  s_nop 0
  buffer_load_dwordx4 v192, s[28:31], s78 offen offset:0 lds
  buffer_load_dwordx4 v193, s[28:31], s78 offen offset:1056 lds
  buffer_load_dwordx4 v194, s[28:31], s78 offen offset:2112 lds
  buffer_load_dwordx4 v195, s[28:31], s78 offen offset:3168 lds
  s_add_u32 s78, s60, 8192
  s_and_b32 s78, s78, 0x3fff
  s_mul_i32 s78, s78, 96
  s_add_u32 m0, s84, 8448
  s_nop 0
  buffer_load_dwordx4 v192, s[28:31], s78 offen offset:0 lds
  buffer_load_dwordx4 v193, s[28:31], s78 offen offset:1056 lds
  buffer_load_dwordx4 v194, s[28:31], s78 offen offset:2112 lds
  buffer_load_dwordx4 v195, s[28:31], s78 offen offset:3168 lds
  s_add_u32 s78, s60, 9216
  s_and_b32 s78, s78, 0x3fff
  s_mul_i32 s78, s78, 96
  s_add_u32 m0, s84, 12672
  s_nop 0
  buffer_load_dwordx4 v192, s[28:31], s78 offen offset:0 lds
  buffer_load_dwordx4 v193, s[28:31], s78 offen offset:1056 lds
  buffer_load_dwordx4 v194, s[28:31], s78 offen offset:2112 lds
  buffer_load_dwordx4 v195, s[28:31], s78 offen offset:3168 lds
  s_waitcnt vmcnt(18)
  ds_read_b64_tr_b16 a[64:65], v196 offset:0
  ds_read_b64_tr_b16 a[66:67], v196 offset:512
  ds_read_b64_tr_b16 a[68:69], v196 offset:32
  ds_read_b64_tr_b16 a[70:71], v196 offset:544
  ds_read_b64_tr_b16 a[72:73], v196 offset:64
  ds_read_b64_tr_b16 a[74:75], v196 offset:576
  ds_read_b64_tr_b16 a[76:77], v196 offset:96
  ds_read_b64_tr_b16 a[78:79], v196 offset:608
  ds_read_b64_tr_b16 a[80:81], v196 offset:4224
  ds_read_b64_tr_b16 a[82:83], v196 offset:4736
  ds_read_b64_tr_b16 a[84:85], v196 offset:4256
  ds_read_b64_tr_b16 a[86:87], v196 offset:4768
  ds_read_b64_tr_b16 a[88:89], v196 offset:4288
  ds_read_b64_tr_b16 a[90:91], v196 offset:4800
  ds_read_b64_tr_b16 a[92:93], v196 offset:4320
  ds_read_b64_tr_b16 a[94:95], v196 offset:4832
  v_and_b32 v12, 15, v1
  v_lshlrev_b32 v12, 3, v12
  v_lshrrev_b32 v14, 4, v1
  v_lshl_add_u32 v12, v14, 8, v12
  v_and_b32 v7, 15, v1
  v_lshlrev_b32 v7, 5, v7
  v_lshl_add_u32 v7, v14, 3, v7
  s_lshl_b32 s66, s52, 9
  s_add_u32 s66, s66, 106496
  v_add_u32 v7, s66, v7
  v_add_u32 v6, s87, v6
  s_mul_i32 s70, s55, 5
  s_lshr_b32 s68, s52, 1
  s_add_u32 s70, s70, s68
  s_lshl_b32 s70, s70, 16
  s_lshl_b32 s68, s56, 1
  s_and_b32 s69, s52, 1
  s_add_u32 s68, s68, s69
  s_lshl_b32 s68, s68, 10
  s_add_u32 s70, s70, s68
  s_add_u32 s70, s70, 23986176
  s_add_u32 s71, s70, 131072
  s_add_u32 s72, s70, 262144
  s_cmp_lt_u32 s52, 2
  s_cselect_b32 s72, s72, 1073741824
  s_mov_b32 s67, 262144
  buffer_load_dwordx2 v[48:49], v12, s[8:11], s76 offen sc1
  buffer_load_dwordx2 v[50:51], v12, s[8:11], s76 offen offset:128 sc1
  s_waitcnt vmcnt(1)
  v_cmp_eq_u32 vcc, -1, v48
  s_waitcnt vmcnt(0)
  v_cmp_eq_u32 s[68:69], -1, v50
  s_or_b64 vcc, vcc, s[68:69]
  s_cmp_eq_u64 vcc, 0
  s_cbranch_scc0 P256
PD257:
  v_add_f32 v8, v48, v50
  v_add_f32 v9, v49, v51
  v_mov_b32 v10, v8
  v_mov_b32 v11, v9
  s_nop 0
  v_permlane16_swap_b32 v8, v10
  v_permlane16_swap_b32 v9, v11
  v_add_f32 v8, v8, v10
  v_add_f32 v9, v9, v11
  v_mov_b32 v10, v8
  v_mov_b32 v11, v9
  s_nop 0
  v_permlane32_swap_b32 v8, v10
  v_permlane32_swap_b32 v9, v11
  v_add_f32 v8, v8, v10
  v_add_f32 v9, v9, v11
  v_mul_f32 v8, 0xbacccccd, v8
  v_mul_f32 v9, 0x3acccccd, v9
  v_fma_f32 v9, -v8, v8, v9
  v_max_f32 v9, 0, v9
  v_add_f32 v10, 0x3727c5ac, v9
  v_rsq_f32 v10, v10
  s_nop 0
  v_mul_f32 v9, v9, v10
  v_mov_b32 v11, 0x3727c5ac
  v_fma_f32 v9, v9, v10, v11
  v_rsq_f32 v9, v9
  s_nop 0
  v_mul_f32 v10, v10, v9
  v_mul_f32 v8, v8, v10
  v_pk_fma_f32 v[16:17], v[16:17], v[10:11], v[8:9] op_sel_hi:[1,0,0]
  s_nop 0
  v_cvt_pk_bf16_f32 v36, v16, v17
  v_pk_fma_f32 v[18:19], v[18:19], v[10:11], v[8:9] op_sel_hi:[1,0,0]
  s_nop 0
  v_cvt_pk_bf16_f32 v37, v18, v19
  v_pk_fma_f32 v[20:21], v[20:21], v[10:11], v[8:9] op_sel_hi:[1,0,0]
  s_nop 0
  v_cvt_pk_bf16_f32 v38, v20, v21
  v_pk_fma_f32 v[22:23], v[22:23], v[10:11], v[8:9] op_sel_hi:[1,0,0]
  s_nop 0
  v_cvt_pk_bf16_f32 v39, v22, v23
  v_pk_fma_f32 v[24:25], v[24:25], v[10:11], v[8:9] op_sel_hi:[1,0,0]
  s_nop 0
  v_cvt_pk_bf16_f32 v40, v24, v25
  v_pk_fma_f32 v[26:27], v[26:27], v[10:11], v[8:9] op_sel_hi:[1,0,0]
  s_nop 0
  v_cvt_pk_bf16_f32 v41, v26, v27
  v_pk_fma_f32 v[28:29], v[28:29], v[10:11], v[8:9] op_sel_hi:[1,0,0]
  s_nop 0
  v_cvt_pk_bf16_f32 v42, v28, v29
  v_pk_fma_f32 v[30:31], v[30:31], v[10:11], v[8:9] op_sel_hi:[1,0,0]
  s_nop 0
  v_cvt_pk_bf16_f32 v43, v30, v31
  v_pk_fma_f32 v[32:33], v[32:33], v[10:11], v[8:9] op_sel_hi:[1,0,0]
  s_nop 0
  v_cvt_pk_bf16_f32 v44, v32, v33
  v_pk_fma_f32 v[34:35], v[34:35], v[10:11], v[8:9] op_sel_hi:[1,0,0]
  s_nop 0
  v_cvt_pk_bf16_f32 v45, v34, v35
  ds_write_b64 v7, v[36:37] offset:0
  ds_write_b64 v7, v[38:39] offset:2048
  ds_write_b64 v7, v[40:41] offset:4096
  ds_write_b64 v7, v[42:43] offset:6144
  ds_write_b64 v7, v[44:45] offset:8192
  s_waitcnt lgkmcnt(0)
  s_barrier
  ds_read_b64_tr_b16 v[48:49], v6 offset:0
  ds_read_b64_tr_b16 v[50:51], v6 offset:512
  ds_read_b64_tr_b16 v[52:53], v6 offset:4096
  ds_read_b64_tr_b16 v[54:55], v6 offset:4608
  ds_read_b64_tr_b16 v[56:57], v6 offset:8192
  ds_read_b64_tr_b16 v[58:59], v6 offset:8704
  s_waitcnt lgkmcnt(4)
  buffer_store_dwordx4 v[48:51], v13, s[8:11], s70 offen sc1
  s_waitcnt lgkmcnt(2)
  buffer_store_dwordx4 v[52:55], v13, s[8:11], s71 offen sc1
  s_waitcnt lgkmcnt(0)
  buffer_store_dwordx4 v[56:59], v13, s[8:11], s72 offen sc1
  ds_read_b64_tr_b16 a[96:97], v197 offset:0
  ds_read_b64_tr_b16 a[98:99], v197 offset:512
  ds_read_b64_tr_b16 a[100:101], v197 offset:32
  ds_read_b64_tr_b16 a[102:103], v197 offset:544
  ds_read_b64_tr_b16 a[104:105], v197 offset:64
  ds_read_b64_tr_b16 a[106:107], v197 offset:576
  ds_read_b64_tr_b16 a[108:109], v197 offset:96
  ds_read_b64_tr_b16 a[110:111], v197 offset:608
  ds_read_b64_tr_b16 a[112:113], v197 offset:4224
  ds_read_b64_tr_b16 a[114:115], v197 offset:4736
  ds_read_b64_tr_b16 a[116:117], v197 offset:4256
  ds_read_b64_tr_b16 a[118:119], v197 offset:4768
  ds_read_b64_tr_b16 a[120:121], v197 offset:4288
  ds_read_b64_tr_b16 a[122:123], v197 offset:4800
  ds_read_b64_tr_b16 a[124:125], v197 offset:4320
  ds_read_b64_tr_b16 a[126:127], v197 offset:4832
  ds_read_b64_tr_b16 a[128:129], v197 offset:8448
  ds_read_b64_tr_b16 a[130:131], v197 offset:8960
  ds_read_b64_tr_b16 a[132:133], v197 offset:8480
  ds_read_b64_tr_b16 a[134:135], v197 offset:8992
  ds_read_b64_tr_b16 a[136:137], v197 offset:8512
  ds_read_b64_tr_b16 a[138:139], v197 offset:9024
  ds_read_b64_tr_b16 a[140:141], v197 offset:8544
  ds_read_b64_tr_b16 a[142:143], v197 offset:9056
  ds_read_b64_tr_b16 a[144:145], v197 offset:12672
  ds_read_b64_tr_b16 a[146:147], v197 offset:13184
  ds_read_b64_tr_b16 a[148:149], v197 offset:12704
  ds_read_b64_tr_b16 a[150:151], v197 offset:13216
  ds_read_b64_tr_b16 a[152:153], v197 offset:12736
  ds_read_b64_tr_b16 a[154:155], v197 offset:13248
  ds_read_b64_tr_b16 a[156:157], v197 offset:12768
  ds_read_b64_tr_b16 a[158:159], v197 offset:13280
  s_add_u32 s78, s60, 10240
  s_and_b32 s78, s78, 0x3fff
  s_mul_i32 s78, s78, 96
  s_add_u32 m0, s84, 16896
  s_nop 0
  buffer_load_dwordx4 v192, s[28:31], s78 offen offset:0 lds
  buffer_load_dwordx4 v193, s[28:31], s78 offen offset:1056 lds
  buffer_load_dwordx4 v194, s[28:31], s78 offen offset:2112 lds
  buffer_load_dwordx4 v195, s[28:31], s78 offen offset:3168 lds
  s_add_u32 s78, s60, 11264
  s_and_b32 s78, s78, 0x3fff
  s_mul_i32 s78, s78, 96
  s_add_u32 m0, s84, 21120
  s_nop 0
  buffer_load_dwordx4 v192, s[28:31], s78 offen offset:0 lds
  buffer_load_dwordx4 v193, s[28:31], s78 offen offset:1056 lds
  buffer_load_dwordx4 v194, s[28:31], s78 offen offset:2112 lds
  buffer_load_dwordx4 v195, s[28:31], s78 offen offset:3168 lds
  s_add_u32 s78, s60, 12288
  s_and_b32 s78, s78, 0x3fff
  s_mul_i32 s78, s78, 96
  s_add_u32 m0, s85, 0
  s_nop 0
  buffer_load_dwordx4 v192, s[28:31], s78 offen offset:0 lds
  buffer_load_dwordx4 v193, s[28:31], s78 offen offset:1056 lds
  buffer_load_dwordx4 v194, s[28:31], s78 offen offset:2112 lds
  buffer_load_dwordx4 v195, s[28:31], s78 offen offset:3168 lds
  s_add_u32 s78, s60, 13312
  s_and_b32 s78, s78, 0x3fff
  s_mul_i32 s78, s78, 96
  s_add_u32 m0, s85, 4224
  s_nop 0
  buffer_load_dwordx4 v192, s[28:31], s78 offen offset:0 lds
  buffer_load_dwordx4 v193, s[28:31], s78 offen offset:1056 lds
  buffer_load_dwordx4 v194, s[28:31], s78 offen offset:2112 lds
  buffer_load_dwordx4 v195, s[28:31], s78 offen offset:3168 lds
  s_waitcnt lgkmcnt(15)
  s_add_u32 s78, s60, 14336
  s_and_b32 s78, s78, 0x3fff
  s_mul_i32 s78, s78, 96
  s_add_u32 m0, s84, 0
  s_nop 0
  buffer_load_dwordx4 v192, s[28:31], s78 offen offset:0 lds
  buffer_load_dwordx4 v193, s[28:31], s78 offen offset:1056 lds
  buffer_load_dwordx4 v194, s[28:31], s78 offen offset:2112 lds
  buffer_load_dwordx4 v195, s[28:31], s78 offen offset:3168 lds
  s_add_u32 s78, s60, 15360
  s_and_b32 s78, s78, 0x3fff
  s_mul_i32 s78, s78, 96
  s_add_u32 m0, s84, 4224
  s_nop 0
  buffer_load_dwordx4 v192, s[28:31], s78 offen offset:0 lds
  buffer_load_dwordx4 v193, s[28:31], s78 offen offset:1056 lds
  buffer_load_dwordx4 v194, s[28:31], s78 offen offset:2112 lds
  buffer_load_dwordx4 v195, s[28:31], s78 offen offset:3168 lds
  v_lshrrev_b32 v6, 3, v1
  v_lshlrev_b32 v6, 14, v6
  v_and_b32 v7, 7, v1
  v_lshl_add_u32 v6, v7, 4, v6
  s_mul_i32 s66, s52, 1572864
  s_lshl_b32 s67, s56, 7
  s_add_u32 s66, s66, s67
  v_add_u32 v198, s66, v6
  v_add_u32 v199, 3040, v198
  v_add_u32 v200, 6080, v198
  v_add_u32 v201, 9120, v198
  v_subrev_u32 v6, s84, v197
  v_add_u32 v6, s86, v6
  s_add_u32 s66, s52, 0
  s_and_b32 s66, s66, 3
  s_lshl_b32 s66, s66, 5
  v_add_u32 v202, s66, v6
  s_add_u32 s66, s52, 1
  s_and_b32 s66, s66, 3
  s_lshl_b32 s66, s66, 5
  v_add_u32 v203, s66, v6
  s_add_u32 s66, s52, 2
  s_and_b32 s66, s66, 3
  s_lshl_b32 s66, s66, 5
  v_add_u32 v204, s66, v6
  s_add_u32 s66, s52, 3
  s_and_b32 s66, s66, 3
  s_lshl_b32 s66, s66, 5
  v_add_u32 v205, s66, v6
  s_mul_i32 s66, s55, 245760
  s_mul_i32 s67, s52, 12288
  s_add_u32 s66, s66, s67
  s_add_u32 s79, s66, 26607616
  v_add_u32 v210, s79, v13
  v_add_u32 v211, 49152, v210
  v_add_u32 v212, 98304, v210
  v_add_u32 v213, 147456, v210
  v_add_u32 v214, 196608, v210
  v_and_b32 v6, 15, v1
  v_lshlrev_b32 v6, 1, v6
  s_lshl_b32 s66, s59, 5
  buffer_load_ushort v246, v6, s[40:43], s66 offen
  s_cmp_eq_u32 s58, 100
  s_cbranch_scc1 ID258
  v_lshrrev_b32 v2, 4, v1
  v_lshlrev_b32 v2, 3, v2
  s_lshl_b32 s66, s57, 7
  buffer_load_dwordx2 v[184:185], v2, s[36:39], s66 offen offset:0
  buffer_load_dwordx2 v[186:187], v2, s[36:39], s66 offen offset:32
  buffer_load_dwordx2 v[188:189], v2, s[36:39], s66 offen offset:64
  buffer_load_dwordx2 v[190:191], v2, s[36:39], s66 offen offset:96
  s_lshl_b32 s74, s58, 18
  s_lshl_b32 s67, s52, 14
  s_add_u32 s74, s74, s67
  s_add_u32 s74, s74, 23986176
  s_mov_b32 s82, 131072
  s_add_u32 s66, s52, 0
  s_and_b32 s66, s66, 3
  s_mul_i32 s67, s66, 38016
  s_lshl_b32 s66, s66, 16
  s_add_u32 s66, s66, s74
  v_add_u32 v206, s66, v13
  v_add_u32 v2, s67, v13
  s_add_u32 s66, s52, 1
  s_and_b32 s66, s66, 3
  s_mul_i32 s67, s66, 38016
  s_lshl_b32 s66, s66, 16
  s_add_u32 s66, s66, s74
  v_add_u32 v207, s66, v13
  v_add_u32 v3, s67, v13
  s_add_u32 s66, s52, 2
  s_and_b32 s66, s66, 3
  s_mul_i32 s67, s66, 38016
  s_lshl_b32 s66, s66, 16
  s_add_u32 s66, s66, s74
  v_add_u32 v208, s66, v13
  v_add_u32 v4, s67, v13
  s_add_u32 s66, s52, 3
  s_and_b32 s66, s66, 3
  s_mul_i32 s67, s66, 38016
  s_lshl_b32 s66, s66, 16
  s_add_u32 s66, s66, s74
  v_add_u32 v209, s66, v13
  v_add_u32 v5, s67, v13
  s_lshl_b32 s66, s58, 2
  s_add_u32 s66, s66, s52
  s_mul_i32 s66, s66, 49152
  s_lshl_b32 s67, s57, 11
  s_add_u32 s66, s66, s67
  s_add_u32 s73, s66, 26607616
  v_mov_b32 v6, 0xbdd2d3e8
  v_mov_b32 v8, 0xc0135761
  v_mov_b32 v10, 1.0
  s_waitcnt vmcnt(25)
  ds_read_b64_tr_b16 a[160:161], v197 offset:16896
  ds_read_b64_tr_b16 a[162:163], v197 offset:17408
  ds_read_b64_tr_b16 a[164:165], v197 offset:16928
  ds_read_b64_tr_b16 a[166:167], v197 offset:17440
  ds_read_b64_tr_b16 a[168:169], v197 offset:16960
  ds_read_b64_tr_b16 a[170:171], v197 offset:17472
  ds_read_b64_tr_b16 a[172:173], v197 offset:16992
  ds_read_b64_tr_b16 a[174:175], v197 offset:17504
  s_waitcnt vmcnt(21)
  ds_read_b64_tr_b16 a[176:177], v197 offset:21120
  ds_read_b64_tr_b16 a[178:179], v197 offset:21632
  ds_read_b64_tr_b16 a[180:181], v197 offset:21152
  ds_read_b64_tr_b16 a[182:183], v197 offset:21664
  ds_read_b64_tr_b16 a[184:185], v197 offset:21184
  ds_read_b64_tr_b16 a[186:187], v197 offset:21696
  ds_read_b64_tr_b16 a[188:189], v197 offset:21216
  ds_read_b64_tr_b16 a[190:191], v197 offset:21728
  s_waitcnt vmcnt(17)
  ds_read_b64_tr_b16 a[192:193], v196 offset:0
  ds_read_b64_tr_b16 a[194:195], v196 offset:512
  ds_read_b64_tr_b16 a[196:197], v196 offset:32
  ds_read_b64_tr_b16 a[198:199], v196 offset:544
  ds_read_b64_tr_b16 a[200:201], v196 offset:64
  ds_read_b64_tr_b16 a[202:203], v196 offset:576
  ds_read_b64_tr_b16 a[204:205], v196 offset:96
  ds_read_b64_tr_b16 a[206:207], v196 offset:608
  s_waitcnt vmcnt(13)
  ds_read_b64_tr_b16 a[208:209], v196 offset:4224
  ds_read_b64_tr_b16 a[210:211], v196 offset:4736
  ds_read_b64_tr_b16 a[212:213], v196 offset:4256
  ds_read_b64_tr_b16 a[214:215], v196 offset:4768
  ds_read_b64_tr_b16 a[216:217], v196 offset:4288
  ds_read_b64_tr_b16 a[218:219], v196 offset:4800
  ds_read_b64_tr_b16 a[220:221], v196 offset:4320
  ds_read_b64_tr_b16 a[222:223], v196 offset:4832
  s_mov_b32 s81, s60
  buffer_load_dwordx4 v[80:83], v206, s[8:11], s81 offen sc1
  buffer_load_dwordx4 v[84:87], v207, s[8:11], s81 offen sc1
  buffer_load_dwordx4 v[88:91], v208, s[8:11], s81 offen sc1
  buffer_load_dwordx4 v[92:95], v209, s[8:11], s81 offen sc1
  s_add_u32 s81, s60, 1024
  s_and_b32 s81, s81, 0x3fff
  buffer_load_dwordx4 v[96:99], v206, s[8:11], s81 offen sc1
  buffer_load_dwordx4 v[100:103], v207, s[8:11], s81 offen sc1
  buffer_load_dwordx4 v[104:107], v208, s[8:11], s81 offen sc1
  buffer_load_dwordx4 v[108:111], v209, s[8:11], s81 offen sc1
  s_add_u32 s81, s60, 2048
  s_and_b32 s81, s81, 0x3fff
  buffer_load_dwordx4 v[112:115], v206, s[8:11], s81 offen sc1
  buffer_load_dwordx4 v[116:119], v207, s[8:11], s81 offen sc1
  buffer_load_dwordx4 v[120:123], v208, s[8:11], s81 offen sc1
  buffer_load_dwordx4 v[124:127], v209, s[8:11], s81 offen sc1
  s_add_u32 s81, s60, 3072
  s_and_b32 s81, s81, 0x3fff
  buffer_load_dwordx4 v[128:131], v206, s[8:11], s81 offen sc1
  buffer_load_dwordx4 v[132:135], v207, s[8:11], s81 offen sc1
  buffer_load_dwordx4 v[136:139], v208, s[8:11], s81 offen sc1
  buffer_load_dwordx4 v[140:143], v209, s[8:11], s81 offen sc1
  s_waitcnt vmcnt(19)
  v_lshlrev_b32 v176, 16, v184
  v_and_b32 v177, 0xffff0000, v184
  v_lshlrev_b32 v178, 16, v185
  v_and_b32 v179, 0xffff0000, v185
  s_waitcnt vmcnt(18)
  v_lshlrev_b32 v180, 16, v186
  v_and_b32 v181, 0xffff0000, v186
  v_lshlrev_b32 v182, 16, v187
  v_and_b32 v183, 0xffff0000, v187
  s_waitcnt vmcnt(17)
  v_lshlrev_b32 v184, 16, v188
  v_and_b32 v185, 0xffff0000, v188
  v_lshlrev_b32 v186, 16, v189
  v_and_b32 v187, 0xffff0000, v189
  s_waitcnt vmcnt(16)
  v_lshlrev_b32 v188, 16, v190
  v_and_b32 v189, 0xffff0000, v190
  v_lshlrev_b32 v190, 16, v191
  v_and_b32 v191, 0xffff0000, v191
VC260:
  s_waitcnt vmcnt(13)
  v_max3_u32 v12, v80, v84, v88
  s_waitcnt vmcnt(12)
  v_max_u32 v12, v12, v92
  v_cmp_eq_u32 vcc, -1, v12
  s_cbranch_vccnz VR261
VK262:
  v_mfma_f32_16x16x32_bf16 v[16:19], a[0:3], v[80:83], v[176:179]
  s_add_u32 s81, s60, 4096
  s_and_b32 s81, s81, 0x3fff
  buffer_load_dwordx4 v[144:147], v206, s[8:11], s81 offen sc1
  v_mfma_f32_16x16x32_bf16 v[20:23], a[4:7], v[80:83], v[180:183]
  ds_read_b64_tr_b16 a[224:225], v197 offset:0
  v_mfma_f32_16x16x32_bf16 v[24:27], a[8:11], v[80:83], v[184:187]
  v_mfma_f32_16x16x32_bf16 v[28:31], a[12:15], v[80:83], v[188:191]
  ds_read_b64_tr_b16 a[226:227], v197 offset:512
  v_mfma_f32_16x16x32_bf16 v[32:35], a[0:3], v[84:87], 0
  buffer_load_dwordx4 v[148:151], v207, s[8:11], s81 offen sc1
  v_mfma_f32_16x16x32_bf16 v[36:39], a[4:7], v[84:87], 0
  ds_read_b64_tr_b16 a[228:229], v197 offset:32
  v_mfma_f32_16x16x32_bf16 v[40:43], a[8:11], v[84:87], 0
  v_mfma_f32_16x16x32_bf16 v[44:47], a[12:15], v[84:87], 0
  ds_read_b64_tr_b16 a[230:231], v197 offset:544
  v_mfma_f32_16x16x32_bf16 v[48:51], a[0:3], v[88:91], 0
  buffer_load_dwordx4 v[152:155], v208, s[8:11], s81 offen sc1
  v_mfma_f32_16x16x32_bf16 v[52:55], a[4:7], v[88:91], 0
  ds_read_b64_tr_b16 a[232:233], v197 offset:64
  v_mfma_f32_16x16x32_bf16 v[56:59], a[8:11], v[88:91], 0
  v_mfma_f32_16x16x32_bf16 v[60:63], a[12:15], v[88:91], 0
  ds_read_b64_tr_b16 a[234:235], v197 offset:576
  v_mfma_f32_16x16x32_bf16 v[64:67], a[0:3], v[92:95], 0
  buffer_load_dwordx4 v[156:159], v209, s[8:11], s81 offen sc1
  v_mfma_f32_16x16x32_bf16 v[68:71], a[4:7], v[92:95], 0
  ds_read_b64_tr_b16 a[236:237], v197 offset:96
  v_mfma_f32_16x16x32_bf16 v[72:75], a[8:11], v[92:95], 0
  v_mfma_f32_16x16x32_bf16 v[76:79], a[12:15], v[92:95], 0
  ds_read_b64_tr_b16 a[238:239], v197 offset:608
VC263:
  s_waitcnt vmcnt(13)
  v_max3_u32 v12, v96, v100, v104
  s_waitcnt vmcnt(12)
  v_max_u32 v12, v12, v108
  v_cmp_eq_u32 vcc, -1, v12
  s_cbranch_vccnz VR264
VK265:
  v_mfma_f32_16x16x32_bf16 v[16:19], a[16:19], v[96:99], v[16:19]
  s_add_u32 s81, s60, 5120
  s_and_b32 s81, s81, 0x3fff
  buffer_load_dwordx4 v[80:83], v206, s[8:11], s81 offen sc1
  v_mfma_f32_16x16x32_bf16 v[20:23], a[20:23], v[96:99], v[20:23]
  ds_read_b64_tr_b16 a[240:241], v197 offset:4224
  v_mfma_f32_16x16x32_bf16 v[24:27], a[24:27], v[96:99], v[24:27]
  v_mfma_f32_16x16x32_bf16 v[28:31], a[28:31], v[96:99], v[28:31]
  ds_read_b64_tr_b16 a[242:243], v197 offset:4736
  v_mfma_f32_16x16x32_bf16 v[32:35], a[16:19], v[100:103], v[32:35]
  buffer_load_dwordx4 v[84:87], v207, s[8:11], s81 offen sc1
  v_mfma_f32_16x16x32_bf16 v[36:39], a[20:23], v[100:103], v[36:39]
  ds_read_b64_tr_b16 a[244:245], v197 offset:4256
  v_mfma_f32_16x16x32_bf16 v[40:43], a[24:27], v[100:103], v[40:43]
  v_mfma_f32_16x16x32_bf16 v[44:47], a[28:31], v[100:103], v[44:47]
  ds_read_b64_tr_b16 a[246:247], v197 offset:4768
  v_mfma_f32_16x16x32_bf16 v[48:51], a[16:19], v[104:107], v[48:51]
  buffer_load_dwordx4 v[88:91], v208, s[8:11], s81 offen sc1
  v_mfma_f32_16x16x32_bf16 v[52:55], a[20:23], v[104:107], v[52:55]
  ds_read_b64_tr_b16 a[248:249], v197 offset:4288
  v_mfma_f32_16x16x32_bf16 v[56:59], a[24:27], v[104:107], v[56:59]
  v_mfma_f32_16x16x32_bf16 v[60:63], a[28:31], v[104:107], v[60:63]
  ds_read_b64_tr_b16 a[250:251], v197 offset:4800
  v_mfma_f32_16x16x32_bf16 v[64:67], a[16:19], v[108:111], v[64:67]
  buffer_load_dwordx4 v[92:95], v209, s[8:11], s81 offen sc1
  v_mfma_f32_16x16x32_bf16 v[68:71], a[20:23], v[108:111], v[68:71]
  ds_read_b64_tr_b16 a[252:253], v197 offset:4320
  v_mfma_f32_16x16x32_bf16 v[72:75], a[24:27], v[108:111], v[72:75]
  v_mfma_f32_16x16x32_bf16 v[76:79], a[28:31], v[108:111], v[76:79]
  ds_read_b64_tr_b16 a[254:255], v197 offset:4832
VC266:
  s_waitcnt vmcnt(13)
  v_max3_u32 v12, v112, v116, v120
  s_waitcnt vmcnt(12)
  v_max_u32 v12, v12, v124
  v_cmp_eq_u32 vcc, -1, v12
  s_cbranch_vccnz VR267
VK268:
  v_mfma_f32_16x16x32_bf16 v[16:19], a[32:35], v[112:115], v[16:19]
  s_add_u32 s81, s60, 6144
  s_and_b32 s81, s81, 0x3fff
  buffer_load_dwordx4 v[96:99], v206, s[8:11], s81 offen sc1
  v_mfma_f32_16x16x32_bf16 v[20:23], a[36:39], v[112:115], v[20:23]
  v_mfma_f32_16x16x32_bf16 v[24:27], a[40:43], v[112:115], v[24:27]
  v_mfma_f32_16x16x32_bf16 v[28:31], a[44:47], v[112:115], v[28:31]
  v_mfma_f32_16x16x32_bf16 v[32:35], a[32:35], v[116:119], v[32:35]
  buffer_load_dwordx4 v[100:103], v207, s[8:11], s81 offen sc1
  v_mfma_f32_16x16x32_bf16 v[36:39], a[36:39], v[116:119], v[36:39]
  v_mfma_f32_16x16x32_bf16 v[40:43], a[40:43], v[116:119], v[40:43]
  v_mfma_f32_16x16x32_bf16 v[44:47], a[44:47], v[116:119], v[44:47]
  v_mfma_f32_16x16x32_bf16 v[48:51], a[32:35], v[120:123], v[48:51]
  buffer_load_dwordx4 v[104:107], v208, s[8:11], s81 offen sc1
  v_mfma_f32_16x16x32_bf16 v[52:55], a[36:39], v[120:123], v[52:55]
  v_mfma_f32_16x16x32_bf16 v[56:59], a[40:43], v[120:123], v[56:59]
  v_mfma_f32_16x16x32_bf16 v[60:63], a[44:47], v[120:123], v[60:63]
  v_mfma_f32_16x16x32_bf16 v[64:67], a[32:35], v[124:127], v[64:67]
  buffer_load_dwordx4 v[108:111], v209, s[8:11], s81 offen sc1
  v_mfma_f32_16x16x32_bf16 v[68:71], a[36:39], v[124:127], v[68:71]
  v_mfma_f32_16x16x32_bf16 v[72:75], a[40:43], v[124:127], v[72:75]
  v_mfma_f32_16x16x32_bf16 v[76:79], a[44:47], v[124:127], v[76:79]
  s_waitcnt lgkmcnt(0)
  s_barrier
VC269:
  s_waitcnt vmcnt(13)
  v_max3_u32 v12, v128, v132, v136
  s_waitcnt vmcnt(12)
  v_max_u32 v12, v12, v140
  v_cmp_eq_u32 vcc, -1, v12
  s_cbranch_vccnz VR270
VK271:
  v_mfma_f32_16x16x32_bf16 v[16:19], a[48:51], v[128:131], v[16:19]
  s_add_u32 s81, s60, 7168
  s_and_b32 s81, s81, 0x3fff
  buffer_load_dwordx4 v[112:115], v206, s[8:11], s81 offen sc1
  v_mfma_f32_16x16x32_bf16 v[20:23], a[52:55], v[128:131], v[20:23]
  v_mfma_f32_16x16x32_bf16 v[24:27], a[56:59], v[128:131], v[24:27]
  v_mfma_f32_16x16x32_bf16 v[28:31], a[60:63], v[128:131], v[28:31]
  v_mfma_f32_16x16x32_bf16 v[32:35], a[48:51], v[132:135], v[32:35]
  buffer_load_dwordx4 v[116:119], v207, s[8:11], s81 offen sc1
  v_mfma_f32_16x16x32_bf16 v[36:39], a[52:55], v[132:135], v[36:39]
  v_mfma_f32_16x16x32_bf16 v[40:43], a[56:59], v[132:135], v[40:43]
  v_mfma_f32_16x16x32_bf16 v[44:47], a[60:63], v[132:135], v[44:47]
  v_mfma_f32_16x16x32_bf16 v[48:51], a[48:51], v[136:139], v[48:51]
  buffer_load_dwordx4 v[120:123], v208, s[8:11], s81 offen sc1
  v_mfma_f32_16x16x32_bf16 v[52:55], a[52:55], v[136:139], v[52:55]
  v_mfma_f32_16x16x32_bf16 v[56:59], a[56:59], v[136:139], v[56:59]
  v_mfma_f32_16x16x32_bf16 v[60:63], a[60:63], v[136:139], v[60:63]
  v_mfma_f32_16x16x32_bf16 v[64:67], a[48:51], v[140:143], v[64:67]
  buffer_load_dwordx4 v[124:127], v209, s[8:11], s81 offen sc1
  v_mfma_f32_16x16x32_bf16 v[68:71], a[52:55], v[140:143], v[68:71]
  v_mfma_f32_16x16x32_bf16 v[72:75], a[56:59], v[140:143], v[72:75]
  v_mfma_f32_16x16x32_bf16 v[76:79], a[60:63], v[140:143], v[76:79]
VC272:
  s_waitcnt vmcnt(13)
  v_max3_u32 v12, v144, v148, v152
  s_waitcnt vmcnt(12)
  v_max_u32 v12, v12, v156
  v_cmp_eq_u32 vcc, -1, v12
  s_cbranch_vccnz VR273
VK274:
  v_mfma_f32_16x16x32_bf16 v[16:19], a[64:67], v[144:147], v[16:19]
  s_add_u32 s81, s60, 8192
  s_and_b32 s81, s81, 0x3fff
  buffer_load_dwordx4 v[128:131], v206, s[8:11], s81 offen sc1
  v_mfma_f32_16x16x32_bf16 v[20:23], a[68:71], v[144:147], v[20:23]
  v_mfma_f32_16x16x32_bf16 v[24:27], a[72:75], v[144:147], v[24:27]
  v_mfma_f32_16x16x32_bf16 v[28:31], a[76:79], v[144:147], v[28:31]
  v_mfma_f32_16x16x32_bf16 v[32:35], a[64:67], v[148:151], v[32:35]
  buffer_load_dwordx4 v[132:135], v207, s[8:11], s81 offen sc1
  v_mfma_f32_16x16x32_bf16 v[36:39], a[68:71], v[148:151], v[36:39]
  v_mfma_f32_16x16x32_bf16 v[40:43], a[72:75], v[148:151], v[40:43]
  v_mfma_f32_16x16x32_bf16 v[44:47], a[76:79], v[148:151], v[44:47]
  v_mfma_f32_16x16x32_bf16 v[48:51], a[64:67], v[152:155], v[48:51]
  buffer_load_dwordx4 v[136:139], v208, s[8:11], s81 offen sc1
  v_mfma_f32_16x16x32_bf16 v[52:55], a[68:71], v[152:155], v[52:55]
  v_mfma_f32_16x16x32_bf16 v[56:59], a[72:75], v[152:155], v[56:59]
  v_mfma_f32_16x16x32_bf16 v[60:63], a[76:79], v[152:155], v[60:63]
  v_mfma_f32_16x16x32_bf16 v[64:67], a[64:67], v[156:159], v[64:67]
  buffer_load_dwordx4 v[140:143], v209, s[8:11], s81 offen sc1
  v_mfma_f32_16x16x32_bf16 v[68:71], a[68:71], v[156:159], v[68:71]
  v_mfma_f32_16x16x32_bf16 v[72:75], a[72:75], v[156:159], v[72:75]
  v_mfma_f32_16x16x32_bf16 v[76:79], a[76:79], v[156:159], v[76:79]
VC275:
  s_waitcnt vmcnt(13)
  v_max3_u32 v12, v80, v84, v88
  s_waitcnt vmcnt(12)
  v_max_u32 v12, v12, v92
  v_cmp_eq_u32 vcc, -1, v12
  s_cbranch_vccnz VR276
VK277:
  v_mfma_f32_16x16x32_bf16 v[16:19], a[80:83], v[80:83], v[16:19]
  s_add_u32 s81, s60, 9216
  s_and_b32 s81, s81, 0x3fff
  buffer_load_dwordx4 v[144:147], v206, s[8:11], s81 offen sc1
  v_mfma_f32_16x16x32_bf16 v[20:23], a[84:87], v[80:83], v[20:23]
  v_mfma_f32_16x16x32_bf16 v[24:27], a[88:91], v[80:83], v[24:27]
  v_mfma_f32_16x16x32_bf16 v[28:31], a[92:95], v[80:83], v[28:31]
  v_mfma_f32_16x16x32_bf16 v[32:35], a[80:83], v[84:87], v[32:35]
  buffer_load_dwordx4 v[148:151], v207, s[8:11], s81 offen sc1
  v_mfma_f32_16x16x32_bf16 v[36:39], a[84:87], v[84:87], v[36:39]
  v_mfma_f32_16x16x32_bf16 v[40:43], a[88:91], v[84:87], v[40:43]
  v_mfma_f32_16x16x32_bf16 v[44:47], a[92:95], v[84:87], v[44:47]
  v_mfma_f32_16x16x32_bf16 v[48:51], a[80:83], v[88:91], v[48:51]
  buffer_load_dwordx4 v[152:155], v208, s[8:11], s81 offen sc1
  v_mfma_f32_16x16x32_bf16 v[52:55], a[84:87], v[88:91], v[52:55]
  v_mfma_f32_16x16x32_bf16 v[56:59], a[88:91], v[88:91], v[56:59]
  v_mfma_f32_16x16x32_bf16 v[60:63], a[92:95], v[88:91], v[60:63]
  v_mfma_f32_16x16x32_bf16 v[64:67], a[80:83], v[92:95], v[64:67]
  buffer_load_dwordx4 v[156:159], v209, s[8:11], s81 offen sc1
  v_mfma_f32_16x16x32_bf16 v[68:71], a[84:87], v[92:95], v[68:71]
  v_mfma_f32_16x16x32_bf16 v[72:75], a[88:91], v[92:95], v[72:75]
  v_mfma_f32_16x16x32_bf16 v[76:79], a[92:95], v[92:95], v[76:79]
VC278:
  s_waitcnt vmcnt(13)
  v_max3_u32 v12, v96, v100, v104
  s_waitcnt vmcnt(12)
  v_max_u32 v12, v12, v108
  v_cmp_eq_u32 vcc, -1, v12
  s_cbranch_vccnz VR279
VK280:
  v_mfma_f32_16x16x32_bf16 v[16:19], a[96:99], v[96:99], v[16:19]
  s_add_u32 s81, s60, 10240
  s_and_b32 s81, s81, 0x3fff
  buffer_load_dwordx4 v[80:83], v206, s[8:11], s81 offen sc1
  v_mfma_f32_16x16x32_bf16 v[20:23], a[100:103], v[96:99], v[20:23]
  v_mfma_f32_16x16x32_bf16 v[24:27], a[104:107], v[96:99], v[24:27]
  v_mfma_f32_16x16x32_bf16 v[28:31], a[108:111], v[96:99], v[28:31]
  v_mfma_f32_16x16x32_bf16 v[32:35], a[96:99], v[100:103], v[32:35]
  buffer_load_dwordx4 v[84:87], v207, s[8:11], s81 offen sc1
  v_mfma_f32_16x16x32_bf16 v[36:39], a[100:103], v[100:103], v[36:39]
  v_mfma_f32_16x16x32_bf16 v[40:43], a[104:107], v[100:103], v[40:43]
  v_mfma_f32_16x16x32_bf16 v[44:47], a[108:111], v[100:103], v[44:47]
  v_mfma_f32_16x16x32_bf16 v[48:51], a[96:99], v[104:107], v[48:51]
  buffer_load_dwordx4 v[88:91], v208, s[8:11], s81 offen sc1
  v_mfma_f32_16x16x32_bf16 v[52:55], a[100:103], v[104:107], v[52:55]
  v_mfma_f32_16x16x32_bf16 v[56:59], a[104:107], v[104:107], v[56:59]
  v_mfma_f32_16x16x32_bf16 v[60:63], a[108:111], v[104:107], v[60:63]
  v_mfma_f32_16x16x32_bf16 v[64:67], a[96:99], v[108:111], v[64:67]
  buffer_load_dwordx4 v[92:95], v209, s[8:11], s81 offen sc1
  v_mfma_f32_16x16x32_bf16 v[68:71], a[100:103], v[108:111], v[68:71]
  v_mfma_f32_16x16x32_bf16 v[72:75], a[104:107], v[108:111], v[72:75]
  v_mfma_f32_16x16x32_bf16 v[76:79], a[108:111], v[108:111], v[76:79]
VC281:
  s_waitcnt vmcnt(13)
  v_max3_u32 v12, v112, v116, v120
  s_waitcnt vmcnt(12)
  v_max_u32 v12, v12, v124
  v_cmp_eq_u32 vcc, -1, v12
  s_cbranch_vccnz VR282
VK283:
  v_mfma_f32_16x16x32_bf16 v[16:19], a[112:115], v[112:115], v[16:19]
  s_add_u32 s81, s60, 11264
  s_and_b32 s81, s81, 0x3fff
  buffer_load_dwordx4 v[96:99], v206, s[8:11], s81 offen sc1
  v_mfma_f32_16x16x32_bf16 v[20:23], a[116:119], v[112:115], v[20:23]
  v_mfma_f32_16x16x32_bf16 v[24:27], a[120:123], v[112:115], v[24:27]
  v_mfma_f32_16x16x32_bf16 v[28:31], a[124:127], v[112:115], v[28:31]
  v_mfma_f32_16x16x32_bf16 v[32:35], a[112:115], v[116:119], v[32:35]
  buffer_load_dwordx4 v[100:103], v207, s[8:11], s81 offen sc1
  v_mfma_f32_16x16x32_bf16 v[36:39], a[116:119], v[116:119], v[36:39]
  v_mfma_f32_16x16x32_bf16 v[40:43], a[120:123], v[116:119], v[40:43]
  v_mfma_f32_16x16x32_bf16 v[44:47], a[124:127], v[116:119], v[44:47]
  v_mfma_f32_16x16x32_bf16 v[48:51], a[112:115], v[120:123], v[48:51]
  buffer_load_dwordx4 v[104:107], v208, s[8:11], s81 offen sc1
  v_mfma_f32_16x16x32_bf16 v[52:55], a[116:119], v[120:123], v[52:55]
  v_mfma_f32_16x16x32_bf16 v[56:59], a[120:123], v[120:123], v[56:59]
  v_mfma_f32_16x16x32_bf16 v[60:63], a[124:127], v[120:123], v[60:63]
  v_mfma_f32_16x16x32_bf16 v[64:67], a[112:115], v[124:127], v[64:67]
  buffer_load_dwordx4 v[108:111], v209, s[8:11], s81 offen sc1
  v_mfma_f32_16x16x32_bf16 v[68:71], a[116:119], v[124:127], v[68:71]
  v_mfma_f32_16x16x32_bf16 v[72:75], a[120:123], v[124:127], v[72:75]
  v_mfma_f32_16x16x32_bf16 v[76:79], a[124:127], v[124:127], v[76:79]
VC284:
  s_waitcnt vmcnt(13)
  v_max3_u32 v12, v128, v132, v136
  s_waitcnt vmcnt(12)
  v_max_u32 v12, v12, v140
  v_cmp_eq_u32 vcc, -1, v12
  s_cbranch_vccnz VR285
VK286:
  v_mfma_f32_16x16x32_bf16 v[16:19], a[128:131], v[128:131], v[16:19]
  s_add_u32 s81, s60, 12288
  s_and_b32 s81, s81, 0x3fff
  buffer_load_dwordx4 v[112:115], v206, s[8:11], s81 offen sc1
  v_mfma_f32_16x16x32_bf16 v[20:23], a[132:135], v[128:131], v[20:23]
  v_mfma_f32_16x16x32_bf16 v[24:27], a[136:139], v[128:131], v[24:27]
  v_mfma_f32_16x16x32_bf16 v[28:31], a[140:143], v[128:131], v[28:31]
  v_mfma_f32_16x16x32_bf16 v[32:35], a[128:131], v[132:135], v[32:35]
  buffer_load_dwordx4 v[116:119], v207, s[8:11], s81 offen sc1
  v_mfma_f32_16x16x32_bf16 v[36:39], a[132:135], v[132:135], v[36:39]
  v_mfma_f32_16x16x32_bf16 v[40:43], a[136:139], v[132:135], v[40:43]
  v_mfma_f32_16x16x32_bf16 v[44:47], a[140:143], v[132:135], v[44:47]
  v_mfma_f32_16x16x32_bf16 v[48:51], a[128:131], v[136:139], v[48:51]
  buffer_load_dwordx4 v[120:123], v208, s[8:11], s81 offen sc1
  v_mfma_f32_16x16x32_bf16 v[52:55], a[132:135], v[136:139], v[52:55]
  v_mfma_f32_16x16x32_bf16 v[56:59], a[136:139], v[136:139], v[56:59]
  v_mfma_f32_16x16x32_bf16 v[60:63], a[140:143], v[136:139], v[60:63]
  v_mfma_f32_16x16x32_bf16 v[64:67], a[128:131], v[140:143], v[64:67]
  buffer_load_dwordx4 v[124:127], v209, s[8:11], s81 offen sc1
  v_mfma_f32_16x16x32_bf16 v[68:71], a[132:135], v[140:143], v[68:71]
  v_mfma_f32_16x16x32_bf16 v[72:75], a[136:139], v[140:143], v[72:75]
  v_mfma_f32_16x16x32_bf16 v[76:79], a[140:143], v[140:143], v[76:79]
VC287:
  s_waitcnt vmcnt(13)
  v_max3_u32 v12, v144, v148, v152
  s_waitcnt vmcnt(12)
  v_max_u32 v12, v12, v156
  v_cmp_eq_u32 vcc, -1, v12
  s_cbranch_vccnz VR288
VK289:
  v_mfma_f32_16x16x32_bf16 v[16:19], a[144:147], v[144:147], v[16:19]
  s_add_u32 s81, s60, 13312
  s_and_b32 s81, s81, 0x3fff
  buffer_load_dwordx4 v[128:131], v206, s[8:11], s81 offen sc1
  v_mfma_f32_16x16x32_bf16 v[20:23], a[148:151], v[144:147], v[20:23]
  v_mfma_f32_16x16x32_bf16 v[24:27], a[152:155], v[144:147], v[24:27]
  v_mfma_f32_16x16x32_bf16 v[28:31], a[156:159], v[144:147], v[28:31]
  v_mfma_f32_16x16x32_bf16 v[32:35], a[144:147], v[148:151], v[32:35]
  buffer_load_dwordx4 v[132:135], v207, s[8:11], s81 offen sc1
  v_mfma_f32_16x16x32_bf16 v[36:39], a[148:151], v[148:151], v[36:39]
  v_mfma_f32_16x16x32_bf16 v[40:43], a[152:155], v[148:151], v[40:43]
  v_mfma_f32_16x16x32_bf16 v[44:47], a[156:159], v[148:151], v[44:47]
  v_mfma_f32_16x16x32_bf16 v[48:51], a[144:147], v[152:155], v[48:51]
  buffer_load_dwordx4 v[136:139], v208, s[8:11], s81 offen sc1
  v_mfma_f32_16x16x32_bf16 v[52:55], a[148:151], v[152:155], v[52:55]
  v_mfma_f32_16x16x32_bf16 v[56:59], a[152:155], v[152:155], v[56:59]
  v_mfma_f32_16x16x32_bf16 v[60:63], a[156:159], v[152:155], v[60:63]
  v_mfma_f32_16x16x32_bf16 v[64:67], a[144:147], v[156:159], v[64:67]
  buffer_load_dwordx4 v[140:143], v209, s[8:11], s81 offen sc1
  v_mfma_f32_16x16x32_bf16 v[68:71], a[148:151], v[156:159], v[68:71]
  v_mfma_f32_16x16x32_bf16 v[72:75], a[152:155], v[156:159], v[72:75]
  v_mfma_f32_16x16x32_bf16 v[76:79], a[156:159], v[156:159], v[76:79]
VC290:
  s_waitcnt vmcnt(13)
  v_max3_u32 v12, v80, v84, v88
  s_waitcnt vmcnt(12)
  v_max_u32 v12, v12, v92
  v_cmp_eq_u32 vcc, -1, v12
  s_cbranch_vccnz VR291
VK292:
  v_mfma_f32_16x16x32_bf16 v[16:19], a[160:163], v[80:83], v[16:19]
  s_add_u32 s81, s60, 14336
  s_and_b32 s81, s81, 0x3fff
  buffer_load_dwordx4 v[144:147], v206, s[8:11], s81 offen sc1
  v_mfma_f32_16x16x32_bf16 v[20:23], a[164:167], v[80:83], v[20:23]
  v_mfma_f32_16x16x32_bf16 v[24:27], a[168:171], v[80:83], v[24:27]
  v_mfma_f32_16x16x32_bf16 v[28:31], a[172:175], v[80:83], v[28:31]
  v_mfma_f32_16x16x32_bf16 v[32:35], a[160:163], v[84:87], v[32:35]
  buffer_load_dwordx4 v[148:151], v207, s[8:11], s81 offen sc1
  v_mfma_f32_16x16x32_bf16 v[36:39], a[164:167], v[84:87], v[36:39]
  v_mfma_f32_16x16x32_bf16 v[40:43], a[168:171], v[84:87], v[40:43]
  v_mfma_f32_16x16x32_bf16 v[44:47], a[172:175], v[84:87], v[44:47]
  v_mfma_f32_16x16x32_bf16 v[48:51], a[160:163], v[88:91], v[48:51]
  buffer_load_dwordx4 v[152:155], v208, s[8:11], s81 offen sc1
  v_mfma_f32_16x16x32_bf16 v[52:55], a[164:167], v[88:91], v[52:55]
  v_mfma_f32_16x16x32_bf16 v[56:59], a[168:171], v[88:91], v[56:59]
  v_mfma_f32_16x16x32_bf16 v[60:63], a[172:175], v[88:91], v[60:63]
  v_mfma_f32_16x16x32_bf16 v[64:67], a[160:163], v[92:95], v[64:67]
  buffer_load_dwordx4 v[156:159], v209, s[8:11], s81 offen sc1
  v_mfma_f32_16x16x32_bf16 v[68:71], a[164:167], v[92:95], v[68:71]
  v_mfma_f32_16x16x32_bf16 v[72:75], a[168:171], v[92:95], v[72:75]
  v_mfma_f32_16x16x32_bf16 v[76:79], a[172:175], v[92:95], v[76:79]
VC293:
  s_waitcnt vmcnt(13)
  v_max3_u32 v12, v96, v100, v104
  s_waitcnt vmcnt(12)
  v_max_u32 v12, v12, v108
  v_cmp_eq_u32 vcc, -1, v12
  s_cbranch_vccnz VR294
VK295:
  v_mfma_f32_16x16x32_bf16 v[16:19], a[176:179], v[96:99], v[16:19]
  s_add_u32 s81, s60, 15360
  s_and_b32 s81, s81, 0x3fff
  buffer_load_dwordx4 v[80:83], v206, s[8:11], s81 offen sc1
  v_mfma_f32_16x16x32_bf16 v[20:23], a[180:183], v[96:99], v[20:23]
  v_mfma_f32_16x16x32_bf16 v[24:27], a[184:187], v[96:99], v[24:27]
  v_mfma_f32_16x16x32_bf16 v[28:31], a[188:191], v[96:99], v[28:31]
  v_mfma_f32_16x16x32_bf16 v[32:35], a[176:179], v[100:103], v[32:35]
  buffer_load_dwordx4 v[84:87], v207, s[8:11], s81 offen sc1
  v_mfma_f32_16x16x32_bf16 v[36:39], a[180:183], v[100:103], v[36:39]
  v_mfma_f32_16x16x32_bf16 v[40:43], a[184:187], v[100:103], v[40:43]
  v_mfma_f32_16x16x32_bf16 v[44:47], a[188:191], v[100:103], v[44:47]
  v_mfma_f32_16x16x32_bf16 v[48:51], a[176:179], v[104:107], v[48:51]
  buffer_load_dwordx4 v[88:91], v208, s[8:11], s81 offen sc1
  v_mfma_f32_16x16x32_bf16 v[52:55], a[180:183], v[104:107], v[52:55]
  v_mfma_f32_16x16x32_bf16 v[56:59], a[184:187], v[104:107], v[56:59]
  v_mfma_f32_16x16x32_bf16 v[60:63], a[188:191], v[104:107], v[60:63]
  v_mfma_f32_16x16x32_bf16 v[64:67], a[176:179], v[108:111], v[64:67]
  buffer_load_dwordx4 v[92:95], v209, s[8:11], s81 offen sc1
  v_mfma_f32_16x16x32_bf16 v[68:71], a[180:183], v[108:111], v[68:71]
  v_mfma_f32_16x16x32_bf16 v[72:75], a[184:187], v[108:111], v[72:75]
  v_mfma_f32_16x16x32_bf16 v[76:79], a[188:191], v[108:111], v[76:79]
VC296:
  s_waitcnt vmcnt(13)
  v_max3_u32 v12, v112, v116, v120
  s_waitcnt vmcnt(12)
  v_max_u32 v12, v12, v124
  v_cmp_eq_u32 vcc, -1, v12
  s_cbranch_vccnz VR297
VK298:
  v_mfma_f32_16x16x32_bf16 v[16:19], a[192:195], v[112:115], v[16:19]
  s_mov_b32 s78, s61
  s_mul_i32 s78, s78, 128
  s_add_u32 m0, s86, 12672
  s_nop 0
  buffer_load_dwordx4 v198, s[32:35], s78 offen offset:0 lds
  v_mfma_f32_16x16x32_bf16 v[20:23], a[196:199], v[112:115], v[20:23]
  v_mfma_f32_16x16x32_bf16 v[24:27], a[200:203], v[112:115], v[24:27]
  v_mfma_f32_16x16x32_bf16 v[28:31], a[204:207], v[112:115], v[28:31]
  v_mfma_f32_16x16x32_bf16 v[32:35], a[192:195], v[116:119], v[32:35]
  buffer_load_dwordx4 v199, s[32:35], s78 offen offset:1056 lds
  v_mfma_f32_16x16x32_bf16 v[36:39], a[196:199], v[116:119], v[36:39]
  v_mfma_f32_16x16x32_bf16 v[40:43], a[200:203], v[116:119], v[40:43]
  v_mfma_f32_16x16x32_bf16 v[44:47], a[204:207], v[116:119], v[44:47]
  v_mfma_f32_16x16x32_bf16 v[48:51], a[192:195], v[120:123], v[48:51]
  buffer_load_dwordx4 v200, s[32:35], s78 offen offset:2112 lds
  v_mfma_f32_16x16x32_bf16 v[52:55], a[196:199], v[120:123], v[52:55]
  v_mfma_f32_16x16x32_bf16 v[56:59], a[200:203], v[120:123], v[56:59]
  v_mfma_f32_16x16x32_bf16 v[60:63], a[204:207], v[120:123], v[60:63]
  v_mfma_f32_16x16x32_bf16 v[64:67], a[192:195], v[124:127], v[64:67]
  buffer_load_dwordx4 v201, s[32:35], s78 offen offset:3168 lds
  v_mfma_f32_16x16x32_bf16 v[68:71], a[196:199], v[124:127], v[68:71]
  v_mfma_f32_16x16x32_bf16 v[72:75], a[200:203], v[124:127], v[72:75]
  v_mfma_f32_16x16x32_bf16 v[76:79], a[204:207], v[124:127], v[76:79]
VC299:
  s_waitcnt vmcnt(13)
  v_max3_u32 v12, v128, v132, v136
  s_waitcnt vmcnt(12)
  v_max_u32 v12, v12, v140
  v_cmp_eq_u32 vcc, -1, v12
  s_cbranch_vccnz VR300
VK301:
  v_mfma_f32_16x16x32_bf16 v[16:19], a[208:211], v[128:131], v[16:19]
  s_add_u32 s78, s61, 1024
  s_sub_u32 s68, s78, 12288
  s_cselect_b32 s78, s78, s68
  s_mul_i32 s78, s78, 128
  s_add_u32 m0, s86, 16896
  s_nop 0
  buffer_load_dwordx4 v198, s[32:35], s78 offen offset:0 lds
  v_mfma_f32_16x16x32_bf16 v[20:23], a[212:215], v[128:131], v[20:23]
  v_mfma_f32_16x16x32_bf16 v[24:27], a[216:219], v[128:131], v[24:27]
  v_mfma_f32_16x16x32_bf16 v[28:31], a[220:223], v[128:131], v[28:31]
  v_mfma_f32_16x16x32_bf16 v[32:35], a[208:211], v[132:135], v[32:35]
  buffer_load_dwordx4 v199, s[32:35], s78 offen offset:1056 lds
  v_mfma_f32_16x16x32_bf16 v[36:39], a[212:215], v[132:135], v[36:39]
  v_mfma_f32_16x16x32_bf16 v[40:43], a[216:219], v[132:135], v[40:43]
  v_mfma_f32_16x16x32_bf16 v[44:47], a[220:223], v[132:135], v[44:47]
  v_mfma_f32_16x16x32_bf16 v[48:51], a[208:211], v[136:139], v[48:51]
  buffer_load_dwordx4 v200, s[32:35], s78 offen offset:2112 lds
  v_mfma_f32_16x16x32_bf16 v[52:55], a[212:215], v[136:139], v[52:55]
  v_mfma_f32_16x16x32_bf16 v[56:59], a[216:219], v[136:139], v[56:59]
  v_mfma_f32_16x16x32_bf16 v[60:63], a[220:223], v[136:139], v[60:63]
  v_mfma_f32_16x16x32_bf16 v[64:67], a[208:211], v[140:143], v[64:67]
  buffer_load_dwordx4 v201, s[32:35], s78 offen offset:3168 lds
  v_mfma_f32_16x16x32_bf16 v[68:71], a[212:215], v[140:143], v[68:71]
  v_mfma_f32_16x16x32_bf16 v[72:75], a[216:219], v[140:143], v[72:75]
  v_mfma_f32_16x16x32_bf16 v[76:79], a[220:223], v[140:143], v[76:79]
VC302:
  s_waitcnt vmcnt(13)
  v_max3_u32 v12, v144, v148, v152
  s_waitcnt vmcnt(12)
  v_max_u32 v12, v12, v156
  v_cmp_eq_u32 vcc, -1, v12
  s_cbranch_vccnz VR303
VK304:
  v_mfma_f32_16x16x32_bf16 v[16:19], a[224:227], v[144:147], v[16:19]
  s_add_u32 s78, s61, 2048
  s_sub_u32 s68, s78, 12288
  s_cselect_b32 s78, s78, s68
  s_mul_i32 s78, s78, 128
  s_add_u32 m0, s86, 21120
  s_nop 0
  buffer_load_dwordx4 v198, s[32:35], s78 offen offset:0 lds
  v_mfma_f32_16x16x32_bf16 v[20:23], a[228:231], v[144:147], v[20:23]
  v_mfma_f32_16x16x32_bf16 v[24:27], a[232:235], v[144:147], v[24:27]
  v_mfma_f32_16x16x32_bf16 v[28:31], a[236:239], v[144:147], v[28:31]
  v_mfma_f32_16x16x32_bf16 v[32:35], a[224:227], v[148:151], v[32:35]
  buffer_load_dwordx4 v199, s[32:35], s78 offen offset:1056 lds
  v_mfma_f32_16x16x32_bf16 v[36:39], a[228:231], v[148:151], v[36:39]
  v_mfma_f32_16x16x32_bf16 v[40:43], a[232:235], v[148:151], v[40:43]
  v_mfma_f32_16x16x32_bf16 v[44:47], a[236:239], v[148:151], v[44:47]
  v_mfma_f32_16x16x32_bf16 v[48:51], a[224:227], v[152:155], v[48:51]
  buffer_load_dwordx4 v200, s[32:35], s78 offen offset:2112 lds
  v_mfma_f32_16x16x32_bf16 v[52:55], a[228:231], v[152:155], v[52:55]
  v_mfma_f32_16x16x32_bf16 v[56:59], a[232:235], v[152:155], v[56:59]
  v_mfma_f32_16x16x32_bf16 v[60:63], a[236:239], v[152:155], v[60:63]
  v_mfma_f32_16x16x32_bf16 v[64:67], a[224:227], v[156:159], v[64:67]
  buffer_load_dwordx4 v201, s[32:35], s78 offen offset:3168 lds
  v_mfma_f32_16x16x32_bf16 v[68:71], a[228:231], v[156:159], v[68:71]
  v_mfma_f32_16x16x32_bf16 v[72:75], a[232:235], v[156:159], v[72:75]
  v_mfma_f32_16x16x32_bf16 v[76:79], a[236:239], v[156:159], v[76:79]
VC305:
  s_waitcnt vmcnt(13)
  v_max3_u32 v12, v80, v84, v88
  s_waitcnt vmcnt(12)
  v_max_u32 v12, v12, v92
  v_cmp_eq_u32 vcc, -1, v12
  s_cbranch_vccnz VR306
VK307:
  v_mfma_f32_16x16x32_bf16 v[32:35], a[240:243], v[84:87], v[32:35]
  s_add_u32 s78, s61, 3072
  s_sub_u32 s68, s78, 12288
  s_cselect_b32 s78, s78, s68
  s_mul_i32 s78, s78, 128
  s_add_u32 m0, s86, 25344
  s_nop 0
  buffer_load_dwordx4 v198, s[32:35], s78 offen offset:0 lds
  v_mfma_f32_16x16x32_bf16 v[36:39], a[244:247], v[84:87], v[36:39]
  v_mfma_f32_16x16x32_bf16 v[40:43], a[248:251], v[84:87], v[40:43]
  v_mfma_f32_16x16x32_bf16 v[44:47], a[252:255], v[84:87], v[44:47]
  v_mfma_f32_16x16x32_bf16 v[48:51], a[240:243], v[88:91], v[48:51]
  buffer_load_dwordx4 v199, s[32:35], s78 offen offset:1056 lds
  v_mfma_f32_16x16x32_bf16 v[52:55], a[244:247], v[88:91], v[52:55]
  ds_write_b128 v3, v[32:35] offset:0
  v_mfma_f32_16x16x32_bf16 v[56:59], a[248:251], v[88:91], v[56:59]
  s_nop 0
  ds_write_b128 v3, v[36:39] offset:1024
  v_mfma_f32_16x16x32_bf16 v[60:63], a[252:255], v[88:91], v[60:63]
  ds_write_b128 v3, v[40:43] offset:2048
  v_mfma_f32_16x16x32_bf16 v[64:67], a[240:243], v[92:95], v[64:67]
  buffer_load_dwordx4 v200, s[32:35], s78 offen offset:2112 lds
  ds_write_b128 v3, v[44:47] offset:3072
  v_mfma_f32_16x16x32_bf16 v[68:71], a[244:247], v[92:95], v[68:71]
  ds_write_b128 v4, v[48:51] offset:4096
  v_mfma_f32_16x16x32_bf16 v[72:75], a[248:251], v[92:95], v[72:75]
  ds_write_b128 v4, v[52:55] offset:5120
  v_mfma_f32_16x16x32_bf16 v[76:79], a[252:255], v[92:95], v[76:79]
  ds_write_b128 v4, v[56:59] offset:6144
  v_mfma_f32_16x16x32_bf16 v[16:19], a[240:243], v[80:83], v[16:19]
  buffer_load_dwordx4 v201, s[32:35], s78 offen offset:3168 lds
  ds_write_b128 v4, v[60:63] offset:7168
  v_mfma_f32_16x16x32_bf16 v[20:23], a[244:247], v[80:83], v[20:23]
  ds_write_b128 v5, v[64:67] offset:8192
  v_mfma_f32_16x16x32_bf16 v[24:27], a[248:251], v[80:83], v[24:27]
  ds_write_b128 v5, v[68:71] offset:9216
  v_mfma_f32_16x16x32_bf16 v[28:31], a[252:255], v[80:83], v[28:31]
  ds_write_b128 v5, v[72:75] offset:10240
  ds_write_b128 v5, v[76:79] offset:11264
  s_add_u32 s78, s61, 4096
  s_sub_u32 s68, s78, 12288
  s_cselect_b32 s78, s78, s68
  s_mul_i32 s78, s78, 128
  s_add_u32 m0, s86, 29568
  s_nop 0
  buffer_load_dwordx4 v198, s[32:35], s78 offen offset:0 lds
  buffer_load_dwordx4 v199, s[32:35], s78 offen offset:1056 lds
  buffer_load_dwordx4 v200, s[32:35], s78 offen offset:2112 lds
  buffer_load_dwordx4 v201, s[32:35], s78 offen offset:3168 lds
  s_waitcnt lgkmcnt(0)
  s_barrier
  ds_read_b128 v[80:83], v2 offset:0
  ds_read_b128 v[96:99], v2 offset:4096
  ds_read_b128 v[112:115], v2 offset:8192
  ds_read_b128 v[84:87], v2 offset:1024
  ds_read_b128 v[100:103], v2 offset:5120
  ds_read_b128 v[116:119], v2 offset:9216
  ds_read_b128 v[88:91], v2 offset:2048
  ds_read_b128 v[104:107], v2 offset:6144
  ds_read_b128 v[120:123], v2 offset:10240
  ds_read_b128 v[92:95], v2 offset:3072
  ds_read_b128 v[108:111], v2 offset:7168
  ds_read_b128 v[124:127], v2 offset:11264
  s_add_u32 s78, s61, 5120
  s_sub_u32 s68, s78, 12288
  s_cselect_b32 s78, s78, s68
  s_mul_i32 s78, s78, 128
  s_add_u32 m0, s86, 33792
  s_nop 0
  buffer_load_dwordx4 v198, s[32:35], s78 offen offset:0 lds
  buffer_load_dwordx4 v199, s[32:35], s78 offen offset:1056 lds
  buffer_load_dwordx4 v200, s[32:35], s78 offen offset:2112 lds
  buffer_load_dwordx4 v201, s[32:35], s78 offen offset:3168 lds
  s_waitcnt lgkmcnt(11)
  v_pk_add_f32 v[16:17], v[16:17], v[80:81]
  v_pk_add_f32 v[18:19], v[18:19], v[82:83]
  s_waitcnt lgkmcnt(8)
  v_pk_add_f32 v[20:21], v[20:21], v[84:85]
  v_pk_add_f32 v[22:23], v[22:23], v[86:87]
  v_pk_add_f32 v[16:17], v[16:17], v[96:97]
  v_pk_add_f32 v[18:19], v[18:19], v[98:99]
  s_waitcnt lgkmcnt(7)
  v_pk_add_f32 v[20:21], v[20:21], v[100:101]
  v_pk_add_f32 v[22:23], v[22:23], v[102:103]
  v_pk_add_f32 v[16:17], v[16:17], v[112:113]
  v_pk_add_f32 v[18:19], v[18:19], v[114:115]
  s_waitcnt lgkmcnt(6)
  v_pk_add_f32 v[20:21], v[20:21], v[116:117]
  v_pk_add_f32 v[22:23], v[22:23], v[118:119]
  v_pk_mul_f32 v[128:129], v[16:17], v[16:17]
  v_pk_mul_f32 v[130:131], v[18:19], v[18:19]
  v_pk_mul_f32 v[132:133], v[20:21], v[20:21]
  v_pk_mul_f32 v[134:135], v[22:23], v[22:23]
  v_pk_fma_f32 v[128:129], v[128:129], v[6:7], v[8:9] op_sel_hi:[1,0,0]
  v_pk_fma_f32 v[130:131], v[130:131], v[6:7], v[8:9] op_sel_hi:[1,0,0]
  v_pk_fma_f32 v[132:133], v[132:133], v[6:7], v[8:9] op_sel_hi:[1,0,0]
  v_pk_fma_f32 v[134:135], v[134:135], v[6:7], v[8:9] op_sel_hi:[1,0,0]
  v_pk_mul_f32 v[128:129], v[128:129], v[16:17]
  v_pk_mul_f32 v[130:131], v[130:131], v[18:19]
  v_pk_mul_f32 v[132:133], v[132:133], v[20:21]
  v_pk_mul_f32 v[134:135], v[134:135], v[22:23]
  v_exp_f32 v128, v128
  v_exp_f32 v129, v129
  v_exp_f32 v130, v130
  v_exp_f32 v131, v131
  v_exp_f32 v132, v132
  v_exp_f32 v133, v133
  v_exp_f32 v134, v134
  v_exp_f32 v135, v135
  v_pk_add_f32 v[128:129], v[128:129], v[10:11] op_sel_hi:[1,0]
  v_pk_add_f32 v[130:131], v[130:131], v[10:11] op_sel_hi:[1,0]
  v_pk_add_f32 v[132:133], v[132:133], v[10:11] op_sel_hi:[1,0]
  v_pk_add_f32 v[134:135], v[134:135], v[10:11] op_sel_hi:[1,0]
  v_rcp_f32 v128, v128
  v_rcp_f32 v129, v129
  v_rcp_f32 v130, v130
  v_rcp_f32 v131, v131
  v_rcp_f32 v132, v132
  v_rcp_f32 v133, v133
  v_rcp_f32 v134, v134
  v_rcp_f32 v135, v135
  v_pk_mul_f32 v[128:129], v[128:129], v[16:17]
  v_pk_mul_f32 v[130:131], v[130:131], v[18:19]
  v_pk_mul_f32 v[132:133], v[132:133], v[20:21]
  v_pk_mul_f32 v[134:135], v[134:135], v[22:23]
  v_cvt_pk_bf16_f32 v144, v128, v129
  v_cvt_pk_bf16_f32 v145, v130, v131
  v_cvt_pk_bf16_f32 v146, v132, v133
  v_cvt_pk_bf16_f32 v147, v134, v135
  buffer_store_dwordx4 v[144:147], v13, s[8:11], s73 offen offset:0 sc1
  s_waitcnt lgkmcnt(5)
  v_pk_add_f32 v[24:25], v[24:25], v[88:89]
  v_pk_add_f32 v[26:27], v[26:27], v[90:91]
  s_waitcnt lgkmcnt(2)
  v_pk_add_f32 v[28:29], v[28:29], v[92:93]
  v_pk_add_f32 v[30:31], v[30:31], v[94:95]
  v_pk_add_f32 v[24:25], v[24:25], v[104:105]
  v_pk_add_f32 v[26:27], v[26:27], v[106:107]
  s_waitcnt lgkmcnt(1)
  v_pk_add_f32 v[28:29], v[28:29], v[108:109]
  v_pk_add_f32 v[30:31], v[30:31], v[110:111]
  v_pk_add_f32 v[24:25], v[24:25], v[120:121]
  v_pk_add_f32 v[26:27], v[26:27], v[122:123]
  s_waitcnt lgkmcnt(0)
  v_pk_add_f32 v[28:29], v[28:29], v[124:125]
  v_pk_add_f32 v[30:31], v[30:31], v[126:127]
  v_pk_mul_f32 v[136:137], v[24:25], v[24:25]
  v_pk_mul_f32 v[138:139], v[26:27], v[26:27]
  v_pk_mul_f32 v[140:141], v[28:29], v[28:29]
  v_pk_mul_f32 v[142:143], v[30:31], v[30:31]
  v_pk_fma_f32 v[136:137], v[136:137], v[6:7], v[8:9] op_sel_hi:[1,0,0]
  v_pk_fma_f32 v[138:139], v[138:139], v[6:7], v[8:9] op_sel_hi:[1,0,0]
  v_pk_fma_f32 v[140:141], v[140:141], v[6:7], v[8:9] op_sel_hi:[1,0,0]
  v_pk_fma_f32 v[142:143], v[142:143], v[6:7], v[8:9] op_sel_hi:[1,0,0]
  v_pk_mul_f32 v[136:137], v[136:137], v[24:25]
  v_pk_mul_f32 v[138:139], v[138:139], v[26:27]
  v_pk_mul_f32 v[140:141], v[140:141], v[28:29]
  v_pk_mul_f32 v[142:143], v[142:143], v[30:31]
  v_exp_f32 v136, v136
  v_exp_f32 v137, v137
  v_exp_f32 v138, v138
  v_exp_f32 v139, v139
  v_exp_f32 v140, v140
  v_exp_f32 v141, v141
  v_exp_f32 v142, v142
  v_exp_f32 v143, v143
  v_pk_add_f32 v[136:137], v[136:137], v[10:11] op_sel_hi:[1,0]
  v_pk_add_f32 v[138:139], v[138:139], v[10:11] op_sel_hi:[1,0]
  v_pk_add_f32 v[140:141], v[140:141], v[10:11] op_sel_hi:[1,0]
  v_pk_add_f32 v[142:143], v[142:143], v[10:11] op_sel_hi:[1,0]
  v_rcp_f32 v136, v136
  v_rcp_f32 v137, v137
  v_rcp_f32 v138, v138
  v_rcp_f32 v139, v139
  v_rcp_f32 v140, v140
  v_rcp_f32 v141, v141
  v_rcp_f32 v142, v142
  v_rcp_f32 v143, v143
  v_pk_mul_f32 v[136:137], v[136:137], v[24:25]
  v_pk_mul_f32 v[138:139], v[138:139], v[26:27]
  v_pk_mul_f32 v[140:141], v[140:141], v[28:29]
  v_pk_mul_f32 v[142:143], v[142:143], v[30:31]
  v_cvt_pk_bf16_f32 v148, v136, v137
  v_cvt_pk_bf16_f32 v149, v138, v139
  v_cvt_pk_bf16_f32 v150, v140, v141
  v_cvt_pk_bf16_f32 v151, v142, v143
  buffer_store_dwordx4 v[148:151], v13, s[8:11], s73 offen offset:1024 sc1
  s_barrier
JN259:
  s_waitcnt vmcnt(22)
  ds_read_b64_tr_b16 a[0:1], v202 offset:12672
  ds_read_b64_tr_b16 a[2:3], v202 offset:13184
  ds_read_b64_tr_b16 a[4:5], v203 offset:12672
  ds_read_b64_tr_b16 a[6:7], v203 offset:13184
  ds_read_b64_tr_b16 a[8:9], v204 offset:12672
  ds_read_b64_tr_b16 a[10:11], v204 offset:13184
  ds_read_b64_tr_b16 a[12:13], v205 offset:12672
  ds_read_b64_tr_b16 a[14:15], v205 offset:13184
  s_waitcnt vmcnt(18)
  ds_read_b64_tr_b16 a[16:17], v202 offset:16896
  ds_read_b64_tr_b16 a[18:19], v202 offset:17408
  ds_read_b64_tr_b16 a[20:21], v203 offset:16896
  ds_read_b64_tr_b16 a[22:23], v203 offset:17408
  ds_read_b64_tr_b16 a[24:25], v204 offset:16896
  ds_read_b64_tr_b16 a[26:27], v204 offset:17408
  ds_read_b64_tr_b16 a[28:29], v205 offset:16896
  ds_read_b64_tr_b16 a[30:31], v205 offset:17408
  s_waitcnt vmcnt(14)
  ds_read_b64_tr_b16 a[32:33], v202 offset:21120
  ds_read_b64_tr_b16 a[34:35], v202 offset:21632
  ds_read_b64_tr_b16 a[36:37], v203 offset:21120
  ds_read_b64_tr_b16 a[38:39], v203 offset:21632
  ds_read_b64_tr_b16 a[40:41], v204 offset:21120
  ds_read_b64_tr_b16 a[42:43], v204 offset:21632
  ds_read_b64_tr_b16 a[44:45], v205 offset:21120
  ds_read_b64_tr_b16 a[46:47], v205 offset:21632
  s_waitcnt vmcnt(10)
  ds_read_b64_tr_b16 a[48:49], v202 offset:25344
  ds_read_b64_tr_b16 a[50:51], v202 offset:25856
  ds_read_b64_tr_b16 a[52:53], v203 offset:25344
  ds_read_b64_tr_b16 a[54:55], v203 offset:25856
  ds_read_b64_tr_b16 a[56:57], v204 offset:25344
  ds_read_b64_tr_b16 a[58:59], v204 offset:25856
  ds_read_b64_tr_b16 a[60:61], v205 offset:25344
  ds_read_b64_tr_b16 a[62:63], v205 offset:25856
  s_add_u32 s78, s61, 6144
  s_sub_u32 s68, s78, 12288
  s_cselect_b32 s78, s78, s68
  s_mul_i32 s78, s78, 128
  s_add_u32 m0, s86, 0
  s_nop 0
  buffer_load_dwordx4 v198, s[32:35], s78 offen offset:0 lds
  s_mov_b32 s82, 131072
  buffer_load_dwordx4 v199, s[32:35], s78 offen offset:1056 lds
  s_add_u32 s66, s52, 1
  buffer_load_dwordx4 v200, s[32:35], s78 offen offset:2112 lds
  s_and_b32 s66, s66, 3
  buffer_load_dwordx4 v201, s[32:35], s78 offen offset:3168 lds
  s_mul_i32 s66, s66, 15360
  s_add_u32 s78, s61, 7168
  s_sub_u32 s68, s78, 12288
  s_cselect_b32 s78, s78, s68
  s_mul_i32 s78, s78, 128
  s_add_u32 m0, s86, 4224
  s_nop 0
  buffer_load_dwordx4 v198, s[32:35], s78 offen offset:0 lds
  s_add_u32 s66, s66, 92160
  buffer_load_dwordx4 v199, s[32:35], s78 offen offset:1056 lds
  v_add_u32 v5, s66, v13
  buffer_load_dwordx4 v200, s[32:35], s78 offen offset:2112 lds
  s_add_u32 s66, s52, 2
  buffer_load_dwordx4 v201, s[32:35], s78 offen offset:3168 lds
  s_and_b32 s66, s66, 3
  s_add_u32 s78, s61, 8192
  s_sub_u32 s68, s78, 12288
  s_cselect_b32 s78, s78, s68
  s_mul_i32 s78, s78, 128
  s_add_u32 m0, s86, 8448
  s_nop 0
  buffer_load_dwordx4 v198, s[32:35], s78 offen offset:0 lds
  s_mul_i32 s66, s66, 15360
  buffer_load_dwordx4 v199, s[32:35], s78 offen offset:1056 lds
  s_add_u32 s66, s66, 92160
  buffer_load_dwordx4 v200, s[32:35], s78 offen offset:2112 lds
  v_add_u32 v6, s66, v13
  buffer_load_dwordx4 v201, s[32:35], s78 offen offset:3168 lds
  s_add_u32 s66, s52, 3
  s_waitcnt lgkmcnt(0)
  s_and_b32 s66, s66, 3
  s_add_u32 s78, s61, 9216
  s_sub_u32 s68, s78, 12288
  s_cselect_b32 s78, s78, s68
  s_mul_i32 s78, s78, 128
  s_add_u32 m0, s86, 12672
  s_nop 0
  buffer_load_dwordx4 v198, s[32:35], s78 offen offset:0 lds
  s_mul_i32 s66, s66, 15360
  buffer_load_dwordx4 v199, s[32:35], s78 offen offset:1056 lds
  s_add_u32 s66, s66, 92160
  buffer_load_dwordx4 v200, s[32:35], s78 offen offset:2112 lds
  v_add_u32 v7, s66, v13
  buffer_load_dwordx4 v201, s[32:35], s78 offen offset:3168 lds
  s_mul_i32 s66, s52, 15360
  s_add_u32 s66, s66, 92160
  s_add_u32 s78, s61, 10240
  s_sub_u32 s68, s78, 12288
  s_cselect_b32 s78, s78, s68
  s_mul_i32 s78, s78, 128
  s_add_u32 m0, s86, 16896
  s_nop 0
  buffer_load_dwordx4 v198, s[32:35], s78 offen offset:0 lds
  v_add_u32 v215, s66, v13
  buffer_load_dwordx4 v199, s[32:35], s78 offen offset:1056 lds
  v_and_b32 v2, 15, v1
  buffer_load_dwordx4 v200, s[32:35], s78 offen offset:2112 lds
  v_mul_u32_u24 v2, 1280, v2
  buffer_load_dwordx4 v201, s[32:35], s78 offen offset:3168 lds
  v_lshrrev_b32 v3, 4, v1
  v_lshl_add_u32 v2, v3, 3, v2
  s_add_u32 s78, s61, 11264
  s_sub_u32 s68, s78, 12288
  s_cselect_b32 s78, s78, s68
  s_mul_i32 s78, s78, 128
  s_add_u32 m0, s86, 21120
  s_nop 0
  buffer_load_dwordx4 v198, s[32:35], s78 offen offset:0 lds
  s_mul_i32 s74, s59, 20480
  buffer_load_dwordx4 v199, s[32:35], s78 offen offset:1056 lds
  s_mul_i32 s66, s55, 160
  buffer_load_dwordx4 v200, s[32:35], s78 offen offset:2112 lds
  s_add_u32 s74, s74, s66
  buffer_load_dwordx4 v201, s[32:35], s78 offen offset:3168 lds
  s_mov_b32 s81, s61
  buffer_load_dwordx4 v[96:99], v210, s[8:11], s81 offen sc1
  buffer_load_dwordx4 v[100:103], v211, s[8:11], s81 offen sc1
  buffer_load_dwordx4 v[104:107], v212, s[8:11], s81 offen sc1
  buffer_load_dwordx4 v[108:111], v213, s[8:11], s81 offen sc1
  buffer_load_dwordx4 v[112:115], v214, s[8:11], s81 offen sc1
  s_add_u32 s81, s61, 1024
  s_sub_u32 s68, s81, 12288
  s_cselect_b32 s81, s81, s68
  buffer_load_dwordx4 v[116:119], v210, s[8:11], s81 offen sc1
  buffer_load_dwordx4 v[120:123], v211, s[8:11], s81 offen sc1
  buffer_load_dwordx4 v[124:127], v212, s[8:11], s81 offen sc1
  buffer_load_dwordx4 v[128:131], v213, s[8:11], s81 offen sc1
  buffer_load_dwordx4 v[132:135], v214, s[8:11], s81 offen sc1
  s_add_u32 s81, s61, 2048
  s_sub_u32 s68, s81, 12288
  s_cselect_b32 s81, s81, s68
  buffer_load_dwordx4 v[136:139], v210, s[8:11], s81 offen sc1
  buffer_load_dwordx4 v[140:143], v211, s[8:11], s81 offen sc1
  buffer_load_dwordx4 v[144:147], v212, s[8:11], s81 offen sc1
  buffer_load_dwordx4 v[148:151], v213, s[8:11], s81 offen sc1
  buffer_load_dwordx4 v[152:155], v214, s[8:11], s81 offen sc1
VC308:
  s_waitcnt vmcnt(12)
  v_max3_u32 v8, v96, v100, v104
  s_waitcnt vmcnt(10)
  v_max3_u32 v8, v8, v108, v112
  v_cmp_eq_u32 vcc, -1, v8
  s_cbranch_vccnz VR309
VK310:
  v_mfma_f32_16x16x32_bf16 v[16:19], v[96:99], a[0:3], 0
  s_add_u32 s81, s61, 3072
  s_sub_u32 s68, s81, 12288
  s_cselect_b32 s81, s81, s68
  buffer_load_dwordx4 v[156:159], v210, s[8:11], s81 offen sc1
  v_mfma_f32_16x16x32_bf16 v[36:39], v[96:99], a[4:7], 0
  ds_read_b64_tr_b16 a[64:65], v202 offset:29568
  v_mfma_f32_16x16x32_bf16 v[56:59], v[96:99], a[8:11], 0
  v_mfma_f32_16x16x32_bf16 v[76:79], v[96:99], a[12:15], 0
  ds_read_b64_tr_b16 a[66:67], v202 offset:30080
  v_mfma_f32_16x16x32_bf16 v[20:23], v[100:103], a[0:3], 0
  buffer_load_dwordx4 v[160:163], v211, s[8:11], s81 offen sc1
  v_mfma_f32_16x16x32_bf16 v[40:43], v[100:103], a[4:7], 0
  ds_read_b64_tr_b16 a[68:69], v203 offset:29568
  v_mfma_f32_16x16x32_bf16 v[60:63], v[100:103], a[8:11], 0
  v_mfma_f32_16x16x32_bf16 v[80:83], v[100:103], a[12:15], 0
  ds_read_b64_tr_b16 a[70:71], v203 offset:30080
  v_mfma_f32_16x16x32_bf16 v[24:27], v[104:107], a[0:3], 0
  buffer_load_dwordx4 v[164:167], v212, s[8:11], s81 offen sc1
  v_mfma_f32_16x16x32_bf16 v[44:47], v[104:107], a[4:7], 0
  v_mfma_f32_16x16x32_bf16 v[64:67], v[104:107], a[8:11], 0
  ds_read_b64_tr_b16 a[72:73], v204 offset:29568
  v_mfma_f32_16x16x32_bf16 v[84:87], v[104:107], a[12:15], 0
  v_mfma_f32_16x16x32_bf16 v[28:31], v[108:111], a[0:3], 0
  buffer_load_dwordx4 v[168:171], v213, s[8:11], s81 offen sc1
  ds_read_b64_tr_b16 a[74:75], v204 offset:30080
  v_mfma_f32_16x16x32_bf16 v[48:51], v[108:111], a[4:7], 0
  v_mfma_f32_16x16x32_bf16 v[68:71], v[108:111], a[8:11], 0
  ds_read_b64_tr_b16 a[76:77], v205 offset:29568
  v_mfma_f32_16x16x32_bf16 v[88:91], v[108:111], a[12:15], 0
  v_mfma_f32_16x16x32_bf16 v[32:35], v[112:115], a[0:3], 0
  buffer_load_dwordx4 v[172:175], v214, s[8:11], s81 offen sc1
  v_mfma_f32_16x16x32_bf16 v[52:55], v[112:115], a[4:7], 0
  ds_read_b64_tr_b16 a[78:79], v205 offset:30080
  v_mfma_f32_16x16x32_bf16 v[72:75], v[112:115], a[8:11], 0
  v_mfma_f32_16x16x32_bf16 v[92:95], v[112:115], a[12:15], 0
VC311:
  s_waitcnt vmcnt(12)
  v_max3_u32 v8, v116, v120, v124
  s_waitcnt vmcnt(10)
  v_max3_u32 v8, v8, v128, v132
  v_cmp_eq_u32 vcc, -1, v8
  s_cbranch_vccnz VR312
VK313:
  v_mfma_f32_16x16x32_bf16 v[16:19], v[116:119], a[16:19], v[16:19]
  s_add_u32 s81, s61, 4096
  s_sub_u32 s68, s81, 12288
  s_cselect_b32 s81, s81, s68
  buffer_load_dwordx4 v[96:99], v210, s[8:11], s81 offen sc1
  v_mfma_f32_16x16x32_bf16 v[36:39], v[116:119], a[20:23], v[36:39]
  ds_read_b64_tr_b16 a[80:81], v202 offset:33792
  v_mfma_f32_16x16x32_bf16 v[56:59], v[116:119], a[24:27], v[56:59]
  v_mfma_f32_16x16x32_bf16 v[76:79], v[116:119], a[28:31], v[76:79]
  ds_read_b64_tr_b16 a[82:83], v202 offset:34304
  v_mfma_f32_16x16x32_bf16 v[20:23], v[120:123], a[16:19], v[20:23]
  buffer_load_dwordx4 v[100:103], v211, s[8:11], s81 offen sc1
  v_mfma_f32_16x16x32_bf16 v[40:43], v[120:123], a[20:23], v[40:43]
  ds_read_b64_tr_b16 a[84:85], v203 offset:33792
  v_mfma_f32_16x16x32_bf16 v[60:63], v[120:123], a[24:27], v[60:63]
  v_mfma_f32_16x16x32_bf16 v[80:83], v[120:123], a[28:31], v[80:83]
  ds_read_b64_tr_b16 a[86:87], v203 offset:34304
  v_mfma_f32_16x16x32_bf16 v[24:27], v[124:127], a[16:19], v[24:27]
  buffer_load_dwordx4 v[104:107], v212, s[8:11], s81 offen sc1
  v_mfma_f32_16x16x32_bf16 v[44:47], v[124:127], a[20:23], v[44:47]
  v_mfma_f32_16x16x32_bf16 v[64:67], v[124:127], a[24:27], v[64:67]
  ds_read_b64_tr_b16 a[88:89], v204 offset:33792
  v_mfma_f32_16x16x32_bf16 v[84:87], v[124:127], a[28:31], v[84:87]
  v_mfma_f32_16x16x32_bf16 v[28:31], v[128:131], a[16:19], v[28:31]
  buffer_load_dwordx4 v[108:111], v213, s[8:11], s81 offen sc1
  ds_read_b64_tr_b16 a[90:91], v204 offset:34304
  v_mfma_f32_16x16x32_bf16 v[48:51], v[128:131], a[20:23], v[48:51]
  v_mfma_f32_16x16x32_bf16 v[68:71], v[128:131], a[24:27], v[68:71]
  ds_read_b64_tr_b16 a[92:93], v205 offset:33792
  v_mfma_f32_16x16x32_bf16 v[88:91], v[128:131], a[28:31], v[88:91]
  v_mfma_f32_16x16x32_bf16 v[32:35], v[132:135], a[16:19], v[32:35]
  buffer_load_dwordx4 v[112:115], v214, s[8:11], s81 offen sc1
  v_mfma_f32_16x16x32_bf16 v[52:55], v[132:135], a[20:23], v[52:55]
  ds_read_b64_tr_b16 a[94:95], v205 offset:34304
  v_mfma_f32_16x16x32_bf16 v[72:75], v[132:135], a[24:27], v[72:75]
  v_mfma_f32_16x16x32_bf16 v[92:95], v[132:135], a[28:31], v[92:95]
VC314:
  s_waitcnt vmcnt(12)
  v_max3_u32 v8, v136, v140, v144
  s_waitcnt vmcnt(10)
  v_max3_u32 v8, v8, v148, v152
  v_cmp_eq_u32 vcc, -1, v8
  s_cbranch_vccnz VR315
VK316:
  v_mfma_f32_16x16x32_bf16 v[16:19], v[136:139], a[32:35], v[16:19]
  s_add_u32 s81, s61, 5120
  s_sub_u32 s68, s81, 12288
  s_cselect_b32 s81, s81, s68
  buffer_load_dwordx4 v[116:119], v210, s[8:11], s81 offen sc1
  v_mfma_f32_16x16x32_bf16 v[36:39], v[136:139], a[36:39], v[36:39]
  ds_read_b64_tr_b16 a[96:97], v202 offset:0
  v_mfma_f32_16x16x32_bf16 v[56:59], v[136:139], a[40:43], v[56:59]
  v_mfma_f32_16x16x32_bf16 v[76:79], v[136:139], a[44:47], v[76:79]
  ds_read_b64_tr_b16 a[98:99], v202 offset:512
  v_mfma_f32_16x16x32_bf16 v[20:23], v[140:143], a[32:35], v[20:23]
  buffer_load_dwordx4 v[120:123], v211, s[8:11], s81 offen sc1
  v_mfma_f32_16x16x32_bf16 v[40:43], v[140:143], a[36:39], v[40:43]
  ds_read_b64_tr_b16 a[100:101], v203 offset:0
  v_mfma_f32_16x16x32_bf16 v[60:63], v[140:143], a[40:43], v[60:63]
  v_mfma_f32_16x16x32_bf16 v[80:83], v[140:143], a[44:47], v[80:83]
  ds_read_b64_tr_b16 a[102:103], v203 offset:512
  v_mfma_f32_16x16x32_bf16 v[24:27], v[144:147], a[32:35], v[24:27]
  buffer_load_dwordx4 v[124:127], v212, s[8:11], s81 offen sc1
  v_mfma_f32_16x16x32_bf16 v[44:47], v[144:147], a[36:39], v[44:47]
  v_mfma_f32_16x16x32_bf16 v[64:67], v[144:147], a[40:43], v[64:67]
  ds_read_b64_tr_b16 a[104:105], v204 offset:0
  v_mfma_f32_16x16x32_bf16 v[84:87], v[144:147], a[44:47], v[84:87]
  v_mfma_f32_16x16x32_bf16 v[28:31], v[148:151], a[32:35], v[28:31]
  buffer_load_dwordx4 v[128:131], v213, s[8:11], s81 offen sc1
  ds_read_b64_tr_b16 a[106:107], v204 offset:512
  v_mfma_f32_16x16x32_bf16 v[48:51], v[148:151], a[36:39], v[48:51]
  v_mfma_f32_16x16x32_bf16 v[68:71], v[148:151], a[40:43], v[68:71]
  ds_read_b64_tr_b16 a[108:109], v205 offset:0
  v_mfma_f32_16x16x32_bf16 v[88:91], v[148:151], a[44:47], v[88:91]
  v_mfma_f32_16x16x32_bf16 v[32:35], v[152:155], a[32:35], v[32:35]
  buffer_load_dwordx4 v[132:135], v214, s[8:11], s81 offen sc1
  v_mfma_f32_16x16x32_bf16 v[52:55], v[152:155], a[36:39], v[52:55]
  ds_read_b64_tr_b16 a[110:111], v205 offset:512
  v_mfma_f32_16x16x32_bf16 v[72:75], v[152:155], a[40:43], v[72:75]
  v_mfma_f32_16x16x32_bf16 v[92:95], v[152:155], a[44:47], v[92:95]
VC317:
  s_waitcnt vmcnt(12)
  v_max3_u32 v8, v156, v160, v164
  s_waitcnt vmcnt(10)
  v_max3_u32 v8, v8, v168, v172
  v_cmp_eq_u32 vcc, -1, v8
  s_cbranch_vccnz VR318
VK319:
  v_mfma_f32_16x16x32_bf16 v[16:19], v[156:159], a[48:51], v[16:19]
  s_add_u32 s81, s61, 6144
  s_sub_u32 s68, s81, 12288
  s_cselect_b32 s81, s81, s68
  buffer_load_dwordx4 v[136:139], v210, s[8:11], s81 offen sc1
  v_mfma_f32_16x16x32_bf16 v[36:39], v[156:159], a[52:55], v[36:39]
  ds_read_b64_tr_b16 a[112:113], v202 offset:4224
  v_mfma_f32_16x16x32_bf16 v[56:59], v[156:159], a[56:59], v[56:59]
  v_mfma_f32_16x16x32_bf16 v[76:79], v[156:159], a[60:63], v[76:79]
  ds_read_b64_tr_b16 a[114:115], v202 offset:4736
  v_mfma_f32_16x16x32_bf16 v[20:23], v[160:163], a[48:51], v[20:23]
  buffer_load_dwordx4 v[140:143], v211, s[8:11], s81 offen sc1
  v_mfma_f32_16x16x32_bf16 v[40:43], v[160:163], a[52:55], v[40:43]
  ds_read_b64_tr_b16 a[116:117], v203 offset:4224
  v_mfma_f32_16x16x32_bf16 v[60:63], v[160:163], a[56:59], v[60:63]
  v_mfma_f32_16x16x32_bf16 v[80:83], v[160:163], a[60:63], v[80:83]
  ds_read_b64_tr_b16 a[118:119], v203 offset:4736
  v_mfma_f32_16x16x32_bf16 v[24:27], v[164:167], a[48:51], v[24:27]
  buffer_load_dwordx4 v[144:147], v212, s[8:11], s81 offen sc1
  v_mfma_f32_16x16x32_bf16 v[44:47], v[164:167], a[52:55], v[44:47]
  v_mfma_f32_16x16x32_bf16 v[64:67], v[164:167], a[56:59], v[64:67]
  ds_read_b64_tr_b16 a[120:121], v204 offset:4224
  v_mfma_f32_16x16x32_bf16 v[84:87], v[164:167], a[60:63], v[84:87]
  v_mfma_f32_16x16x32_bf16 v[28:31], v[168:171], a[48:51], v[28:31]
  buffer_load_dwordx4 v[148:151], v213, s[8:11], s81 offen sc1
  ds_read_b64_tr_b16 a[122:123], v204 offset:4736
  v_mfma_f32_16x16x32_bf16 v[48:51], v[168:171], a[52:55], v[48:51]
  v_mfma_f32_16x16x32_bf16 v[68:71], v[168:171], a[56:59], v[68:71]
  ds_read_b64_tr_b16 a[124:125], v205 offset:4224
  v_mfma_f32_16x16x32_bf16 v[88:91], v[168:171], a[60:63], v[88:91]
  v_mfma_f32_16x16x32_bf16 v[32:35], v[172:175], a[48:51], v[32:35]
  buffer_load_dwordx4 v[152:155], v214, s[8:11], s81 offen sc1
  v_mfma_f32_16x16x32_bf16 v[52:55], v[172:175], a[52:55], v[52:55]
  ds_read_b64_tr_b16 a[126:127], v205 offset:4736
  v_mfma_f32_16x16x32_bf16 v[72:75], v[172:175], a[56:59], v[72:75]
  v_mfma_f32_16x16x32_bf16 v[92:95], v[172:175], a[60:63], v[92:95]
VC320:
  s_waitcnt vmcnt(12)
  v_max3_u32 v8, v96, v100, v104
  s_waitcnt vmcnt(10)
  v_max3_u32 v8, v8, v108, v112
  v_cmp_eq_u32 vcc, -1, v8
  s_cbranch_vccnz VR321
VK322:
  s_waitcnt lgkmcnt(15)
  v_mfma_f32_16x16x32_bf16 v[16:19], v[96:99], a[64:67], v[16:19]
  s_add_u32 s81, s61, 7168
  s_sub_u32 s68, s81, 12288
  s_cselect_b32 s81, s81, s68
  buffer_load_dwordx4 v[156:159], v210, s[8:11], s81 offen sc1
  v_mfma_f32_16x16x32_bf16 v[36:39], v[96:99], a[68:71], v[36:39]
  ds_read_b64_tr_b16 a[128:129], v202 offset:8448
  v_mfma_f32_16x16x32_bf16 v[56:59], v[96:99], a[72:75], v[56:59]
  v_mfma_f32_16x16x32_bf16 v[76:79], v[96:99], a[76:79], v[76:79]
  ds_read_b64_tr_b16 a[130:131], v202 offset:8960
  v_mfma_f32_16x16x32_bf16 v[20:23], v[100:103], a[64:67], v[20:23]
  buffer_load_dwordx4 v[160:163], v211, s[8:11], s81 offen sc1
  v_mfma_f32_16x16x32_bf16 v[40:43], v[100:103], a[68:71], v[40:43]
  ds_read_b64_tr_b16 a[132:133], v203 offset:8448
  v_mfma_f32_16x16x32_bf16 v[60:63], v[100:103], a[72:75], v[60:63]
  v_mfma_f32_16x16x32_bf16 v[80:83], v[100:103], a[76:79], v[80:83]
  ds_read_b64_tr_b16 a[134:135], v203 offset:8960
  v_mfma_f32_16x16x32_bf16 v[24:27], v[104:107], a[64:67], v[24:27]
  buffer_load_dwordx4 v[164:167], v212, s[8:11], s81 offen sc1
  v_mfma_f32_16x16x32_bf16 v[44:47], v[104:107], a[68:71], v[44:47]
  v_mfma_f32_16x16x32_bf16 v[64:67], v[104:107], a[72:75], v[64:67]
  ds_read_b64_tr_b16 a[136:137], v204 offset:8448
  v_mfma_f32_16x16x32_bf16 v[84:87], v[104:107], a[76:79], v[84:87]
  v_mfma_f32_16x16x32_bf16 v[28:31], v[108:111], a[64:67], v[28:31]
  buffer_load_dwordx4 v[168:171], v213, s[8:11], s81 offen sc1
  ds_read_b64_tr_b16 a[138:139], v204 offset:8960
  v_mfma_f32_16x16x32_bf16 v[48:51], v[108:111], a[68:71], v[48:51]
  v_mfma_f32_16x16x32_bf16 v[68:71], v[108:111], a[72:75], v[68:71]
  ds_read_b64_tr_b16 a[140:141], v205 offset:8448
  v_mfma_f32_16x16x32_bf16 v[88:91], v[108:111], a[76:79], v[88:91]
  v_mfma_f32_16x16x32_bf16 v[32:35], v[112:115], a[64:67], v[32:35]
  buffer_load_dwordx4 v[172:175], v214, s[8:11], s81 offen sc1
  v_mfma_f32_16x16x32_bf16 v[52:55], v[112:115], a[68:71], v[52:55]
  ds_read_b64_tr_b16 a[142:143], v205 offset:8960
  v_mfma_f32_16x16x32_bf16 v[72:75], v[112:115], a[72:75], v[72:75]
  v_mfma_f32_16x16x32_bf16 v[92:95], v[112:115], a[76:79], v[92:95]
VC323:
  s_waitcnt vmcnt(12)
  v_max3_u32 v8, v116, v120, v124
  s_waitcnt vmcnt(10)
  v_max3_u32 v8, v8, v128, v132
  v_cmp_eq_u32 vcc, -1, v8
  s_cbranch_vccnz VR324
VK325:
  v_mfma_f32_16x16x32_bf16 v[16:19], v[116:119], a[80:83], v[16:19]
  s_add_u32 s81, s61, 8192
  s_sub_u32 s68, s81, 12288
  s_cselect_b32 s81, s81, s68
  buffer_load_dwordx4 v[96:99], v210, s[8:11], s81 offen sc1
  v_mfma_f32_16x16x32_bf16 v[36:39], v[116:119], a[84:87], v[36:39]
  ds_read_b64_tr_b16 a[144:145], v202 offset:12672
  v_mfma_f32_16x16x32_bf16 v[56:59], v[116:119], a[88:91], v[56:59]
  v_mfma_f32_16x16x32_bf16 v[76:79], v[116:119], a[92:95], v[76:79]
  ds_read_b64_tr_b16 a[146:147], v202 offset:13184
  v_mfma_f32_16x16x32_bf16 v[20:23], v[120:123], a[80:83], v[20:23]
  buffer_load_dwordx4 v[100:103], v211, s[8:11], s81 offen sc1
  v_mfma_f32_16x16x32_bf16 v[40:43], v[120:123], a[84:87], v[40:43]
  ds_read_b64_tr_b16 a[148:149], v203 offset:12672
  v_mfma_f32_16x16x32_bf16 v[60:63], v[120:123], a[88:91], v[60:63]
  v_mfma_f32_16x16x32_bf16 v[80:83], v[120:123], a[92:95], v[80:83]
  ds_read_b64_tr_b16 a[150:151], v203 offset:13184
  v_mfma_f32_16x16x32_bf16 v[24:27], v[124:127], a[80:83], v[24:27]
  buffer_load_dwordx4 v[104:107], v212, s[8:11], s81 offen sc1
  v_mfma_f32_16x16x32_bf16 v[44:47], v[124:127], a[84:87], v[44:47]
  v_mfma_f32_16x16x32_bf16 v[64:67], v[124:127], a[88:91], v[64:67]
  ds_read_b64_tr_b16 a[152:153], v204 offset:12672
  v_mfma_f32_16x16x32_bf16 v[84:87], v[124:127], a[92:95], v[84:87]
  v_mfma_f32_16x16x32_bf16 v[28:31], v[128:131], a[80:83], v[28:31]
  buffer_load_dwordx4 v[108:111], v213, s[8:11], s81 offen sc1
  ds_read_b64_tr_b16 a[154:155], v204 offset:13184
  v_mfma_f32_16x16x32_bf16 v[48:51], v[128:131], a[84:87], v[48:51]
  v_mfma_f32_16x16x32_bf16 v[68:71], v[128:131], a[88:91], v[68:71]
  ds_read_b64_tr_b16 a[156:157], v205 offset:12672
  v_mfma_f32_16x16x32_bf16 v[88:91], v[128:131], a[92:95], v[88:91]
  v_mfma_f32_16x16x32_bf16 v[32:35], v[132:135], a[80:83], v[32:35]
  buffer_load_dwordx4 v[112:115], v214, s[8:11], s81 offen sc1
  v_mfma_f32_16x16x32_bf16 v[52:55], v[132:135], a[84:87], v[52:55]
  ds_read_b64_tr_b16 a[158:159], v205 offset:13184
  v_mfma_f32_16x16x32_bf16 v[72:75], v[132:135], a[88:91], v[72:75]
  v_mfma_f32_16x16x32_bf16 v[92:95], v[132:135], a[92:95], v[92:95]
VC326:
  s_waitcnt vmcnt(12)
  v_max3_u32 v8, v136, v140, v144
  s_waitcnt vmcnt(10)
  v_max3_u32 v8, v8, v148, v152
  v_cmp_eq_u32 vcc, -1, v8
  s_cbranch_vccnz VR327
VK328:
  s_waitcnt lgkmcnt(15)
  v_mfma_f32_16x16x32_bf16 v[16:19], v[136:139], a[96:99], v[16:19]
  s_add_u32 s81, s61, 9216
  s_sub_u32 s68, s81, 12288
  s_cselect_b32 s81, s81, s68
  buffer_load_dwordx4 v[116:119], v210, s[8:11], s81 offen sc1
  v_mfma_f32_16x16x32_bf16 v[36:39], v[136:139], a[100:103], v[36:39]
  ds_read_b64_tr_b16 a[160:161], v202 offset:16896
  v_mfma_f32_16x16x32_bf16 v[56:59], v[136:139], a[104:107], v[56:59]
  v_mfma_f32_16x16x32_bf16 v[76:79], v[136:139], a[108:111], v[76:79]
  ds_read_b64_tr_b16 a[162:163], v202 offset:17408
  v_mfma_f32_16x16x32_bf16 v[20:23], v[140:143], a[96:99], v[20:23]
  buffer_load_dwordx4 v[120:123], v211, s[8:11], s81 offen sc1
  v_mfma_f32_16x16x32_bf16 v[40:43], v[140:143], a[100:103], v[40:43]
  ds_read_b64_tr_b16 a[164:165], v203 offset:16896
  v_mfma_f32_16x16x32_bf16 v[60:63], v[140:143], a[104:107], v[60:63]
  v_mfma_f32_16x16x32_bf16 v[80:83], v[140:143], a[108:111], v[80:83]
  ds_read_b64_tr_b16 a[166:167], v203 offset:17408
  v_mfma_f32_16x16x32_bf16 v[24:27], v[144:147], a[96:99], v[24:27]
  buffer_load_dwordx4 v[124:127], v212, s[8:11], s81 offen sc1
  v_mfma_f32_16x16x32_bf16 v[44:47], v[144:147], a[100:103], v[44:47]
  v_mfma_f32_16x16x32_bf16 v[64:67], v[144:147], a[104:107], v[64:67]
  ds_read_b64_tr_b16 a[168:169], v204 offset:16896
  v_mfma_f32_16x16x32_bf16 v[84:87], v[144:147], a[108:111], v[84:87]
  v_mfma_f32_16x16x32_bf16 v[28:31], v[148:151], a[96:99], v[28:31]
  buffer_load_dwordx4 v[128:131], v213, s[8:11], s81 offen sc1
  ds_read_b64_tr_b16 a[170:171], v204 offset:17408
  v_mfma_f32_16x16x32_bf16 v[48:51], v[148:151], a[100:103], v[48:51]
  v_mfma_f32_16x16x32_bf16 v[68:71], v[148:151], a[104:107], v[68:71]
  ds_read_b64_tr_b16 a[172:173], v205 offset:16896
  v_mfma_f32_16x16x32_bf16 v[88:91], v[148:151], a[108:111], v[88:91]
  v_mfma_f32_16x16x32_bf16 v[32:35], v[152:155], a[96:99], v[32:35]
  buffer_load_dwordx4 v[132:135], v214, s[8:11], s81 offen sc1
  v_mfma_f32_16x16x32_bf16 v[52:55], v[152:155], a[100:103], v[52:55]
  ds_read_b64_tr_b16 a[174:175], v205 offset:17408
  v_mfma_f32_16x16x32_bf16 v[72:75], v[152:155], a[104:107], v[72:75]
  v_mfma_f32_16x16x32_bf16 v[92:95], v[152:155], a[108:111], v[92:95]
VC329:
  s_waitcnt vmcnt(12)
  v_max3_u32 v8, v156, v160, v164
  s_waitcnt vmcnt(10)
  v_max3_u32 v8, v8, v168, v172
  v_cmp_eq_u32 vcc, -1, v8
  s_cbranch_vccnz VR330
VK331:
  v_mfma_f32_16x16x32_bf16 v[16:19], v[156:159], a[112:115], v[16:19]
  s_add_u32 s81, s61, 10240
  s_sub_u32 s68, s81, 12288
  s_cselect_b32 s81, s81, s68
  buffer_load_dwordx4 v[136:139], v210, s[8:11], s81 offen sc1
  v_mfma_f32_16x16x32_bf16 v[36:39], v[156:159], a[116:119], v[36:39]
  ds_read_b64_tr_b16 a[176:177], v202 offset:21120
  v_mfma_f32_16x16x32_bf16 v[56:59], v[156:159], a[120:123], v[56:59]
  v_mfma_f32_16x16x32_bf16 v[76:79], v[156:159], a[124:127], v[76:79]
  ds_read_b64_tr_b16 a[178:179], v202 offset:21632
  v_mfma_f32_16x16x32_bf16 v[20:23], v[160:163], a[112:115], v[20:23]
  buffer_load_dwordx4 v[140:143], v211, s[8:11], s81 offen sc1
  v_mfma_f32_16x16x32_bf16 v[40:43], v[160:163], a[116:119], v[40:43]
  ds_read_b64_tr_b16 a[180:181], v203 offset:21120
  v_mfma_f32_16x16x32_bf16 v[60:63], v[160:163], a[120:123], v[60:63]
  v_mfma_f32_16x16x32_bf16 v[80:83], v[160:163], a[124:127], v[80:83]
  ds_read_b64_tr_b16 a[182:183], v203 offset:21632
  v_mfma_f32_16x16x32_bf16 v[24:27], v[164:167], a[112:115], v[24:27]
  buffer_load_dwordx4 v[144:147], v212, s[8:11], s81 offen sc1
  v_mfma_f32_16x16x32_bf16 v[44:47], v[164:167], a[116:119], v[44:47]
  v_mfma_f32_16x16x32_bf16 v[64:67], v[164:167], a[120:123], v[64:67]
  ds_read_b64_tr_b16 a[184:185], v204 offset:21120
  v_mfma_f32_16x16x32_bf16 v[84:87], v[164:167], a[124:127], v[84:87]
  v_mfma_f32_16x16x32_bf16 v[28:31], v[168:171], a[112:115], v[28:31]
  buffer_load_dwordx4 v[148:151], v213, s[8:11], s81 offen sc1
  ds_read_b64_tr_b16 a[186:187], v204 offset:21632
  v_mfma_f32_16x16x32_bf16 v[48:51], v[168:171], a[116:119], v[48:51]
  v_mfma_f32_16x16x32_bf16 v[68:71], v[168:171], a[120:123], v[68:71]
  ds_read_b64_tr_b16 a[188:189], v205 offset:21120
  v_mfma_f32_16x16x32_bf16 v[88:91], v[168:171], a[124:127], v[88:91]
  v_mfma_f32_16x16x32_bf16 v[32:35], v[172:175], a[112:115], v[32:35]
  buffer_load_dwordx4 v[152:155], v214, s[8:11], s81 offen sc1
  v_mfma_f32_16x16x32_bf16 v[52:55], v[172:175], a[116:119], v[52:55]
  ds_read_b64_tr_b16 a[190:191], v205 offset:21632
  v_mfma_f32_16x16x32_bf16 v[72:75], v[172:175], a[120:123], v[72:75]
  v_mfma_f32_16x16x32_bf16 v[92:95], v[172:175], a[124:127], v[92:95]
VC332:
  s_waitcnt vmcnt(12)
  v_max3_u32 v8, v96, v100, v104
  s_waitcnt vmcnt(10)
  v_max3_u32 v8, v8, v108, v112
  v_cmp_eq_u32 vcc, -1, v8
  s_cbranch_vccnz VR333
VK334:
  s_waitcnt lgkmcnt(15)
  v_mfma_f32_16x16x32_bf16 v[16:19], v[96:99], a[128:131], v[16:19]
  s_add_u32 s81, s61, 11264
  s_sub_u32 s68, s81, 12288
  s_cselect_b32 s81, s81, s68
  buffer_load_dwordx4 v[156:159], v210, s[8:11], s81 offen sc1
  v_mfma_f32_16x16x32_bf16 v[36:39], v[96:99], a[132:135], v[36:39]
  v_mfma_f32_16x16x32_bf16 v[56:59], v[96:99], a[136:139], v[56:59]
  v_mfma_f32_16x16x32_bf16 v[76:79], v[96:99], a[140:143], v[76:79]
  v_mfma_f32_16x16x32_bf16 v[20:23], v[100:103], a[128:131], v[20:23]
  buffer_load_dwordx4 v[160:163], v211, s[8:11], s81 offen sc1
  v_mfma_f32_16x16x32_bf16 v[40:43], v[100:103], a[132:135], v[40:43]
  s_waitcnt lgkmcnt(0)
  s_barrier
  v_mfma_f32_16x16x32_bf16 v[60:63], v[100:103], a[136:139], v[60:63]
  v_mfma_f32_16x16x32_bf16 v[80:83], v[100:103], a[140:143], v[80:83]
  v_mfma_f32_16x16x32_bf16 v[24:27], v[104:107], a[128:131], v[24:27]
  buffer_load_dwordx4 v[164:167], v212, s[8:11], s81 offen sc1
  v_mfma_f32_16x16x32_bf16 v[44:47], v[104:107], a[132:135], v[44:47]
  v_mfma_f32_16x16x32_bf16 v[64:67], v[104:107], a[136:139], v[64:67]
  v_mfma_f32_16x16x32_bf16 v[84:87], v[104:107], a[140:143], v[84:87]
  v_mfma_f32_16x16x32_bf16 v[28:31], v[108:111], a[128:131], v[28:31]
  buffer_load_dwordx4 v[168:171], v213, s[8:11], s81 offen sc1
  v_mfma_f32_16x16x32_bf16 v[48:51], v[108:111], a[132:135], v[48:51]
  v_mfma_f32_16x16x32_bf16 v[68:71], v[108:111], a[136:139], v[68:71]
  v_mfma_f32_16x16x32_bf16 v[88:91], v[108:111], a[140:143], v[88:91]
  v_mfma_f32_16x16x32_bf16 v[32:35], v[112:115], a[128:131], v[32:35]
  buffer_load_dwordx4 v[172:175], v214, s[8:11], s81 offen sc1
  v_mfma_f32_16x16x32_bf16 v[52:55], v[112:115], a[132:135], v[52:55]
  v_mfma_f32_16x16x32_bf16 v[72:75], v[112:115], a[136:139], v[72:75]
  v_mfma_f32_16x16x32_bf16 v[92:95], v[112:115], a[140:143], v[92:95]
VC335:
  s_waitcnt vmcnt(12)
  v_max3_u32 v8, v116, v120, v124
  s_waitcnt vmcnt(10)
  v_max3_u32 v8, v8, v128, v132
  v_cmp_eq_u32 vcc, -1, v8
  s_cbranch_vccnz VR336
VK337:
  v_mfma_f32_16x16x32_bf16 v[16:19], v[116:119], a[144:147], v[16:19]
  v_mfma_f32_16x16x32_bf16 v[36:39], v[116:119], a[148:151], v[36:39]
  v_mfma_f32_16x16x32_bf16 v[56:59], v[116:119], a[152:155], v[56:59]
  v_mfma_f32_16x16x32_bf16 v[76:79], v[116:119], a[156:159], v[76:79]
  v_mfma_f32_16x16x32_bf16 v[20:23], v[120:123], a[144:147], v[20:23]
  v_mfma_f32_16x16x32_bf16 v[40:43], v[120:123], a[148:151], v[40:43]
  v_mfma_f32_16x16x32_bf16 v[60:63], v[120:123], a[152:155], v[60:63]
  v_mfma_f32_16x16x32_bf16 v[80:83], v[120:123], a[156:159], v[80:83]
  v_mfma_f32_16x16x32_bf16 v[24:27], v[124:127], a[144:147], v[24:27]
  v_mfma_f32_16x16x32_bf16 v[44:47], v[124:127], a[148:151], v[44:47]
  v_mfma_f32_16x16x32_bf16 v[64:67], v[124:127], a[152:155], v[64:67]
  v_mfma_f32_16x16x32_bf16 v[84:87], v[124:127], a[156:159], v[84:87]
  v_mfma_f32_16x16x32_bf16 v[28:31], v[128:131], a[144:147], v[28:31]
  v_mfma_f32_16x16x32_bf16 v[48:51], v[128:131], a[148:151], v[48:51]
  v_mfma_f32_16x16x32_bf16 v[68:71], v[128:131], a[152:155], v[68:71]
  v_mfma_f32_16x16x32_bf16 v[88:91], v[128:131], a[156:159], v[88:91]
  v_mfma_f32_16x16x32_bf16 v[32:35], v[132:135], a[144:147], v[32:35]
  v_mfma_f32_16x16x32_bf16 v[52:55], v[132:135], a[148:151], v[52:55]
  v_mfma_f32_16x16x32_bf16 v[72:75], v[132:135], a[152:155], v[72:75]
  v_mfma_f32_16x16x32_bf16 v[92:95], v[132:135], a[156:159], v[92:95]
VC338:
  s_waitcnt vmcnt(7)
  v_max3_u32 v8, v136, v140, v144
  s_waitcnt vmcnt(5)
  v_max3_u32 v8, v8, v148, v152
  v_cmp_eq_u32 vcc, -1, v8
  s_cbranch_vccnz VR339
VK340:
  v_mfma_f32_16x16x32_bf16 v[16:19], v[136:139], a[160:163], v[16:19]
  v_mfma_f32_16x16x32_bf16 v[36:39], v[136:139], a[164:167], v[36:39]
  v_mfma_f32_16x16x32_bf16 v[56:59], v[136:139], a[168:171], v[56:59]
  v_mfma_f32_16x16x32_bf16 v[76:79], v[136:139], a[172:175], v[76:79]
  v_mfma_f32_16x16x32_bf16 v[20:23], v[140:143], a[160:163], v[20:23]
  v_mfma_f32_16x16x32_bf16 v[40:43], v[140:143], a[164:167], v[40:43]
  v_mfma_f32_16x16x32_bf16 v[60:63], v[140:143], a[168:171], v[60:63]
  v_mfma_f32_16x16x32_bf16 v[80:83], v[140:143], a[172:175], v[80:83]
  v_mfma_f32_16x16x32_bf16 v[24:27], v[144:147], a[160:163], v[24:27]
  v_mfma_f32_16x16x32_bf16 v[44:47], v[144:147], a[164:167], v[44:47]
  v_mfma_f32_16x16x32_bf16 v[64:67], v[144:147], a[168:171], v[64:67]
  v_mfma_f32_16x16x32_bf16 v[84:87], v[144:147], a[172:175], v[84:87]
  v_mfma_f32_16x16x32_bf16 v[28:31], v[148:151], a[160:163], v[28:31]
  v_mfma_f32_16x16x32_bf16 v[48:51], v[148:151], a[164:167], v[48:51]
  v_mfma_f32_16x16x32_bf16 v[68:71], v[148:151], a[168:171], v[68:71]
  v_mfma_f32_16x16x32_bf16 v[88:91], v[148:151], a[172:175], v[88:91]
  v_mfma_f32_16x16x32_bf16 v[32:35], v[152:155], a[160:163], v[32:35]
  v_mfma_f32_16x16x32_bf16 v[52:55], v[152:155], a[164:167], v[52:55]
  v_mfma_f32_16x16x32_bf16 v[72:75], v[152:155], a[168:171], v[72:75]
  v_mfma_f32_16x16x32_bf16 v[92:95], v[152:155], a[172:175], v[92:95]
VC341:
  s_waitcnt vmcnt(2)
  v_max3_u32 v8, v156, v160, v164
  s_waitcnt vmcnt(0)
  v_max3_u32 v8, v8, v168, v172
  v_cmp_eq_u32 vcc, -1, v8
  s_cbranch_vccnz VR342
VK343:
  v_mfma_f32_16x16x32_bf16 v[36:39], v[156:159], a[180:183], v[36:39]
  v_mfma_f32_16x16x32_bf16 v[56:59], v[156:159], a[184:187], v[56:59]
  v_mfma_f32_16x16x32_bf16 v[76:79], v[156:159], a[188:191], v[76:79]
  v_mfma_f32_16x16x32_bf16 v[16:19], v[156:159], a[176:179], v[16:19]
  v_mfma_f32_16x16x32_bf16 v[40:43], v[160:163], a[180:183], v[40:43]
  v_mfma_f32_16x16x32_bf16 v[60:63], v[160:163], a[184:187], v[60:63]
  s_nop 2
  ds_write_b128 v5, v[36:39] offset:0
  v_mfma_f32_16x16x32_bf16 v[80:83], v[160:163], a[188:191], v[80:83]
  ds_write_b128 v6, v[56:59] offset:5120
  v_mfma_f32_16x16x32_bf16 v[20:23], v[160:163], a[176:179], v[20:23]
  ds_write_b128 v7, v[76:79] offset:10240
  v_mfma_f32_16x16x32_bf16 v[44:47], v[164:167], a[180:183], v[44:47]
  v_mfma_f32_16x16x32_bf16 v[64:67], v[164:167], a[184:187], v[64:67]
  ds_write_b128 v5, v[40:43] offset:1024
  v_mfma_f32_16x16x32_bf16 v[84:87], v[164:167], a[188:191], v[84:87]
  ds_write_b128 v6, v[60:63] offset:6144
  v_mfma_f32_16x16x32_bf16 v[24:27], v[164:167], a[176:179], v[24:27]
  ds_write_b128 v7, v[80:83] offset:11264
  v_mfma_f32_16x16x32_bf16 v[48:51], v[168:171], a[180:183], v[48:51]
  v_mfma_f32_16x16x32_bf16 v[68:71], v[168:171], a[184:187], v[68:71]
  ds_write_b128 v5, v[44:47] offset:2048
  v_mfma_f32_16x16x32_bf16 v[88:91], v[168:171], a[188:191], v[88:91]
  ds_write_b128 v6, v[64:67] offset:7168
  v_mfma_f32_16x16x32_bf16 v[28:31], v[168:171], a[176:179], v[28:31]
  ds_write_b128 v7, v[84:87] offset:12288
  v_mfma_f32_16x16x32_bf16 v[52:55], v[172:175], a[180:183], v[52:55]
  v_mfma_f32_16x16x32_bf16 v[72:75], v[172:175], a[184:187], v[72:75]
  ds_write_b128 v5, v[48:51] offset:3072
  v_mfma_f32_16x16x32_bf16 v[92:95], v[172:175], a[188:191], v[92:95]
  ds_write_b128 v6, v[68:71] offset:8192
  v_mfma_f32_16x16x32_bf16 v[32:35], v[172:175], a[176:179], v[32:35]
  ds_write_b128 v7, v[88:91] offset:13312
  s_nop 1
  ds_write_b128 v5, v[52:55] offset:4096
  ds_write_b128 v6, v[72:75] offset:9216
  s_nop 0
  ds_write_b128 v7, v[92:95] offset:14336
  v_lshlrev_b32 v156, 16, v236
  v_and_b32 v157, 0xffff0000, v236
  v_lshlrev_b32 v158, 16, v237
  v_and_b32 v159, 0xffff0000, v237
  v_lshlrev_b32 v160, 16, v238
  v_and_b32 v161, 0xffff0000, v238
  v_lshlrev_b32 v162, 16, v239
  v_and_b32 v163, 0xffff0000, v239
  v_lshlrev_b32 v164, 16, v240
  v_and_b32 v165, 0xffff0000, v240
  v_lshlrev_b32 v166, 16, v241
  v_and_b32 v167, 0xffff0000, v241
  v_lshlrev_b32 v168, 16, v242
  v_and_b32 v169, 0xffff0000, v242
  v_lshlrev_b32 v170, 16, v243
  v_and_b32 v171, 0xffff0000, v243
  v_lshlrev_b32 v172, 16, v244
  v_and_b32 v173, 0xffff0000, v244
  v_lshlrev_b32 v174, 16, v245
  v_and_b32 v175, 0xffff0000, v245
  v_lshlrev_b32 v10, 16, v246
  v_pk_add_f32 v[16:17], v[16:17], v[10:11] op_sel_hi:[1,0]
  v_pk_add_f32 v[18:19], v[18:19], v[10:11] op_sel_hi:[1,0]
  v_pk_add_f32 v[20:21], v[20:21], v[10:11] op_sel_hi:[1,0]
  v_pk_add_f32 v[22:23], v[22:23], v[10:11] op_sel_hi:[1,0]
  v_pk_add_f32 v[24:25], v[24:25], v[10:11] op_sel_hi:[1,0]
  v_pk_add_f32 v[26:27], v[26:27], v[10:11] op_sel_hi:[1,0]
  v_pk_add_f32 v[28:29], v[28:29], v[10:11] op_sel_hi:[1,0]
  v_pk_add_f32 v[30:31], v[30:31], v[10:11] op_sel_hi:[1,0]
  v_pk_add_f32 v[32:33], v[32:33], v[10:11] op_sel_hi:[1,0]
  v_pk_add_f32 v[34:35], v[34:35], v[10:11] op_sel_hi:[1,0]
  v_pk_add_f32 v[16:17], v[16:17], v[156:157]
  v_pk_add_f32 v[18:19], v[18:19], v[158:159]
  v_pk_add_f32 v[20:21], v[20:21], v[160:161]
  v_pk_add_f32 v[22:23], v[22:23], v[162:163]
  v_pk_add_f32 v[24:25], v[24:25], v[164:165]
  v_pk_add_f32 v[26:27], v[26:27], v[166:167]
  v_pk_add_f32 v[28:29], v[28:29], v[168:169]
  v_pk_add_f32 v[30:31], v[30:31], v[170:171]
  v_pk_add_f32 v[32:33], v[32:33], v[172:173]
  v_pk_add_f32 v[34:35], v[34:35], v[174:175]
  s_waitcnt lgkmcnt(0)
  s_barrier
  ds_read_b128 v[96:99], v215 offset:0
  ds_read_b128 v[116:119], v215 offset:5120
  ds_read_b128 v[136:139], v215 offset:10240
  ds_read_b128 v[100:103], v215 offset:1024
  ds_read_b128 v[120:123], v215 offset:6144
  ds_read_b128 v[140:143], v215 offset:11264
  ds_read_b128 v[104:107], v215 offset:2048
  ds_read_b128 v[124:127], v215 offset:7168
  ds_read_b128 v[144:147], v215 offset:12288
  ds_read_b128 v[108:111], v215 offset:3072
  ds_read_b128 v[128:131], v215 offset:8192
  ds_read_b128 v[148:151], v215 offset:13312
  ds_read_b128 v[112:115], v215 offset:4096
  ds_read_b128 v[132:135], v215 offset:9216
  ds_read_b128 v[152:155], v215 offset:14336
  s_waitcnt lgkmcnt(14)
  v_pk_add_f32 v[16:17], v[16:17], v[96:97]
  v_pk_add_f32 v[18:19], v[18:19], v[98:99]
  s_waitcnt lgkmcnt(13)
  v_pk_add_f32 v[16:17], v[16:17], v[116:117]
  v_pk_add_f32 v[18:19], v[18:19], v[118:119]
  s_waitcnt lgkmcnt(12)
  v_pk_add_f32 v[16:17], v[16:17], v[136:137]
  v_pk_add_f32 v[18:19], v[18:19], v[138:139]
  v_cvt_pk_bf16_f32 v236, v16, v17
  v_cvt_pk_bf16_f32 v237, v18, v19
  s_waitcnt lgkmcnt(11)
  v_pk_add_f32 v[20:21], v[20:21], v[100:101]
  v_pk_add_f32 v[22:23], v[22:23], v[102:103]
  s_waitcnt lgkmcnt(10)
  v_pk_add_f32 v[20:21], v[20:21], v[120:121]
  v_pk_add_f32 v[22:23], v[22:23], v[122:123]
  s_waitcnt lgkmcnt(9)
  v_pk_add_f32 v[20:21], v[20:21], v[140:141]
  v_pk_add_f32 v[22:23], v[22:23], v[142:143]
  v_cvt_pk_bf16_f32 v238, v20, v21
  v_cvt_pk_bf16_f32 v239, v22, v23
  s_waitcnt lgkmcnt(8)
  v_pk_add_f32 v[24:25], v[24:25], v[104:105]
  v_pk_add_f32 v[26:27], v[26:27], v[106:107]
  s_waitcnt lgkmcnt(7)
  v_pk_add_f32 v[24:25], v[24:25], v[124:125]
  v_pk_add_f32 v[26:27], v[26:27], v[126:127]
  s_waitcnt lgkmcnt(6)
  v_pk_add_f32 v[24:25], v[24:25], v[144:145]
  v_pk_add_f32 v[26:27], v[26:27], v[146:147]
  v_cvt_pk_bf16_f32 v240, v24, v25
  v_cvt_pk_bf16_f32 v241, v26, v27
  s_waitcnt lgkmcnt(5)
  v_pk_add_f32 v[28:29], v[28:29], v[108:109]
  v_pk_add_f32 v[30:31], v[30:31], v[110:111]
  s_waitcnt lgkmcnt(4)
  v_pk_add_f32 v[28:29], v[28:29], v[128:129]
  v_pk_add_f32 v[30:31], v[30:31], v[130:131]
  s_waitcnt lgkmcnt(3)
  v_pk_add_f32 v[28:29], v[28:29], v[148:149]
  v_pk_add_f32 v[30:31], v[30:31], v[150:151]
  v_cvt_pk_bf16_f32 v242, v28, v29
  v_cvt_pk_bf16_f32 v243, v30, v31
  s_waitcnt lgkmcnt(2)
  v_pk_add_f32 v[32:33], v[32:33], v[112:113]
  v_pk_add_f32 v[34:35], v[34:35], v[114:115]
  s_waitcnt lgkmcnt(1)
  v_pk_add_f32 v[32:33], v[32:33], v[132:133]
  v_pk_add_f32 v[34:35], v[34:35], v[134:135]
  s_waitcnt lgkmcnt(0)
  v_pk_add_f32 v[32:33], v[32:33], v[152:153]
  v_pk_add_f32 v[34:35], v[34:35], v[154:155]
  v_cvt_pk_bf16_f32 v244, v32, v33
  v_cvt_pk_bf16_f32 v245, v34, v35
  buffer_store_dwordx2 v[236:237], v2, s[44:47], s74 offen offset:0
  buffer_store_dwordx2 v[238:239], v2, s[44:47], s74 offen offset:32
  buffer_store_dwordx2 v[240:241], v2, s[44:47], s74 offen offset:64
  buffer_store_dwordx2 v[242:243], v2, s[44:47], s74 offen offset:96
  buffer_store_dwordx2 v[244:245], v2, s[44:47], s74 offen offset:128
  s_waitcnt vmcnt(0)
END:
  s_endpgm
  s_waitcnt vmcnt(0) lgkmcnt(0)
VR11:
  s_cmp_eq_u32 s82, 0
  s_cbranch_scc1 VK12
  s_sub_u32 s82, s82, 1
  s_nop 7
  buffer_load_dwordx2 v[188:189], v14, s[8:11], s72 offen offset:0 sc1
  buffer_load_dwordx2 v[190:191], v14, s[8:11], s72 offen offset:128 sc1
  buffer_load_dwordx2 v[192:193], v14, s[8:11], s72 offen offset:256 sc1
  buffer_load_dwordx2 v[194:195], v14, s[8:11], s72 offen offset:384 sc1
  s_waitcnt vmcnt(0)
  s_branch VC10
VR14:
  s_cmp_eq_u32 s82, 0
  s_cbranch_scc1 VK15
  s_sub_u32 s82, s82, 1
  s_nop 7
  s_add_u32 s66, s72, 0
  buffer_load_dwordx4 v[80:83], v5, s[8:11], s66 offen sc1
  s_add_u32 s66, s72, 4096
  buffer_load_dwordx4 v[84:87], v5, s[8:11], s66 offen sc1
  s_add_u32 s66, s72, 8192
  buffer_load_dwordx4 v[88:91], v5, s[8:11], s66 offen sc1
  s_add_u32 s66, s72, 12288
  buffer_load_dwordx4 v[92:95], v5, s[8:11], s66 offen sc1
  s_waitcnt vmcnt(0)
  s_branch VC13
VR17:
  s_cmp_eq_u32 s82, 0
  s_cbranch_scc1 VK18
  s_sub_u32 s82, s82, 1
  s_nop 7
  s_add_u32 s66, s72, 16384
  buffer_load_dwordx4 v[96:99], v5, s[8:11], s66 offen sc1
  s_add_u32 s66, s72, 20480
  buffer_load_dwordx4 v[100:103], v5, s[8:11], s66 offen sc1
  s_add_u32 s66, s72, 24576
  buffer_load_dwordx4 v[104:107], v5, s[8:11], s66 offen sc1
  s_add_u32 s66, s72, 28672
  buffer_load_dwordx4 v[108:111], v5, s[8:11], s66 offen sc1
  s_waitcnt vmcnt(0)
  s_branch VC16
VR20:
  s_cmp_eq_u32 s82, 0
  s_cbranch_scc1 VK21
  s_sub_u32 s82, s82, 1
  s_nop 7
  s_add_u32 s66, s72, 32768
  buffer_load_dwordx4 v[112:115], v5, s[8:11], s66 offen sc1
  s_add_u32 s66, s72, 36864
  buffer_load_dwordx4 v[116:119], v5, s[8:11], s66 offen sc1
  s_add_u32 s66, s72, 40960
  buffer_load_dwordx4 v[120:123], v5, s[8:11], s66 offen sc1
  s_add_u32 s66, s72, 45056
  buffer_load_dwordx4 v[124:127], v5, s[8:11], s66 offen sc1
  s_waitcnt vmcnt(0)
  s_branch VC19
VR23:
  s_cmp_eq_u32 s82, 0
  s_cbranch_scc1 VK24
  s_sub_u32 s82, s82, 1
  s_nop 7
  s_add_u32 s66, s72, 49152
  buffer_load_dwordx4 v[128:131], v5, s[8:11], s66 offen sc1
  s_add_u32 s66, s72, 53248
  buffer_load_dwordx4 v[132:135], v5, s[8:11], s66 offen sc1
  s_add_u32 s66, s72, 57344
  buffer_load_dwordx4 v[136:139], v5, s[8:11], s66 offen sc1
  s_add_u32 s66, s72, 61440
  buffer_load_dwordx4 v[140:143], v5, s[8:11], s66 offen sc1
  s_waitcnt vmcnt(0)
  s_branch VC22
FC25:
  s_mov_b32 s67, 262144
P27:
  buffer_load_dword v15, v4, s[8:11], 0 offen sc1
  s_waitcnt vmcnt(0)
  v_subrev_u32 v15, s83, v15
  v_cmp_gt_u32 vcc, 128, v15
  s_cmp_eq_u64 vcc, -1
  s_cbranch_scc1 PD28
  s_sub_u32 s67, s67, 1
  s_cmp_lg_u32 s67, 0
  s_cbranch_scc1 P27
PD28:
  s_waitcnt vmcnt(0)
  s_branch FK26
VR30:
  s_cmp_eq_u32 s82, 0
  s_cbranch_scc1 VK31
  s_sub_u32 s82, s82, 1
  s_nop 7
  s_add_u32 s66, s75, 0
  buffer_load_dwordx4 v[48:51], v13, s[8:11], s66 offen offset:0 sc1
  s_add_u32 s66, s75, 0
  buffer_load_dwordx4 v[52:55], v13, s[8:11], s66 offen offset:1024 sc1
  s_waitcnt vmcnt(0)
  s_branch VC29
VR33:
  s_cmp_eq_u32 s82, 0
  s_cbranch_scc1 VK34
  s_sub_u32 s82, s82, 1
  s_nop 7
  s_add_u32 s66, s75, 0
  buffer_load_dwordx4 v[56:59], v13, s[8:11], s66 offen offset:2048 sc1
  s_add_u32 s66, s75, 0
  buffer_load_dwordx4 v[60:63], v13, s[8:11], s66 offen offset:3072 sc1
  s_waitcnt vmcnt(0)
  s_branch VC32
VR36:
  s_cmp_eq_u32 s82, 0
  s_cbranch_scc1 VK37
  s_sub_u32 s82, s82, 1
  s_nop 7
  s_add_u32 s66, s75, 4096
  buffer_load_dwordx4 v[64:67], v13, s[8:11], s66 offen offset:0 sc1
  s_add_u32 s66, s75, 4096
  buffer_load_dwordx4 v[68:71], v13, s[8:11], s66 offen offset:1024 sc1
  s_waitcnt vmcnt(0)
  s_branch VC35
VR39:
  s_cmp_eq_u32 s82, 0
  s_cbranch_scc1 VK40
  s_sub_u32 s82, s82, 1
  s_nop 7
  s_add_u32 s66, s75, 4096
  buffer_load_dwordx4 v[72:75], v13, s[8:11], s66 offen offset:2048 sc1
  s_add_u32 s66, s75, 4096
  buffer_load_dwordx4 v[76:79], v13, s[8:11], s66 offen offset:3072 sc1
  s_waitcnt vmcnt(0)
  s_branch VC38
VR42:
  s_cmp_eq_u32 s82, 0
  s_cbranch_scc1 VK43
  s_sub_u32 s82, s82, 1
  s_nop 7
  s_add_u32 s66, s75, 8192
  buffer_load_dwordx4 v[80:83], v13, s[8:11], s66 offen offset:0 sc1
  s_add_u32 s66, s75, 8192
  buffer_load_dwordx4 v[84:87], v13, s[8:11], s66 offen offset:1024 sc1
  s_waitcnt vmcnt(0)
  s_branch VC41
VR45:
  s_cmp_eq_u32 s82, 0
  s_cbranch_scc1 VK46
  s_sub_u32 s82, s82, 1
  s_nop 7
  s_add_u32 s66, s75, 8192
  buffer_load_dwordx4 v[88:91], v13, s[8:11], s66 offen offset:2048 sc1
  s_add_u32 s66, s75, 8192
  buffer_load_dwordx4 v[92:95], v13, s[8:11], s66 offen offset:3072 sc1
  s_waitcnt vmcnt(0)
  s_branch VC44
VR48:
  s_cmp_eq_u32 s82, 0
  s_cbranch_scc1 VK49
  s_sub_u32 s82, s82, 1
  s_nop 7
  s_add_u32 s66, s75, 12288
  buffer_load_dwordx4 v[96:99], v13, s[8:11], s66 offen offset:0 sc1
  s_add_u32 s66, s75, 12288
  buffer_load_dwordx4 v[100:103], v13, s[8:11], s66 offen offset:1024 sc1
  s_waitcnt vmcnt(0)
  s_branch VC47
VR51:
  s_cmp_eq_u32 s82, 0
  s_cbranch_scc1 VK52
  s_sub_u32 s82, s82, 1
  s_nop 7
  s_add_u32 s66, s75, 12288
  buffer_load_dwordx4 v[104:107], v13, s[8:11], s66 offen offset:2048 sc1
  s_add_u32 s66, s75, 12288
  buffer_load_dwordx4 v[108:111], v13, s[8:11], s66 offen offset:3072 sc1
  s_waitcnt vmcnt(0)
  s_branch VC50
VR54:
  s_cmp_eq_u32 s82, 0
  s_cbranch_scc1 VK55
  s_sub_u32 s82, s82, 1
  s_nop 7
  s_add_u32 s66, s75, 16384
  buffer_load_dwordx4 v[112:115], v13, s[8:11], s66 offen offset:0 sc1
  s_add_u32 s66, s75, 16384
  buffer_load_dwordx4 v[116:119], v13, s[8:11], s66 offen offset:1024 sc1
  s_waitcnt vmcnt(0)
  s_branch VC53
VR57:
  s_cmp_eq_u32 s82, 0
  s_cbranch_scc1 VK58
  s_sub_u32 s82, s82, 1
  s_nop 7
  s_add_u32 s66, s75, 16384
  buffer_load_dwordx4 v[120:123], v13, s[8:11], s66 offen offset:2048 sc1
  s_add_u32 s66, s75, 16384
  buffer_load_dwordx4 v[124:127], v13, s[8:11], s66 offen offset:3072 sc1
  s_waitcnt vmcnt(0)
  s_branch VC56
P59:
  s_sub_u32 s67, s67, 1
  buffer_load_dwordx2 v[48:49], v12, s[8:11], s76 offen sc1
  buffer_load_dwordx2 v[50:51], v12, s[8:11], s76 offen offset:128 sc1
  s_waitcnt vmcnt(0)
  v_cmp_eq_u32 vcc, -1, v48
  v_cmp_eq_u32 s[68:69], -1, v50
  s_or_b64 vcc, vcc, s[68:69]
  s_cmp_eq_u64 vcc, 0
  s_cbranch_scc1 PD60
  s_cmp_lg_u32 s67, 0
  s_cbranch_scc1 P59
  s_branch PD60
ID61:
  s_waitcnt vmcnt(0) lgkmcnt(0)
  s_barrier
  s_lshr_b32 s66, s2, 3
  s_and_b32 s66, s66, 1
  s_lshl_b32 s66, s66, 2
  s_add_u32 s66, s66, s52
  s_mul_i32 s66, s66, 786432
  s_and_b32 s67, s56, 24
  s_lshl_b32 s67, s67, 7
  s_add_u32 s66, s66, s67
  v_lshlrev_b32 v16, 12, v1
  s_add_u32 s67, s66, 0
  buffer_load_dword v17, v16, s[32:35], s67 offen offset:384
  s_add_u32 s67, s66, 262144
  buffer_load_dword v18, v16, s[32:35], s67 offen offset:384
  s_add_u32 s67, s66, 524288
  buffer_load_dword v19, v16, s[32:35], s67 offen offset:384
  s_mov_b32 s78, s61
  s_mul_i32 s78, s78, 128
  s_add_u32 m0, s86, 12672
  s_nop 0
  buffer_load_dwordx4 v198, s[32:35], s78 offen offset:0 lds
  buffer_load_dwordx4 v199, s[32:35], s78 offen offset:1056 lds
  buffer_load_dwordx4 v200, s[32:35], s78 offen offset:2112 lds
  buffer_load_dwordx4 v201, s[32:35], s78 offen offset:3168 lds
  s_add_u32 s78, s61, 1024
  s_sub_u32 s68, s78, 12288
  s_cselect_b32 s78, s78, s68
  s_mul_i32 s78, s78, 128
  s_add_u32 m0, s86, 16896
  s_nop 0
  buffer_load_dwordx4 v198, s[32:35], s78 offen offset:0 lds
  buffer_load_dwordx4 v199, s[32:35], s78 offen offset:1056 lds
  buffer_load_dwordx4 v200, s[32:35], s78 offen offset:2112 lds
  buffer_load_dwordx4 v201, s[32:35], s78 offen offset:3168 lds
  s_add_u32 s78, s61, 2048
  s_sub_u32 s68, s78, 12288
  s_cselect_b32 s78, s78, s68
  s_mul_i32 s78, s78, 128
  s_add_u32 m0, s86, 21120
  s_nop 0
  buffer_load_dwordx4 v198, s[32:35], s78 offen offset:0 lds
  buffer_load_dwordx4 v199, s[32:35], s78 offen offset:1056 lds
  buffer_load_dwordx4 v200, s[32:35], s78 offen offset:2112 lds
  buffer_load_dwordx4 v201, s[32:35], s78 offen offset:3168 lds
  s_add_u32 s78, s61, 3072
  s_sub_u32 s68, s78, 12288
  s_cselect_b32 s78, s78, s68
  s_mul_i32 s78, s78, 128
  s_add_u32 m0, s86, 25344
  s_nop 0
  buffer_load_dwordx4 v198, s[32:35], s78 offen offset:0 lds
  buffer_load_dwordx4 v199, s[32:35], s78 offen offset:1056 lds
  buffer_load_dwordx4 v200, s[32:35], s78 offen offset:2112 lds
  buffer_load_dwordx4 v201, s[32:35], s78 offen offset:3168 lds
  s_add_u32 s78, s61, 4096
  s_sub_u32 s68, s78, 12288
  s_cselect_b32 s78, s78, s68
  s_mul_i32 s78, s78, 128
  s_add_u32 m0, s86, 29568
  s_nop 0
  buffer_load_dwordx4 v198, s[32:35], s78 offen offset:0 lds
  buffer_load_dwordx4 v199, s[32:35], s78 offen offset:1056 lds
  buffer_load_dwordx4 v200, s[32:35], s78 offen offset:2112 lds
  buffer_load_dwordx4 v201, s[32:35], s78 offen offset:3168 lds
  s_add_u32 s78, s61, 5120
  s_sub_u32 s68, s78, 12288
  s_cselect_b32 s78, s78, s68
  s_mul_i32 s78, s78, 128
  s_add_u32 m0, s86, 33792
  s_nop 0
  buffer_load_dwordx4 v198, s[32:35], s78 offen offset:0 lds
  buffer_load_dwordx4 v199, s[32:35], s78 offen offset:1056 lds
  buffer_load_dwordx4 v200, s[32:35], s78 offen offset:2112 lds
  buffer_load_dwordx4 v201, s[32:35], s78 offen offset:3168 lds
  s_waitcnt vmcnt(0)
  s_branch JN62
VR64:
  s_cmp_eq_u32 s82, 0
  s_cbranch_scc1 VK65
  s_sub_u32 s82, s82, 1
  s_nop 7
  s_mov_b32 s66, s60
  buffer_load_dwordx4 v[80:83], v206, s[8:11], s66 offen sc1
  buffer_load_dwordx4 v[84:87], v207, s[8:11], s66 offen sc1
  buffer_load_dwordx4 v[88:91], v208, s[8:11], s66 offen sc1
  buffer_load_dwordx4 v[92:95], v209, s[8:11], s66 offen sc1
  s_waitcnt vmcnt(0)
  v_max3_u32 v12, v80, v84, v88
  v_max_u32 v12, v12, v92
  v_cmp_eq_u32 vcc, -1, v12
  s_cbranch_vccnz VR64
  v_max3_u32 v12, v96, v100, v104
  v_max3_u32 v12, v12, v108, v112
  v_max3_u32 v12, v12, v116, v120
  v_max3_u32 v12, v12, v124, v128
  v_max3_u32 v12, v12, v132, v136
  v_max_u32 v12, v12, v140
  v_cmp_eq_u32 vcc, -1, v12
  s_cbranch_vccz VK65
  s_add_u32 s66, s60, 1024
  s_and_b32 s66, s66, 0x3fff
  buffer_load_dwordx4 v[96:99], v206, s[8:11], s66 offen sc1
  buffer_load_dwordx4 v[100:103], v207, s[8:11], s66 offen sc1
  buffer_load_dwordx4 v[104:107], v208, s[8:11], s66 offen sc1
  buffer_load_dwordx4 v[108:111], v209, s[8:11], s66 offen sc1
  s_add_u32 s66, s60, 2048
  s_and_b32 s66, s66, 0x3fff
  buffer_load_dwordx4 v[112:115], v206, s[8:11], s66 offen sc1
  buffer_load_dwordx4 v[116:119], v207, s[8:11], s66 offen sc1
  buffer_load_dwordx4 v[120:123], v208, s[8:11], s66 offen sc1
  buffer_load_dwordx4 v[124:127], v209, s[8:11], s66 offen sc1
  s_add_u32 s66, s60, 3072
  s_and_b32 s66, s66, 0x3fff
  buffer_load_dwordx4 v[128:131], v206, s[8:11], s66 offen sc1
  buffer_load_dwordx4 v[132:135], v207, s[8:11], s66 offen sc1
  buffer_load_dwordx4 v[136:139], v208, s[8:11], s66 offen sc1
  buffer_load_dwordx4 v[140:143], v209, s[8:11], s66 offen sc1
  s_waitcnt vmcnt(0)
  s_nop 1
  s_branch VK65
VR67:
  s_cmp_eq_u32 s82, 0
  s_cbranch_scc1 VK68
  s_sub_u32 s82, s82, 1
  s_nop 7
  s_add_u32 s66, s60, 1024
  s_and_b32 s66, s66, 0x3fff
  buffer_load_dwordx4 v[96:99], v206, s[8:11], s66 offen sc1
  buffer_load_dwordx4 v[100:103], v207, s[8:11], s66 offen sc1
  buffer_load_dwordx4 v[104:107], v208, s[8:11], s66 offen sc1
  buffer_load_dwordx4 v[108:111], v209, s[8:11], s66 offen sc1
  s_waitcnt vmcnt(0)
  v_max3_u32 v12, v96, v100, v104
  v_max_u32 v12, v12, v108
  v_cmp_eq_u32 vcc, -1, v12
  s_cbranch_vccnz VR67
  v_max3_u32 v12, v112, v116, v120
  v_max3_u32 v12, v12, v124, v128
  v_max3_u32 v12, v12, v132, v136
  v_max3_u32 v12, v12, v140, v144
  v_max3_u32 v12, v12, v148, v152
  v_max_u32 v12, v12, v156
  v_cmp_eq_u32 vcc, -1, v12
  s_cbranch_vccz VK68
  s_add_u32 s66, s60, 2048
  s_and_b32 s66, s66, 0x3fff
  buffer_load_dwordx4 v[112:115], v206, s[8:11], s66 offen sc1
  buffer_load_dwordx4 v[116:119], v207, s[8:11], s66 offen sc1
  buffer_load_dwordx4 v[120:123], v208, s[8:11], s66 offen sc1
  buffer_load_dwordx4 v[124:127], v209, s[8:11], s66 offen sc1
  s_add_u32 s66, s60, 3072
  s_and_b32 s66, s66, 0x3fff
  buffer_load_dwordx4 v[128:131], v206, s[8:11], s66 offen sc1
  buffer_load_dwordx4 v[132:135], v207, s[8:11], s66 offen sc1
  buffer_load_dwordx4 v[136:139], v208, s[8:11], s66 offen sc1
  buffer_load_dwordx4 v[140:143], v209, s[8:11], s66 offen sc1
  s_add_u32 s66, s60, 4096
  s_and_b32 s66, s66, 0x3fff
  buffer_load_dwordx4 v[144:147], v206, s[8:11], s66 offen sc1
  buffer_load_dwordx4 v[148:151], v207, s[8:11], s66 offen sc1
  buffer_load_dwordx4 v[152:155], v208, s[8:11], s66 offen sc1
  buffer_load_dwordx4 v[156:159], v209, s[8:11], s66 offen sc1
  s_waitcnt vmcnt(0)
  s_nop 1
  s_branch VK68
VR70:
  s_cmp_eq_u32 s82, 0
  s_cbranch_scc1 VK71
  s_sub_u32 s82, s82, 1
  s_nop 7
  s_add_u32 s66, s60, 2048
  s_and_b32 s66, s66, 0x3fff
  buffer_load_dwordx4 v[112:115], v206, s[8:11], s66 offen sc1
  buffer_load_dwordx4 v[116:119], v207, s[8:11], s66 offen sc1
  buffer_load_dwordx4 v[120:123], v208, s[8:11], s66 offen sc1
  buffer_load_dwordx4 v[124:127], v209, s[8:11], s66 offen sc1
  s_waitcnt vmcnt(0)
  v_max3_u32 v12, v112, v116, v120
  v_max_u32 v12, v12, v124
  v_cmp_eq_u32 vcc, -1, v12
  s_cbranch_vccnz VR70
  v_max3_u32 v12, v128, v132, v136
  v_max3_u32 v12, v12, v140, v144
  v_max3_u32 v12, v12, v148, v152
  v_max3_u32 v12, v12, v156, v80
  v_max3_u32 v12, v12, v84, v88
  v_max_u32 v12, v12, v92
  v_cmp_eq_u32 vcc, -1, v12
  s_cbranch_vccz VK71
  s_add_u32 s66, s60, 3072
  s_and_b32 s66, s66, 0x3fff
  buffer_load_dwordx4 v[128:131], v206, s[8:11], s66 offen sc1
  buffer_load_dwordx4 v[132:135], v207, s[8:11], s66 offen sc1
  buffer_load_dwordx4 v[136:139], v208, s[8:11], s66 offen sc1
  buffer_load_dwordx4 v[140:143], v209, s[8:11], s66 offen sc1
  s_add_u32 s66, s60, 4096
  s_and_b32 s66, s66, 0x3fff
  buffer_load_dwordx4 v[144:147], v206, s[8:11], s66 offen sc1
  buffer_load_dwordx4 v[148:151], v207, s[8:11], s66 offen sc1
  buffer_load_dwordx4 v[152:155], v208, s[8:11], s66 offen sc1
  buffer_load_dwordx4 v[156:159], v209, s[8:11], s66 offen sc1
  s_add_u32 s66, s60, 5120
  s_and_b32 s66, s66, 0x3fff
  buffer_load_dwordx4 v[80:83], v206, s[8:11], s66 offen sc1
  buffer_load_dwordx4 v[84:87], v207, s[8:11], s66 offen sc1
  buffer_load_dwordx4 v[88:91], v208, s[8:11], s66 offen sc1
  buffer_load_dwordx4 v[92:95], v209, s[8:11], s66 offen sc1
  s_waitcnt vmcnt(0)
  s_nop 1
  s_branch VK71
VR73:
  s_cmp_eq_u32 s82, 0
  s_cbranch_scc1 VK74
  s_sub_u32 s82, s82, 1
  s_nop 7
  s_add_u32 s66, s60, 3072
  s_and_b32 s66, s66, 0x3fff
  buffer_load_dwordx4 v[128:131], v206, s[8:11], s66 offen sc1
  buffer_load_dwordx4 v[132:135], v207, s[8:11], s66 offen sc1
  buffer_load_dwordx4 v[136:139], v208, s[8:11], s66 offen sc1
  buffer_load_dwordx4 v[140:143], v209, s[8:11], s66 offen sc1
  s_waitcnt vmcnt(0)
  v_max3_u32 v12, v128, v132, v136
  v_max_u32 v12, v12, v140
  v_cmp_eq_u32 vcc, -1, v12
  s_cbranch_vccnz VR73
  v_max3_u32 v12, v144, v148, v152
  v_max3_u32 v12, v12, v156, v80
  v_max3_u32 v12, v12, v84, v88
  v_max3_u32 v12, v12, v92, v96
  v_max3_u32 v12, v12, v100, v104
  v_max_u32 v12, v12, v108
  v_cmp_eq_u32 vcc, -1, v12
  s_cbranch_vccz VK74
  s_add_u32 s66, s60, 4096
  s_and_b32 s66, s66, 0x3fff
  buffer_load_dwordx4 v[144:147], v206, s[8:11], s66 offen sc1
  buffer_load_dwordx4 v[148:151], v207, s[8:11], s66 offen sc1
  buffer_load_dwordx4 v[152:155], v208, s[8:11], s66 offen sc1
  buffer_load_dwordx4 v[156:159], v209, s[8:11], s66 offen sc1
  s_add_u32 s66, s60, 5120
  s_and_b32 s66, s66, 0x3fff
  buffer_load_dwordx4 v[80:83], v206, s[8:11], s66 offen sc1
  buffer_load_dwordx4 v[84:87], v207, s[8:11], s66 offen sc1
  buffer_load_dwordx4 v[88:91], v208, s[8:11], s66 offen sc1
  buffer_load_dwordx4 v[92:95], v209, s[8:11], s66 offen sc1
  s_add_u32 s66, s60, 6144
  s_and_b32 s66, s66, 0x3fff
  buffer_load_dwordx4 v[96:99], v206, s[8:11], s66 offen sc1
  buffer_load_dwordx4 v[100:103], v207, s[8:11], s66 offen sc1
  buffer_load_dwordx4 v[104:107], v208, s[8:11], s66 offen sc1
  buffer_load_dwordx4 v[108:111], v209, s[8:11], s66 offen sc1
  s_waitcnt vmcnt(0)
  s_nop 1
  s_branch VK74
VR76:
  s_cmp_eq_u32 s82, 0
  s_cbranch_scc1 VK77
  s_sub_u32 s82, s82, 1
  s_nop 7
  s_add_u32 s66, s60, 4096
  s_and_b32 s66, s66, 0x3fff
  buffer_load_dwordx4 v[144:147], v206, s[8:11], s66 offen sc1
  buffer_load_dwordx4 v[148:151], v207, s[8:11], s66 offen sc1
  buffer_load_dwordx4 v[152:155], v208, s[8:11], s66 offen sc1
  buffer_load_dwordx4 v[156:159], v209, s[8:11], s66 offen sc1
  s_waitcnt vmcnt(0)
  v_max3_u32 v12, v144, v148, v152
  v_max_u32 v12, v12, v156
  v_cmp_eq_u32 vcc, -1, v12
  s_cbranch_vccnz VR76
  v_max3_u32 v12, v80, v84, v88
  v_max3_u32 v12, v12, v92, v96
  v_max3_u32 v12, v12, v100, v104
  v_max3_u32 v12, v12, v108, v112
  v_max3_u32 v12, v12, v116, v120
  v_max_u32 v12, v12, v124
  v_cmp_eq_u32 vcc, -1, v12
  s_cbranch_vccz VK77
  s_add_u32 s66, s60, 5120
  s_and_b32 s66, s66, 0x3fff
  buffer_load_dwordx4 v[80:83], v206, s[8:11], s66 offen sc1
  buffer_load_dwordx4 v[84:87], v207, s[8:11], s66 offen sc1
  buffer_load_dwordx4 v[88:91], v208, s[8:11], s66 offen sc1
  buffer_load_dwordx4 v[92:95], v209, s[8:11], s66 offen sc1
  s_add_u32 s66, s60, 6144
  s_and_b32 s66, s66, 0x3fff
  buffer_load_dwordx4 v[96:99], v206, s[8:11], s66 offen sc1
  buffer_load_dwordx4 v[100:103], v207, s[8:11], s66 offen sc1
  buffer_load_dwordx4 v[104:107], v208, s[8:11], s66 offen sc1
  buffer_load_dwordx4 v[108:111], v209, s[8:11], s66 offen sc1
  s_add_u32 s66, s60, 7168
  s_and_b32 s66, s66, 0x3fff
  buffer_load_dwordx4 v[112:115], v206, s[8:11], s66 offen sc1
  buffer_load_dwordx4 v[116:119], v207, s[8:11], s66 offen sc1
  buffer_load_dwordx4 v[120:123], v208, s[8:11], s66 offen sc1
  buffer_load_dwordx4 v[124:127], v209, s[8:11], s66 offen sc1
  s_waitcnt vmcnt(0)
  s_nop 1
  s_branch VK77
VR79:
  s_cmp_eq_u32 s82, 0
  s_cbranch_scc1 VK80
  s_sub_u32 s82, s82, 1
  s_nop 7
  s_add_u32 s66, s60, 5120
  s_and_b32 s66, s66, 0x3fff
  buffer_load_dwordx4 v[80:83], v206, s[8:11], s66 offen sc1
  buffer_load_dwordx4 v[84:87], v207, s[8:11], s66 offen sc1
  buffer_load_dwordx4 v[88:91], v208, s[8:11], s66 offen sc1
  buffer_load_dwordx4 v[92:95], v209, s[8:11], s66 offen sc1
  s_waitcnt vmcnt(0)
  v_max3_u32 v12, v80, v84, v88
  v_max_u32 v12, v12, v92
  v_cmp_eq_u32 vcc, -1, v12
  s_cbranch_vccnz VR79
  v_max3_u32 v12, v96, v100, v104
  v_max3_u32 v12, v12, v108, v112
  v_max3_u32 v12, v12, v116, v120
  v_max3_u32 v12, v12, v124, v128
  v_max3_u32 v12, v12, v132, v136
  v_max_u32 v12, v12, v140
  v_cmp_eq_u32 vcc, -1, v12
  s_cbranch_vccz VK80
  s_add_u32 s66, s60, 6144
  s_and_b32 s66, s66, 0x3fff
  buffer_load_dwordx4 v[96:99], v206, s[8:11], s66 offen sc1
  buffer_load_dwordx4 v[100:103], v207, s[8:11], s66 offen sc1
  buffer_load_dwordx4 v[104:107], v208, s[8:11], s66 offen sc1
  buffer_load_dwordx4 v[108:111], v209, s[8:11], s66 offen sc1
  s_add_u32 s66, s60, 7168
  s_and_b32 s66, s66, 0x3fff
  buffer_load_dwordx4 v[112:115], v206, s[8:11], s66 offen sc1
  buffer_load_dwordx4 v[116:119], v207, s[8:11], s66 offen sc1
  buffer_load_dwordx4 v[120:123], v208, s[8:11], s66 offen sc1
  buffer_load_dwordx4 v[124:127], v209, s[8:11], s66 offen sc1
  s_add_u32 s66, s60, 8192
  s_and_b32 s66, s66, 0x3fff
  buffer_load_dwordx4 v[128:131], v206, s[8:11], s66 offen sc1
  buffer_load_dwordx4 v[132:135], v207, s[8:11], s66 offen sc1
  buffer_load_dwordx4 v[136:139], v208, s[8:11], s66 offen sc1
  buffer_load_dwordx4 v[140:143], v209, s[8:11], s66 offen sc1
  s_waitcnt vmcnt(0)
  s_nop 1
  s_branch VK80
VR82:
  s_cmp_eq_u32 s82, 0
  s_cbranch_scc1 VK83
  s_sub_u32 s82, s82, 1
  s_nop 7
  s_add_u32 s66, s60, 6144
  s_and_b32 s66, s66, 0x3fff
  buffer_load_dwordx4 v[96:99], v206, s[8:11], s66 offen sc1
  buffer_load_dwordx4 v[100:103], v207, s[8:11], s66 offen sc1
  buffer_load_dwordx4 v[104:107], v208, s[8:11], s66 offen sc1
  buffer_load_dwordx4 v[108:111], v209, s[8:11], s66 offen sc1
  s_waitcnt vmcnt(0)
  v_max3_u32 v12, v96, v100, v104
  v_max_u32 v12, v12, v108
  v_cmp_eq_u32 vcc, -1, v12
  s_cbranch_vccnz VR82
  v_max3_u32 v12, v112, v116, v120
  v_max3_u32 v12, v12, v124, v128
  v_max3_u32 v12, v12, v132, v136
  v_max3_u32 v12, v12, v140, v144
  v_max3_u32 v12, v12, v148, v152
  v_max_u32 v12, v12, v156
  v_cmp_eq_u32 vcc, -1, v12
  s_cbranch_vccz VK83
  s_add_u32 s66, s60, 7168
  s_and_b32 s66, s66, 0x3fff
  buffer_load_dwordx4 v[112:115], v206, s[8:11], s66 offen sc1
  buffer_load_dwordx4 v[116:119], v207, s[8:11], s66 offen sc1
  buffer_load_dwordx4 v[120:123], v208, s[8:11], s66 offen sc1
  buffer_load_dwordx4 v[124:127], v209, s[8:11], s66 offen sc1
  s_add_u32 s66, s60, 8192
  s_and_b32 s66, s66, 0x3fff
  buffer_load_dwordx4 v[128:131], v206, s[8:11], s66 offen sc1
  buffer_load_dwordx4 v[132:135], v207, s[8:11], s66 offen sc1
  buffer_load_dwordx4 v[136:139], v208, s[8:11], s66 offen sc1
  buffer_load_dwordx4 v[140:143], v209, s[8:11], s66 offen sc1
  s_add_u32 s66, s60, 9216
  s_and_b32 s66, s66, 0x3fff
  buffer_load_dwordx4 v[144:147], v206, s[8:11], s66 offen sc1
  buffer_load_dwordx4 v[148:151], v207, s[8:11], s66 offen sc1
  buffer_load_dwordx4 v[152:155], v208, s[8:11], s66 offen sc1
  buffer_load_dwordx4 v[156:159], v209, s[8:11], s66 offen sc1
  s_waitcnt vmcnt(0)
  s_nop 1
  s_branch VK83
VR85:
  s_cmp_eq_u32 s82, 0
  s_cbranch_scc1 VK86
  s_sub_u32 s82, s82, 1
  s_nop 7
  s_add_u32 s66, s60, 7168
  s_and_b32 s66, s66, 0x3fff
  buffer_load_dwordx4 v[112:115], v206, s[8:11], s66 offen sc1
  buffer_load_dwordx4 v[116:119], v207, s[8:11], s66 offen sc1
  buffer_load_dwordx4 v[120:123], v208, s[8:11], s66 offen sc1
  buffer_load_dwordx4 v[124:127], v209, s[8:11], s66 offen sc1
  s_waitcnt vmcnt(0)
  v_max3_u32 v12, v112, v116, v120
  v_max_u32 v12, v12, v124
  v_cmp_eq_u32 vcc, -1, v12
  s_cbranch_vccnz VR85
  v_max3_u32 v12, v128, v132, v136
  v_max3_u32 v12, v12, v140, v144
  v_max3_u32 v12, v12, v148, v152
  v_max3_u32 v12, v12, v156, v80
  v_max3_u32 v12, v12, v84, v88
  v_max_u32 v12, v12, v92
  v_cmp_eq_u32 vcc, -1, v12
  s_cbranch_vccz VK86
  s_add_u32 s66, s60, 8192
  s_and_b32 s66, s66, 0x3fff
  buffer_load_dwordx4 v[128:131], v206, s[8:11], s66 offen sc1
  buffer_load_dwordx4 v[132:135], v207, s[8:11], s66 offen sc1
  buffer_load_dwordx4 v[136:139], v208, s[8:11], s66 offen sc1
  buffer_load_dwordx4 v[140:143], v209, s[8:11], s66 offen sc1
  s_add_u32 s66, s60, 9216
  s_and_b32 s66, s66, 0x3fff
  buffer_load_dwordx4 v[144:147], v206, s[8:11], s66 offen sc1
  buffer_load_dwordx4 v[148:151], v207, s[8:11], s66 offen sc1
  buffer_load_dwordx4 v[152:155], v208, s[8:11], s66 offen sc1
  buffer_load_dwordx4 v[156:159], v209, s[8:11], s66 offen sc1
  s_add_u32 s66, s60, 10240
  s_and_b32 s66, s66, 0x3fff
  buffer_load_dwordx4 v[80:83], v206, s[8:11], s66 offen sc1
  buffer_load_dwordx4 v[84:87], v207, s[8:11], s66 offen sc1
  buffer_load_dwordx4 v[88:91], v208, s[8:11], s66 offen sc1
  buffer_load_dwordx4 v[92:95], v209, s[8:11], s66 offen sc1
  s_waitcnt vmcnt(0)
  s_nop 1
  s_branch VK86
VR88:
  s_cmp_eq_u32 s82, 0
  s_cbranch_scc1 VK89
  s_sub_u32 s82, s82, 1
  s_nop 7
  s_add_u32 s66, s60, 8192
  s_and_b32 s66, s66, 0x3fff
  buffer_load_dwordx4 v[128:131], v206, s[8:11], s66 offen sc1
  buffer_load_dwordx4 v[132:135], v207, s[8:11], s66 offen sc1
  buffer_load_dwordx4 v[136:139], v208, s[8:11], s66 offen sc1
  buffer_load_dwordx4 v[140:143], v209, s[8:11], s66 offen sc1
  s_waitcnt vmcnt(0)
  v_max3_u32 v12, v128, v132, v136
  v_max_u32 v12, v12, v140
  v_cmp_eq_u32 vcc, -1, v12
  s_cbranch_vccnz VR88
  v_max3_u32 v12, v144, v148, v152
  v_max3_u32 v12, v12, v156, v80
  v_max3_u32 v12, v12, v84, v88
  v_max3_u32 v12, v12, v92, v96
  v_max3_u32 v12, v12, v100, v104
  v_max_u32 v12, v12, v108
  v_cmp_eq_u32 vcc, -1, v12
  s_cbranch_vccz VK89
  s_add_u32 s66, s60, 9216
  s_and_b32 s66, s66, 0x3fff
  buffer_load_dwordx4 v[144:147], v206, s[8:11], s66 offen sc1
  buffer_load_dwordx4 v[148:151], v207, s[8:11], s66 offen sc1
  buffer_load_dwordx4 v[152:155], v208, s[8:11], s66 offen sc1
  buffer_load_dwordx4 v[156:159], v209, s[8:11], s66 offen sc1
  s_add_u32 s66, s60, 10240
  s_and_b32 s66, s66, 0x3fff
  buffer_load_dwordx4 v[80:83], v206, s[8:11], s66 offen sc1
  buffer_load_dwordx4 v[84:87], v207, s[8:11], s66 offen sc1
  buffer_load_dwordx4 v[88:91], v208, s[8:11], s66 offen sc1
  buffer_load_dwordx4 v[92:95], v209, s[8:11], s66 offen sc1
  s_add_u32 s66, s60, 11264
  s_and_b32 s66, s66, 0x3fff
  buffer_load_dwordx4 v[96:99], v206, s[8:11], s66 offen sc1
  buffer_load_dwordx4 v[100:103], v207, s[8:11], s66 offen sc1
  buffer_load_dwordx4 v[104:107], v208, s[8:11], s66 offen sc1
  buffer_load_dwordx4 v[108:111], v209, s[8:11], s66 offen sc1
  s_waitcnt vmcnt(0)
  s_nop 1
  s_branch VK89
VR91:
  s_cmp_eq_u32 s82, 0
  s_cbranch_scc1 VK92
  s_sub_u32 s82, s82, 1
  s_nop 7
  s_add_u32 s66, s60, 9216
  s_and_b32 s66, s66, 0x3fff
  buffer_load_dwordx4 v[144:147], v206, s[8:11], s66 offen sc1
  buffer_load_dwordx4 v[148:151], v207, s[8:11], s66 offen sc1
  buffer_load_dwordx4 v[152:155], v208, s[8:11], s66 offen sc1
  buffer_load_dwordx4 v[156:159], v209, s[8:11], s66 offen sc1
  s_waitcnt vmcnt(0)
  v_max3_u32 v12, v144, v148, v152
  v_max_u32 v12, v12, v156
  v_cmp_eq_u32 vcc, -1, v12
  s_cbranch_vccnz VR91
  v_max3_u32 v12, v80, v84, v88
  v_max3_u32 v12, v12, v92, v96
  v_max3_u32 v12, v12, v100, v104
  v_max3_u32 v12, v12, v108, v112
  v_max3_u32 v12, v12, v116, v120
  v_max_u32 v12, v12, v124
  v_cmp_eq_u32 vcc, -1, v12
  s_cbranch_vccz VK92
  s_add_u32 s66, s60, 10240
  s_and_b32 s66, s66, 0x3fff
  buffer_load_dwordx4 v[80:83], v206, s[8:11], s66 offen sc1
  buffer_load_dwordx4 v[84:87], v207, s[8:11], s66 offen sc1
  buffer_load_dwordx4 v[88:91], v208, s[8:11], s66 offen sc1
  buffer_load_dwordx4 v[92:95], v209, s[8:11], s66 offen sc1
  s_add_u32 s66, s60, 11264
  s_and_b32 s66, s66, 0x3fff
  buffer_load_dwordx4 v[96:99], v206, s[8:11], s66 offen sc1
  buffer_load_dwordx4 v[100:103], v207, s[8:11], s66 offen sc1
  buffer_load_dwordx4 v[104:107], v208, s[8:11], s66 offen sc1
  buffer_load_dwordx4 v[108:111], v209, s[8:11], s66 offen sc1
  s_add_u32 s66, s60, 12288
  s_and_b32 s66, s66, 0x3fff
  buffer_load_dwordx4 v[112:115], v206, s[8:11], s66 offen sc1
  buffer_load_dwordx4 v[116:119], v207, s[8:11], s66 offen sc1
  buffer_load_dwordx4 v[120:123], v208, s[8:11], s66 offen sc1
  buffer_load_dwordx4 v[124:127], v209, s[8:11], s66 offen sc1
  s_waitcnt vmcnt(0)
  s_nop 1
  s_branch VK92
VR94:
  s_cmp_eq_u32 s82, 0
  s_cbranch_scc1 VK95
  s_sub_u32 s82, s82, 1
  s_nop 7
  s_add_u32 s66, s60, 10240
  s_and_b32 s66, s66, 0x3fff
  buffer_load_dwordx4 v[80:83], v206, s[8:11], s66 offen sc1
  buffer_load_dwordx4 v[84:87], v207, s[8:11], s66 offen sc1
  buffer_load_dwordx4 v[88:91], v208, s[8:11], s66 offen sc1
  buffer_load_dwordx4 v[92:95], v209, s[8:11], s66 offen sc1
  s_waitcnt vmcnt(0)
  v_max3_u32 v12, v80, v84, v88
  v_max_u32 v12, v12, v92
  v_cmp_eq_u32 vcc, -1, v12
  s_cbranch_vccnz VR94
  v_max3_u32 v12, v96, v100, v104
  v_max3_u32 v12, v12, v108, v112
  v_max3_u32 v12, v12, v116, v120
  v_max3_u32 v12, v12, v124, v128
  v_max3_u32 v12, v12, v132, v136
  v_max_u32 v12, v12, v140
  v_cmp_eq_u32 vcc, -1, v12
  s_cbranch_vccz VK95
  s_add_u32 s66, s60, 11264
  s_and_b32 s66, s66, 0x3fff
  buffer_load_dwordx4 v[96:99], v206, s[8:11], s66 offen sc1
  buffer_load_dwordx4 v[100:103], v207, s[8:11], s66 offen sc1
  buffer_load_dwordx4 v[104:107], v208, s[8:11], s66 offen sc1
  buffer_load_dwordx4 v[108:111], v209, s[8:11], s66 offen sc1
  s_add_u32 s66, s60, 12288
  s_and_b32 s66, s66, 0x3fff
  buffer_load_dwordx4 v[112:115], v206, s[8:11], s66 offen sc1
  buffer_load_dwordx4 v[116:119], v207, s[8:11], s66 offen sc1
  buffer_load_dwordx4 v[120:123], v208, s[8:11], s66 offen sc1
  buffer_load_dwordx4 v[124:127], v209, s[8:11], s66 offen sc1
  s_add_u32 s66, s60, 13312
  s_and_b32 s66, s66, 0x3fff
  buffer_load_dwordx4 v[128:131], v206, s[8:11], s66 offen sc1
  buffer_load_dwordx4 v[132:135], v207, s[8:11], s66 offen sc1
  buffer_load_dwordx4 v[136:139], v208, s[8:11], s66 offen sc1
  buffer_load_dwordx4 v[140:143], v209, s[8:11], s66 offen sc1
  s_waitcnt vmcnt(0)
  s_nop 1
  s_branch VK95
VR97:
  s_cmp_eq_u32 s82, 0
  s_cbranch_scc1 VK98
  s_sub_u32 s82, s82, 1
  s_nop 7
  s_add_u32 s66, s60, 11264
  s_and_b32 s66, s66, 0x3fff
  buffer_load_dwordx4 v[96:99], v206, s[8:11], s66 offen sc1
  buffer_load_dwordx4 v[100:103], v207, s[8:11], s66 offen sc1
  buffer_load_dwordx4 v[104:107], v208, s[8:11], s66 offen sc1
  buffer_load_dwordx4 v[108:111], v209, s[8:11], s66 offen sc1
  s_waitcnt vmcnt(0)
  v_max3_u32 v12, v96, v100, v104
  v_max_u32 v12, v12, v108
  v_cmp_eq_u32 vcc, -1, v12
  s_cbranch_vccnz VR97
  v_max3_u32 v12, v112, v116, v120
  v_max3_u32 v12, v12, v124, v128
  v_max3_u32 v12, v12, v132, v136
  v_max3_u32 v12, v12, v140, v144
  v_max3_u32 v12, v12, v148, v152
  v_max_u32 v12, v12, v156
  v_cmp_eq_u32 vcc, -1, v12
  s_cbranch_vccz VK98
  s_add_u32 s66, s60, 12288
  s_and_b32 s66, s66, 0x3fff
  buffer_load_dwordx4 v[112:115], v206, s[8:11], s66 offen sc1
  buffer_load_dwordx4 v[116:119], v207, s[8:11], s66 offen sc1
  buffer_load_dwordx4 v[120:123], v208, s[8:11], s66 offen sc1
  buffer_load_dwordx4 v[124:127], v209, s[8:11], s66 offen sc1
  s_add_u32 s66, s60, 13312
  s_and_b32 s66, s66, 0x3fff
  buffer_load_dwordx4 v[128:131], v206, s[8:11], s66 offen sc1
  buffer_load_dwordx4 v[132:135], v207, s[8:11], s66 offen sc1
  buffer_load_dwordx4 v[136:139], v208, s[8:11], s66 offen sc1
  buffer_load_dwordx4 v[140:143], v209, s[8:11], s66 offen sc1
  s_add_u32 s66, s60, 14336
  s_and_b32 s66, s66, 0x3fff
  buffer_load_dwordx4 v[144:147], v206, s[8:11], s66 offen sc1
  buffer_load_dwordx4 v[148:151], v207, s[8:11], s66 offen sc1
  buffer_load_dwordx4 v[152:155], v208, s[8:11], s66 offen sc1
  buffer_load_dwordx4 v[156:159], v209, s[8:11], s66 offen sc1
  s_waitcnt vmcnt(0)
  s_nop 1
  s_branch VK98
VR100:
  s_cmp_eq_u32 s82, 0
  s_cbranch_scc1 VK101
  s_sub_u32 s82, s82, 1
  s_nop 7
  s_add_u32 s66, s60, 12288
  s_and_b32 s66, s66, 0x3fff
  buffer_load_dwordx4 v[112:115], v206, s[8:11], s66 offen sc1
  buffer_load_dwordx4 v[116:119], v207, s[8:11], s66 offen sc1
  buffer_load_dwordx4 v[120:123], v208, s[8:11], s66 offen sc1
  buffer_load_dwordx4 v[124:127], v209, s[8:11], s66 offen sc1
  s_waitcnt vmcnt(0)
  v_max3_u32 v12, v112, v116, v120
  v_max_u32 v12, v12, v124
  v_cmp_eq_u32 vcc, -1, v12
  s_cbranch_vccnz VR100
  v_max3_u32 v12, v128, v132, v136
  v_max3_u32 v12, v12, v140, v144
  v_max3_u32 v12, v12, v148, v152
  v_max3_u32 v12, v12, v156, v80
  v_max3_u32 v12, v12, v84, v88
  v_max_u32 v12, v12, v92
  v_cmp_eq_u32 vcc, -1, v12
  s_cbranch_vccz VK101
  s_add_u32 s66, s60, 13312
  s_and_b32 s66, s66, 0x3fff
  buffer_load_dwordx4 v[128:131], v206, s[8:11], s66 offen sc1
  buffer_load_dwordx4 v[132:135], v207, s[8:11], s66 offen sc1
  buffer_load_dwordx4 v[136:139], v208, s[8:11], s66 offen sc1
  buffer_load_dwordx4 v[140:143], v209, s[8:11], s66 offen sc1
  s_add_u32 s66, s60, 14336
  s_and_b32 s66, s66, 0x3fff
  buffer_load_dwordx4 v[144:147], v206, s[8:11], s66 offen sc1
  buffer_load_dwordx4 v[148:151], v207, s[8:11], s66 offen sc1
  buffer_load_dwordx4 v[152:155], v208, s[8:11], s66 offen sc1
  buffer_load_dwordx4 v[156:159], v209, s[8:11], s66 offen sc1
  s_add_u32 s66, s60, 15360
  s_and_b32 s66, s66, 0x3fff
  buffer_load_dwordx4 v[80:83], v206, s[8:11], s66 offen sc1
  buffer_load_dwordx4 v[84:87], v207, s[8:11], s66 offen sc1
  buffer_load_dwordx4 v[88:91], v208, s[8:11], s66 offen sc1
  buffer_load_dwordx4 v[92:95], v209, s[8:11], s66 offen sc1
  s_waitcnt vmcnt(0)
  s_nop 1
  s_branch VK101
VR103:
  s_cmp_eq_u32 s82, 0
  s_cbranch_scc1 VK104
  s_sub_u32 s82, s82, 1
  s_nop 7
  s_add_u32 s66, s60, 13312
  s_and_b32 s66, s66, 0x3fff
  buffer_load_dwordx4 v[128:131], v206, s[8:11], s66 offen sc1
  buffer_load_dwordx4 v[132:135], v207, s[8:11], s66 offen sc1
  buffer_load_dwordx4 v[136:139], v208, s[8:11], s66 offen sc1
  buffer_load_dwordx4 v[140:143], v209, s[8:11], s66 offen sc1
  s_waitcnt vmcnt(0)
  v_max3_u32 v12, v128, v132, v136
  v_max_u32 v12, v12, v140
  v_cmp_eq_u32 vcc, -1, v12
  s_cbranch_vccnz VR103
  v_max3_u32 v12, v144, v148, v152
  v_max3_u32 v12, v12, v156, v80
  v_max3_u32 v12, v12, v84, v88
  v_max_u32 v12, v12, v92
  v_cmp_eq_u32 vcc, -1, v12
  s_cbranch_vccz VK104
  s_add_u32 s66, s60, 14336
  s_and_b32 s66, s66, 0x3fff
  buffer_load_dwordx4 v[144:147], v206, s[8:11], s66 offen sc1
  buffer_load_dwordx4 v[148:151], v207, s[8:11], s66 offen sc1
  buffer_load_dwordx4 v[152:155], v208, s[8:11], s66 offen sc1
  buffer_load_dwordx4 v[156:159], v209, s[8:11], s66 offen sc1
  s_add_u32 s66, s60, 15360
  s_and_b32 s66, s66, 0x3fff
  buffer_load_dwordx4 v[80:83], v206, s[8:11], s66 offen sc1
  buffer_load_dwordx4 v[84:87], v207, s[8:11], s66 offen sc1
  buffer_load_dwordx4 v[88:91], v208, s[8:11], s66 offen sc1
  buffer_load_dwordx4 v[92:95], v209, s[8:11], s66 offen sc1
  s_waitcnt vmcnt(0)
  s_nop 1
  s_branch VK104
VR106:
  s_cmp_eq_u32 s82, 0
  s_cbranch_scc1 VK107
  s_sub_u32 s82, s82, 1
  s_nop 7
  s_add_u32 s66, s60, 14336
  s_and_b32 s66, s66, 0x3fff
  buffer_load_dwordx4 v[144:147], v206, s[8:11], s66 offen sc1
  buffer_load_dwordx4 v[148:151], v207, s[8:11], s66 offen sc1
  buffer_load_dwordx4 v[152:155], v208, s[8:11], s66 offen sc1
  buffer_load_dwordx4 v[156:159], v209, s[8:11], s66 offen sc1
  s_waitcnt vmcnt(0)
  v_max3_u32 v12, v144, v148, v152
  v_max_u32 v12, v12, v156
  v_cmp_eq_u32 vcc, -1, v12
  s_cbranch_vccnz VR106
  v_max3_u32 v12, v80, v84, v88
  v_max_u32 v12, v12, v92
  v_cmp_eq_u32 vcc, -1, v12
  s_cbranch_vccz VK107
  s_add_u32 s66, s60, 15360
  s_and_b32 s66, s66, 0x3fff
  buffer_load_dwordx4 v[80:83], v206, s[8:11], s66 offen sc1
  buffer_load_dwordx4 v[84:87], v207, s[8:11], s66 offen sc1
  buffer_load_dwordx4 v[88:91], v208, s[8:11], s66 offen sc1
  buffer_load_dwordx4 v[92:95], v209, s[8:11], s66 offen sc1
  s_waitcnt vmcnt(0)
  s_nop 1
  s_branch VK107
VR109:
  s_cmp_eq_u32 s82, 0
  s_cbranch_scc1 VK110
  s_sub_u32 s82, s82, 1
  s_nop 7
  s_add_u32 s66, s60, 15360
  s_and_b32 s66, s66, 0x3fff
  buffer_load_dwordx4 v[80:83], v206, s[8:11], s66 offen sc1
  buffer_load_dwordx4 v[84:87], v207, s[8:11], s66 offen sc1
  buffer_load_dwordx4 v[88:91], v208, s[8:11], s66 offen sc1
  buffer_load_dwordx4 v[92:95], v209, s[8:11], s66 offen sc1
  s_waitcnt vmcnt(0)
  s_branch VC108
VR112:
  s_cmp_eq_u32 s82, 0
  s_cbranch_scc1 VK113
  s_sub_u32 s82, s82, 1
  s_nop 7
  s_mov_b32 s66, s61
  buffer_load_dwordx4 v[96:99], v210, s[8:11], s66 offen sc1
  buffer_load_dwordx4 v[100:103], v211, s[8:11], s66 offen sc1
  buffer_load_dwordx4 v[104:107], v212, s[8:11], s66 offen sc1
  buffer_load_dwordx4 v[108:111], v213, s[8:11], s66 offen sc1
  buffer_load_dwordx4 v[112:115], v214, s[8:11], s66 offen sc1
  s_waitcnt vmcnt(0)
  v_max3_u32 v8, v96, v100, v104
  v_max3_u32 v8, v8, v108, v112
  v_cmp_eq_u32 vcc, -1, v8
  s_cbranch_vccnz VR112
  v_max3_u32 v8, v116, v120, v124
  v_max3_u32 v8, v8, v128, v132
  v_max3_u32 v8, v8, v136, v140
  v_max3_u32 v8, v8, v144, v148
  v_max_u32 v8, v8, v152
  v_cmp_eq_u32 vcc, -1, v8
  s_cbranch_vccz VK113
  s_add_u32 s66, s61, 1024
  s_sub_u32 s68, s66, 12288
  s_cselect_b32 s66, s66, s68
  buffer_load_dwordx4 v[116:119], v210, s[8:11], s66 offen sc1
  buffer_load_dwordx4 v[120:123], v211, s[8:11], s66 offen sc1
  buffer_load_dwordx4 v[124:127], v212, s[8:11], s66 offen sc1
  buffer_load_dwordx4 v[128:131], v213, s[8:11], s66 offen sc1
  buffer_load_dwordx4 v[132:135], v214, s[8:11], s66 offen sc1
  s_add_u32 s66, s61, 2048
  s_sub_u32 s68, s66, 12288
  s_cselect_b32 s66, s66, s68
  buffer_load_dwordx4 v[136:139], v210, s[8:11], s66 offen sc1
  buffer_load_dwordx4 v[140:143], v211, s[8:11], s66 offen sc1
  buffer_load_dwordx4 v[144:147], v212, s[8:11], s66 offen sc1
  buffer_load_dwordx4 v[148:151], v213, s[8:11], s66 offen sc1
  buffer_load_dwordx4 v[152:155], v214, s[8:11], s66 offen sc1
  s_waitcnt vmcnt(0)
  s_nop 1
  s_branch VK113
VR115:
  s_cmp_eq_u32 s82, 0
  s_cbranch_scc1 VK116
  s_sub_u32 s82, s82, 1
  s_nop 7
  s_add_u32 s66, s61, 1024
  s_sub_u32 s68, s66, 12288
  s_cselect_b32 s66, s66, s68
  buffer_load_dwordx4 v[116:119], v210, s[8:11], s66 offen sc1
  buffer_load_dwordx4 v[120:123], v211, s[8:11], s66 offen sc1
  buffer_load_dwordx4 v[124:127], v212, s[8:11], s66 offen sc1
  buffer_load_dwordx4 v[128:131], v213, s[8:11], s66 offen sc1
  buffer_load_dwordx4 v[132:135], v214, s[8:11], s66 offen sc1
  s_waitcnt vmcnt(0)
  v_max3_u32 v8, v116, v120, v124
  v_max3_u32 v8, v8, v128, v132
  v_cmp_eq_u32 vcc, -1, v8
  s_cbranch_vccnz VR115
  v_max3_u32 v8, v136, v140, v144
  v_max3_u32 v8, v8, v148, v152
  v_max3_u32 v8, v8, v156, v160
  v_max3_u32 v8, v8, v164, v168
  v_max_u32 v8, v8, v172
  v_cmp_eq_u32 vcc, -1, v8
  s_cbranch_vccz VK116
  s_add_u32 s66, s61, 2048
  s_sub_u32 s68, s66, 12288
  s_cselect_b32 s66, s66, s68
  buffer_load_dwordx4 v[136:139], v210, s[8:11], s66 offen sc1
  buffer_load_dwordx4 v[140:143], v211, s[8:11], s66 offen sc1
  buffer_load_dwordx4 v[144:147], v212, s[8:11], s66 offen sc1
  buffer_load_dwordx4 v[148:151], v213, s[8:11], s66 offen sc1
  buffer_load_dwordx4 v[152:155], v214, s[8:11], s66 offen sc1
  s_add_u32 s66, s61, 3072
  s_sub_u32 s68, s66, 12288
  s_cselect_b32 s66, s66, s68
  buffer_load_dwordx4 v[156:159], v210, s[8:11], s66 offen sc1
  buffer_load_dwordx4 v[160:163], v211, s[8:11], s66 offen sc1
  buffer_load_dwordx4 v[164:167], v212, s[8:11], s66 offen sc1
  buffer_load_dwordx4 v[168:171], v213, s[8:11], s66 offen sc1
  buffer_load_dwordx4 v[172:175], v214, s[8:11], s66 offen sc1
  s_waitcnt vmcnt(0)
  s_nop 1
  s_branch VK116
VR118:
  s_cmp_eq_u32 s82, 0
  s_cbranch_scc1 VK119
  s_sub_u32 s82, s82, 1
  s_nop 7
  s_add_u32 s66, s61, 2048
  s_sub_u32 s68, s66, 12288
  s_cselect_b32 s66, s66, s68
  buffer_load_dwordx4 v[136:139], v210, s[8:11], s66 offen sc1
  buffer_load_dwordx4 v[140:143], v211, s[8:11], s66 offen sc1
  buffer_load_dwordx4 v[144:147], v212, s[8:11], s66 offen sc1
  buffer_load_dwordx4 v[148:151], v213, s[8:11], s66 offen sc1
  buffer_load_dwordx4 v[152:155], v214, s[8:11], s66 offen sc1
  s_waitcnt vmcnt(0)
  v_max3_u32 v8, v136, v140, v144
  v_max3_u32 v8, v8, v148, v152
  v_cmp_eq_u32 vcc, -1, v8
  s_cbranch_vccnz VR118
  v_max3_u32 v8, v156, v160, v164
  v_max3_u32 v8, v8, v168, v172
  v_max3_u32 v8, v8, v96, v100
  v_max3_u32 v8, v8, v104, v108
  v_max_u32 v8, v8, v112
  v_cmp_eq_u32 vcc, -1, v8
  s_cbranch_vccz VK119
  s_add_u32 s66, s61, 3072
  s_sub_u32 s68, s66, 12288
  s_cselect_b32 s66, s66, s68
  buffer_load_dwordx4 v[156:159], v210, s[8:11], s66 offen sc1
  buffer_load_dwordx4 v[160:163], v211, s[8:11], s66 offen sc1
  buffer_load_dwordx4 v[164:167], v212, s[8:11], s66 offen sc1
  buffer_load_dwordx4 v[168:171], v213, s[8:11], s66 offen sc1
  buffer_load_dwordx4 v[172:175], v214, s[8:11], s66 offen sc1
  s_add_u32 s66, s61, 4096
  s_sub_u32 s68, s66, 12288
  s_cselect_b32 s66, s66, s68
  buffer_load_dwordx4 v[96:99], v210, s[8:11], s66 offen sc1
  buffer_load_dwordx4 v[100:103], v211, s[8:11], s66 offen sc1
  buffer_load_dwordx4 v[104:107], v212, s[8:11], s66 offen sc1
  buffer_load_dwordx4 v[108:111], v213, s[8:11], s66 offen sc1
  buffer_load_dwordx4 v[112:115], v214, s[8:11], s66 offen sc1
  s_waitcnt vmcnt(0)
  s_nop 1
  s_branch VK119
VR121:
  s_cmp_eq_u32 s82, 0
  s_cbranch_scc1 VK122
  s_sub_u32 s82, s82, 1
  s_nop 7
  s_add_u32 s66, s61, 3072
  s_sub_u32 s68, s66, 12288
  s_cselect_b32 s66, s66, s68
  buffer_load_dwordx4 v[156:159], v210, s[8:11], s66 offen sc1
  buffer_load_dwordx4 v[160:163], v211, s[8:11], s66 offen sc1
  buffer_load_dwordx4 v[164:167], v212, s[8:11], s66 offen sc1
  buffer_load_dwordx4 v[168:171], v213, s[8:11], s66 offen sc1
  buffer_load_dwordx4 v[172:175], v214, s[8:11], s66 offen sc1
  s_waitcnt vmcnt(0)
  v_max3_u32 v8, v156, v160, v164
  v_max3_u32 v8, v8, v168, v172
  v_cmp_eq_u32 vcc, -1, v8
  s_cbranch_vccnz VR121
  v_max3_u32 v8, v96, v100, v104
  v_max3_u32 v8, v8, v108, v112
  v_max3_u32 v8, v8, v116, v120
  v_max3_u32 v8, v8, v124, v128
  v_max_u32 v8, v8, v132
  v_cmp_eq_u32 vcc, -1, v8
  s_cbranch_vccz VK122
  s_add_u32 s66, s61, 4096
  s_sub_u32 s68, s66, 12288
  s_cselect_b32 s66, s66, s68
  buffer_load_dwordx4 v[96:99], v210, s[8:11], s66 offen sc1
  buffer_load_dwordx4 v[100:103], v211, s[8:11], s66 offen sc1
  buffer_load_dwordx4 v[104:107], v212, s[8:11], s66 offen sc1
  buffer_load_dwordx4 v[108:111], v213, s[8:11], s66 offen sc1
  buffer_load_dwordx4 v[112:115], v214, s[8:11], s66 offen sc1
  s_add_u32 s66, s61, 5120
  s_sub_u32 s68, s66, 12288
  s_cselect_b32 s66, s66, s68
  buffer_load_dwordx4 v[116:119], v210, s[8:11], s66 offen sc1
  buffer_load_dwordx4 v[120:123], v211, s[8:11], s66 offen sc1
  buffer_load_dwordx4 v[124:127], v212, s[8:11], s66 offen sc1
  buffer_load_dwordx4 v[128:131], v213, s[8:11], s66 offen sc1
  buffer_load_dwordx4 v[132:135], v214, s[8:11], s66 offen sc1
  s_waitcnt vmcnt(0)
  s_nop 1
  s_branch VK122
VR124:
  s_cmp_eq_u32 s82, 0
  s_cbranch_scc1 VK125
  s_sub_u32 s82, s82, 1
  s_nop 7
  s_add_u32 s66, s61, 4096
  s_sub_u32 s68, s66, 12288
  s_cselect_b32 s66, s66, s68
  buffer_load_dwordx4 v[96:99], v210, s[8:11], s66 offen sc1
  buffer_load_dwordx4 v[100:103], v211, s[8:11], s66 offen sc1
  buffer_load_dwordx4 v[104:107], v212, s[8:11], s66 offen sc1
  buffer_load_dwordx4 v[108:111], v213, s[8:11], s66 offen sc1
  buffer_load_dwordx4 v[112:115], v214, s[8:11], s66 offen sc1
  s_waitcnt vmcnt(0)
  v_max3_u32 v8, v96, v100, v104
  v_max3_u32 v8, v8, v108, v112
  v_cmp_eq_u32 vcc, -1, v8
  s_cbranch_vccnz VR124
  v_max3_u32 v8, v116, v120, v124
  v_max3_u32 v8, v8, v128, v132
  v_max3_u32 v8, v8, v136, v140
  v_max3_u32 v8, v8, v144, v148
  v_max_u32 v8, v8, v152
  v_cmp_eq_u32 vcc, -1, v8
  s_cbranch_vccz VK125
  s_add_u32 s66, s61, 5120
  s_sub_u32 s68, s66, 12288
  s_cselect_b32 s66, s66, s68
  buffer_load_dwordx4 v[116:119], v210, s[8:11], s66 offen sc1
  buffer_load_dwordx4 v[120:123], v211, s[8:11], s66 offen sc1
  buffer_load_dwordx4 v[124:127], v212, s[8:11], s66 offen sc1
  buffer_load_dwordx4 v[128:131], v213, s[8:11], s66 offen sc1
  buffer_load_dwordx4 v[132:135], v214, s[8:11], s66 offen sc1
  s_add_u32 s66, s61, 6144
  s_sub_u32 s68, s66, 12288
  s_cselect_b32 s66, s66, s68
  buffer_load_dwordx4 v[136:139], v210, s[8:11], s66 offen sc1
  buffer_load_dwordx4 v[140:143], v211, s[8:11], s66 offen sc1
  buffer_load_dwordx4 v[144:147], v212, s[8:11], s66 offen sc1
  buffer_load_dwordx4 v[148:151], v213, s[8:11], s66 offen sc1
  buffer_load_dwordx4 v[152:155], v214, s[8:11], s66 offen sc1
  s_waitcnt vmcnt(0)
  s_nop 1
  s_branch VK125
VR127:
  s_cmp_eq_u32 s82, 0
  s_cbranch_scc1 VK128
  s_sub_u32 s82, s82, 1
  s_nop 7
  s_add_u32 s66, s61, 5120
  s_sub_u32 s68, s66, 12288
  s_cselect_b32 s66, s66, s68
  buffer_load_dwordx4 v[116:119], v210, s[8:11], s66 offen sc1
  buffer_load_dwordx4 v[120:123], v211, s[8:11], s66 offen sc1
  buffer_load_dwordx4 v[124:127], v212, s[8:11], s66 offen sc1
  buffer_load_dwordx4 v[128:131], v213, s[8:11], s66 offen sc1
  buffer_load_dwordx4 v[132:135], v214, s[8:11], s66 offen sc1
  s_waitcnt vmcnt(0)
  v_max3_u32 v8, v116, v120, v124
  v_max3_u32 v8, v8, v128, v132
  v_cmp_eq_u32 vcc, -1, v8
  s_cbranch_vccnz VR127
  v_max3_u32 v8, v136, v140, v144
  v_max3_u32 v8, v8, v148, v152
  v_max3_u32 v8, v8, v156, v160
  v_max3_u32 v8, v8, v164, v168
  v_max_u32 v8, v8, v172
  v_cmp_eq_u32 vcc, -1, v8
  s_cbranch_vccz VK128
  s_add_u32 s66, s61, 6144
  s_sub_u32 s68, s66, 12288
  s_cselect_b32 s66, s66, s68
  buffer_load_dwordx4 v[136:139], v210, s[8:11], s66 offen sc1
  buffer_load_dwordx4 v[140:143], v211, s[8:11], s66 offen sc1
  buffer_load_dwordx4 v[144:147], v212, s[8:11], s66 offen sc1
  buffer_load_dwordx4 v[148:151], v213, s[8:11], s66 offen sc1
  buffer_load_dwordx4 v[152:155], v214, s[8:11], s66 offen sc1
  s_add_u32 s66, s61, 7168
  s_sub_u32 s68, s66, 12288
  s_cselect_b32 s66, s66, s68
  buffer_load_dwordx4 v[156:159], v210, s[8:11], s66 offen sc1
  buffer_load_dwordx4 v[160:163], v211, s[8:11], s66 offen sc1
  buffer_load_dwordx4 v[164:167], v212, s[8:11], s66 offen sc1
  buffer_load_dwordx4 v[168:171], v213, s[8:11], s66 offen sc1
  buffer_load_dwordx4 v[172:175], v214, s[8:11], s66 offen sc1
  s_waitcnt vmcnt(0)
  s_nop 1
  s_branch VK128
VR130:
  s_cmp_eq_u32 s82, 0
  s_cbranch_scc1 VK131
  s_sub_u32 s82, s82, 1
  s_nop 7
  s_add_u32 s66, s61, 6144
  s_sub_u32 s68, s66, 12288
  s_cselect_b32 s66, s66, s68
  buffer_load_dwordx4 v[136:139], v210, s[8:11], s66 offen sc1
  buffer_load_dwordx4 v[140:143], v211, s[8:11], s66 offen sc1
  buffer_load_dwordx4 v[144:147], v212, s[8:11], s66 offen sc1
  buffer_load_dwordx4 v[148:151], v213, s[8:11], s66 offen sc1
  buffer_load_dwordx4 v[152:155], v214, s[8:11], s66 offen sc1
  s_waitcnt vmcnt(0)
  v_max3_u32 v8, v136, v140, v144
  v_max3_u32 v8, v8, v148, v152
  v_cmp_eq_u32 vcc, -1, v8
  s_cbranch_vccnz VR130
  v_max3_u32 v8, v156, v160, v164
  v_max3_u32 v8, v8, v168, v172
  v_max3_u32 v8, v8, v96, v100
  v_max3_u32 v8, v8, v104, v108
  v_max_u32 v8, v8, v112
  v_cmp_eq_u32 vcc, -1, v8
  s_cbranch_vccz VK131
  s_add_u32 s66, s61, 7168
  s_sub_u32 s68, s66, 12288
  s_cselect_b32 s66, s66, s68
  buffer_load_dwordx4 v[156:159], v210, s[8:11], s66 offen sc1
  buffer_load_dwordx4 v[160:163], v211, s[8:11], s66 offen sc1
  buffer_load_dwordx4 v[164:167], v212, s[8:11], s66 offen sc1
  buffer_load_dwordx4 v[168:171], v213, s[8:11], s66 offen sc1
  buffer_load_dwordx4 v[172:175], v214, s[8:11], s66 offen sc1
  s_add_u32 s66, s61, 8192
  s_sub_u32 s68, s66, 12288
  s_cselect_b32 s66, s66, s68
  buffer_load_dwordx4 v[96:99], v210, s[8:11], s66 offen sc1
  buffer_load_dwordx4 v[100:103], v211, s[8:11], s66 offen sc1
  buffer_load_dwordx4 v[104:107], v212, s[8:11], s66 offen sc1
  buffer_load_dwordx4 v[108:111], v213, s[8:11], s66 offen sc1
  buffer_load_dwordx4 v[112:115], v214, s[8:11], s66 offen sc1
  s_waitcnt vmcnt(0)
  s_nop 1
  s_branch VK131
VR133:
  s_cmp_eq_u32 s82, 0
  s_cbranch_scc1 VK134
  s_sub_u32 s82, s82, 1
  s_nop 7
  s_add_u32 s66, s61, 7168
  s_sub_u32 s68, s66, 12288
  s_cselect_b32 s66, s66, s68
  buffer_load_dwordx4 v[156:159], v210, s[8:11], s66 offen sc1
  buffer_load_dwordx4 v[160:163], v211, s[8:11], s66 offen sc1
  buffer_load_dwordx4 v[164:167], v212, s[8:11], s66 offen sc1
  buffer_load_dwordx4 v[168:171], v213, s[8:11], s66 offen sc1
  buffer_load_dwordx4 v[172:175], v214, s[8:11], s66 offen sc1
  s_waitcnt vmcnt(0)
  v_max3_u32 v8, v156, v160, v164
  v_max3_u32 v8, v8, v168, v172
  v_cmp_eq_u32 vcc, -1, v8
  s_cbranch_vccnz VR133
  v_max3_u32 v8, v96, v100, v104
  v_max3_u32 v8, v8, v108, v112
  v_max3_u32 v8, v8, v116, v120
  v_max3_u32 v8, v8, v124, v128
  v_max_u32 v8, v8, v132
  v_cmp_eq_u32 vcc, -1, v8
  s_cbranch_vccz VK134
  s_add_u32 s66, s61, 8192
  s_sub_u32 s68, s66, 12288
  s_cselect_b32 s66, s66, s68
  buffer_load_dwordx4 v[96:99], v210, s[8:11], s66 offen sc1
  buffer_load_dwordx4 v[100:103], v211, s[8:11], s66 offen sc1
  buffer_load_dwordx4 v[104:107], v212, s[8:11], s66 offen sc1
  buffer_load_dwordx4 v[108:111], v213, s[8:11], s66 offen sc1
  buffer_load_dwordx4 v[112:115], v214, s[8:11], s66 offen sc1
  s_add_u32 s66, s61, 9216
  s_sub_u32 s68, s66, 12288
  s_cselect_b32 s66, s66, s68
  buffer_load_dwordx4 v[116:119], v210, s[8:11], s66 offen sc1
  buffer_load_dwordx4 v[120:123], v211, s[8:11], s66 offen sc1
  buffer_load_dwordx4 v[124:127], v212, s[8:11], s66 offen sc1
  buffer_load_dwordx4 v[128:131], v213, s[8:11], s66 offen sc1
  buffer_load_dwordx4 v[132:135], v214, s[8:11], s66 offen sc1
  s_waitcnt vmcnt(0)
  s_nop 1
  s_branch VK134
VR136:
  s_cmp_eq_u32 s82, 0
  s_cbranch_scc1 VK137
  s_sub_u32 s82, s82, 1
  s_nop 7
  s_add_u32 s66, s61, 8192
  s_sub_u32 s68, s66, 12288
  s_cselect_b32 s66, s66, s68
  buffer_load_dwordx4 v[96:99], v210, s[8:11], s66 offen sc1
  buffer_load_dwordx4 v[100:103], v211, s[8:11], s66 offen sc1
  buffer_load_dwordx4 v[104:107], v212, s[8:11], s66 offen sc1
  buffer_load_dwordx4 v[108:111], v213, s[8:11], s66 offen sc1
  buffer_load_dwordx4 v[112:115], v214, s[8:11], s66 offen sc1
  s_waitcnt vmcnt(0)
  v_max3_u32 v8, v96, v100, v104
  v_max3_u32 v8, v8, v108, v112
  v_cmp_eq_u32 vcc, -1, v8
  s_cbranch_vccnz VR136
  v_max3_u32 v8, v116, v120, v124
  v_max3_u32 v8, v8, v128, v132
  v_max3_u32 v8, v8, v136, v140
  v_max3_u32 v8, v8, v144, v148
  v_max_u32 v8, v8, v152
  v_cmp_eq_u32 vcc, -1, v8
  s_cbranch_vccz VK137
  s_add_u32 s66, s61, 9216
  s_sub_u32 s68, s66, 12288
  s_cselect_b32 s66, s66, s68
  buffer_load_dwordx4 v[116:119], v210, s[8:11], s66 offen sc1
  buffer_load_dwordx4 v[120:123], v211, s[8:11], s66 offen sc1
  buffer_load_dwordx4 v[124:127], v212, s[8:11], s66 offen sc1
  buffer_load_dwordx4 v[128:131], v213, s[8:11], s66 offen sc1
  buffer_load_dwordx4 v[132:135], v214, s[8:11], s66 offen sc1
  s_add_u32 s66, s61, 10240
  s_sub_u32 s68, s66, 12288
  s_cselect_b32 s66, s66, s68
  buffer_load_dwordx4 v[136:139], v210, s[8:11], s66 offen sc1
  buffer_load_dwordx4 v[140:143], v211, s[8:11], s66 offen sc1
  buffer_load_dwordx4 v[144:147], v212, s[8:11], s66 offen sc1
  buffer_load_dwordx4 v[148:151], v213, s[8:11], s66 offen sc1
  buffer_load_dwordx4 v[152:155], v214, s[8:11], s66 offen sc1
  s_waitcnt vmcnt(0)
  s_nop 1
  s_branch VK137
VR139:
  s_cmp_eq_u32 s82, 0
  s_cbranch_scc1 VK140
  s_sub_u32 s82, s82, 1
  s_nop 7
  s_add_u32 s66, s61, 9216
  s_sub_u32 s68, s66, 12288
  s_cselect_b32 s66, s66, s68
  buffer_load_dwordx4 v[116:119], v210, s[8:11], s66 offen sc1
  buffer_load_dwordx4 v[120:123], v211, s[8:11], s66 offen sc1
  buffer_load_dwordx4 v[124:127], v212, s[8:11], s66 offen sc1
  buffer_load_dwordx4 v[128:131], v213, s[8:11], s66 offen sc1
  buffer_load_dwordx4 v[132:135], v214, s[8:11], s66 offen sc1
  s_waitcnt vmcnt(0)
  v_max3_u32 v8, v116, v120, v124
  v_max3_u32 v8, v8, v128, v132
  v_cmp_eq_u32 vcc, -1, v8
  s_cbranch_vccnz VR139
  v_max3_u32 v8, v136, v140, v144
  v_max3_u32 v8, v8, v148, v152
  v_max3_u32 v8, v8, v156, v160
  v_max3_u32 v8, v8, v164, v168
  v_max_u32 v8, v8, v172
  v_cmp_eq_u32 vcc, -1, v8
  s_cbranch_vccz VK140
  s_add_u32 s66, s61, 10240
  s_sub_u32 s68, s66, 12288
  s_cselect_b32 s66, s66, s68
  buffer_load_dwordx4 v[136:139], v210, s[8:11], s66 offen sc1
  buffer_load_dwordx4 v[140:143], v211, s[8:11], s66 offen sc1
  buffer_load_dwordx4 v[144:147], v212, s[8:11], s66 offen sc1
  buffer_load_dwordx4 v[148:151], v213, s[8:11], s66 offen sc1
  buffer_load_dwordx4 v[152:155], v214, s[8:11], s66 offen sc1
  s_add_u32 s66, s61, 11264
  s_sub_u32 s68, s66, 12288
  s_cselect_b32 s66, s66, s68
  buffer_load_dwordx4 v[156:159], v210, s[8:11], s66 offen sc1
  buffer_load_dwordx4 v[160:163], v211, s[8:11], s66 offen sc1
  buffer_load_dwordx4 v[164:167], v212, s[8:11], s66 offen sc1
  buffer_load_dwordx4 v[168:171], v213, s[8:11], s66 offen sc1
  buffer_load_dwordx4 v[172:175], v214, s[8:11], s66 offen sc1
  s_waitcnt vmcnt(0)
  s_nop 1
  s_branch VK140
VR142:
  s_cmp_eq_u32 s82, 0
  s_cbranch_scc1 VK143
  s_sub_u32 s82, s82, 1
  s_nop 7
  s_add_u32 s66, s61, 10240
  s_sub_u32 s68, s66, 12288
  s_cselect_b32 s66, s66, s68
  buffer_load_dwordx4 v[136:139], v210, s[8:11], s66 offen sc1
  buffer_load_dwordx4 v[140:143], v211, s[8:11], s66 offen sc1
  buffer_load_dwordx4 v[144:147], v212, s[8:11], s66 offen sc1
  buffer_load_dwordx4 v[148:151], v213, s[8:11], s66 offen sc1
  buffer_load_dwordx4 v[152:155], v214, s[8:11], s66 offen sc1
  s_waitcnt vmcnt(0)
  v_max3_u32 v8, v136, v140, v144
  v_max3_u32 v8, v8, v148, v152
  v_cmp_eq_u32 vcc, -1, v8
  s_cbranch_vccnz VR142
  v_max3_u32 v8, v156, v160, v164
  v_max3_u32 v8, v8, v168, v172
  v_cmp_eq_u32 vcc, -1, v8
  s_cbranch_vccz VK143
  s_add_u32 s66, s61, 11264
  s_sub_u32 s68, s66, 12288
  s_cselect_b32 s66, s66, s68
  buffer_load_dwordx4 v[156:159], v210, s[8:11], s66 offen sc1
  buffer_load_dwordx4 v[160:163], v211, s[8:11], s66 offen sc1
  buffer_load_dwordx4 v[164:167], v212, s[8:11], s66 offen sc1
  buffer_load_dwordx4 v[168:171], v213, s[8:11], s66 offen sc1
  buffer_load_dwordx4 v[172:175], v214, s[8:11], s66 offen sc1
  s_waitcnt vmcnt(0)
  s_nop 1
  s_branch VK143
VR145:
  s_cmp_eq_u32 s82, 0
  s_cbranch_scc1 VK146
  s_sub_u32 s82, s82, 1
  s_nop 7
  s_add_u32 s66, s61, 11264
  s_sub_u32 s68, s66, 12288
  s_cselect_b32 s66, s66, s68
  buffer_load_dwordx4 v[156:159], v210, s[8:11], s66 offen sc1
  buffer_load_dwordx4 v[160:163], v211, s[8:11], s66 offen sc1
  buffer_load_dwordx4 v[164:167], v212, s[8:11], s66 offen sc1
  buffer_load_dwordx4 v[168:171], v213, s[8:11], s66 offen sc1
  buffer_load_dwordx4 v[172:175], v214, s[8:11], s66 offen sc1
  s_waitcnt vmcnt(0)
  s_branch VC144
VR148:
  s_cmp_eq_u32 s82, 0
  s_cbranch_scc1 VK149
  s_sub_u32 s82, s82, 1
  s_nop 7
  s_add_u32 s66, s73, 0
  buffer_load_dwordx4 a[0:3], v13, s[8:11], s66 offen offset:0 sc1
  s_add_u32 s66, s73, 0
  buffer_load_dwordx4 a[4:7], v13, s[8:11], s66 offen offset:1024 sc1
  s_waitcnt vmcnt(0)
  s_branch VC147
VR151:
  s_cmp_eq_u32 s82, 0
  s_cbranch_scc1 VK152
  s_sub_u32 s82, s82, 1
  s_nop 7
  s_add_u32 s66, s73, 0
  buffer_load_dwordx4 a[8:11], v13, s[8:11], s66 offen offset:2048 sc1
  s_add_u32 s66, s73, 0
  buffer_load_dwordx4 a[12:15], v13, s[8:11], s66 offen offset:3072 sc1
  s_waitcnt vmcnt(0)
  s_branch VC150
VR154:
  s_cmp_eq_u32 s82, 0
  s_cbranch_scc1 VK155
  s_sub_u32 s82, s82, 1
  s_nop 7
  s_add_u32 s66, s73, 4096
  buffer_load_dwordx4 a[16:19], v13, s[8:11], s66 offen offset:0 sc1
  s_add_u32 s66, s73, 4096
  buffer_load_dwordx4 a[20:23], v13, s[8:11], s66 offen offset:1024 sc1
  s_waitcnt vmcnt(0)
  s_branch VC153
VR157:
  s_cmp_eq_u32 s82, 0
  s_cbranch_scc1 VK158
  s_sub_u32 s82, s82, 1
  s_nop 7
  s_add_u32 s66, s73, 4096
  buffer_load_dwordx4 a[24:27], v13, s[8:11], s66 offen offset:2048 sc1
  s_add_u32 s66, s73, 4096
  buffer_load_dwordx4 a[28:31], v13, s[8:11], s66 offen offset:3072 sc1
  s_waitcnt vmcnt(0)
  s_branch VC156
VR160:
  s_cmp_eq_u32 s82, 0
  s_cbranch_scc1 VK161
  s_sub_u32 s82, s82, 1
  s_nop 7
  s_add_u32 s66, s73, 8192
  buffer_load_dwordx4 a[32:35], v13, s[8:11], s66 offen offset:0 sc1
  s_add_u32 s66, s73, 8192
  buffer_load_dwordx4 a[36:39], v13, s[8:11], s66 offen offset:1024 sc1
  s_waitcnt vmcnt(0)
  s_branch VC159
VR163:
  s_cmp_eq_u32 s82, 0
  s_cbranch_scc1 VK164
  s_sub_u32 s82, s82, 1
  s_nop 7
  s_add_u32 s66, s73, 8192
  buffer_load_dwordx4 a[40:43], v13, s[8:11], s66 offen offset:2048 sc1
  s_add_u32 s66, s73, 8192
  buffer_load_dwordx4 a[44:47], v13, s[8:11], s66 offen offset:3072 sc1
  s_waitcnt vmcnt(0)
  s_branch VC162
VR166:
  s_cmp_eq_u32 s82, 0
  s_cbranch_scc1 VK167
  s_sub_u32 s82, s82, 1
  s_nop 7
  s_add_u32 s66, s73, 12288
  buffer_load_dwordx4 a[48:51], v13, s[8:11], s66 offen offset:0 sc1
  s_add_u32 s66, s73, 12288
  buffer_load_dwordx4 a[52:55], v13, s[8:11], s66 offen offset:1024 sc1
  s_waitcnt vmcnt(0)
  s_branch VC165
VR169:
  s_cmp_eq_u32 s82, 0
  s_cbranch_scc1 VK170
  s_sub_u32 s82, s82, 1
  s_nop 7
  s_add_u32 s66, s73, 12288
  buffer_load_dwordx4 a[56:59], v13, s[8:11], s66 offen offset:2048 sc1
  s_add_u32 s66, s73, 12288
  buffer_load_dwordx4 a[60:63], v13, s[8:11], s66 offen offset:3072 sc1
  s_waitcnt vmcnt(0)
  s_branch VC168
VR172:
  s_cmp_eq_u32 s82, 0
  s_cbranch_scc1 VK173
  s_sub_u32 s82, s82, 1
  s_nop 7
  s_add_u32 s66, s73, 16384
  buffer_load_dwordx4 a[64:67], v13, s[8:11], s66 offen offset:0 sc1
  s_add_u32 s66, s73, 16384
  buffer_load_dwordx4 a[68:71], v13, s[8:11], s66 offen offset:1024 sc1
  s_waitcnt vmcnt(0)
  s_branch VC171
VR175:
  s_cmp_eq_u32 s82, 0
  s_cbranch_scc1 VK176
  s_sub_u32 s82, s82, 1
  s_nop 7
  s_add_u32 s66, s73, 16384
  buffer_load_dwordx4 a[72:75], v13, s[8:11], s66 offen offset:2048 sc1
  s_add_u32 s66, s73, 16384
  buffer_load_dwordx4 a[76:79], v13, s[8:11], s66 offen offset:3072 sc1
  s_waitcnt vmcnt(0)
  s_branch VC174
VR178:
  s_cmp_eq_u32 s82, 0
  s_cbranch_scc1 VK179
  s_sub_u32 s82, s82, 1
  s_nop 7
  s_add_u32 s66, s73, 20480
  buffer_load_dwordx4 a[80:83], v13, s[8:11], s66 offen offset:0 sc1
  s_add_u32 s66, s73, 20480
  buffer_load_dwordx4 a[84:87], v13, s[8:11], s66 offen offset:1024 sc1
  s_waitcnt vmcnt(0)
  s_branch VC177
VR181:
  s_cmp_eq_u32 s82, 0
  s_cbranch_scc1 VK182
  s_sub_u32 s82, s82, 1
  s_nop 7
  s_add_u32 s66, s73, 20480
  buffer_load_dwordx4 a[88:91], v13, s[8:11], s66 offen offset:2048 sc1
  s_add_u32 s66, s73, 20480
  buffer_load_dwordx4 a[92:95], v13, s[8:11], s66 offen offset:3072 sc1
  s_waitcnt vmcnt(0)
  s_branch VC180
VR184:
  s_cmp_eq_u32 s82, 0
  s_cbranch_scc1 VK185
  s_sub_u32 s82, s82, 1
  s_nop 7
  s_add_u32 s66, s73, 24576
  buffer_load_dwordx4 a[96:99], v13, s[8:11], s66 offen offset:0 sc1
  s_add_u32 s66, s73, 24576
  buffer_load_dwordx4 a[100:103], v13, s[8:11], s66 offen offset:1024 sc1
  s_waitcnt vmcnt(0)
  s_branch VC183
VR187:
  s_cmp_eq_u32 s82, 0
  s_cbranch_scc1 VK188
  s_sub_u32 s82, s82, 1
  s_nop 7
  s_add_u32 s66, s73, 24576
  buffer_load_dwordx4 a[104:107], v13, s[8:11], s66 offen offset:2048 sc1
  s_add_u32 s66, s73, 24576
  buffer_load_dwordx4 a[108:111], v13, s[8:11], s66 offen offset:3072 sc1
  s_waitcnt vmcnt(0)
  s_branch VC186
VR190:
  s_cmp_eq_u32 s82, 0
  s_cbranch_scc1 VK191
  s_sub_u32 s82, s82, 1
  s_nop 7
  s_add_u32 s66, s73, 28672
  buffer_load_dwordx4 a[112:115], v13, s[8:11], s66 offen offset:0 sc1
  s_add_u32 s66, s73, 28672
  buffer_load_dwordx4 a[116:119], v13, s[8:11], s66 offen offset:1024 sc1
  s_waitcnt vmcnt(0)
  s_branch VC189
VR193:
  s_cmp_eq_u32 s82, 0
  s_cbranch_scc1 VK194
  s_sub_u32 s82, s82, 1
  s_nop 7
  s_add_u32 s66, s73, 28672
  buffer_load_dwordx4 a[120:123], v13, s[8:11], s66 offen offset:2048 sc1
  s_add_u32 s66, s73, 28672
  buffer_load_dwordx4 a[124:127], v13, s[8:11], s66 offen offset:3072 sc1
  s_waitcnt vmcnt(0)
  s_branch VC192
VR196:
  s_cmp_eq_u32 s82, 0
  s_cbranch_scc1 VK197
  s_sub_u32 s82, s82, 1
  s_nop 7
  s_add_u32 s66, s73, 32768
  buffer_load_dwordx4 a[128:131], v13, s[8:11], s66 offen offset:0 sc1
  s_add_u32 s66, s73, 32768
  buffer_load_dwordx4 a[132:135], v13, s[8:11], s66 offen offset:1024 sc1
  s_waitcnt vmcnt(0)
  s_branch VC195
VR199:
  s_cmp_eq_u32 s82, 0
  s_cbranch_scc1 VK200
  s_sub_u32 s82, s82, 1
  s_nop 7
  s_add_u32 s66, s73, 32768
  buffer_load_dwordx4 a[136:139], v13, s[8:11], s66 offen offset:2048 sc1
  s_add_u32 s66, s73, 32768
  buffer_load_dwordx4 a[140:143], v13, s[8:11], s66 offen offset:3072 sc1
  s_waitcnt vmcnt(0)
  s_branch VC198
VR202:
  s_cmp_eq_u32 s82, 0
  s_cbranch_scc1 VK203
  s_sub_u32 s82, s82, 1
  s_nop 7
  s_add_u32 s66, s73, 36864
  buffer_load_dwordx4 a[144:147], v13, s[8:11], s66 offen offset:0 sc1
  s_add_u32 s66, s73, 36864
  buffer_load_dwordx4 a[148:151], v13, s[8:11], s66 offen offset:1024 sc1
  s_waitcnt vmcnt(0)
  s_branch VC201
VR205:
  s_cmp_eq_u32 s82, 0
  s_cbranch_scc1 VK206
  s_sub_u32 s82, s82, 1
  s_nop 7
  s_add_u32 s66, s73, 36864
  buffer_load_dwordx4 a[152:155], v13, s[8:11], s66 offen offset:2048 sc1
  s_add_u32 s66, s73, 36864
  buffer_load_dwordx4 a[156:159], v13, s[8:11], s66 offen offset:3072 sc1
  s_waitcnt vmcnt(0)
  s_branch VC204
VR208:
  s_cmp_eq_u32 s82, 0
  s_cbranch_scc1 VK209
  s_sub_u32 s82, s82, 1
  s_nop 7
  buffer_load_dwordx2 v[188:189], v14, s[8:11], s72 offen offset:0 sc1
  buffer_load_dwordx2 v[190:191], v14, s[8:11], s72 offen offset:128 sc1
  buffer_load_dwordx2 v[192:193], v14, s[8:11], s72 offen offset:256 sc1
  buffer_load_dwordx2 v[194:195], v14, s[8:11], s72 offen offset:384 sc1
  s_waitcnt vmcnt(0)
  s_branch VC207
VR211:
  s_cmp_eq_u32 s82, 0
  s_cbranch_scc1 VK212
  s_sub_u32 s82, s82, 1
  s_nop 7
  s_add_u32 s66, s72, 0
  buffer_load_dwordx4 v[80:83], v5, s[8:11], s66 offen sc1
  s_add_u32 s66, s72, 4096
  buffer_load_dwordx4 v[84:87], v5, s[8:11], s66 offen sc1
  s_add_u32 s66, s72, 8192
  buffer_load_dwordx4 v[88:91], v5, s[8:11], s66 offen sc1
  s_add_u32 s66, s72, 12288
  buffer_load_dwordx4 v[92:95], v5, s[8:11], s66 offen sc1
  s_waitcnt vmcnt(0)
  s_branch VC210
VR214:
  s_cmp_eq_u32 s82, 0
  s_cbranch_scc1 VK215
  s_sub_u32 s82, s82, 1
  s_nop 7
  s_add_u32 s66, s72, 16384
  buffer_load_dwordx4 v[96:99], v5, s[8:11], s66 offen sc1
  s_add_u32 s66, s72, 20480
  buffer_load_dwordx4 v[100:103], v5, s[8:11], s66 offen sc1
  s_add_u32 s66, s72, 24576
  buffer_load_dwordx4 v[104:107], v5, s[8:11], s66 offen sc1
  s_add_u32 s66, s72, 28672
  buffer_load_dwordx4 v[108:111], v5, s[8:11], s66 offen sc1
  s_waitcnt vmcnt(0)
  s_branch VC213
VR217:
  s_cmp_eq_u32 s82, 0
  s_cbranch_scc1 VK218
  s_sub_u32 s82, s82, 1
  s_nop 7
  s_add_u32 s66, s72, 32768
  buffer_load_dwordx4 v[112:115], v5, s[8:11], s66 offen sc1
  s_add_u32 s66, s72, 36864
  buffer_load_dwordx4 v[116:119], v5, s[8:11], s66 offen sc1
  s_add_u32 s66, s72, 40960
  buffer_load_dwordx4 v[120:123], v5, s[8:11], s66 offen sc1
  s_add_u32 s66, s72, 45056
  buffer_load_dwordx4 v[124:127], v5, s[8:11], s66 offen sc1
  s_waitcnt vmcnt(0)
  s_branch VC216
VR220:
  s_cmp_eq_u32 s82, 0
  s_cbranch_scc1 VK221
  s_sub_u32 s82, s82, 1
  s_nop 7
  s_add_u32 s66, s72, 49152
  buffer_load_dwordx4 v[128:131], v5, s[8:11], s66 offen sc1
  s_add_u32 s66, s72, 53248
  buffer_load_dwordx4 v[132:135], v5, s[8:11], s66 offen sc1
  s_add_u32 s66, s72, 57344
  buffer_load_dwordx4 v[136:139], v5, s[8:11], s66 offen sc1
  s_add_u32 s66, s72, 61440
  buffer_load_dwordx4 v[140:143], v5, s[8:11], s66 offen sc1
  s_waitcnt vmcnt(0)
  s_branch VC219
FC222:
  s_mov_b32 s67, 262144
P224:
  buffer_load_dword v15, v4, s[8:11], 0 offen sc1
  s_waitcnt vmcnt(0)
  v_subrev_u32 v15, s83, v15
  v_cmp_gt_u32 vcc, 128, v15
  s_cmp_eq_u64 vcc, -1
  s_cbranch_scc1 PD225
  s_sub_u32 s67, s67, 1
  s_cmp_lg_u32 s67, 0
  s_cbranch_scc1 P224
PD225:
  s_waitcnt vmcnt(0)
  s_branch FK223
VR227:
  s_cmp_eq_u32 s82, 0
  s_cbranch_scc1 VK228
  s_sub_u32 s82, s82, 1
  s_nop 7
  s_add_u32 s66, s75, 0
  buffer_load_dwordx4 v[48:51], v13, s[8:11], s66 offen offset:0 sc1
  s_add_u32 s66, s75, 0
  buffer_load_dwordx4 v[52:55], v13, s[8:11], s66 offen offset:1024 sc1
  s_waitcnt vmcnt(0)
  s_branch VC226
VR230:
  s_cmp_eq_u32 s82, 0
  s_cbranch_scc1 VK231
  s_sub_u32 s82, s82, 1
  s_nop 7
  s_add_u32 s66, s75, 0
  buffer_load_dwordx4 v[56:59], v13, s[8:11], s66 offen offset:2048 sc1
  s_add_u32 s66, s75, 0
  buffer_load_dwordx4 v[60:63], v13, s[8:11], s66 offen offset:3072 sc1
  s_waitcnt vmcnt(0)
  s_branch VC229
VR233:
  s_cmp_eq_u32 s82, 0
  s_cbranch_scc1 VK234
  s_sub_u32 s82, s82, 1
  s_nop 7
  s_add_u32 s66, s75, 4096
  buffer_load_dwordx4 v[64:67], v13, s[8:11], s66 offen offset:0 sc1
  s_add_u32 s66, s75, 4096
  buffer_load_dwordx4 v[68:71], v13, s[8:11], s66 offen offset:1024 sc1
  s_waitcnt vmcnt(0)
  s_branch VC232
VR236:
  s_cmp_eq_u32 s82, 0
  s_cbranch_scc1 VK237
  s_sub_u32 s82, s82, 1
  s_nop 7
  s_add_u32 s66, s75, 4096
  buffer_load_dwordx4 v[72:75], v13, s[8:11], s66 offen offset:2048 sc1
  s_add_u32 s66, s75, 4096
  buffer_load_dwordx4 v[76:79], v13, s[8:11], s66 offen offset:3072 sc1
  s_waitcnt vmcnt(0)
  s_branch VC235
VR239:
  s_cmp_eq_u32 s82, 0
  s_cbranch_scc1 VK240
  s_sub_u32 s82, s82, 1
  s_nop 7
  s_add_u32 s66, s75, 8192
  buffer_load_dwordx4 v[80:83], v13, s[8:11], s66 offen offset:0 sc1
  s_add_u32 s66, s75, 8192
  buffer_load_dwordx4 v[84:87], v13, s[8:11], s66 offen offset:1024 sc1
  s_waitcnt vmcnt(0)
  s_branch VC238
VR242:
  s_cmp_eq_u32 s82, 0
  s_cbranch_scc1 VK243
  s_sub_u32 s82, s82, 1
  s_nop 7
  s_add_u32 s66, s75, 8192
  buffer_load_dwordx4 v[88:91], v13, s[8:11], s66 offen offset:2048 sc1
  s_add_u32 s66, s75, 8192
  buffer_load_dwordx4 v[92:95], v13, s[8:11], s66 offen offset:3072 sc1
  s_waitcnt vmcnt(0)
  s_branch VC241
VR245:
  s_cmp_eq_u32 s82, 0
  s_cbranch_scc1 VK246
  s_sub_u32 s82, s82, 1
  s_nop 7
  s_add_u32 s66, s75, 12288
  buffer_load_dwordx4 v[96:99], v13, s[8:11], s66 offen offset:0 sc1
  s_add_u32 s66, s75, 12288
  buffer_load_dwordx4 v[100:103], v13, s[8:11], s66 offen offset:1024 sc1
  s_waitcnt vmcnt(0)
  s_branch VC244
VR248:
  s_cmp_eq_u32 s82, 0
  s_cbranch_scc1 VK249
  s_sub_u32 s82, s82, 1
  s_nop 7
  s_add_u32 s66, s75, 12288
  buffer_load_dwordx4 v[104:107], v13, s[8:11], s66 offen offset:2048 sc1
  s_add_u32 s66, s75, 12288
  buffer_load_dwordx4 v[108:111], v13, s[8:11], s66 offen offset:3072 sc1
  s_waitcnt vmcnt(0)
  s_branch VC247
VR251:
  s_cmp_eq_u32 s82, 0
  s_cbranch_scc1 VK252
  s_sub_u32 s82, s82, 1
  s_nop 7
  s_add_u32 s66, s75, 16384
  buffer_load_dwordx4 v[112:115], v13, s[8:11], s66 offen offset:0 sc1
  s_add_u32 s66, s75, 16384
  buffer_load_dwordx4 v[116:119], v13, s[8:11], s66 offen offset:1024 sc1
  s_waitcnt vmcnt(0)
  s_branch VC250
VR254:
  s_cmp_eq_u32 s82, 0
  s_cbranch_scc1 VK255
  s_sub_u32 s82, s82, 1
  s_nop 7
  s_add_u32 s66, s75, 16384
  buffer_load_dwordx4 v[120:123], v13, s[8:11], s66 offen offset:2048 sc1
  s_add_u32 s66, s75, 16384
  buffer_load_dwordx4 v[124:127], v13, s[8:11], s66 offen offset:3072 sc1
  s_waitcnt vmcnt(0)
  s_branch VC253
P256:
  s_sub_u32 s67, s67, 1
  buffer_load_dwordx2 v[48:49], v12, s[8:11], s76 offen sc1
  buffer_load_dwordx2 v[50:51], v12, s[8:11], s76 offen offset:128 sc1
  s_waitcnt vmcnt(0)
  v_cmp_eq_u32 vcc, -1, v48
  v_cmp_eq_u32 s[68:69], -1, v50
  s_or_b64 vcc, vcc, s[68:69]
  s_cmp_eq_u64 vcc, 0
  s_cbranch_scc1 PD257
  s_cmp_lg_u32 s67, 0
  s_cbranch_scc1 P256
  s_branch PD257
ID258:
  s_waitcnt vmcnt(0) lgkmcnt(0)
  s_barrier
  s_lshr_b32 s66, s2, 3
  s_and_b32 s66, s66, 1
  s_lshl_b32 s66, s66, 2
  s_add_u32 s66, s66, s52
  s_mul_i32 s66, s66, 786432
  s_and_b32 s67, s56, 24
  s_lshl_b32 s67, s67, 7
  s_add_u32 s66, s66, s67
  v_lshlrev_b32 v16, 12, v1
  s_add_u32 s67, s66, 0
  buffer_load_dword v17, v16, s[32:35], s67 offen offset:384
  s_add_u32 s67, s66, 262144
  buffer_load_dword v18, v16, s[32:35], s67 offen offset:384
  s_add_u32 s67, s66, 524288
  buffer_load_dword v19, v16, s[32:35], s67 offen offset:384
  s_mov_b32 s78, s61
  s_mul_i32 s78, s78, 128
  s_add_u32 m0, s86, 12672
  s_nop 0
  buffer_load_dwordx4 v198, s[32:35], s78 offen offset:0 lds
  buffer_load_dwordx4 v199, s[32:35], s78 offen offset:1056 lds
  buffer_load_dwordx4 v200, s[32:35], s78 offen offset:2112 lds
  buffer_load_dwordx4 v201, s[32:35], s78 offen offset:3168 lds
  s_add_u32 s78, s61, 1024
  s_sub_u32 s68, s78, 12288
  s_cselect_b32 s78, s78, s68
  s_mul_i32 s78, s78, 128
  s_add_u32 m0, s86, 16896
  s_nop 0
  buffer_load_dwordx4 v198, s[32:35], s78 offen offset:0 lds
  buffer_load_dwordx4 v199, s[32:35], s78 offen offset:1056 lds
  buffer_load_dwordx4 v200, s[32:35], s78 offen offset:2112 lds
  buffer_load_dwordx4 v201, s[32:35], s78 offen offset:3168 lds
  s_add_u32 s78, s61, 2048
  s_sub_u32 s68, s78, 12288
  s_cselect_b32 s78, s78, s68
  s_mul_i32 s78, s78, 128
  s_add_u32 m0, s86, 21120
  s_nop 0
  buffer_load_dwordx4 v198, s[32:35], s78 offen offset:0 lds
  buffer_load_dwordx4 v199, s[32:35], s78 offen offset:1056 lds
  buffer_load_dwordx4 v200, s[32:35], s78 offen offset:2112 lds
  buffer_load_dwordx4 v201, s[32:35], s78 offen offset:3168 lds
  s_add_u32 s78, s61, 3072
  s_sub_u32 s68, s78, 12288
  s_cselect_b32 s78, s78, s68
  s_mul_i32 s78, s78, 128
  s_add_u32 m0, s86, 25344
  s_nop 0
  buffer_load_dwordx4 v198, s[32:35], s78 offen offset:0 lds
  buffer_load_dwordx4 v199, s[32:35], s78 offen offset:1056 lds
  buffer_load_dwordx4 v200, s[32:35], s78 offen offset:2112 lds
  buffer_load_dwordx4 v201, s[32:35], s78 offen offset:3168 lds
  s_add_u32 s78, s61, 4096
  s_sub_u32 s68, s78, 12288
  s_cselect_b32 s78, s78, s68
  s_mul_i32 s78, s78, 128
  s_add_u32 m0, s86, 29568
  s_nop 0
  buffer_load_dwordx4 v198, s[32:35], s78 offen offset:0 lds
  buffer_load_dwordx4 v199, s[32:35], s78 offen offset:1056 lds
  buffer_load_dwordx4 v200, s[32:35], s78 offen offset:2112 lds
  buffer_load_dwordx4 v201, s[32:35], s78 offen offset:3168 lds
  s_add_u32 s78, s61, 5120
  s_sub_u32 s68, s78, 12288
  s_cselect_b32 s78, s78, s68
  s_mul_i32 s78, s78, 128
  s_add_u32 m0, s86, 33792
  s_nop 0
  buffer_load_dwordx4 v198, s[32:35], s78 offen offset:0 lds
  buffer_load_dwordx4 v199, s[32:35], s78 offen offset:1056 lds
  buffer_load_dwordx4 v200, s[32:35], s78 offen offset:2112 lds
  buffer_load_dwordx4 v201, s[32:35], s78 offen offset:3168 lds
  s_waitcnt vmcnt(0)
  s_branch JN259
VR261:
  s_cmp_eq_u32 s82, 0
  s_cbranch_scc1 VK262
  s_sub_u32 s82, s82, 1
  s_nop 7
  s_mov_b32 s66, s60
  buffer_load_dwordx4 v[80:83], v206, s[8:11], s66 offen sc1
  buffer_load_dwordx4 v[84:87], v207, s[8:11], s66 offen sc1
  buffer_load_dwordx4 v[88:91], v208, s[8:11], s66 offen sc1
  buffer_load_dwordx4 v[92:95], v209, s[8:11], s66 offen sc1
  s_waitcnt vmcnt(0)
  v_max3_u32 v12, v80, v84, v88
  v_max_u32 v12, v12, v92
  v_cmp_eq_u32 vcc, -1, v12
  s_cbranch_vccnz VR261
  v_max3_u32 v12, v96, v100, v104
  v_max3_u32 v12, v12, v108, v112
  v_max3_u32 v12, v12, v116, v120
  v_max3_u32 v12, v12, v124, v128
  v_max3_u32 v12, v12, v132, v136
  v_max_u32 v12, v12, v140
  v_cmp_eq_u32 vcc, -1, v12
  s_cbranch_vccz VK262
  s_add_u32 s66, s60, 1024
  s_and_b32 s66, s66, 0x3fff
  buffer_load_dwordx4 v[96:99], v206, s[8:11], s66 offen sc1
  buffer_load_dwordx4 v[100:103], v207, s[8:11], s66 offen sc1
  buffer_load_dwordx4 v[104:107], v208, s[8:11], s66 offen sc1
  buffer_load_dwordx4 v[108:111], v209, s[8:11], s66 offen sc1
  s_add_u32 s66, s60, 2048
  s_and_b32 s66, s66, 0x3fff
  buffer_load_dwordx4 v[112:115], v206, s[8:11], s66 offen sc1
  buffer_load_dwordx4 v[116:119], v207, s[8:11], s66 offen sc1
  buffer_load_dwordx4 v[120:123], v208, s[8:11], s66 offen sc1
  buffer_load_dwordx4 v[124:127], v209, s[8:11], s66 offen sc1
  s_add_u32 s66, s60, 3072
  s_and_b32 s66, s66, 0x3fff
  buffer_load_dwordx4 v[128:131], v206, s[8:11], s66 offen sc1
  buffer_load_dwordx4 v[132:135], v207, s[8:11], s66 offen sc1
  buffer_load_dwordx4 v[136:139], v208, s[8:11], s66 offen sc1
  buffer_load_dwordx4 v[140:143], v209, s[8:11], s66 offen sc1
  s_waitcnt vmcnt(0)
  s_nop 1
  s_branch VK262
VR264:
  s_cmp_eq_u32 s82, 0
  s_cbranch_scc1 VK265
  s_sub_u32 s82, s82, 1
  s_nop 7
  s_add_u32 s66, s60, 1024
  s_and_b32 s66, s66, 0x3fff
  buffer_load_dwordx4 v[96:99], v206, s[8:11], s66 offen sc1
  buffer_load_dwordx4 v[100:103], v207, s[8:11], s66 offen sc1
  buffer_load_dwordx4 v[104:107], v208, s[8:11], s66 offen sc1
  buffer_load_dwordx4 v[108:111], v209, s[8:11], s66 offen sc1
  s_waitcnt vmcnt(0)
  v_max3_u32 v12, v96, v100, v104
  v_max_u32 v12, v12, v108
  v_cmp_eq_u32 vcc, -1, v12
  s_cbranch_vccnz VR264
  v_max3_u32 v12, v112, v116, v120
  v_max3_u32 v12, v12, v124, v128
  v_max3_u32 v12, v12, v132, v136
  v_max3_u32 v12, v12, v140, v144
  v_max3_u32 v12, v12, v148, v152
  v_max_u32 v12, v12, v156
  v_cmp_eq_u32 vcc, -1, v12
  s_cbranch_vccz VK265
  s_add_u32 s66, s60, 2048
  s_and_b32 s66, s66, 0x3fff
  buffer_load_dwordx4 v[112:115], v206, s[8:11], s66 offen sc1
  buffer_load_dwordx4 v[116:119], v207, s[8:11], s66 offen sc1
  buffer_load_dwordx4 v[120:123], v208, s[8:11], s66 offen sc1
  buffer_load_dwordx4 v[124:127], v209, s[8:11], s66 offen sc1
  s_add_u32 s66, s60, 3072
  s_and_b32 s66, s66, 0x3fff
  buffer_load_dwordx4 v[128:131], v206, s[8:11], s66 offen sc1
  buffer_load_dwordx4 v[132:135], v207, s[8:11], s66 offen sc1
  buffer_load_dwordx4 v[136:139], v208, s[8:11], s66 offen sc1
  buffer_load_dwordx4 v[140:143], v209, s[8:11], s66 offen sc1
  s_add_u32 s66, s60, 4096
  s_and_b32 s66, s66, 0x3fff
  buffer_load_dwordx4 v[144:147], v206, s[8:11], s66 offen sc1
  buffer_load_dwordx4 v[148:151], v207, s[8:11], s66 offen sc1
  buffer_load_dwordx4 v[152:155], v208, s[8:11], s66 offen sc1
  buffer_load_dwordx4 v[156:159], v209, s[8:11], s66 offen sc1
  s_waitcnt vmcnt(0)
  s_nop 1
  s_branch VK265
VR267:
  s_cmp_eq_u32 s82, 0
  s_cbranch_scc1 VK268
  s_sub_u32 s82, s82, 1
  s_nop 7
  s_add_u32 s66, s60, 2048
  s_and_b32 s66, s66, 0x3fff
  buffer_load_dwordx4 v[112:115], v206, s[8:11], s66 offen sc1
  buffer_load_dwordx4 v[116:119], v207, s[8:11], s66 offen sc1
  buffer_load_dwordx4 v[120:123], v208, s[8:11], s66 offen sc1
  buffer_load_dwordx4 v[124:127], v209, s[8:11], s66 offen sc1
  s_waitcnt vmcnt(0)
  v_max3_u32 v12, v112, v116, v120
  v_max_u32 v12, v12, v124
  v_cmp_eq_u32 vcc, -1, v12
  s_cbranch_vccnz VR267
  v_max3_u32 v12, v128, v132, v136
  v_max3_u32 v12, v12, v140, v144
  v_max3_u32 v12, v12, v148, v152
  v_max3_u32 v12, v12, v156, v80
  v_max3_u32 v12, v12, v84, v88
  v_max_u32 v12, v12, v92
  v_cmp_eq_u32 vcc, -1, v12
  s_cbranch_vccz VK268
  s_add_u32 s66, s60, 3072
  s_and_b32 s66, s66, 0x3fff
  buffer_load_dwordx4 v[128:131], v206, s[8:11], s66 offen sc1
  buffer_load_dwordx4 v[132:135], v207, s[8:11], s66 offen sc1
  buffer_load_dwordx4 v[136:139], v208, s[8:11], s66 offen sc1
  buffer_load_dwordx4 v[140:143], v209, s[8:11], s66 offen sc1
  s_add_u32 s66, s60, 4096
  s_and_b32 s66, s66, 0x3fff
  buffer_load_dwordx4 v[144:147], v206, s[8:11], s66 offen sc1
  buffer_load_dwordx4 v[148:151], v207, s[8:11], s66 offen sc1
  buffer_load_dwordx4 v[152:155], v208, s[8:11], s66 offen sc1
  buffer_load_dwordx4 v[156:159], v209, s[8:11], s66 offen sc1
  s_add_u32 s66, s60, 5120
  s_and_b32 s66, s66, 0x3fff
  buffer_load_dwordx4 v[80:83], v206, s[8:11], s66 offen sc1
  buffer_load_dwordx4 v[84:87], v207, s[8:11], s66 offen sc1
  buffer_load_dwordx4 v[88:91], v208, s[8:11], s66 offen sc1
  buffer_load_dwordx4 v[92:95], v209, s[8:11], s66 offen sc1
  s_waitcnt vmcnt(0)
  s_nop 1
  s_branch VK268
VR270:
  s_cmp_eq_u32 s82, 0
  s_cbranch_scc1 VK271
  s_sub_u32 s82, s82, 1
  s_nop 7
  s_add_u32 s66, s60, 3072
  s_and_b32 s66, s66, 0x3fff
  buffer_load_dwordx4 v[128:131], v206, s[8:11], s66 offen sc1
  buffer_load_dwordx4 v[132:135], v207, s[8:11], s66 offen sc1
  buffer_load_dwordx4 v[136:139], v208, s[8:11], s66 offen sc1
  buffer_load_dwordx4 v[140:143], v209, s[8:11], s66 offen sc1
  s_waitcnt vmcnt(0)
  v_max3_u32 v12, v128, v132, v136
  v_max_u32 v12, v12, v140
  v_cmp_eq_u32 vcc, -1, v12
  s_cbranch_vccnz VR270
  v_max3_u32 v12, v144, v148, v152
  v_max3_u32 v12, v12, v156, v80
  v_max3_u32 v12, v12, v84, v88
  v_max3_u32 v12, v12, v92, v96
  v_max3_u32 v12, v12, v100, v104
  v_max_u32 v12, v12, v108
  v_cmp_eq_u32 vcc, -1, v12
  s_cbranch_vccz VK271
  s_add_u32 s66, s60, 4096
  s_and_b32 s66, s66, 0x3fff
  buffer_load_dwordx4 v[144:147], v206, s[8:11], s66 offen sc1
  buffer_load_dwordx4 v[148:151], v207, s[8:11], s66 offen sc1
  buffer_load_dwordx4 v[152:155], v208, s[8:11], s66 offen sc1
  buffer_load_dwordx4 v[156:159], v209, s[8:11], s66 offen sc1
  s_add_u32 s66, s60, 5120
  s_and_b32 s66, s66, 0x3fff
  buffer_load_dwordx4 v[80:83], v206, s[8:11], s66 offen sc1
  buffer_load_dwordx4 v[84:87], v207, s[8:11], s66 offen sc1
  buffer_load_dwordx4 v[88:91], v208, s[8:11], s66 offen sc1
  buffer_load_dwordx4 v[92:95], v209, s[8:11], s66 offen sc1
  s_add_u32 s66, s60, 6144
  s_and_b32 s66, s66, 0x3fff
  buffer_load_dwordx4 v[96:99], v206, s[8:11], s66 offen sc1
  buffer_load_dwordx4 v[100:103], v207, s[8:11], s66 offen sc1
  buffer_load_dwordx4 v[104:107], v208, s[8:11], s66 offen sc1
  buffer_load_dwordx4 v[108:111], v209, s[8:11], s66 offen sc1
  s_waitcnt vmcnt(0)
  s_nop 1
  s_branch VK271
VR273:
  s_cmp_eq_u32 s82, 0
  s_cbranch_scc1 VK274
  s_sub_u32 s82, s82, 1
  s_nop 7
  s_add_u32 s66, s60, 4096
  s_and_b32 s66, s66, 0x3fff
  buffer_load_dwordx4 v[144:147], v206, s[8:11], s66 offen sc1
  buffer_load_dwordx4 v[148:151], v207, s[8:11], s66 offen sc1
  buffer_load_dwordx4 v[152:155], v208, s[8:11], s66 offen sc1
  buffer_load_dwordx4 v[156:159], v209, s[8:11], s66 offen sc1
  s_waitcnt vmcnt(0)
  v_max3_u32 v12, v144, v148, v152
  v_max_u32 v12, v12, v156
  v_cmp_eq_u32 vcc, -1, v12
  s_cbranch_vccnz VR273
  v_max3_u32 v12, v80, v84, v88
  v_max3_u32 v12, v12, v92, v96
  v_max3_u32 v12, v12, v100, v104
  v_max3_u32 v12, v12, v108, v112
  v_max3_u32 v12, v12, v116, v120
  v_max_u32 v12, v12, v124
  v_cmp_eq_u32 vcc, -1, v12
  s_cbranch_vccz VK274
  s_add_u32 s66, s60, 5120
  s_and_b32 s66, s66, 0x3fff
  buffer_load_dwordx4 v[80:83], v206, s[8:11], s66 offen sc1
  buffer_load_dwordx4 v[84:87], v207, s[8:11], s66 offen sc1
  buffer_load_dwordx4 v[88:91], v208, s[8:11], s66 offen sc1
  buffer_load_dwordx4 v[92:95], v209, s[8:11], s66 offen sc1
  s_add_u32 s66, s60, 6144
  s_and_b32 s66, s66, 0x3fff
  buffer_load_dwordx4 v[96:99], v206, s[8:11], s66 offen sc1
  buffer_load_dwordx4 v[100:103], v207, s[8:11], s66 offen sc1
  buffer_load_dwordx4 v[104:107], v208, s[8:11], s66 offen sc1
  buffer_load_dwordx4 v[108:111], v209, s[8:11], s66 offen sc1
  s_add_u32 s66, s60, 7168
  s_and_b32 s66, s66, 0x3fff
  buffer_load_dwordx4 v[112:115], v206, s[8:11], s66 offen sc1
  buffer_load_dwordx4 v[116:119], v207, s[8:11], s66 offen sc1
  buffer_load_dwordx4 v[120:123], v208, s[8:11], s66 offen sc1
  buffer_load_dwordx4 v[124:127], v209, s[8:11], s66 offen sc1
  s_waitcnt vmcnt(0)
  s_nop 1
  s_branch VK274
VR276:
  s_cmp_eq_u32 s82, 0
  s_cbranch_scc1 VK277
  s_sub_u32 s82, s82, 1
  s_nop 7
  s_add_u32 s66, s60, 5120
  s_and_b32 s66, s66, 0x3fff
  buffer_load_dwordx4 v[80:83], v206, s[8:11], s66 offen sc1
  buffer_load_dwordx4 v[84:87], v207, s[8:11], s66 offen sc1
  buffer_load_dwordx4 v[88:91], v208, s[8:11], s66 offen sc1
  buffer_load_dwordx4 v[92:95], v209, s[8:11], s66 offen sc1
  s_waitcnt vmcnt(0)
  v_max3_u32 v12, v80, v84, v88
  v_max_u32 v12, v12, v92
  v_cmp_eq_u32 vcc, -1, v12
  s_cbranch_vccnz VR276
  v_max3_u32 v12, v96, v100, v104
  v_max3_u32 v12, v12, v108, v112
  v_max3_u32 v12, v12, v116, v120
  v_max3_u32 v12, v12, v124, v128
  v_max3_u32 v12, v12, v132, v136
  v_max_u32 v12, v12, v140
  v_cmp_eq_u32 vcc, -1, v12
  s_cbranch_vccz VK277
  s_add_u32 s66, s60, 6144
  s_and_b32 s66, s66, 0x3fff
  buffer_load_dwordx4 v[96:99], v206, s[8:11], s66 offen sc1
  buffer_load_dwordx4 v[100:103], v207, s[8:11], s66 offen sc1
  buffer_load_dwordx4 v[104:107], v208, s[8:11], s66 offen sc1
  buffer_load_dwordx4 v[108:111], v209, s[8:11], s66 offen sc1
  s_add_u32 s66, s60, 7168
  s_and_b32 s66, s66, 0x3fff
  buffer_load_dwordx4 v[112:115], v206, s[8:11], s66 offen sc1
  buffer_load_dwordx4 v[116:119], v207, s[8:11], s66 offen sc1
  buffer_load_dwordx4 v[120:123], v208, s[8:11], s66 offen sc1
  buffer_load_dwordx4 v[124:127], v209, s[8:11], s66 offen sc1
  s_add_u32 s66, s60, 8192
  s_and_b32 s66, s66, 0x3fff
  buffer_load_dwordx4 v[128:131], v206, s[8:11], s66 offen sc1
  buffer_load_dwordx4 v[132:135], v207, s[8:11], s66 offen sc1
  buffer_load_dwordx4 v[136:139], v208, s[8:11], s66 offen sc1
  buffer_load_dwordx4 v[140:143], v209, s[8:11], s66 offen sc1
  s_waitcnt vmcnt(0)
  s_nop 1
  s_branch VK277
VR279:
  s_cmp_eq_u32 s82, 0
  s_cbranch_scc1 VK280
  s_sub_u32 s82, s82, 1
  s_nop 7
  s_add_u32 s66, s60, 6144
  s_and_b32 s66, s66, 0x3fff
  buffer_load_dwordx4 v[96:99], v206, s[8:11], s66 offen sc1
  buffer_load_dwordx4 v[100:103], v207, s[8:11], s66 offen sc1
  buffer_load_dwordx4 v[104:107], v208, s[8:11], s66 offen sc1
  buffer_load_dwordx4 v[108:111], v209, s[8:11], s66 offen sc1
  s_waitcnt vmcnt(0)
  v_max3_u32 v12, v96, v100, v104
  v_max_u32 v12, v12, v108
  v_cmp_eq_u32 vcc, -1, v12
  s_cbranch_vccnz VR279
  v_max3_u32 v12, v112, v116, v120
  v_max3_u32 v12, v12, v124, v128
  v_max3_u32 v12, v12, v132, v136
  v_max3_u32 v12, v12, v140, v144
  v_max3_u32 v12, v12, v148, v152
  v_max_u32 v12, v12, v156
  v_cmp_eq_u32 vcc, -1, v12
  s_cbranch_vccz VK280
  s_add_u32 s66, s60, 7168
  s_and_b32 s66, s66, 0x3fff
  buffer_load_dwordx4 v[112:115], v206, s[8:11], s66 offen sc1
  buffer_load_dwordx4 v[116:119], v207, s[8:11], s66 offen sc1
  buffer_load_dwordx4 v[120:123], v208, s[8:11], s66 offen sc1
  buffer_load_dwordx4 v[124:127], v209, s[8:11], s66 offen sc1
  s_add_u32 s66, s60, 8192
  s_and_b32 s66, s66, 0x3fff
  buffer_load_dwordx4 v[128:131], v206, s[8:11], s66 offen sc1
  buffer_load_dwordx4 v[132:135], v207, s[8:11], s66 offen sc1
  buffer_load_dwordx4 v[136:139], v208, s[8:11], s66 offen sc1
  buffer_load_dwordx4 v[140:143], v209, s[8:11], s66 offen sc1
  s_add_u32 s66, s60, 9216
  s_and_b32 s66, s66, 0x3fff
  buffer_load_dwordx4 v[144:147], v206, s[8:11], s66 offen sc1
  buffer_load_dwordx4 v[148:151], v207, s[8:11], s66 offen sc1
  buffer_load_dwordx4 v[152:155], v208, s[8:11], s66 offen sc1
  buffer_load_dwordx4 v[156:159], v209, s[8:11], s66 offen sc1
  s_waitcnt vmcnt(0)
  s_nop 1
  s_branch VK280
VR282:
  s_cmp_eq_u32 s82, 0
  s_cbranch_scc1 VK283
  s_sub_u32 s82, s82, 1
  s_nop 7
  s_add_u32 s66, s60, 7168
  s_and_b32 s66, s66, 0x3fff
  buffer_load_dwordx4 v[112:115], v206, s[8:11], s66 offen sc1
  buffer_load_dwordx4 v[116:119], v207, s[8:11], s66 offen sc1
  buffer_load_dwordx4 v[120:123], v208, s[8:11], s66 offen sc1
  buffer_load_dwordx4 v[124:127], v209, s[8:11], s66 offen sc1
  s_waitcnt vmcnt(0)
  v_max3_u32 v12, v112, v116, v120
  v_max_u32 v12, v12, v124
  v_cmp_eq_u32 vcc, -1, v12
  s_cbranch_vccnz VR282
  v_max3_u32 v12, v128, v132, v136
  v_max3_u32 v12, v12, v140, v144
  v_max3_u32 v12, v12, v148, v152
  v_max3_u32 v12, v12, v156, v80
  v_max3_u32 v12, v12, v84, v88
  v_max_u32 v12, v12, v92
  v_cmp_eq_u32 vcc, -1, v12
  s_cbranch_vccz VK283
  s_add_u32 s66, s60, 8192
  s_and_b32 s66, s66, 0x3fff
  buffer_load_dwordx4 v[128:131], v206, s[8:11], s66 offen sc1
  buffer_load_dwordx4 v[132:135], v207, s[8:11], s66 offen sc1
  buffer_load_dwordx4 v[136:139], v208, s[8:11], s66 offen sc1
  buffer_load_dwordx4 v[140:143], v209, s[8:11], s66 offen sc1
  s_add_u32 s66, s60, 9216
  s_and_b32 s66, s66, 0x3fff
  buffer_load_dwordx4 v[144:147], v206, s[8:11], s66 offen sc1
  buffer_load_dwordx4 v[148:151], v207, s[8:11], s66 offen sc1
  buffer_load_dwordx4 v[152:155], v208, s[8:11], s66 offen sc1
  buffer_load_dwordx4 v[156:159], v209, s[8:11], s66 offen sc1
  s_add_u32 s66, s60, 10240
  s_and_b32 s66, s66, 0x3fff
  buffer_load_dwordx4 v[80:83], v206, s[8:11], s66 offen sc1
  buffer_load_dwordx4 v[84:87], v207, s[8:11], s66 offen sc1
  buffer_load_dwordx4 v[88:91], v208, s[8:11], s66 offen sc1
  buffer_load_dwordx4 v[92:95], v209, s[8:11], s66 offen sc1
  s_waitcnt vmcnt(0)
  s_nop 1
  s_branch VK283
VR285:
  s_cmp_eq_u32 s82, 0
  s_cbranch_scc1 VK286
  s_sub_u32 s82, s82, 1
  s_nop 7
  s_add_u32 s66, s60, 8192
  s_and_b32 s66, s66, 0x3fff
  buffer_load_dwordx4 v[128:131], v206, s[8:11], s66 offen sc1
  buffer_load_dwordx4 v[132:135], v207, s[8:11], s66 offen sc1
  buffer_load_dwordx4 v[136:139], v208, s[8:11], s66 offen sc1
  buffer_load_dwordx4 v[140:143], v209, s[8:11], s66 offen sc1
  s_waitcnt vmcnt(0)
  v_max3_u32 v12, v128, v132, v136
  v_max_u32 v12, v12, v140
  v_cmp_eq_u32 vcc, -1, v12
  s_cbranch_vccnz VR285
  v_max3_u32 v12, v144, v148, v152
  v_max3_u32 v12, v12, v156, v80
  v_max3_u32 v12, v12, v84, v88
  v_max3_u32 v12, v12, v92, v96
  v_max3_u32 v12, v12, v100, v104
  v_max_u32 v12, v12, v108
  v_cmp_eq_u32 vcc, -1, v12
  s_cbranch_vccz VK286
  s_add_u32 s66, s60, 9216
  s_and_b32 s66, s66, 0x3fff
  buffer_load_dwordx4 v[144:147], v206, s[8:11], s66 offen sc1
  buffer_load_dwordx4 v[148:151], v207, s[8:11], s66 offen sc1
  buffer_load_dwordx4 v[152:155], v208, s[8:11], s66 offen sc1
  buffer_load_dwordx4 v[156:159], v209, s[8:11], s66 offen sc1
  s_add_u32 s66, s60, 10240
  s_and_b32 s66, s66, 0x3fff
  buffer_load_dwordx4 v[80:83], v206, s[8:11], s66 offen sc1
  buffer_load_dwordx4 v[84:87], v207, s[8:11], s66 offen sc1
  buffer_load_dwordx4 v[88:91], v208, s[8:11], s66 offen sc1
  buffer_load_dwordx4 v[92:95], v209, s[8:11], s66 offen sc1
  s_add_u32 s66, s60, 11264
  s_and_b32 s66, s66, 0x3fff
  buffer_load_dwordx4 v[96:99], v206, s[8:11], s66 offen sc1
  buffer_load_dwordx4 v[100:103], v207, s[8:11], s66 offen sc1
  buffer_load_dwordx4 v[104:107], v208, s[8:11], s66 offen sc1
  buffer_load_dwordx4 v[108:111], v209, s[8:11], s66 offen sc1
  s_waitcnt vmcnt(0)
  s_nop 1
  s_branch VK286
VR288:
  s_cmp_eq_u32 s82, 0
  s_cbranch_scc1 VK289
  s_sub_u32 s82, s82, 1
  s_nop 7
  s_add_u32 s66, s60, 9216
  s_and_b32 s66, s66, 0x3fff
  buffer_load_dwordx4 v[144:147], v206, s[8:11], s66 offen sc1
  buffer_load_dwordx4 v[148:151], v207, s[8:11], s66 offen sc1
  buffer_load_dwordx4 v[152:155], v208, s[8:11], s66 offen sc1
  buffer_load_dwordx4 v[156:159], v209, s[8:11], s66 offen sc1
  s_waitcnt vmcnt(0)
  v_max3_u32 v12, v144, v148, v152
  v_max_u32 v12, v12, v156
  v_cmp_eq_u32 vcc, -1, v12
  s_cbranch_vccnz VR288
  v_max3_u32 v12, v80, v84, v88
  v_max3_u32 v12, v12, v92, v96
  v_max3_u32 v12, v12, v100, v104
  v_max3_u32 v12, v12, v108, v112
  v_max3_u32 v12, v12, v116, v120
  v_max_u32 v12, v12, v124
  v_cmp_eq_u32 vcc, -1, v12
  s_cbranch_vccz VK289
  s_add_u32 s66, s60, 10240
  s_and_b32 s66, s66, 0x3fff
  buffer_load_dwordx4 v[80:83], v206, s[8:11], s66 offen sc1
  buffer_load_dwordx4 v[84:87], v207, s[8:11], s66 offen sc1
  buffer_load_dwordx4 v[88:91], v208, s[8:11], s66 offen sc1
  buffer_load_dwordx4 v[92:95], v209, s[8:11], s66 offen sc1
  s_add_u32 s66, s60, 11264
  s_and_b32 s66, s66, 0x3fff
  buffer_load_dwordx4 v[96:99], v206, s[8:11], s66 offen sc1
  buffer_load_dwordx4 v[100:103], v207, s[8:11], s66 offen sc1
  buffer_load_dwordx4 v[104:107], v208, s[8:11], s66 offen sc1
  buffer_load_dwordx4 v[108:111], v209, s[8:11], s66 offen sc1
  s_add_u32 s66, s60, 12288
  s_and_b32 s66, s66, 0x3fff
  buffer_load_dwordx4 v[112:115], v206, s[8:11], s66 offen sc1
  buffer_load_dwordx4 v[116:119], v207, s[8:11], s66 offen sc1
  buffer_load_dwordx4 v[120:123], v208, s[8:11], s66 offen sc1
  buffer_load_dwordx4 v[124:127], v209, s[8:11], s66 offen sc1
  s_waitcnt vmcnt(0)
  s_nop 1
  s_branch VK289
VR291:
  s_cmp_eq_u32 s82, 0
  s_cbranch_scc1 VK292
  s_sub_u32 s82, s82, 1
  s_nop 7
  s_add_u32 s66, s60, 10240
  s_and_b32 s66, s66, 0x3fff
  buffer_load_dwordx4 v[80:83], v206, s[8:11], s66 offen sc1
  buffer_load_dwordx4 v[84:87], v207, s[8:11], s66 offen sc1
  buffer_load_dwordx4 v[88:91], v208, s[8:11], s66 offen sc1
  buffer_load_dwordx4 v[92:95], v209, s[8:11], s66 offen sc1
  s_waitcnt vmcnt(0)
  v_max3_u32 v12, v80, v84, v88
  v_max_u32 v12, v12, v92
  v_cmp_eq_u32 vcc, -1, v12
  s_cbranch_vccnz VR291
  v_max3_u32 v12, v96, v100, v104
  v_max3_u32 v12, v12, v108, v112
  v_max3_u32 v12, v12, v116, v120
  v_max3_u32 v12, v12, v124, v128
  v_max3_u32 v12, v12, v132, v136
  v_max_u32 v12, v12, v140
  v_cmp_eq_u32 vcc, -1, v12
  s_cbranch_vccz VK292
  s_add_u32 s66, s60, 11264
  s_and_b32 s66, s66, 0x3fff
  buffer_load_dwordx4 v[96:99], v206, s[8:11], s66 offen sc1
  buffer_load_dwordx4 v[100:103], v207, s[8:11], s66 offen sc1
  buffer_load_dwordx4 v[104:107], v208, s[8:11], s66 offen sc1
  buffer_load_dwordx4 v[108:111], v209, s[8:11], s66 offen sc1
  s_add_u32 s66, s60, 12288
  s_and_b32 s66, s66, 0x3fff
  buffer_load_dwordx4 v[112:115], v206, s[8:11], s66 offen sc1
  buffer_load_dwordx4 v[116:119], v207, s[8:11], s66 offen sc1
  buffer_load_dwordx4 v[120:123], v208, s[8:11], s66 offen sc1
  buffer_load_dwordx4 v[124:127], v209, s[8:11], s66 offen sc1
  s_add_u32 s66, s60, 13312
  s_and_b32 s66, s66, 0x3fff
  buffer_load_dwordx4 v[128:131], v206, s[8:11], s66 offen sc1
  buffer_load_dwordx4 v[132:135], v207, s[8:11], s66 offen sc1
  buffer_load_dwordx4 v[136:139], v208, s[8:11], s66 offen sc1
  buffer_load_dwordx4 v[140:143], v209, s[8:11], s66 offen sc1
  s_waitcnt vmcnt(0)
  s_nop 1
  s_branch VK292
VR294:
  s_cmp_eq_u32 s82, 0
  s_cbranch_scc1 VK295
  s_sub_u32 s82, s82, 1
  s_nop 7
  s_add_u32 s66, s60, 11264
  s_and_b32 s66, s66, 0x3fff
  buffer_load_dwordx4 v[96:99], v206, s[8:11], s66 offen sc1
  buffer_load_dwordx4 v[100:103], v207, s[8:11], s66 offen sc1
  buffer_load_dwordx4 v[104:107], v208, s[8:11], s66 offen sc1
  buffer_load_dwordx4 v[108:111], v209, s[8:11], s66 offen sc1
  s_waitcnt vmcnt(0)
  v_max3_u32 v12, v96, v100, v104
  v_max_u32 v12, v12, v108
  v_cmp_eq_u32 vcc, -1, v12
  s_cbranch_vccnz VR294
  v_max3_u32 v12, v112, v116, v120
  v_max3_u32 v12, v12, v124, v128
  v_max3_u32 v12, v12, v132, v136
  v_max3_u32 v12, v12, v140, v144
  v_max3_u32 v12, v12, v148, v152
  v_max_u32 v12, v12, v156
  v_cmp_eq_u32 vcc, -1, v12
  s_cbranch_vccz VK295
  s_add_u32 s66, s60, 12288
  s_and_b32 s66, s66, 0x3fff
  buffer_load_dwordx4 v[112:115], v206, s[8:11], s66 offen sc1
  buffer_load_dwordx4 v[116:119], v207, s[8:11], s66 offen sc1
  buffer_load_dwordx4 v[120:123], v208, s[8:11], s66 offen sc1
  buffer_load_dwordx4 v[124:127], v209, s[8:11], s66 offen sc1
  s_add_u32 s66, s60, 13312
  s_and_b32 s66, s66, 0x3fff
  buffer_load_dwordx4 v[128:131], v206, s[8:11], s66 offen sc1
  buffer_load_dwordx4 v[132:135], v207, s[8:11], s66 offen sc1
  buffer_load_dwordx4 v[136:139], v208, s[8:11], s66 offen sc1
  buffer_load_dwordx4 v[140:143], v209, s[8:11], s66 offen sc1
  s_add_u32 s66, s60, 14336
  s_and_b32 s66, s66, 0x3fff
  buffer_load_dwordx4 v[144:147], v206, s[8:11], s66 offen sc1
  buffer_load_dwordx4 v[148:151], v207, s[8:11], s66 offen sc1
  buffer_load_dwordx4 v[152:155], v208, s[8:11], s66 offen sc1
  buffer_load_dwordx4 v[156:159], v209, s[8:11], s66 offen sc1
  s_waitcnt vmcnt(0)
  s_nop 1
  s_branch VK295
VR297:
  s_cmp_eq_u32 s82, 0
  s_cbranch_scc1 VK298
  s_sub_u32 s82, s82, 1
  s_nop 7
  s_add_u32 s66, s60, 12288
  s_and_b32 s66, s66, 0x3fff
  buffer_load_dwordx4 v[112:115], v206, s[8:11], s66 offen sc1
  buffer_load_dwordx4 v[116:119], v207, s[8:11], s66 offen sc1
  buffer_load_dwordx4 v[120:123], v208, s[8:11], s66 offen sc1
  buffer_load_dwordx4 v[124:127], v209, s[8:11], s66 offen sc1
  s_waitcnt vmcnt(0)
  v_max3_u32 v12, v112, v116, v120
  v_max_u32 v12, v12, v124
  v_cmp_eq_u32 vcc, -1, v12
  s_cbranch_vccnz VR297
  v_max3_u32 v12, v128, v132, v136
  v_max3_u32 v12, v12, v140, v144
  v_max3_u32 v12, v12, v148, v152
  v_max3_u32 v12, v12, v156, v80
  v_max3_u32 v12, v12, v84, v88
  v_max_u32 v12, v12, v92
  v_cmp_eq_u32 vcc, -1, v12
  s_cbranch_vccz VK298
  s_add_u32 s66, s60, 13312
  s_and_b32 s66, s66, 0x3fff
  buffer_load_dwordx4 v[128:131], v206, s[8:11], s66 offen sc1
  buffer_load_dwordx4 v[132:135], v207, s[8:11], s66 offen sc1
  buffer_load_dwordx4 v[136:139], v208, s[8:11], s66 offen sc1
  buffer_load_dwordx4 v[140:143], v209, s[8:11], s66 offen sc1
  s_add_u32 s66, s60, 14336
  s_and_b32 s66, s66, 0x3fff
  buffer_load_dwordx4 v[144:147], v206, s[8:11], s66 offen sc1
  buffer_load_dwordx4 v[148:151], v207, s[8:11], s66 offen sc1
  buffer_load_dwordx4 v[152:155], v208, s[8:11], s66 offen sc1
  buffer_load_dwordx4 v[156:159], v209, s[8:11], s66 offen sc1
  s_add_u32 s66, s60, 15360
  s_and_b32 s66, s66, 0x3fff
  buffer_load_dwordx4 v[80:83], v206, s[8:11], s66 offen sc1
  buffer_load_dwordx4 v[84:87], v207, s[8:11], s66 offen sc1
  buffer_load_dwordx4 v[88:91], v208, s[8:11], s66 offen sc1
  buffer_load_dwordx4 v[92:95], v209, s[8:11], s66 offen sc1
  s_waitcnt vmcnt(0)
  s_nop 1
  s_branch VK298
VR300:
  s_cmp_eq_u32 s82, 0
  s_cbranch_scc1 VK301
  s_sub_u32 s82, s82, 1
  s_nop 7
  s_add_u32 s66, s60, 13312
  s_and_b32 s66, s66, 0x3fff
  buffer_load_dwordx4 v[128:131], v206, s[8:11], s66 offen sc1
  buffer_load_dwordx4 v[132:135], v207, s[8:11], s66 offen sc1
  buffer_load_dwordx4 v[136:139], v208, s[8:11], s66 offen sc1
  buffer_load_dwordx4 v[140:143], v209, s[8:11], s66 offen sc1
  s_waitcnt vmcnt(0)
  v_max3_u32 v12, v128, v132, v136
  v_max_u32 v12, v12, v140
  v_cmp_eq_u32 vcc, -1, v12
  s_cbranch_vccnz VR300
  v_max3_u32 v12, v144, v148, v152
  v_max3_u32 v12, v12, v156, v80
  v_max3_u32 v12, v12, v84, v88
  v_max_u32 v12, v12, v92
  v_cmp_eq_u32 vcc, -1, v12
  s_cbranch_vccz VK301
  s_add_u32 s66, s60, 14336
  s_and_b32 s66, s66, 0x3fff
  buffer_load_dwordx4 v[144:147], v206, s[8:11], s66 offen sc1
  buffer_load_dwordx4 v[148:151], v207, s[8:11], s66 offen sc1
  buffer_load_dwordx4 v[152:155], v208, s[8:11], s66 offen sc1
  buffer_load_dwordx4 v[156:159], v209, s[8:11], s66 offen sc1
  s_add_u32 s66, s60, 15360
  s_and_b32 s66, s66, 0x3fff
  buffer_load_dwordx4 v[80:83], v206, s[8:11], s66 offen sc1
  buffer_load_dwordx4 v[84:87], v207, s[8:11], s66 offen sc1
  buffer_load_dwordx4 v[88:91], v208, s[8:11], s66 offen sc1
  buffer_load_dwordx4 v[92:95], v209, s[8:11], s66 offen sc1
  s_waitcnt vmcnt(0)
  s_nop 1
  s_branch VK301
VR303:
  s_cmp_eq_u32 s82, 0
  s_cbranch_scc1 VK304
  s_sub_u32 s82, s82, 1
  s_nop 7
  s_add_u32 s66, s60, 14336
  s_and_b32 s66, s66, 0x3fff
  buffer_load_dwordx4 v[144:147], v206, s[8:11], s66 offen sc1
  buffer_load_dwordx4 v[148:151], v207, s[8:11], s66 offen sc1
  buffer_load_dwordx4 v[152:155], v208, s[8:11], s66 offen sc1
  buffer_load_dwordx4 v[156:159], v209, s[8:11], s66 offen sc1
  s_waitcnt vmcnt(0)
  v_max3_u32 v12, v144, v148, v152
  v_max_u32 v12, v12, v156
  v_cmp_eq_u32 vcc, -1, v12
  s_cbranch_vccnz VR303
  v_max3_u32 v12, v80, v84, v88
  v_max_u32 v12, v12, v92
  v_cmp_eq_u32 vcc, -1, v12
  s_cbranch_vccz VK304
  s_add_u32 s66, s60, 15360
  s_and_b32 s66, s66, 0x3fff
  buffer_load_dwordx4 v[80:83], v206, s[8:11], s66 offen sc1
  buffer_load_dwordx4 v[84:87], v207, s[8:11], s66 offen sc1
  buffer_load_dwordx4 v[88:91], v208, s[8:11], s66 offen sc1
  buffer_load_dwordx4 v[92:95], v209, s[8:11], s66 offen sc1
  s_waitcnt vmcnt(0)
  s_nop 1
  s_branch VK304
VR306:
  s_cmp_eq_u32 s82, 0
  s_cbranch_scc1 VK307
  s_sub_u32 s82, s82, 1
  s_nop 7
  s_add_u32 s66, s60, 15360
  s_and_b32 s66, s66, 0x3fff
  buffer_load_dwordx4 v[80:83], v206, s[8:11], s66 offen sc1
  buffer_load_dwordx4 v[84:87], v207, s[8:11], s66 offen sc1
  buffer_load_dwordx4 v[88:91], v208, s[8:11], s66 offen sc1
  buffer_load_dwordx4 v[92:95], v209, s[8:11], s66 offen sc1
  s_waitcnt vmcnt(0)
  s_branch VC305
VR309:
  s_cmp_eq_u32 s82, 0
  s_cbranch_scc1 VK310
  s_sub_u32 s82, s82, 1
  s_nop 7
  s_mov_b32 s66, s61
  buffer_load_dwordx4 v[96:99], v210, s[8:11], s66 offen sc1
  buffer_load_dwordx4 v[100:103], v211, s[8:11], s66 offen sc1
  buffer_load_dwordx4 v[104:107], v212, s[8:11], s66 offen sc1
  buffer_load_dwordx4 v[108:111], v213, s[8:11], s66 offen sc1
  buffer_load_dwordx4 v[112:115], v214, s[8:11], s66 offen sc1
  s_waitcnt vmcnt(0)
  v_max3_u32 v8, v96, v100, v104
  v_max3_u32 v8, v8, v108, v112
  v_cmp_eq_u32 vcc, -1, v8
  s_cbranch_vccnz VR309
  v_max3_u32 v8, v116, v120, v124
  v_max3_u32 v8, v8, v128, v132
  v_max3_u32 v8, v8, v136, v140
  v_max3_u32 v8, v8, v144, v148
  v_max_u32 v8, v8, v152
  v_cmp_eq_u32 vcc, -1, v8
  s_cbranch_vccz VK310
  s_add_u32 s66, s61, 1024
  s_sub_u32 s68, s66, 12288
  s_cselect_b32 s66, s66, s68
  buffer_load_dwordx4 v[116:119], v210, s[8:11], s66 offen sc1
  buffer_load_dwordx4 v[120:123], v211, s[8:11], s66 offen sc1
  buffer_load_dwordx4 v[124:127], v212, s[8:11], s66 offen sc1
  buffer_load_dwordx4 v[128:131], v213, s[8:11], s66 offen sc1
  buffer_load_dwordx4 v[132:135], v214, s[8:11], s66 offen sc1
  s_add_u32 s66, s61, 2048
  s_sub_u32 s68, s66, 12288
  s_cselect_b32 s66, s66, s68
  buffer_load_dwordx4 v[136:139], v210, s[8:11], s66 offen sc1
  buffer_load_dwordx4 v[140:143], v211, s[8:11], s66 offen sc1
  buffer_load_dwordx4 v[144:147], v212, s[8:11], s66 offen sc1
  buffer_load_dwordx4 v[148:151], v213, s[8:11], s66 offen sc1
  buffer_load_dwordx4 v[152:155], v214, s[8:11], s66 offen sc1
  s_waitcnt vmcnt(0)
  s_nop 1
  s_branch VK310
VR312:
  s_cmp_eq_u32 s82, 0
  s_cbranch_scc1 VK313
  s_sub_u32 s82, s82, 1
  s_nop 7
  s_add_u32 s66, s61, 1024
  s_sub_u32 s68, s66, 12288
  s_cselect_b32 s66, s66, s68
  buffer_load_dwordx4 v[116:119], v210, s[8:11], s66 offen sc1
  buffer_load_dwordx4 v[120:123], v211, s[8:11], s66 offen sc1
  buffer_load_dwordx4 v[124:127], v212, s[8:11], s66 offen sc1
  buffer_load_dwordx4 v[128:131], v213, s[8:11], s66 offen sc1
  buffer_load_dwordx4 v[132:135], v214, s[8:11], s66 offen sc1
  s_waitcnt vmcnt(0)
  v_max3_u32 v8, v116, v120, v124
  v_max3_u32 v8, v8, v128, v132
  v_cmp_eq_u32 vcc, -1, v8
  s_cbranch_vccnz VR312
  v_max3_u32 v8, v136, v140, v144
  v_max3_u32 v8, v8, v148, v152
  v_max3_u32 v8, v8, v156, v160
  v_max3_u32 v8, v8, v164, v168
  v_max_u32 v8, v8, v172
  v_cmp_eq_u32 vcc, -1, v8
  s_cbranch_vccz VK313
  s_add_u32 s66, s61, 2048
  s_sub_u32 s68, s66, 12288
  s_cselect_b32 s66, s66, s68
  buffer_load_dwordx4 v[136:139], v210, s[8:11], s66 offen sc1
  buffer_load_dwordx4 v[140:143], v211, s[8:11], s66 offen sc1
  buffer_load_dwordx4 v[144:147], v212, s[8:11], s66 offen sc1
  buffer_load_dwordx4 v[148:151], v213, s[8:11], s66 offen sc1
  buffer_load_dwordx4 v[152:155], v214, s[8:11], s66 offen sc1
  s_add_u32 s66, s61, 3072
  s_sub_u32 s68, s66, 12288
  s_cselect_b32 s66, s66, s68
  buffer_load_dwordx4 v[156:159], v210, s[8:11], s66 offen sc1
  buffer_load_dwordx4 v[160:163], v211, s[8:11], s66 offen sc1
  buffer_load_dwordx4 v[164:167], v212, s[8:11], s66 offen sc1
  buffer_load_dwordx4 v[168:171], v213, s[8:11], s66 offen sc1
  buffer_load_dwordx4 v[172:175], v214, s[8:11], s66 offen sc1
  s_waitcnt vmcnt(0)
  s_nop 1
  s_branch VK313
VR315:
  s_cmp_eq_u32 s82, 0
  s_cbranch_scc1 VK316
  s_sub_u32 s82, s82, 1
  s_nop 7
  s_add_u32 s66, s61, 2048
  s_sub_u32 s68, s66, 12288
  s_cselect_b32 s66, s66, s68
  buffer_load_dwordx4 v[136:139], v210, s[8:11], s66 offen sc1
  buffer_load_dwordx4 v[140:143], v211, s[8:11], s66 offen sc1
  buffer_load_dwordx4 v[144:147], v212, s[8:11], s66 offen sc1
  buffer_load_dwordx4 v[148:151], v213, s[8:11], s66 offen sc1
  buffer_load_dwordx4 v[152:155], v214, s[8:11], s66 offen sc1
  s_waitcnt vmcnt(0)
  v_max3_u32 v8, v136, v140, v144
  v_max3_u32 v8, v8, v148, v152
  v_cmp_eq_u32 vcc, -1, v8
  s_cbranch_vccnz VR315
  v_max3_u32 v8, v156, v160, v164
  v_max3_u32 v8, v8, v168, v172
  v_max3_u32 v8, v8, v96, v100
  v_max3_u32 v8, v8, v104, v108
  v_max_u32 v8, v8, v112
  v_cmp_eq_u32 vcc, -1, v8
  s_cbranch_vccz VK316
  s_add_u32 s66, s61, 3072
  s_sub_u32 s68, s66, 12288
  s_cselect_b32 s66, s66, s68
  buffer_load_dwordx4 v[156:159], v210, s[8:11], s66 offen sc1
  buffer_load_dwordx4 v[160:163], v211, s[8:11], s66 offen sc1
  buffer_load_dwordx4 v[164:167], v212, s[8:11], s66 offen sc1
  buffer_load_dwordx4 v[168:171], v213, s[8:11], s66 offen sc1
  buffer_load_dwordx4 v[172:175], v214, s[8:11], s66 offen sc1
  s_add_u32 s66, s61, 4096
  s_sub_u32 s68, s66, 12288
  s_cselect_b32 s66, s66, s68
  buffer_load_dwordx4 v[96:99], v210, s[8:11], s66 offen sc1
  buffer_load_dwordx4 v[100:103], v211, s[8:11], s66 offen sc1
  buffer_load_dwordx4 v[104:107], v212, s[8:11], s66 offen sc1
  buffer_load_dwordx4 v[108:111], v213, s[8:11], s66 offen sc1
  buffer_load_dwordx4 v[112:115], v214, s[8:11], s66 offen sc1
  s_waitcnt vmcnt(0)
  s_nop 1
  s_branch VK316
VR318:
  s_cmp_eq_u32 s82, 0
  s_cbranch_scc1 VK319
  s_sub_u32 s82, s82, 1
  s_nop 7
  s_add_u32 s66, s61, 3072
  s_sub_u32 s68, s66, 12288
  s_cselect_b32 s66, s66, s68
  buffer_load_dwordx4 v[156:159], v210, s[8:11], s66 offen sc1
  buffer_load_dwordx4 v[160:163], v211, s[8:11], s66 offen sc1
  buffer_load_dwordx4 v[164:167], v212, s[8:11], s66 offen sc1
  buffer_load_dwordx4 v[168:171], v213, s[8:11], s66 offen sc1
  buffer_load_dwordx4 v[172:175], v214, s[8:11], s66 offen sc1
  s_waitcnt vmcnt(0)
  v_max3_u32 v8, v156, v160, v164
  v_max3_u32 v8, v8, v168, v172
  v_cmp_eq_u32 vcc, -1, v8
  s_cbranch_vccnz VR318
  v_max3_u32 v8, v96, v100, v104
  v_max3_u32 v8, v8, v108, v112
  v_max3_u32 v8, v8, v116, v120
  v_max3_u32 v8, v8, v124, v128
  v_max_u32 v8, v8, v132
  v_cmp_eq_u32 vcc, -1, v8
  s_cbranch_vccz VK319
  s_add_u32 s66, s61, 4096
  s_sub_u32 s68, s66, 12288
  s_cselect_b32 s66, s66, s68
  buffer_load_dwordx4 v[96:99], v210, s[8:11], s66 offen sc1
  buffer_load_dwordx4 v[100:103], v211, s[8:11], s66 offen sc1
  buffer_load_dwordx4 v[104:107], v212, s[8:11], s66 offen sc1
  buffer_load_dwordx4 v[108:111], v213, s[8:11], s66 offen sc1
  buffer_load_dwordx4 v[112:115], v214, s[8:11], s66 offen sc1
  s_add_u32 s66, s61, 5120
  s_sub_u32 s68, s66, 12288
  s_cselect_b32 s66, s66, s68
  buffer_load_dwordx4 v[116:119], v210, s[8:11], s66 offen sc1
  buffer_load_dwordx4 v[120:123], v211, s[8:11], s66 offen sc1
  buffer_load_dwordx4 v[124:127], v212, s[8:11], s66 offen sc1
  buffer_load_dwordx4 v[128:131], v213, s[8:11], s66 offen sc1
  buffer_load_dwordx4 v[132:135], v214, s[8:11], s66 offen sc1
  s_waitcnt vmcnt(0)
  s_nop 1
  s_branch VK319
VR321:
  s_cmp_eq_u32 s82, 0
  s_cbranch_scc1 VK322
  s_sub_u32 s82, s82, 1
  s_nop 7
  s_add_u32 s66, s61, 4096
  s_sub_u32 s68, s66, 12288
  s_cselect_b32 s66, s66, s68
  buffer_load_dwordx4 v[96:99], v210, s[8:11], s66 offen sc1
  buffer_load_dwordx4 v[100:103], v211, s[8:11], s66 offen sc1
  buffer_load_dwordx4 v[104:107], v212, s[8:11], s66 offen sc1
  buffer_load_dwordx4 v[108:111], v213, s[8:11], s66 offen sc1
  buffer_load_dwordx4 v[112:115], v214, s[8:11], s66 offen sc1
  s_waitcnt vmcnt(0)
  v_max3_u32 v8, v96, v100, v104
  v_max3_u32 v8, v8, v108, v112
  v_cmp_eq_u32 vcc, -1, v8
  s_cbranch_vccnz VR321
  v_max3_u32 v8, v116, v120, v124
  v_max3_u32 v8, v8, v128, v132
  v_max3_u32 v8, v8, v136, v140
  v_max3_u32 v8, v8, v144, v148
  v_max_u32 v8, v8, v152
  v_cmp_eq_u32 vcc, -1, v8
  s_cbranch_vccz VK322
  s_add_u32 s66, s61, 5120
  s_sub_u32 s68, s66, 12288
  s_cselect_b32 s66, s66, s68
  buffer_load_dwordx4 v[116:119], v210, s[8:11], s66 offen sc1
  buffer_load_dwordx4 v[120:123], v211, s[8:11], s66 offen sc1
  buffer_load_dwordx4 v[124:127], v212, s[8:11], s66 offen sc1
  buffer_load_dwordx4 v[128:131], v213, s[8:11], s66 offen sc1
  buffer_load_dwordx4 v[132:135], v214, s[8:11], s66 offen sc1
  s_add_u32 s66, s61, 6144
  s_sub_u32 s68, s66, 12288
  s_cselect_b32 s66, s66, s68
  buffer_load_dwordx4 v[136:139], v210, s[8:11], s66 offen sc1
  buffer_load_dwordx4 v[140:143], v211, s[8:11], s66 offen sc1
  buffer_load_dwordx4 v[144:147], v212, s[8:11], s66 offen sc1
  buffer_load_dwordx4 v[148:151], v213, s[8:11], s66 offen sc1
  buffer_load_dwordx4 v[152:155], v214, s[8:11], s66 offen sc1
  s_waitcnt vmcnt(0)
  s_nop 1
  s_branch VK322
VR324:
  s_cmp_eq_u32 s82, 0
  s_cbranch_scc1 VK325
  s_sub_u32 s82, s82, 1
  s_nop 7
  s_add_u32 s66, s61, 5120
  s_sub_u32 s68, s66, 12288
  s_cselect_b32 s66, s66, s68
  buffer_load_dwordx4 v[116:119], v210, s[8:11], s66 offen sc1
  buffer_load_dwordx4 v[120:123], v211, s[8:11], s66 offen sc1
  buffer_load_dwordx4 v[124:127], v212, s[8:11], s66 offen sc1
  buffer_load_dwordx4 v[128:131], v213, s[8:11], s66 offen sc1
  buffer_load_dwordx4 v[132:135], v214, s[8:11], s66 offen sc1
  s_waitcnt vmcnt(0)
  v_max3_u32 v8, v116, v120, v124
  v_max3_u32 v8, v8, v128, v132
  v_cmp_eq_u32 vcc, -1, v8
  s_cbranch_vccnz VR324
  v_max3_u32 v8, v136, v140, v144
  v_max3_u32 v8, v8, v148, v152
  v_max3_u32 v8, v8, v156, v160
  v_max3_u32 v8, v8, v164, v168
  v_max_u32 v8, v8, v172
  v_cmp_eq_u32 vcc, -1, v8
  s_cbranch_vccz VK325
  s_add_u32 s66, s61, 6144
  s_sub_u32 s68, s66, 12288
  s_cselect_b32 s66, s66, s68
  buffer_load_dwordx4 v[136:139], v210, s[8:11], s66 offen sc1
  buffer_load_dwordx4 v[140:143], v211, s[8:11], s66 offen sc1
  buffer_load_dwordx4 v[144:147], v212, s[8:11], s66 offen sc1
  buffer_load_dwordx4 v[148:151], v213, s[8:11], s66 offen sc1
  buffer_load_dwordx4 v[152:155], v214, s[8:11], s66 offen sc1
  s_add_u32 s66, s61, 7168
  s_sub_u32 s68, s66, 12288
  s_cselect_b32 s66, s66, s68
  buffer_load_dwordx4 v[156:159], v210, s[8:11], s66 offen sc1
  buffer_load_dwordx4 v[160:163], v211, s[8:11], s66 offen sc1
  buffer_load_dwordx4 v[164:167], v212, s[8:11], s66 offen sc1
  buffer_load_dwordx4 v[168:171], v213, s[8:11], s66 offen sc1
  buffer_load_dwordx4 v[172:175], v214, s[8:11], s66 offen sc1
  s_waitcnt vmcnt(0)
  s_nop 1
  s_branch VK325
VR327:
  s_cmp_eq_u32 s82, 0
  s_cbranch_scc1 VK328
  s_sub_u32 s82, s82, 1
  s_nop 7
  s_add_u32 s66, s61, 6144
  s_sub_u32 s68, s66, 12288
  s_cselect_b32 s66, s66, s68
  buffer_load_dwordx4 v[136:139], v210, s[8:11], s66 offen sc1
  buffer_load_dwordx4 v[140:143], v211, s[8:11], s66 offen sc1
  buffer_load_dwordx4 v[144:147], v212, s[8:11], s66 offen sc1
  buffer_load_dwordx4 v[148:151], v213, s[8:11], s66 offen sc1
  buffer_load_dwordx4 v[152:155], v214, s[8:11], s66 offen sc1
  s_waitcnt vmcnt(0)
  v_max3_u32 v8, v136, v140, v144
  v_max3_u32 v8, v8, v148, v152
  v_cmp_eq_u32 vcc, -1, v8
  s_cbranch_vccnz VR327
  v_max3_u32 v8, v156, v160, v164
  v_max3_u32 v8, v8, v168, v172
  v_max3_u32 v8, v8, v96, v100
  v_max3_u32 v8, v8, v104, v108
  v_max_u32 v8, v8, v112
  v_cmp_eq_u32 vcc, -1, v8
  s_cbranch_vccz VK328
  s_add_u32 s66, s61, 7168
  s_sub_u32 s68, s66, 12288
  s_cselect_b32 s66, s66, s68
  buffer_load_dwordx4 v[156:159], v210, s[8:11], s66 offen sc1
  buffer_load_dwordx4 v[160:163], v211, s[8:11], s66 offen sc1
  buffer_load_dwordx4 v[164:167], v212, s[8:11], s66 offen sc1
  buffer_load_dwordx4 v[168:171], v213, s[8:11], s66 offen sc1
  buffer_load_dwordx4 v[172:175], v214, s[8:11], s66 offen sc1
  s_add_u32 s66, s61, 8192
  s_sub_u32 s68, s66, 12288
  s_cselect_b32 s66, s66, s68
  buffer_load_dwordx4 v[96:99], v210, s[8:11], s66 offen sc1
  buffer_load_dwordx4 v[100:103], v211, s[8:11], s66 offen sc1
  buffer_load_dwordx4 v[104:107], v212, s[8:11], s66 offen sc1
  buffer_load_dwordx4 v[108:111], v213, s[8:11], s66 offen sc1
  buffer_load_dwordx4 v[112:115], v214, s[8:11], s66 offen sc1
  s_waitcnt vmcnt(0)
  s_nop 1
  s_branch VK328
VR330:
  s_cmp_eq_u32 s82, 0
  s_cbranch_scc1 VK331
  s_sub_u32 s82, s82, 1
  s_nop 7
  s_add_u32 s66, s61, 7168
  s_sub_u32 s68, s66, 12288
  s_cselect_b32 s66, s66, s68
  buffer_load_dwordx4 v[156:159], v210, s[8:11], s66 offen sc1
  buffer_load_dwordx4 v[160:163], v211, s[8:11], s66 offen sc1
  buffer_load_dwordx4 v[164:167], v212, s[8:11], s66 offen sc1
  buffer_load_dwordx4 v[168:171], v213, s[8:11], s66 offen sc1
  buffer_load_dwordx4 v[172:175], v214, s[8:11], s66 offen sc1
  s_waitcnt vmcnt(0)
  v_max3_u32 v8, v156, v160, v164
  v_max3_u32 v8, v8, v168, v172
  v_cmp_eq_u32 vcc, -1, v8
  s_cbranch_vccnz VR330
  v_max3_u32 v8, v96, v100, v104
  v_max3_u32 v8, v8, v108, v112
  v_max3_u32 v8, v8, v116, v120
  v_max3_u32 v8, v8, v124, v128
  v_max_u32 v8, v8, v132
  v_cmp_eq_u32 vcc, -1, v8
  s_cbranch_vccz VK331
  s_add_u32 s66, s61, 8192
  s_sub_u32 s68, s66, 12288
  s_cselect_b32 s66, s66, s68
  buffer_load_dwordx4 v[96:99], v210, s[8:11], s66 offen sc1
  buffer_load_dwordx4 v[100:103], v211, s[8:11], s66 offen sc1
  buffer_load_dwordx4 v[104:107], v212, s[8:11], s66 offen sc1
  buffer_load_dwordx4 v[108:111], v213, s[8:11], s66 offen sc1
  buffer_load_dwordx4 v[112:115], v214, s[8:11], s66 offen sc1
  s_add_u32 s66, s61, 9216
  s_sub_u32 s68, s66, 12288
  s_cselect_b32 s66, s66, s68
  buffer_load_dwordx4 v[116:119], v210, s[8:11], s66 offen sc1
  buffer_load_dwordx4 v[120:123], v211, s[8:11], s66 offen sc1
  buffer_load_dwordx4 v[124:127], v212, s[8:11], s66 offen sc1
  buffer_load_dwordx4 v[128:131], v213, s[8:11], s66 offen sc1
  buffer_load_dwordx4 v[132:135], v214, s[8:11], s66 offen sc1
  s_waitcnt vmcnt(0)
  s_nop 1
  s_branch VK331
VR333:
  s_cmp_eq_u32 s82, 0
  s_cbranch_scc1 VK334
  s_sub_u32 s82, s82, 1
  s_nop 7
  s_add_u32 s66, s61, 8192
  s_sub_u32 s68, s66, 12288
  s_cselect_b32 s66, s66, s68
  buffer_load_dwordx4 v[96:99], v210, s[8:11], s66 offen sc1
  buffer_load_dwordx4 v[100:103], v211, s[8:11], s66 offen sc1
  buffer_load_dwordx4 v[104:107], v212, s[8:11], s66 offen sc1
  buffer_load_dwordx4 v[108:111], v213, s[8:11], s66 offen sc1
  buffer_load_dwordx4 v[112:115], v214, s[8:11], s66 offen sc1
  s_waitcnt vmcnt(0)
  v_max3_u32 v8, v96, v100, v104
  v_max3_u32 v8, v8, v108, v112
  v_cmp_eq_u32 vcc, -1, v8
  s_cbranch_vccnz VR333
  v_max3_u32 v8, v116, v120, v124
  v_max3_u32 v8, v8, v128, v132
  v_max3_u32 v8, v8, v136, v140
  v_max3_u32 v8, v8, v144, v148
  v_max_u32 v8, v8, v152
  v_cmp_eq_u32 vcc, -1, v8
  s_cbranch_vccz VK334
  s_add_u32 s66, s61, 9216
  s_sub_u32 s68, s66, 12288
  s_cselect_b32 s66, s66, s68
  buffer_load_dwordx4 v[116:119], v210, s[8:11], s66 offen sc1
  buffer_load_dwordx4 v[120:123], v211, s[8:11], s66 offen sc1
  buffer_load_dwordx4 v[124:127], v212, s[8:11], s66 offen sc1
  buffer_load_dwordx4 v[128:131], v213, s[8:11], s66 offen sc1
  buffer_load_dwordx4 v[132:135], v214, s[8:11], s66 offen sc1
  s_add_u32 s66, s61, 10240
  s_sub_u32 s68, s66, 12288
  s_cselect_b32 s66, s66, s68
  buffer_load_dwordx4 v[136:139], v210, s[8:11], s66 offen sc1
  buffer_load_dwordx4 v[140:143], v211, s[8:11], s66 offen sc1
  buffer_load_dwordx4 v[144:147], v212, s[8:11], s66 offen sc1
  buffer_load_dwordx4 v[148:151], v213, s[8:11], s66 offen sc1
  buffer_load_dwordx4 v[152:155], v214, s[8:11], s66 offen sc1
  s_waitcnt vmcnt(0)
  s_nop 1
  s_branch VK334
VR336:
  s_cmp_eq_u32 s82, 0
  s_cbranch_scc1 VK337
  s_sub_u32 s82, s82, 1
  s_nop 7
  s_add_u32 s66, s61, 9216
  s_sub_u32 s68, s66, 12288
  s_cselect_b32 s66, s66, s68
  buffer_load_dwordx4 v[116:119], v210, s[8:11], s66 offen sc1
  buffer_load_dwordx4 v[120:123], v211, s[8:11], s66 offen sc1
  buffer_load_dwordx4 v[124:127], v212, s[8:11], s66 offen sc1
  buffer_load_dwordx4 v[128:131], v213, s[8:11], s66 offen sc1
  buffer_load_dwordx4 v[132:135], v214, s[8:11], s66 offen sc1
  s_waitcnt vmcnt(0)
  v_max3_u32 v8, v116, v120, v124
  v_max3_u32 v8, v8, v128, v132
  v_cmp_eq_u32 vcc, -1, v8
  s_cbranch_vccnz VR336
  v_max3_u32 v8, v136, v140, v144
  v_max3_u32 v8, v8, v148, v152
  v_max3_u32 v8, v8, v156, v160
  v_max3_u32 v8, v8, v164, v168
  v_max_u32 v8, v8, v172
  v_cmp_eq_u32 vcc, -1, v8
  s_cbranch_vccz VK337
  s_add_u32 s66, s61, 10240
  s_sub_u32 s68, s66, 12288
  s_cselect_b32 s66, s66, s68
  buffer_load_dwordx4 v[136:139], v210, s[8:11], s66 offen sc1
  buffer_load_dwordx4 v[140:143], v211, s[8:11], s66 offen sc1
  buffer_load_dwordx4 v[144:147], v212, s[8:11], s66 offen sc1
  buffer_load_dwordx4 v[148:151], v213, s[8:11], s66 offen sc1
  buffer_load_dwordx4 v[152:155], v214, s[8:11], s66 offen sc1
  s_add_u32 s66, s61, 11264
  s_sub_u32 s68, s66, 12288
  s_cselect_b32 s66, s66, s68
  buffer_load_dwordx4 v[156:159], v210, s[8:11], s66 offen sc1
  buffer_load_dwordx4 v[160:163], v211, s[8:11], s66 offen sc1
  buffer_load_dwordx4 v[164:167], v212, s[8:11], s66 offen sc1
  buffer_load_dwordx4 v[168:171], v213, s[8:11], s66 offen sc1
  buffer_load_dwordx4 v[172:175], v214, s[8:11], s66 offen sc1
  s_waitcnt vmcnt(0)
  s_nop 1
  s_branch VK337
VR339:
  s_cmp_eq_u32 s82, 0
  s_cbranch_scc1 VK340
  s_sub_u32 s82, s82, 1
  s_nop 7
  s_add_u32 s66, s61, 10240
  s_sub_u32 s68, s66, 12288
  s_cselect_b32 s66, s66, s68
  buffer_load_dwordx4 v[136:139], v210, s[8:11], s66 offen sc1
  buffer_load_dwordx4 v[140:143], v211, s[8:11], s66 offen sc1
  buffer_load_dwordx4 v[144:147], v212, s[8:11], s66 offen sc1
  buffer_load_dwordx4 v[148:151], v213, s[8:11], s66 offen sc1
  buffer_load_dwordx4 v[152:155], v214, s[8:11], s66 offen sc1
  s_waitcnt vmcnt(0)
  v_max3_u32 v8, v136, v140, v144
  v_max3_u32 v8, v8, v148, v152
  v_cmp_eq_u32 vcc, -1, v8
  s_cbranch_vccnz VR339
  v_max3_u32 v8, v156, v160, v164
  v_max3_u32 v8, v8, v168, v172
  v_cmp_eq_u32 vcc, -1, v8
  s_cbranch_vccz VK340
  s_add_u32 s66, s61, 11264
  s_sub_u32 s68, s66, 12288
  s_cselect_b32 s66, s66, s68
  buffer_load_dwordx4 v[156:159], v210, s[8:11], s66 offen sc1
  buffer_load_dwordx4 v[160:163], v211, s[8:11], s66 offen sc1
  buffer_load_dwordx4 v[164:167], v212, s[8:11], s66 offen sc1
  buffer_load_dwordx4 v[168:171], v213, s[8:11], s66 offen sc1
  buffer_load_dwordx4 v[172:175], v214, s[8:11], s66 offen sc1
  s_waitcnt vmcnt(0)
  s_nop 1
  s_branch VK340
VR342:
  s_cmp_eq_u32 s82, 0
  s_cbranch_scc1 VK343
  s_sub_u32 s82, s82, 1
  s_nop 7
  s_add_u32 s66, s61, 11264
  s_sub_u32 s68, s66, 12288
  s_cselect_b32 s66, s66, s68
  buffer_load_dwordx4 v[156:159], v210, s[8:11], s66 offen sc1
  buffer_load_dwordx4 v[160:163], v211, s[8:11], s66 offen sc1
  buffer_load_dwordx4 v[164:167], v212, s[8:11], s66 offen sc1
  buffer_load_dwordx4 v[168:171], v213, s[8:11], s66 offen sc1
  buffer_load_dwordx4 v[172:175], v214, s[8:11], s66 offen sc1
  s_waitcnt vmcnt(0)
  s_branch VC341
  s_endpgm
CODE_END:
.section .rodata,"a"
.p2align 6
.amdhsa_kernel interleave_layers__linear_kernel_hedgehog__mixer_token_mlp__prompt_kernel
  .amdhsa_next_free_vgpr 512
  .amdhsa_next_free_sgpr 102
  .amdhsa_accum_offset 256
  .amdhsa_group_segment_fixed_size 0
  .amdhsa_kernarg_size 96
  .amdhsa_user_sgpr_count 2
  .amdhsa_user_sgpr_kernarg_segment_ptr 1
  .amdhsa_system_sgpr_workgroup_id_x 1
.end_amdhsa_kernel
```
